```python
import torch

def _softmax(x, axis=-1):
    return torch.softmax(x, dim=axis)

def _gelu(x):
    return torch.nn.functional.gelu(x, approximate='tanh')

def _silu(x):
    return torch.nn.functional.silu(x)

def _sigmoid(x):
    return torch.sigmoid(x)

def _layernorm(x, axis=-1, eps=1e-05):
    m = x.mean(dim=axis, keepdim=True)
    v = x.var(dim=axis, keepdim=True, unbiased=False)
    return (x - m) / torch.sqrt(v + eps)

def _scatter_add(tgt, idx, src, axis=0):
    return tgt.clone().index_add_(axis, idx, src)

def _segment_sum(src, seg, n):
    out = torch.zeros((n,) + src.shape[1:], dtype=src.dtype)
    return out.index_add_(0, seg, src)

def _pad(x, pw):
    flat = tuple((v for pair in reversed(pw) for v in pair))
    return torch.nn.functional.pad(x, flat)
kernel_name = 'adaLN_cond__memory_aug_recurrent_mem_tr__glu_gated_swiglu__prompt'

def setup_inputs():

    _w = lambda a: (lambda t: t.to(torch.bfloat16) if t.is_floating_point() else t)(torch.as_tensor(a))

    def _A_setup():
        B, S, Dm = (1, 2048, 640)
        H, Dh = (32, 192)
        M, seg = (8, 32)
        seg = min(seg, S)
        S = S // seg * seg
        return {'x': _w((lambda *s: torch.randn(*s, dtype=torch.bfloat16) * 0.05)(B, S, Dm)), 'mem0': _w((lambda *s: torch.randn(*s, dtype=torch.bfloat16) * 0.8)(B, M, Dm)), 'Wq': _w((lambda *s: torch.randn(*s, dtype=torch.bfloat16) * 0.8)(Dm, H, Dh) * Dm ** (-0.5)), 'Wk': _w((lambda *s: torch.randn(*s, dtype=torch.bfloat16) * 0.8)(Dm, H, Dh) * Dm ** (-0.5)), 'Wv': _w((lambda *s: torch.randn(*s, dtype=torch.bfloat16) * 0.8)(Dm, H, Dh) * Dm ** (-0.5)), 'Wo': _w((lambda *s: torch.randn(*s, dtype=torch.bfloat16) * 0.8)(H, Dh, Dm) * (H * Dh) ** (-0.5)), 'seg_len': seg}
    _A_in = _A_setup()

    def _B_setup():
        B, S, D, F = (1, 2048, 640, 1536)
        return {'x': _w((lambda *s: torch.randn(*s, dtype=torch.bfloat16) * 0.05)(B, S, D)), 'w1': _w((lambda *s: torch.randn(*s, dtype=torch.bfloat16) * 0.4)(D, F) * (2.0 / D) ** 0.5), 'w3': _w((lambda *s: torch.randn(*s, dtype=torch.bfloat16) * 0.4)(D, F) * (2.0 / D) ** 0.5), 'w2': _w((lambda *s: torch.randn(*s, dtype=torch.bfloat16) * 0.4)(F, D) * (2.0 / F) ** 0.5)}
    _B_in = _B_setup()
    return {'A_x': _A_in['x'], 'A_mem0': _A_in['mem0'], 'A_Wq': _A_in['Wq'], 'A_Wk': _A_in['Wk'], 'A_Wv': _A_in['Wv'], 'A_Wo': _A_in['Wo'], 'A_seg_len': _A_in['seg_len'], 'B_x': _B_in['x'], 'B_w1': _B_in['w1'], 'B_w3': _B_in['w3'], 'B_w2': _B_in['w2'], 'c': _w((lambda *s: torch.randn(*s, dtype=torch.bfloat16) * 0.1)(1, 640) * 8.0), 'w_mod': _w((lambda *s: torch.randn(*s, dtype=torch.bfloat16) * 0.1)(640, 6 * 640) * 640 ** (-0.5) * 8.0)}

def reference(A_x, A_mem0, A_Wq, A_Wk, A_Wv, A_Wo, A_seg_len, B_x, B_w1, B_w3, B_w2, c, w_mod):

    def _A_ref(x, mem0, Wq, Wk, Wv, Wo, seg_len):
        B, S, Dm = x.shape
        H, Dh = (Wq.shape[1], Wq.shape[2])
        M = mem0.shape[1]
        scale = Dh ** (-0.5)
        n_seg = S // seg_len
        L = M + seg_len
        idx = torch.arange(L)
        mask = (idx[:, None] < M) | (idx[:, None] >= idx[None, :])
        mem = mem0
        outs = []
        for s in range(n_seg):
            xs = x[:, s * seg_len:(s + 1) * seg_len, :].clone()
            h = torch.concatenate([mem, xs], axis=1)
            q = torch.einsum('btd,dhe->bhte', h, Wq)
            k = torch.einsum('btd,dhe->bhte', h, Wk)
            v = torch.einsum('btd,dhe->bhte', h, Wv)
            scores = torch.einsum('bhqe,bhke->bhqk', q, k) * scale
            scores = torch.where(mask[None, None], scores, -1000000000.0)
            p = _softmax(scores, axis=-1)
            o = torch.einsum('bhqk,bhke->bhqe', p, v)
            o = torch.einsum('bhte,hed->btd', o, Wo)
            mem = o[:, :M, :].clone()
            outs.append(o[:, M:, :])
        return torch.concatenate(outs, axis=1)

    def _B_ref(x, w1, w3, w2):
        gate = torch.einsum('bsd,df->bsf', x, w1)
        up = torch.einsum('bsd,df->bsf', x, w3)
        h = _silu(gate) * up
        out = torch.einsum('bsf,fd->bsd', h, w2)
        return out
    x = A_x
    mod = (_silu(c) @ w_mod).reshape(c.shape[0], 6, 1, -1)
    sa, ca, ga, sb, cb, gb = (mod[:, 0].clone(), mod[:, 1].clone(), mod[:, 2].clone(), mod[:, 3].clone(), mod[:, 4].clone(), mod[:, 5].clone())
    h = _layernorm(x, axis=-1) * (1 + ca) + sa
    x = x + ga * _A_ref(h, A_mem0, A_Wq, A_Wk, A_Wv, A_Wo, A_seg_len)
    h = _layernorm(x, axis=-1) * (1 + cb) + sb
    x = x + gb * _B_ref(h, B_w1, B_w3, B_w2)
    return x
```

```asm
; @launch kernel=mega_kernel grid=(256,1,1) block=(256,1,1) lds=151936
.amdgcn_target "amdgcn-amd-amdhsa--gfx950"
.text
.globl mega_kernel
.p2align 8
.type mega_kernel,@function
mega_kernel:
    s_cmp_lt_u32 s2, 256
    s_cbranch_scc1 mega_kernel_ok07
    s_endpgm
mega_kernel_ok07:
    s_load_dwordx2 s[8:9], s[0:1], 120
    s_load_dwordx2 s[12:13], s[0:1], 112
    v_lshrrev_b32 v1, 6, v0
    v_and_b32 v2, 63, v0
    v_and_b32 v3, 15, v0
    v_bfe_u32 v4, v0, 4, 2
    v_readfirstlane_b32 s74, v1
    v_lshlrev_b32 v20, 4, v2
    s_mov_b32 s72, 0x05040100
    s_mov_b32 s73, 0x07060302
    s_waitcnt lgkmcnt(0)
    s_mov_b32 s60, s8
    s_and_b32 s61, s9, 0xffff
    s_mov_b32 s62, 268435456
    s_mov_b32 s63, 0x00020000
    s_mov_b32 s88, s12
    s_and_b32 s89, s13, 0xffff
    s_mov_b32 s90, 256
    s_mov_b32 s91, 0x00020000
    s_cmp_lt_u32 s2, 64
    s_cbranch_scc1 mega_kernel_nboot29
    s_cmp_ge_u32 s2, 104
    s_cbranch_scc1 mega_kernel_nboot8
    s_sub_u32 s98, s2, 64
    s_cmp_ge_u32 s98, 30
    s_cbranch_scc1 mega_kernel_nmod10
    s_load_dwordx2 s[4:5], s[0:1], 88
    s_load_dwordx2 s[6:7], s[0:1], 96
    s_waitcnt lgkmcnt(0)
    s_mov_b32 s12, s4
    s_and_b32 s13, s5, 0xffff
    s_mov_b32 s14, 1280
    s_mov_b32 s15, 0x00020000
    s_mov_b32 s16, s6
    s_and_b32 s17, s7, 0xffff
    s_mov_b32 s18, 4915200
    s_mov_b32 s19, 0x00020000
    s_mul_i32 s11, s74, 160
    v_add_u32 v5, 0, v2
    v_add_u32 v5, s11, v5
    v_lshlrev_b32 v5, 1, v5
    buffer_load_ushort v8, v5, s[12:15], 0 offen
    v_add_u32 v5, 64, v2
    v_add_u32 v5, s11, v5
    v_lshlrev_b32 v5, 1, v5
    buffer_load_ushort v9, v5, s[12:15], 0 offen
    v_add_u32 v5, 128, v2
    v_add_u32 v5, s11, v5
    v_lshlrev_b32 v5, 1, v5
    buffer_load_ushort v10, v5, s[12:15], 0 offen
    s_lshl_b32 s3, s98, 8
    v_lshlrev_b32 v6, 2, v2
    v_add_u32 v6, s3, v6
    s_mul_i32 s10, s11, 7680
    buffer_load_dword v40, v6, s[16:19], s10 offen
    s_add_u32 s10, s10, 7680
    buffer_load_dword v41, v6, s[16:19], s10 offen
    s_add_u32 s10, s10, 7680
    buffer_load_dword v42, v6, s[16:19], s10 offen
    s_add_u32 s10, s10, 7680
    buffer_load_dword v43, v6, s[16:19], s10 offen
    s_add_u32 s10, s10, 7680
    buffer_load_dword v44, v6, s[16:19], s10 offen
    s_add_u32 s10, s10, 7680
    buffer_load_dword v45, v6, s[16:19], s10 offen
    s_add_u32 s10, s10, 7680
    buffer_load_dword v46, v6, s[16:19], s10 offen
    s_add_u32 s10, s10, 7680
    buffer_load_dword v47, v6, s[16:19], s10 offen
    s_add_u32 s10, s10, 7680
    buffer_load_dword v48, v6, s[16:19], s10 offen
    s_add_u32 s10, s10, 7680
    buffer_load_dword v49, v6, s[16:19], s10 offen
    s_add_u32 s10, s10, 7680
    buffer_load_dword v50, v6, s[16:19], s10 offen
    s_add_u32 s10, s10, 7680
    buffer_load_dword v51, v6, s[16:19], s10 offen
    s_add_u32 s10, s10, 7680
    buffer_load_dword v52, v6, s[16:19], s10 offen
    s_add_u32 s10, s10, 7680
    buffer_load_dword v53, v6, s[16:19], s10 offen
    s_add_u32 s10, s10, 7680
    buffer_load_dword v54, v6, s[16:19], s10 offen
    s_add_u32 s10, s10, 7680
    buffer_load_dword v55, v6, s[16:19], s10 offen
    s_add_u32 s10, s10, 7680
    buffer_load_dword v56, v6, s[16:19], s10 offen
    s_add_u32 s10, s10, 7680
    buffer_load_dword v57, v6, s[16:19], s10 offen
    s_add_u32 s10, s10, 7680
    buffer_load_dword v58, v6, s[16:19], s10 offen
    s_add_u32 s10, s10, 7680
    buffer_load_dword v59, v6, s[16:19], s10 offen
    s_add_u32 s10, s10, 7680
    buffer_load_dword v60, v6, s[16:19], s10 offen
    s_add_u32 s10, s10, 7680
    buffer_load_dword v61, v6, s[16:19], s10 offen
    s_add_u32 s10, s10, 7680
    buffer_load_dword v62, v6, s[16:19], s10 offen
    s_add_u32 s10, s10, 7680
    buffer_load_dword v63, v6, s[16:19], s10 offen
    s_add_u32 s10, s10, 7680
    buffer_load_dword v64, v6, s[16:19], s10 offen
    s_add_u32 s10, s10, 7680
    buffer_load_dword v65, v6, s[16:19], s10 offen
    s_add_u32 s10, s10, 7680
    buffer_load_dword v66, v6, s[16:19], s10 offen
    s_add_u32 s10, s10, 7680
    buffer_load_dword v67, v6, s[16:19], s10 offen
    s_add_u32 s10, s10, 7680
    buffer_load_dword v68, v6, s[16:19], s10 offen
    s_add_u32 s10, s10, 7680
    buffer_load_dword v69, v6, s[16:19], s10 offen
    s_add_u32 s10, s10, 7680
    buffer_load_dword v70, v6, s[16:19], s10 offen
    s_add_u32 s10, s10, 7680
    buffer_load_dword v71, v6, s[16:19], s10 offen
    s_add_u32 s10, s10, 7680
    buffer_load_dword v72, v6, s[16:19], s10 offen
    s_add_u32 s10, s10, 7680
    buffer_load_dword v73, v6, s[16:19], s10 offen
    s_add_u32 s10, s10, 7680
    buffer_load_dword v74, v6, s[16:19], s10 offen
    s_add_u32 s10, s10, 7680
    buffer_load_dword v75, v6, s[16:19], s10 offen
    s_add_u32 s10, s10, 7680
    buffer_load_dword v76, v6, s[16:19], s10 offen
    s_add_u32 s10, s10, 7680
    buffer_load_dword v77, v6, s[16:19], s10 offen
    s_add_u32 s10, s10, 7680
    buffer_load_dword v78, v6, s[16:19], s10 offen
    s_add_u32 s10, s10, 7680
    buffer_load_dword v79, v6, s[16:19], s10 offen
    s_add_u32 s10, s10, 7680
    buffer_load_dword v80, v6, s[16:19], s10 offen
    s_add_u32 s10, s10, 7680
    buffer_load_dword v81, v6, s[16:19], s10 offen
    s_add_u32 s10, s10, 7680
    buffer_load_dword v82, v6, s[16:19], s10 offen
    s_add_u32 s10, s10, 7680
    buffer_load_dword v83, v6, s[16:19], s10 offen
    s_add_u32 s10, s10, 7680
    buffer_load_dword v84, v6, s[16:19], s10 offen
    s_add_u32 s10, s10, 7680
    buffer_load_dword v85, v6, s[16:19], s10 offen
    s_add_u32 s10, s10, 7680
    buffer_load_dword v86, v6, s[16:19], s10 offen
    s_add_u32 s10, s10, 7680
    buffer_load_dword v87, v6, s[16:19], s10 offen
    s_add_u32 s10, s10, 7680
    buffer_load_dword v88, v6, s[16:19], s10 offen
    s_add_u32 s10, s10, 7680
    buffer_load_dword v89, v6, s[16:19], s10 offen
    s_add_u32 s10, s10, 7680
    buffer_load_dword v90, v6, s[16:19], s10 offen
    s_add_u32 s10, s10, 7680
    buffer_load_dword v91, v6, s[16:19], s10 offen
    s_add_u32 s10, s10, 7680
    buffer_load_dword v92, v6, s[16:19], s10 offen
    s_add_u32 s10, s10, 7680
    buffer_load_dword v93, v6, s[16:19], s10 offen
    s_add_u32 s10, s10, 7680
    buffer_load_dword v94, v6, s[16:19], s10 offen
    s_add_u32 s10, s10, 7680
    buffer_load_dword v95, v6, s[16:19], s10 offen
    s_add_u32 s10, s10, 7680
    buffer_load_dword v96, v6, s[16:19], s10 offen
    s_add_u32 s10, s10, 7680
    buffer_load_dword v97, v6, s[16:19], s10 offen
    s_add_u32 s10, s10, 7680
    buffer_load_dword v98, v6, s[16:19], s10 offen
    s_add_u32 s10, s10, 7680
    buffer_load_dword v99, v6, s[16:19], s10 offen
    s_add_u32 s10, s10, 7680
    buffer_load_dword v100, v6, s[16:19], s10 offen
    s_add_u32 s10, s10, 7680
    buffer_load_dword v101, v6, s[16:19], s10 offen
    s_add_u32 s10, s10, 7680
    buffer_load_dword v102, v6, s[16:19], s10 offen
    s_add_u32 s10, s10, 7680
    buffer_load_dword v103, v6, s[16:19], s10 offen
    s_add_u32 s10, s10, 7680
    buffer_load_dword v104, v6, s[16:19], s10 offen
    s_add_u32 s10, s10, 7680
    buffer_load_dword v105, v6, s[16:19], s10 offen
    s_add_u32 s10, s10, 7680
    buffer_load_dword v106, v6, s[16:19], s10 offen
    s_add_u32 s10, s10, 7680
    buffer_load_dword v107, v6, s[16:19], s10 offen
    s_add_u32 s10, s10, 7680
    buffer_load_dword v108, v6, s[16:19], s10 offen
    s_add_u32 s10, s10, 7680
    buffer_load_dword v109, v6, s[16:19], s10 offen
    s_add_u32 s10, s10, 7680
    buffer_load_dword v110, v6, s[16:19], s10 offen
    s_add_u32 s10, s10, 7680
    buffer_load_dword v111, v6, s[16:19], s10 offen
    s_add_u32 s10, s10, 7680
    buffer_load_dword v112, v6, s[16:19], s10 offen
    s_add_u32 s10, s10, 7680
    buffer_load_dword v113, v6, s[16:19], s10 offen
    s_add_u32 s10, s10, 7680
    buffer_load_dword v114, v6, s[16:19], s10 offen
    s_add_u32 s10, s10, 7680
    buffer_load_dword v115, v6, s[16:19], s10 offen
    s_add_u32 s10, s10, 7680
    buffer_load_dword v116, v6, s[16:19], s10 offen
    s_add_u32 s10, s10, 7680
    buffer_load_dword v117, v6, s[16:19], s10 offen
    s_add_u32 s10, s10, 7680
    buffer_load_dword v118, v6, s[16:19], s10 offen
    s_add_u32 s10, s10, 7680
    buffer_load_dword v119, v6, s[16:19], s10 offen
    s_add_u32 s10, s10, 7680
    buffer_load_dword v120, v6, s[16:19], s10 offen
    s_add_u32 s10, s10, 7680
    buffer_load_dword v121, v6, s[16:19], s10 offen
    s_add_u32 s10, s10, 7680
    buffer_load_dword v122, v6, s[16:19], s10 offen
    s_add_u32 s10, s10, 7680
    buffer_load_dword v123, v6, s[16:19], s10 offen
    s_add_u32 s10, s10, 7680
    buffer_load_dword v124, v6, s[16:19], s10 offen
    s_add_u32 s10, s10, 7680
    buffer_load_dword v125, v6, s[16:19], s10 offen
    s_add_u32 s10, s10, 7680
    buffer_load_dword v126, v6, s[16:19], s10 offen
    s_add_u32 s10, s10, 7680
    buffer_load_dword v127, v6, s[16:19], s10 offen
    s_add_u32 s10, s10, 7680
    buffer_load_dword v128, v6, s[16:19], s10 offen
    s_add_u32 s10, s10, 7680
    buffer_load_dword v129, v6, s[16:19], s10 offen
    s_add_u32 s10, s10, 7680
    buffer_load_dword v130, v6, s[16:19], s10 offen
    s_add_u32 s10, s10, 7680
    buffer_load_dword v131, v6, s[16:19], s10 offen
    s_add_u32 s10, s10, 7680
    buffer_load_dword v132, v6, s[16:19], s10 offen
    s_add_u32 s10, s10, 7680
    buffer_load_dword v133, v6, s[16:19], s10 offen
    s_add_u32 s10, s10, 7680
    buffer_load_dword v134, v6, s[16:19], s10 offen
    s_add_u32 s10, s10, 7680
    buffer_load_dword v135, v6, s[16:19], s10 offen
    s_add_u32 s10, s10, 7680
    buffer_load_dword v136, v6, s[16:19], s10 offen
    s_add_u32 s10, s10, 7680
    buffer_load_dword v137, v6, s[16:19], s10 offen
    s_add_u32 s10, s10, 7680
    buffer_load_dword v138, v6, s[16:19], s10 offen
    s_add_u32 s10, s10, 7680
    buffer_load_dword v139, v6, s[16:19], s10 offen
    s_add_u32 s10, s10, 7680
    buffer_load_dword v140, v6, s[16:19], s10 offen
    s_add_u32 s10, s10, 7680
    buffer_load_dword v141, v6, s[16:19], s10 offen
    s_add_u32 s10, s10, 7680
    buffer_load_dword v142, v6, s[16:19], s10 offen
    s_add_u32 s10, s10, 7680
    buffer_load_dword v143, v6, s[16:19], s10 offen
    s_add_u32 s10, s10, 7680
    buffer_load_dword v144, v6, s[16:19], s10 offen
    s_add_u32 s10, s10, 7680
    buffer_load_dword v145, v6, s[16:19], s10 offen
    s_add_u32 s10, s10, 7680
    buffer_load_dword v146, v6, s[16:19], s10 offen
    s_add_u32 s10, s10, 7680
    buffer_load_dword v147, v6, s[16:19], s10 offen
    s_add_u32 s10, s10, 7680
    buffer_load_dword v148, v6, s[16:19], s10 offen
    s_add_u32 s10, s10, 7680
    buffer_load_dword v149, v6, s[16:19], s10 offen
    s_add_u32 s10, s10, 7680
    buffer_load_dword v150, v6, s[16:19], s10 offen
    s_add_u32 s10, s10, 7680
    buffer_load_dword v151, v6, s[16:19], s10 offen
    s_add_u32 s10, s10, 7680
    buffer_load_dword v152, v6, s[16:19], s10 offen
    s_add_u32 s10, s10, 7680
    buffer_load_dword v153, v6, s[16:19], s10 offen
    s_add_u32 s10, s10, 7680
    buffer_load_dword v154, v6, s[16:19], s10 offen
    s_add_u32 s10, s10, 7680
    buffer_load_dword v155, v6, s[16:19], s10 offen
    s_add_u32 s10, s10, 7680
    buffer_load_dword v156, v6, s[16:19], s10 offen
    s_add_u32 s10, s10, 7680
    buffer_load_dword v157, v6, s[16:19], s10 offen
    s_add_u32 s10, s10, 7680
    buffer_load_dword v158, v6, s[16:19], s10 offen
    s_add_u32 s10, s10, 7680
    buffer_load_dword v159, v6, s[16:19], s10 offen
    s_add_u32 s10, s10, 7680
    buffer_load_dword v160, v6, s[16:19], s10 offen
    s_add_u32 s10, s10, 7680
    buffer_load_dword v161, v6, s[16:19], s10 offen
    s_add_u32 s10, s10, 7680
    buffer_load_dword v162, v6, s[16:19], s10 offen
    s_add_u32 s10, s10, 7680
    buffer_load_dword v163, v6, s[16:19], s10 offen
    s_add_u32 s10, s10, 7680
    buffer_load_dword v164, v6, s[16:19], s10 offen
    s_add_u32 s10, s10, 7680
    buffer_load_dword v165, v6, s[16:19], s10 offen
    s_add_u32 s10, s10, 7680
    buffer_load_dword v166, v6, s[16:19], s10 offen
    s_add_u32 s10, s10, 7680
    buffer_load_dword v167, v6, s[16:19], s10 offen
    s_add_u32 s10, s10, 7680
    buffer_load_dword v168, v6, s[16:19], s10 offen
    s_add_u32 s10, s10, 7680
    buffer_load_dword v169, v6, s[16:19], s10 offen
    s_add_u32 s10, s10, 7680
    buffer_load_dword v170, v6, s[16:19], s10 offen
    s_add_u32 s10, s10, 7680
    buffer_load_dword v171, v6, s[16:19], s10 offen
    s_add_u32 s10, s10, 7680
    buffer_load_dword v172, v6, s[16:19], s10 offen
    s_add_u32 s10, s10, 7680
    buffer_load_dword v173, v6, s[16:19], s10 offen
    s_add_u32 s10, s10, 7680
    buffer_load_dword v174, v6, s[16:19], s10 offen
    s_add_u32 s10, s10, 7680
    buffer_load_dword v175, v6, s[16:19], s10 offen
    s_add_u32 s10, s10, 7680
    buffer_load_dword v176, v6, s[16:19], s10 offen
    s_add_u32 s10, s10, 7680
    buffer_load_dword v177, v6, s[16:19], s10 offen
    s_add_u32 s10, s10, 7680
    buffer_load_dword v178, v6, s[16:19], s10 offen
    s_add_u32 s10, s10, 7680
    buffer_load_dword v179, v6, s[16:19], s10 offen
    s_add_u32 s10, s10, 7680
    buffer_load_dword v180, v6, s[16:19], s10 offen
    s_add_u32 s10, s10, 7680
    buffer_load_dword v181, v6, s[16:19], s10 offen
    s_add_u32 s10, s10, 7680
    buffer_load_dword v182, v6, s[16:19], s10 offen
    s_add_u32 s10, s10, 7680
    buffer_load_dword v183, v6, s[16:19], s10 offen
    s_add_u32 s10, s10, 7680
    buffer_load_dword v184, v6, s[16:19], s10 offen
    s_add_u32 s10, s10, 7680
    buffer_load_dword v185, v6, s[16:19], s10 offen
    s_add_u32 s10, s10, 7680
    buffer_load_dword v186, v6, s[16:19], s10 offen
    s_add_u32 s10, s10, 7680
    buffer_load_dword v187, v6, s[16:19], s10 offen
    s_add_u32 s10, s10, 7680
    buffer_load_dword v188, v6, s[16:19], s10 offen
    s_add_u32 s10, s10, 7680
    buffer_load_dword v189, v6, s[16:19], s10 offen
    s_add_u32 s10, s10, 7680
    buffer_load_dword v190, v6, s[16:19], s10 offen
    s_add_u32 s10, s10, 7680
    buffer_load_dword v191, v6, s[16:19], s10 offen
    s_add_u32 s10, s10, 7680
    buffer_load_dword v192, v6, s[16:19], s10 offen
    s_add_u32 s10, s10, 7680
    buffer_load_dword v193, v6, s[16:19], s10 offen
    s_add_u32 s10, s10, 7680
    buffer_load_dword v194, v6, s[16:19], s10 offen
    s_add_u32 s10, s10, 7680
    buffer_load_dword v195, v6, s[16:19], s10 offen
    s_add_u32 s10, s10, 7680
    buffer_load_dword v196, v6, s[16:19], s10 offen
    s_add_u32 s10, s10, 7680
    buffer_load_dword v197, v6, s[16:19], s10 offen
    s_add_u32 s10, s10, 7680
    buffer_load_dword v198, v6, s[16:19], s10 offen
    s_add_u32 s10, s10, 7680
    buffer_load_dword v199, v6, s[16:19], s10 offen
    s_add_u32 s10, s10, 7680
    s_waitcnt vmcnt(63)
    v_lshlrev_b32 v8, 16, v8
    v_mul_f32 v5, 0xbfb8aa3b, v8
    v_exp_f32 v5, v5
    s_nop 0
    v_add_f32 v5, 1.0, v5
    v_rcp_f32 v5, v5
    s_nop 0
    v_mul_f32 v5, v8, v5
    v_cvt_pk_bf16_f32 v5, v5, v5
    v_lshlrev_b32 v8, 16, v5
    v_lshlrev_b32 v9, 16, v9
    v_mul_f32 v5, 0xbfb8aa3b, v9
    v_exp_f32 v5, v5
    s_nop 0
    v_add_f32 v5, 1.0, v5
    v_rcp_f32 v5, v5
    s_nop 0
    v_mul_f32 v5, v9, v5
    v_cvt_pk_bf16_f32 v5, v5, v5
    v_lshlrev_b32 v9, 16, v5
    v_lshlrev_b32 v10, 16, v10
    v_mul_f32 v5, 0xbfb8aa3b, v10
    v_exp_f32 v5, v5
    s_nop 0
    v_add_f32 v5, 1.0, v5
    v_rcp_f32 v5, v5
    s_nop 0
    v_mul_f32 v5, v10, v5
    v_cvt_pk_bf16_f32 v5, v5, v5
    v_lshlrev_b32 v10, 16, v5
    v_mov_b32 v12, 0
    v_mov_b32 v13, 0
    s_waitcnt vmcnt(0)
    v_readlane_b32 s20, v8, 0
    v_readlane_b32 s21, v8, 1
    v_readlane_b32 s22, v8, 2
    v_readlane_b32 s23, v8, 3
    v_readlane_b32 s24, v8, 4
    v_readlane_b32 s25, v8, 5
    v_readlane_b32 s26, v8, 6
    v_readlane_b32 s27, v8, 7
    v_readlane_b32 s28, v8, 8
    v_readlane_b32 s29, v8, 9
    v_readlane_b32 s30, v8, 10
    v_readlane_b32 s31, v8, 11
    v_readlane_b32 s32, v8, 12
    v_readlane_b32 s33, v8, 13
    v_readlane_b32 s34, v8, 14
    v_readlane_b32 s35, v8, 15
    v_readlane_b32 s36, v8, 16
    v_readlane_b32 s37, v8, 17
    v_readlane_b32 s38, v8, 18
    v_readlane_b32 s39, v8, 19
    v_readlane_b32 s40, v8, 20
    v_readlane_b32 s41, v8, 21
    v_readlane_b32 s42, v8, 22
    v_readlane_b32 s43, v8, 23
    v_readlane_b32 s44, v8, 24
    v_readlane_b32 s45, v8, 25
    v_readlane_b32 s46, v8, 26
    v_readlane_b32 s47, v8, 27
    v_readlane_b32 s48, v8, 28
    v_readlane_b32 s49, v8, 29
    v_readlane_b32 s50, v8, 30
    v_readlane_b32 s51, v8, 31
    v_lshlrev_b32 v16, 16, v40
    v_and_b32 v17, 0xffff0000, v40
    v_fmac_f32 v12, s20, v16
    v_fmac_f32 v13, s20, v17
    v_lshlrev_b32 v16, 16, v41
    v_and_b32 v17, 0xffff0000, v41
    v_fmac_f32 v12, s21, v16
    v_fmac_f32 v13, s21, v17
    v_lshlrev_b32 v16, 16, v42
    v_and_b32 v17, 0xffff0000, v42
    v_fmac_f32 v12, s22, v16
    v_fmac_f32 v13, s22, v17
    v_lshlrev_b32 v16, 16, v43
    v_and_b32 v17, 0xffff0000, v43
    v_fmac_f32 v12, s23, v16
    v_fmac_f32 v13, s23, v17
    v_lshlrev_b32 v16, 16, v44
    v_and_b32 v17, 0xffff0000, v44
    v_fmac_f32 v12, s24, v16
    v_fmac_f32 v13, s24, v17
    v_lshlrev_b32 v16, 16, v45
    v_and_b32 v17, 0xffff0000, v45
    v_fmac_f32 v12, s25, v16
    v_fmac_f32 v13, s25, v17
    v_lshlrev_b32 v16, 16, v46
    v_and_b32 v17, 0xffff0000, v46
    v_fmac_f32 v12, s26, v16
    v_fmac_f32 v13, s26, v17
    v_lshlrev_b32 v16, 16, v47
    v_and_b32 v17, 0xffff0000, v47
    v_fmac_f32 v12, s27, v16
    v_fmac_f32 v13, s27, v17
    v_lshlrev_b32 v16, 16, v48
    v_and_b32 v17, 0xffff0000, v48
    v_fmac_f32 v12, s28, v16
    v_fmac_f32 v13, s28, v17
    v_lshlrev_b32 v16, 16, v49
    v_and_b32 v17, 0xffff0000, v49
    v_fmac_f32 v12, s29, v16
    v_fmac_f32 v13, s29, v17
    v_lshlrev_b32 v16, 16, v50
    v_and_b32 v17, 0xffff0000, v50
    v_fmac_f32 v12, s30, v16
    v_fmac_f32 v13, s30, v17
    v_lshlrev_b32 v16, 16, v51
    v_and_b32 v17, 0xffff0000, v51
    v_fmac_f32 v12, s31, v16
    v_fmac_f32 v13, s31, v17
    v_lshlrev_b32 v16, 16, v52
    v_and_b32 v17, 0xffff0000, v52
    v_fmac_f32 v12, s32, v16
    v_fmac_f32 v13, s32, v17
    v_lshlrev_b32 v16, 16, v53
    v_and_b32 v17, 0xffff0000, v53
    v_fmac_f32 v12, s33, v16
    v_fmac_f32 v13, s33, v17
    v_lshlrev_b32 v16, 16, v54
    v_and_b32 v17, 0xffff0000, v54
    v_fmac_f32 v12, s34, v16
    v_fmac_f32 v13, s34, v17
    v_lshlrev_b32 v16, 16, v55
    v_and_b32 v17, 0xffff0000, v55
    v_fmac_f32 v12, s35, v16
    v_fmac_f32 v13, s35, v17
    v_lshlrev_b32 v16, 16, v56
    v_and_b32 v17, 0xffff0000, v56
    v_fmac_f32 v12, s36, v16
    v_fmac_f32 v13, s36, v17
    v_lshlrev_b32 v16, 16, v57
    v_and_b32 v17, 0xffff0000, v57
    v_fmac_f32 v12, s37, v16
    v_fmac_f32 v13, s37, v17
    v_lshlrev_b32 v16, 16, v58
    v_and_b32 v17, 0xffff0000, v58
    v_fmac_f32 v12, s38, v16
    v_fmac_f32 v13, s38, v17
    v_lshlrev_b32 v16, 16, v59
    v_and_b32 v17, 0xffff0000, v59
    v_fmac_f32 v12, s39, v16
    v_fmac_f32 v13, s39, v17
    v_lshlrev_b32 v16, 16, v60
    v_and_b32 v17, 0xffff0000, v60
    v_fmac_f32 v12, s40, v16
    v_fmac_f32 v13, s40, v17
    v_lshlrev_b32 v16, 16, v61
    v_and_b32 v17, 0xffff0000, v61
    v_fmac_f32 v12, s41, v16
    v_fmac_f32 v13, s41, v17
    v_lshlrev_b32 v16, 16, v62
    v_and_b32 v17, 0xffff0000, v62
    v_fmac_f32 v12, s42, v16
    v_fmac_f32 v13, s42, v17
    v_lshlrev_b32 v16, 16, v63
    v_and_b32 v17, 0xffff0000, v63
    v_fmac_f32 v12, s43, v16
    v_fmac_f32 v13, s43, v17
    v_lshlrev_b32 v16, 16, v64
    v_and_b32 v17, 0xffff0000, v64
    v_fmac_f32 v12, s44, v16
    v_fmac_f32 v13, s44, v17
    v_lshlrev_b32 v16, 16, v65
    v_and_b32 v17, 0xffff0000, v65
    v_fmac_f32 v12, s45, v16
    v_fmac_f32 v13, s45, v17
    v_lshlrev_b32 v16, 16, v66
    v_and_b32 v17, 0xffff0000, v66
    v_fmac_f32 v12, s46, v16
    v_fmac_f32 v13, s46, v17
    v_lshlrev_b32 v16, 16, v67
    v_and_b32 v17, 0xffff0000, v67
    v_fmac_f32 v12, s47, v16
    v_fmac_f32 v13, s47, v17
    v_lshlrev_b32 v16, 16, v68
    v_and_b32 v17, 0xffff0000, v68
    v_fmac_f32 v12, s48, v16
    v_fmac_f32 v13, s48, v17
    v_lshlrev_b32 v16, 16, v69
    v_and_b32 v17, 0xffff0000, v69
    v_fmac_f32 v12, s49, v16
    v_fmac_f32 v13, s49, v17
    v_lshlrev_b32 v16, 16, v70
    v_and_b32 v17, 0xffff0000, v70
    v_fmac_f32 v12, s50, v16
    v_fmac_f32 v13, s50, v17
    v_lshlrev_b32 v16, 16, v71
    v_and_b32 v17, 0xffff0000, v71
    v_fmac_f32 v12, s51, v16
    v_fmac_f32 v13, s51, v17
    v_readlane_b32 s20, v8, 32
    v_readlane_b32 s21, v8, 33
    v_readlane_b32 s22, v8, 34
    v_readlane_b32 s23, v8, 35
    v_readlane_b32 s24, v8, 36
    v_readlane_b32 s25, v8, 37
    v_readlane_b32 s26, v8, 38
    v_readlane_b32 s27, v8, 39
    v_readlane_b32 s28, v8, 40
    v_readlane_b32 s29, v8, 41
    v_readlane_b32 s30, v8, 42
    v_readlane_b32 s31, v8, 43
    v_readlane_b32 s32, v8, 44
    v_readlane_b32 s33, v8, 45
    v_readlane_b32 s34, v8, 46
    v_readlane_b32 s35, v8, 47
    v_readlane_b32 s36, v8, 48
    v_readlane_b32 s37, v8, 49
    v_readlane_b32 s38, v8, 50
    v_readlane_b32 s39, v8, 51
    v_readlane_b32 s40, v8, 52
    v_readlane_b32 s41, v8, 53
    v_readlane_b32 s42, v8, 54
    v_readlane_b32 s43, v8, 55
    v_readlane_b32 s44, v8, 56
    v_readlane_b32 s45, v8, 57
    v_readlane_b32 s46, v8, 58
    v_readlane_b32 s47, v8, 59
    v_readlane_b32 s48, v8, 60
    v_readlane_b32 s49, v8, 61
    v_readlane_b32 s50, v8, 62
    v_readlane_b32 s51, v8, 63
    v_lshlrev_b32 v16, 16, v72
    v_and_b32 v17, 0xffff0000, v72
    v_fmac_f32 v12, s20, v16
    v_fmac_f32 v13, s20, v17
    v_lshlrev_b32 v16, 16, v73
    v_and_b32 v17, 0xffff0000, v73
    v_fmac_f32 v12, s21, v16
    v_fmac_f32 v13, s21, v17
    v_lshlrev_b32 v16, 16, v74
    v_and_b32 v17, 0xffff0000, v74
    v_fmac_f32 v12, s22, v16
    v_fmac_f32 v13, s22, v17
    v_lshlrev_b32 v16, 16, v75
    v_and_b32 v17, 0xffff0000, v75
    v_fmac_f32 v12, s23, v16
    v_fmac_f32 v13, s23, v17
    v_lshlrev_b32 v16, 16, v76
    v_and_b32 v17, 0xffff0000, v76
    v_fmac_f32 v12, s24, v16
    v_fmac_f32 v13, s24, v17
    v_lshlrev_b32 v16, 16, v77
    v_and_b32 v17, 0xffff0000, v77
    v_fmac_f32 v12, s25, v16
    v_fmac_f32 v13, s25, v17
    v_lshlrev_b32 v16, 16, v78
    v_and_b32 v17, 0xffff0000, v78
    v_fmac_f32 v12, s26, v16
    v_fmac_f32 v13, s26, v17
    v_lshlrev_b32 v16, 16, v79
    v_and_b32 v17, 0xffff0000, v79
    v_fmac_f32 v12, s27, v16
    v_fmac_f32 v13, s27, v17
    v_lshlrev_b32 v16, 16, v80
    v_and_b32 v17, 0xffff0000, v80
    v_fmac_f32 v12, s28, v16
    v_fmac_f32 v13, s28, v17
    v_lshlrev_b32 v16, 16, v81
    v_and_b32 v17, 0xffff0000, v81
    v_fmac_f32 v12, s29, v16
    v_fmac_f32 v13, s29, v17
    v_lshlrev_b32 v16, 16, v82
    v_and_b32 v17, 0xffff0000, v82
    v_fmac_f32 v12, s30, v16
    v_fmac_f32 v13, s30, v17
    v_lshlrev_b32 v16, 16, v83
    v_and_b32 v17, 0xffff0000, v83
    v_fmac_f32 v12, s31, v16
    v_fmac_f32 v13, s31, v17
    v_lshlrev_b32 v16, 16, v84
    v_and_b32 v17, 0xffff0000, v84
    v_fmac_f32 v12, s32, v16
    v_fmac_f32 v13, s32, v17
    v_lshlrev_b32 v16, 16, v85
    v_and_b32 v17, 0xffff0000, v85
    v_fmac_f32 v12, s33, v16
    v_fmac_f32 v13, s33, v17
    v_lshlrev_b32 v16, 16, v86
    v_and_b32 v17, 0xffff0000, v86
    v_fmac_f32 v12, s34, v16
    v_fmac_f32 v13, s34, v17
    v_lshlrev_b32 v16, 16, v87
    v_and_b32 v17, 0xffff0000, v87
    v_fmac_f32 v12, s35, v16
    v_fmac_f32 v13, s35, v17
    v_lshlrev_b32 v16, 16, v88
    v_and_b32 v17, 0xffff0000, v88
    v_fmac_f32 v12, s36, v16
    v_fmac_f32 v13, s36, v17
    v_lshlrev_b32 v16, 16, v89
    v_and_b32 v17, 0xffff0000, v89
    v_fmac_f32 v12, s37, v16
    v_fmac_f32 v13, s37, v17
    v_lshlrev_b32 v16, 16, v90
    v_and_b32 v17, 0xffff0000, v90
    v_fmac_f32 v12, s38, v16
    v_fmac_f32 v13, s38, v17
    v_lshlrev_b32 v16, 16, v91
    v_and_b32 v17, 0xffff0000, v91
    v_fmac_f32 v12, s39, v16
    v_fmac_f32 v13, s39, v17
    v_lshlrev_b32 v16, 16, v92
    v_and_b32 v17, 0xffff0000, v92
    v_fmac_f32 v12, s40, v16
    v_fmac_f32 v13, s40, v17
    v_lshlrev_b32 v16, 16, v93
    v_and_b32 v17, 0xffff0000, v93
    v_fmac_f32 v12, s41, v16
    v_fmac_f32 v13, s41, v17
    v_lshlrev_b32 v16, 16, v94
    v_and_b32 v17, 0xffff0000, v94
    v_fmac_f32 v12, s42, v16
    v_fmac_f32 v13, s42, v17
    v_lshlrev_b32 v16, 16, v95
    v_and_b32 v17, 0xffff0000, v95
    v_fmac_f32 v12, s43, v16
    v_fmac_f32 v13, s43, v17
    v_lshlrev_b32 v16, 16, v96
    v_and_b32 v17, 0xffff0000, v96
    v_fmac_f32 v12, s44, v16
    v_fmac_f32 v13, s44, v17
    v_lshlrev_b32 v16, 16, v97
    v_and_b32 v17, 0xffff0000, v97
    v_fmac_f32 v12, s45, v16
    v_fmac_f32 v13, s45, v17
    v_lshlrev_b32 v16, 16, v98
    v_and_b32 v17, 0xffff0000, v98
    v_fmac_f32 v12, s46, v16
    v_fmac_f32 v13, s46, v17
    v_lshlrev_b32 v16, 16, v99
    v_and_b32 v17, 0xffff0000, v99
    v_fmac_f32 v12, s47, v16
    v_fmac_f32 v13, s47, v17
    v_lshlrev_b32 v16, 16, v100
    v_and_b32 v17, 0xffff0000, v100
    v_fmac_f32 v12, s48, v16
    v_fmac_f32 v13, s48, v17
    v_lshlrev_b32 v16, 16, v101
    v_and_b32 v17, 0xffff0000, v101
    v_fmac_f32 v12, s49, v16
    v_fmac_f32 v13, s49, v17
    v_lshlrev_b32 v16, 16, v102
    v_and_b32 v17, 0xffff0000, v102
    v_fmac_f32 v12, s50, v16
    v_fmac_f32 v13, s50, v17
    v_lshlrev_b32 v16, 16, v103
    v_and_b32 v17, 0xffff0000, v103
    v_fmac_f32 v12, s51, v16
    v_fmac_f32 v13, s51, v17
    v_readlane_b32 s20, v9, 0
    v_readlane_b32 s21, v9, 1
    v_readlane_b32 s22, v9, 2
    v_readlane_b32 s23, v9, 3
    v_readlane_b32 s24, v9, 4
    v_readlane_b32 s25, v9, 5
    v_readlane_b32 s26, v9, 6
    v_readlane_b32 s27, v9, 7
    v_readlane_b32 s28, v9, 8
    v_readlane_b32 s29, v9, 9
    v_readlane_b32 s30, v9, 10
    v_readlane_b32 s31, v9, 11
    v_readlane_b32 s32, v9, 12
    v_readlane_b32 s33, v9, 13
    v_readlane_b32 s34, v9, 14
    v_readlane_b32 s35, v9, 15
    v_readlane_b32 s36, v9, 16
    v_readlane_b32 s37, v9, 17
    v_readlane_b32 s38, v9, 18
    v_readlane_b32 s39, v9, 19
    v_readlane_b32 s40, v9, 20
    v_readlane_b32 s41, v9, 21
    v_readlane_b32 s42, v9, 22
    v_readlane_b32 s43, v9, 23
    v_readlane_b32 s44, v9, 24
    v_readlane_b32 s45, v9, 25
    v_readlane_b32 s46, v9, 26
    v_readlane_b32 s47, v9, 27
    v_readlane_b32 s48, v9, 28
    v_readlane_b32 s49, v9, 29
    v_readlane_b32 s50, v9, 30
    v_readlane_b32 s51, v9, 31
    v_lshlrev_b32 v16, 16, v104
    v_and_b32 v17, 0xffff0000, v104
    v_fmac_f32 v12, s20, v16
    v_fmac_f32 v13, s20, v17
    v_lshlrev_b32 v16, 16, v105
    v_and_b32 v17, 0xffff0000, v105
    v_fmac_f32 v12, s21, v16
    v_fmac_f32 v13, s21, v17
    v_lshlrev_b32 v16, 16, v106
    v_and_b32 v17, 0xffff0000, v106
    v_fmac_f32 v12, s22, v16
    v_fmac_f32 v13, s22, v17
    v_lshlrev_b32 v16, 16, v107
    v_and_b32 v17, 0xffff0000, v107
    v_fmac_f32 v12, s23, v16
    v_fmac_f32 v13, s23, v17
    v_lshlrev_b32 v16, 16, v108
    v_and_b32 v17, 0xffff0000, v108
    v_fmac_f32 v12, s24, v16
    v_fmac_f32 v13, s24, v17
    v_lshlrev_b32 v16, 16, v109
    v_and_b32 v17, 0xffff0000, v109
    v_fmac_f32 v12, s25, v16
    v_fmac_f32 v13, s25, v17
    v_lshlrev_b32 v16, 16, v110
    v_and_b32 v17, 0xffff0000, v110
    v_fmac_f32 v12, s26, v16
    v_fmac_f32 v13, s26, v17
    v_lshlrev_b32 v16, 16, v111
    v_and_b32 v17, 0xffff0000, v111
    v_fmac_f32 v12, s27, v16
    v_fmac_f32 v13, s27, v17
    v_lshlrev_b32 v16, 16, v112
    v_and_b32 v17, 0xffff0000, v112
    v_fmac_f32 v12, s28, v16
    v_fmac_f32 v13, s28, v17
    v_lshlrev_b32 v16, 16, v113
    v_and_b32 v17, 0xffff0000, v113
    v_fmac_f32 v12, s29, v16
    v_fmac_f32 v13, s29, v17
    v_lshlrev_b32 v16, 16, v114
    v_and_b32 v17, 0xffff0000, v114
    v_fmac_f32 v12, s30, v16
    v_fmac_f32 v13, s30, v17
    v_lshlrev_b32 v16, 16, v115
    v_and_b32 v17, 0xffff0000, v115
    v_fmac_f32 v12, s31, v16
    v_fmac_f32 v13, s31, v17
    v_lshlrev_b32 v16, 16, v116
    v_and_b32 v17, 0xffff0000, v116
    v_fmac_f32 v12, s32, v16
    v_fmac_f32 v13, s32, v17
    v_lshlrev_b32 v16, 16, v117
    v_and_b32 v17, 0xffff0000, v117
    v_fmac_f32 v12, s33, v16
    v_fmac_f32 v13, s33, v17
    v_lshlrev_b32 v16, 16, v118
    v_and_b32 v17, 0xffff0000, v118
    v_fmac_f32 v12, s34, v16
    v_fmac_f32 v13, s34, v17
    v_lshlrev_b32 v16, 16, v119
    v_and_b32 v17, 0xffff0000, v119
    v_fmac_f32 v12, s35, v16
    v_fmac_f32 v13, s35, v17
    v_lshlrev_b32 v16, 16, v120
    v_and_b32 v17, 0xffff0000, v120
    v_fmac_f32 v12, s36, v16
    v_fmac_f32 v13, s36, v17
    v_lshlrev_b32 v16, 16, v121
    v_and_b32 v17, 0xffff0000, v121
    v_fmac_f32 v12, s37, v16
    v_fmac_f32 v13, s37, v17
    v_lshlrev_b32 v16, 16, v122
    v_and_b32 v17, 0xffff0000, v122
    v_fmac_f32 v12, s38, v16
    v_fmac_f32 v13, s38, v17
    v_lshlrev_b32 v16, 16, v123
    v_and_b32 v17, 0xffff0000, v123
    v_fmac_f32 v12, s39, v16
    v_fmac_f32 v13, s39, v17
    v_lshlrev_b32 v16, 16, v124
    v_and_b32 v17, 0xffff0000, v124
    v_fmac_f32 v12, s40, v16
    v_fmac_f32 v13, s40, v17
    v_lshlrev_b32 v16, 16, v125
    v_and_b32 v17, 0xffff0000, v125
    v_fmac_f32 v12, s41, v16
    v_fmac_f32 v13, s41, v17
    v_lshlrev_b32 v16, 16, v126
    v_and_b32 v17, 0xffff0000, v126
    v_fmac_f32 v12, s42, v16
    v_fmac_f32 v13, s42, v17
    v_lshlrev_b32 v16, 16, v127
    v_and_b32 v17, 0xffff0000, v127
    v_fmac_f32 v12, s43, v16
    v_fmac_f32 v13, s43, v17
    v_lshlrev_b32 v16, 16, v128
    v_and_b32 v17, 0xffff0000, v128
    v_fmac_f32 v12, s44, v16
    v_fmac_f32 v13, s44, v17
    v_lshlrev_b32 v16, 16, v129
    v_and_b32 v17, 0xffff0000, v129
    v_fmac_f32 v12, s45, v16
    v_fmac_f32 v13, s45, v17
    v_lshlrev_b32 v16, 16, v130
    v_and_b32 v17, 0xffff0000, v130
    v_fmac_f32 v12, s46, v16
    v_fmac_f32 v13, s46, v17
    v_lshlrev_b32 v16, 16, v131
    v_and_b32 v17, 0xffff0000, v131
    v_fmac_f32 v12, s47, v16
    v_fmac_f32 v13, s47, v17
    v_lshlrev_b32 v16, 16, v132
    v_and_b32 v17, 0xffff0000, v132
    v_fmac_f32 v12, s48, v16
    v_fmac_f32 v13, s48, v17
    v_lshlrev_b32 v16, 16, v133
    v_and_b32 v17, 0xffff0000, v133
    v_fmac_f32 v12, s49, v16
    v_fmac_f32 v13, s49, v17
    v_lshlrev_b32 v16, 16, v134
    v_and_b32 v17, 0xffff0000, v134
    v_fmac_f32 v12, s50, v16
    v_fmac_f32 v13, s50, v17
    v_lshlrev_b32 v16, 16, v135
    v_and_b32 v17, 0xffff0000, v135
    v_fmac_f32 v12, s51, v16
    v_fmac_f32 v13, s51, v17
    v_readlane_b32 s20, v9, 32
    v_readlane_b32 s21, v9, 33
    v_readlane_b32 s22, v9, 34
    v_readlane_b32 s23, v9, 35
    v_readlane_b32 s24, v9, 36
    v_readlane_b32 s25, v9, 37
    v_readlane_b32 s26, v9, 38
    v_readlane_b32 s27, v9, 39
    v_readlane_b32 s28, v9, 40
    v_readlane_b32 s29, v9, 41
    v_readlane_b32 s30, v9, 42
    v_readlane_b32 s31, v9, 43
    v_readlane_b32 s32, v9, 44
    v_readlane_b32 s33, v9, 45
    v_readlane_b32 s34, v9, 46
    v_readlane_b32 s35, v9, 47
    v_readlane_b32 s36, v9, 48
    v_readlane_b32 s37, v9, 49
    v_readlane_b32 s38, v9, 50
    v_readlane_b32 s39, v9, 51
    v_readlane_b32 s40, v9, 52
    v_readlane_b32 s41, v9, 53
    v_readlane_b32 s42, v9, 54
    v_readlane_b32 s43, v9, 55
    v_readlane_b32 s44, v9, 56
    v_readlane_b32 s45, v9, 57
    v_readlane_b32 s46, v9, 58
    v_readlane_b32 s47, v9, 59
    v_readlane_b32 s48, v9, 60
    v_readlane_b32 s49, v9, 61
    v_readlane_b32 s50, v9, 62
    v_readlane_b32 s51, v9, 63
    v_lshlrev_b32 v16, 16, v136
    v_and_b32 v17, 0xffff0000, v136
    v_fmac_f32 v12, s20, v16
    v_fmac_f32 v13, s20, v17
    v_lshlrev_b32 v16, 16, v137
    v_and_b32 v17, 0xffff0000, v137
    v_fmac_f32 v12, s21, v16
    v_fmac_f32 v13, s21, v17
    v_lshlrev_b32 v16, 16, v138
    v_and_b32 v17, 0xffff0000, v138
    v_fmac_f32 v12, s22, v16
    v_fmac_f32 v13, s22, v17
    v_lshlrev_b32 v16, 16, v139
    v_and_b32 v17, 0xffff0000, v139
    v_fmac_f32 v12, s23, v16
    v_fmac_f32 v13, s23, v17
    v_lshlrev_b32 v16, 16, v140
    v_and_b32 v17, 0xffff0000, v140
    v_fmac_f32 v12, s24, v16
    v_fmac_f32 v13, s24, v17
    v_lshlrev_b32 v16, 16, v141
    v_and_b32 v17, 0xffff0000, v141
    v_fmac_f32 v12, s25, v16
    v_fmac_f32 v13, s25, v17
    v_lshlrev_b32 v16, 16, v142
    v_and_b32 v17, 0xffff0000, v142
    v_fmac_f32 v12, s26, v16
    v_fmac_f32 v13, s26, v17
    v_lshlrev_b32 v16, 16, v143
    v_and_b32 v17, 0xffff0000, v143
    v_fmac_f32 v12, s27, v16
    v_fmac_f32 v13, s27, v17
    v_lshlrev_b32 v16, 16, v144
    v_and_b32 v17, 0xffff0000, v144
    v_fmac_f32 v12, s28, v16
    v_fmac_f32 v13, s28, v17
    v_lshlrev_b32 v16, 16, v145
    v_and_b32 v17, 0xffff0000, v145
    v_fmac_f32 v12, s29, v16
    v_fmac_f32 v13, s29, v17
    v_lshlrev_b32 v16, 16, v146
    v_and_b32 v17, 0xffff0000, v146
    v_fmac_f32 v12, s30, v16
    v_fmac_f32 v13, s30, v17
    v_lshlrev_b32 v16, 16, v147
    v_and_b32 v17, 0xffff0000, v147
    v_fmac_f32 v12, s31, v16
    v_fmac_f32 v13, s31, v17
    v_lshlrev_b32 v16, 16, v148
    v_and_b32 v17, 0xffff0000, v148
    v_fmac_f32 v12, s32, v16
    v_fmac_f32 v13, s32, v17
    v_lshlrev_b32 v16, 16, v149
    v_and_b32 v17, 0xffff0000, v149
    v_fmac_f32 v12, s33, v16
    v_fmac_f32 v13, s33, v17
    v_lshlrev_b32 v16, 16, v150
    v_and_b32 v17, 0xffff0000, v150
    v_fmac_f32 v12, s34, v16
    v_fmac_f32 v13, s34, v17
    v_lshlrev_b32 v16, 16, v151
    v_and_b32 v17, 0xffff0000, v151
    v_fmac_f32 v12, s35, v16
    v_fmac_f32 v13, s35, v17
    v_lshlrev_b32 v16, 16, v152
    v_and_b32 v17, 0xffff0000, v152
    v_fmac_f32 v12, s36, v16
    v_fmac_f32 v13, s36, v17
    v_lshlrev_b32 v16, 16, v153
    v_and_b32 v17, 0xffff0000, v153
    v_fmac_f32 v12, s37, v16
    v_fmac_f32 v13, s37, v17
    v_lshlrev_b32 v16, 16, v154
    v_and_b32 v17, 0xffff0000, v154
    v_fmac_f32 v12, s38, v16
    v_fmac_f32 v13, s38, v17
    v_lshlrev_b32 v16, 16, v155
    v_and_b32 v17, 0xffff0000, v155
    v_fmac_f32 v12, s39, v16
    v_fmac_f32 v13, s39, v17
    v_lshlrev_b32 v16, 16, v156
    v_and_b32 v17, 0xffff0000, v156
    v_fmac_f32 v12, s40, v16
    v_fmac_f32 v13, s40, v17
    v_lshlrev_b32 v16, 16, v157
    v_and_b32 v17, 0xffff0000, v157
    v_fmac_f32 v12, s41, v16
    v_fmac_f32 v13, s41, v17
    v_lshlrev_b32 v16, 16, v158
    v_and_b32 v17, 0xffff0000, v158
    v_fmac_f32 v12, s42, v16
    v_fmac_f32 v13, s42, v17
    v_lshlrev_b32 v16, 16, v159
    v_and_b32 v17, 0xffff0000, v159
    v_fmac_f32 v12, s43, v16
    v_fmac_f32 v13, s43, v17
    v_lshlrev_b32 v16, 16, v160
    v_and_b32 v17, 0xffff0000, v160
    v_fmac_f32 v12, s44, v16
    v_fmac_f32 v13, s44, v17
    v_lshlrev_b32 v16, 16, v161
    v_and_b32 v17, 0xffff0000, v161
    v_fmac_f32 v12, s45, v16
    v_fmac_f32 v13, s45, v17
    v_lshlrev_b32 v16, 16, v162
    v_and_b32 v17, 0xffff0000, v162
    v_fmac_f32 v12, s46, v16
    v_fmac_f32 v13, s46, v17
    v_lshlrev_b32 v16, 16, v163
    v_and_b32 v17, 0xffff0000, v163
    v_fmac_f32 v12, s47, v16
    v_fmac_f32 v13, s47, v17
    v_lshlrev_b32 v16, 16, v164
    v_and_b32 v17, 0xffff0000, v164
    v_fmac_f32 v12, s48, v16
    v_fmac_f32 v13, s48, v17
    v_lshlrev_b32 v16, 16, v165
    v_and_b32 v17, 0xffff0000, v165
    v_fmac_f32 v12, s49, v16
    v_fmac_f32 v13, s49, v17
    v_lshlrev_b32 v16, 16, v166
    v_and_b32 v17, 0xffff0000, v166
    v_fmac_f32 v12, s50, v16
    v_fmac_f32 v13, s50, v17
    v_lshlrev_b32 v16, 16, v167
    v_and_b32 v17, 0xffff0000, v167
    v_fmac_f32 v12, s51, v16
    v_fmac_f32 v13, s51, v17
    v_readlane_b32 s20, v10, 0
    v_readlane_b32 s21, v10, 1
    v_readlane_b32 s22, v10, 2
    v_readlane_b32 s23, v10, 3
    v_readlane_b32 s24, v10, 4
    v_readlane_b32 s25, v10, 5
    v_readlane_b32 s26, v10, 6
    v_readlane_b32 s27, v10, 7
    v_readlane_b32 s28, v10, 8
    v_readlane_b32 s29, v10, 9
    v_readlane_b32 s30, v10, 10
    v_readlane_b32 s31, v10, 11
    v_readlane_b32 s32, v10, 12
    v_readlane_b32 s33, v10, 13
    v_readlane_b32 s34, v10, 14
    v_readlane_b32 s35, v10, 15
    v_readlane_b32 s36, v10, 16
    v_readlane_b32 s37, v10, 17
    v_readlane_b32 s38, v10, 18
    v_readlane_b32 s39, v10, 19
    v_readlane_b32 s40, v10, 20
    v_readlane_b32 s41, v10, 21
    v_readlane_b32 s42, v10, 22
    v_readlane_b32 s43, v10, 23
    v_readlane_b32 s44, v10, 24
    v_readlane_b32 s45, v10, 25
    v_readlane_b32 s46, v10, 26
    v_readlane_b32 s47, v10, 27
    v_readlane_b32 s48, v10, 28
    v_readlane_b32 s49, v10, 29
    v_readlane_b32 s50, v10, 30
    v_readlane_b32 s51, v10, 31
    v_lshlrev_b32 v16, 16, v168
    v_and_b32 v17, 0xffff0000, v168
    v_fmac_f32 v12, s20, v16
    v_fmac_f32 v13, s20, v17
    v_lshlrev_b32 v16, 16, v169
    v_and_b32 v17, 0xffff0000, v169
    v_fmac_f32 v12, s21, v16
    v_fmac_f32 v13, s21, v17
    v_lshlrev_b32 v16, 16, v170
    v_and_b32 v17, 0xffff0000, v170
    v_fmac_f32 v12, s22, v16
    v_fmac_f32 v13, s22, v17
    v_lshlrev_b32 v16, 16, v171
    v_and_b32 v17, 0xffff0000, v171
    v_fmac_f32 v12, s23, v16
    v_fmac_f32 v13, s23, v17
    v_lshlrev_b32 v16, 16, v172
    v_and_b32 v17, 0xffff0000, v172
    v_fmac_f32 v12, s24, v16
    v_fmac_f32 v13, s24, v17
    v_lshlrev_b32 v16, 16, v173
    v_and_b32 v17, 0xffff0000, v173
    v_fmac_f32 v12, s25, v16
    v_fmac_f32 v13, s25, v17
    v_lshlrev_b32 v16, 16, v174
    v_and_b32 v17, 0xffff0000, v174
    v_fmac_f32 v12, s26, v16
    v_fmac_f32 v13, s26, v17
    v_lshlrev_b32 v16, 16, v175
    v_and_b32 v17, 0xffff0000, v175
    v_fmac_f32 v12, s27, v16
    v_fmac_f32 v13, s27, v17
    v_lshlrev_b32 v16, 16, v176
    v_and_b32 v17, 0xffff0000, v176
    v_fmac_f32 v12, s28, v16
    v_fmac_f32 v13, s28, v17
    v_lshlrev_b32 v16, 16, v177
    v_and_b32 v17, 0xffff0000, v177
    v_fmac_f32 v12, s29, v16
    v_fmac_f32 v13, s29, v17
    v_lshlrev_b32 v16, 16, v178
    v_and_b32 v17, 0xffff0000, v178
    v_fmac_f32 v12, s30, v16
    v_fmac_f32 v13, s30, v17
    v_lshlrev_b32 v16, 16, v179
    v_and_b32 v17, 0xffff0000, v179
    v_fmac_f32 v12, s31, v16
    v_fmac_f32 v13, s31, v17
    v_lshlrev_b32 v16, 16, v180
    v_and_b32 v17, 0xffff0000, v180
    v_fmac_f32 v12, s32, v16
    v_fmac_f32 v13, s32, v17
    v_lshlrev_b32 v16, 16, v181
    v_and_b32 v17, 0xffff0000, v181
    v_fmac_f32 v12, s33, v16
    v_fmac_f32 v13, s33, v17
    v_lshlrev_b32 v16, 16, v182
    v_and_b32 v17, 0xffff0000, v182
    v_fmac_f32 v12, s34, v16
    v_fmac_f32 v13, s34, v17
    v_lshlrev_b32 v16, 16, v183
    v_and_b32 v17, 0xffff0000, v183
    v_fmac_f32 v12, s35, v16
    v_fmac_f32 v13, s35, v17
    v_lshlrev_b32 v16, 16, v184
    v_and_b32 v17, 0xffff0000, v184
    v_fmac_f32 v12, s36, v16
    v_fmac_f32 v13, s36, v17
    v_lshlrev_b32 v16, 16, v185
    v_and_b32 v17, 0xffff0000, v185
    v_fmac_f32 v12, s37, v16
    v_fmac_f32 v13, s37, v17
    v_lshlrev_b32 v16, 16, v186
    v_and_b32 v17, 0xffff0000, v186
    v_fmac_f32 v12, s38, v16
    v_fmac_f32 v13, s38, v17
    v_lshlrev_b32 v16, 16, v187
    v_and_b32 v17, 0xffff0000, v187
    v_fmac_f32 v12, s39, v16
    v_fmac_f32 v13, s39, v17
    v_lshlrev_b32 v16, 16, v188
    v_and_b32 v17, 0xffff0000, v188
    v_fmac_f32 v12, s40, v16
    v_fmac_f32 v13, s40, v17
    v_lshlrev_b32 v16, 16, v189
    v_and_b32 v17, 0xffff0000, v189
    v_fmac_f32 v12, s41, v16
    v_fmac_f32 v13, s41, v17
    v_lshlrev_b32 v16, 16, v190
    v_and_b32 v17, 0xffff0000, v190
    v_fmac_f32 v12, s42, v16
    v_fmac_f32 v13, s42, v17
    v_lshlrev_b32 v16, 16, v191
    v_and_b32 v17, 0xffff0000, v191
    v_fmac_f32 v12, s43, v16
    v_fmac_f32 v13, s43, v17
    v_lshlrev_b32 v16, 16, v192
    v_and_b32 v17, 0xffff0000, v192
    v_fmac_f32 v12, s44, v16
    v_fmac_f32 v13, s44, v17
    v_lshlrev_b32 v16, 16, v193
    v_and_b32 v17, 0xffff0000, v193
    v_fmac_f32 v12, s45, v16
    v_fmac_f32 v13, s45, v17
    v_lshlrev_b32 v16, 16, v194
    v_and_b32 v17, 0xffff0000, v194
    v_fmac_f32 v12, s46, v16
    v_fmac_f32 v13, s46, v17
    v_lshlrev_b32 v16, 16, v195
    v_and_b32 v17, 0xffff0000, v195
    v_fmac_f32 v12, s47, v16
    v_fmac_f32 v13, s47, v17
    v_lshlrev_b32 v16, 16, v196
    v_and_b32 v17, 0xffff0000, v196
    v_fmac_f32 v12, s48, v16
    v_fmac_f32 v13, s48, v17
    v_lshlrev_b32 v16, 16, v197
    v_and_b32 v17, 0xffff0000, v197
    v_fmac_f32 v12, s49, v16
    v_fmac_f32 v13, s49, v17
    v_lshlrev_b32 v16, 16, v198
    v_and_b32 v17, 0xffff0000, v198
    v_fmac_f32 v12, s50, v16
    v_fmac_f32 v13, s50, v17
    v_lshlrev_b32 v16, 16, v199
    v_and_b32 v17, 0xffff0000, v199
    v_fmac_f32 v12, s51, v16
    v_fmac_f32 v13, s51, v17
    v_lshlrev_b32 v16, 3, v0
    ds_write_b64 v16, v[12:13]
    s_waitcnt lgkmcnt(0)
    s_barrier
    v_and_b32 v16, 127, v0
    v_lshlrev_b32 v16, 2, v16
    ds_read_b32 v20, v16 offset:0
    ds_read_b32 v21, v16 offset:512
    ds_read_b32 v22, v16 offset:1024
    ds_read_b32 v23, v16 offset:1536
    s_waitcnt lgkmcnt(0)
    v_add_f32 v20, v20, v21
    v_add_f32 v20, v20, v22
    v_add_f32 v20, v20, v23
    v_cvt_pk_bf16_f32 v20, v20, v20
    v_lshlrev_b32 v20, 16, v20
    s_lshl_b32 s3, s98, 7
    v_and_b32 v17, 127, v0
    v_add_u32 v17, s3, v17
    v_add_f32 v21, 1.0, v20
    v_cvt_pk_bf16_f32 v21, v21, v21
    v_lshlrev_b32 v21, 16, v21
    v_subrev_u32 v18, 640, v17
    v_subrev_u32 v19, 2560, v17
    v_min_u32 v18, v18, v19
    v_cmp_gt_u32 vcc, 640, v18
    s_nop 1
    v_cndmask_b32 v20, v20, v21, vcc
    v_lshlrev_b32 v17, 2, v17
    buffer_store_dword v20, v17, s[60:63], 0 offen sc1
    s_waitcnt vmcnt(0)
    s_barrier
    s_cmp_lg_u32 s74, 0
    s_cbranch_scc1 mega_kernel_ca11
    v_mov_b32 v5, 1
    v_mov_b32 v6, 128
    s_mov_b64 exec, 1
    buffer_atomic_add v5, v6, s[88:91], 0 offen sc1
    s_mov_b64 exec, -1
mega_kernel_ca11:
    v_lshlrev_b32 v20, 4, v2
mega_kernel_nmod10:
    s_branch mega_kernel_nboot29
mega_kernel_nboot8:
    s_cmp_lt_u32 s2, 208
    s_cbranch_scc1 mega_kernel_nboot29
    s_sub_u32 s98, s2, 208
    s_lshl_b32 s98, s98, 2
    s_add_u32 s98, s98, s74
    s_cmp_ge_u32 s98, 128
    s_cbranch_scc1 mega_kernel_ln1s12
    s_load_dwordx2 s[4:5], s[0:1], 0
    s_waitcnt lgkmcnt(0)
    s_mov_b32 s12, s4
    s_and_b32 s13, s5, 0xffff
    s_mov_b32 s14, 2621440
    s_mov_b32 s15, 0x00020000
    s_lshl_b32 s3, s98, 4
    v_add_u32 v5, s3, v3
    s_movk_i32 s3, 1280
    v_mul_lo_u32 v5, v5, s3
    v_lshl_add_u32 v5, v4, 4, v5
    buffer_load_dwordx4 v[40:43], v5, s[12:15], 0 offen offset:0
    buffer_load_dwordx4 v[44:47], v5, s[12:15], 0 offen offset:64
    buffer_load_dwordx4 v[48:51], v5, s[12:15], 0 offen offset:128
    buffer_load_dwordx4 v[52:55], v5, s[12:15], 0 offen offset:192
    buffer_load_dwordx4 v[56:59], v5, s[12:15], 0 offen offset:256
    buffer_load_dwordx4 v[60:63], v5, s[12:15], 0 offen offset:320
    buffer_load_dwordx4 v[64:67], v5, s[12:15], 0 offen offset:384
    buffer_load_dwordx4 v[68:71], v5, s[12:15], 0 offen offset:448
    buffer_load_dwordx4 v[72:75], v5, s[12:15], 0 offen offset:512
    buffer_load_dwordx4 v[76:79], v5, s[12:15], 0 offen offset:576
    buffer_load_dwordx4 v[80:83], v5, s[12:15], 0 offen offset:640
    buffer_load_dwordx4 v[84:87], v5, s[12:15], 0 offen offset:704
    buffer_load_dwordx4 v[88:91], v5, s[12:15], 0 offen offset:768
    buffer_load_dwordx4 v[92:95], v5, s[12:15], 0 offen offset:832
    buffer_load_dwordx4 v[96:99], v5, s[12:15], 0 offen offset:896
    buffer_load_dwordx4 v[100:103], v5, s[12:15], 0 offen offset:960
    buffer_load_dwordx4 v[104:107], v5, s[12:15], 0 offen offset:1024
    buffer_load_dwordx4 v[108:111], v5, s[12:15], 0 offen offset:1088
    buffer_load_dwordx4 v[112:115], v5, s[12:15], 0 offen offset:1152
    buffer_load_dwordx4 v[116:119], v5, s[12:15], 0 offen offset:1216
    v_mov_b32 v6, 0
    v_mov_b32 v7, 0
    s_waitcnt vmcnt(0)
    v_lshlrev_b32 v8, 16, v40
    v_and_b32 v9, 0xffff0000, v40
    v_add_f32 v6, v6, v8
    v_add_f32 v7, v7, v9
    v_lshlrev_b32 v8, 16, v41
    v_and_b32 v9, 0xffff0000, v41
    v_add_f32 v6, v6, v8
    v_add_f32 v7, v7, v9
    v_lshlrev_b32 v8, 16, v42
    v_and_b32 v9, 0xffff0000, v42
    v_add_f32 v6, v6, v8
    v_add_f32 v7, v7, v9
    v_lshlrev_b32 v8, 16, v43
    v_and_b32 v9, 0xffff0000, v43
    v_add_f32 v6, v6, v8
    v_add_f32 v7, v7, v9
    v_lshlrev_b32 v8, 16, v44
    v_and_b32 v9, 0xffff0000, v44
    v_add_f32 v6, v6, v8
    v_add_f32 v7, v7, v9
    v_lshlrev_b32 v8, 16, v45
    v_and_b32 v9, 0xffff0000, v45
    v_add_f32 v6, v6, v8
    v_add_f32 v7, v7, v9
    v_lshlrev_b32 v8, 16, v46
    v_and_b32 v9, 0xffff0000, v46
    v_add_f32 v6, v6, v8
    v_add_f32 v7, v7, v9
    v_lshlrev_b32 v8, 16, v47
    v_and_b32 v9, 0xffff0000, v47
    v_add_f32 v6, v6, v8
    v_add_f32 v7, v7, v9
    v_lshlrev_b32 v8, 16, v48
    v_and_b32 v9, 0xffff0000, v48
    v_add_f32 v6, v6, v8
    v_add_f32 v7, v7, v9
    v_lshlrev_b32 v8, 16, v49
    v_and_b32 v9, 0xffff0000, v49
    v_add_f32 v6, v6, v8
    v_add_f32 v7, v7, v9
    v_lshlrev_b32 v8, 16, v50
    v_and_b32 v9, 0xffff0000, v50
    v_add_f32 v6, v6, v8
    v_add_f32 v7, v7, v9
    v_lshlrev_b32 v8, 16, v51
    v_and_b32 v9, 0xffff0000, v51
    v_add_f32 v6, v6, v8
    v_add_f32 v7, v7, v9
    v_lshlrev_b32 v8, 16, v52
    v_and_b32 v9, 0xffff0000, v52
    v_add_f32 v6, v6, v8
    v_add_f32 v7, v7, v9
    v_lshlrev_b32 v8, 16, v53
    v_and_b32 v9, 0xffff0000, v53
    v_add_f32 v6, v6, v8
    v_add_f32 v7, v7, v9
    v_lshlrev_b32 v8, 16, v54
    v_and_b32 v9, 0xffff0000, v54
    v_add_f32 v6, v6, v8
    v_add_f32 v7, v7, v9
    v_lshlrev_b32 v8, 16, v55
    v_and_b32 v9, 0xffff0000, v55
    v_add_f32 v6, v6, v8
    v_add_f32 v7, v7, v9
    v_lshlrev_b32 v8, 16, v56
    v_and_b32 v9, 0xffff0000, v56
    v_add_f32 v6, v6, v8
    v_add_f32 v7, v7, v9
    v_lshlrev_b32 v8, 16, v57
    v_and_b32 v9, 0xffff0000, v57
    v_add_f32 v6, v6, v8
    v_add_f32 v7, v7, v9
    v_lshlrev_b32 v8, 16, v58
    v_and_b32 v9, 0xffff0000, v58
    v_add_f32 v6, v6, v8
    v_add_f32 v7, v7, v9
    v_lshlrev_b32 v8, 16, v59
    v_and_b32 v9, 0xffff0000, v59
    v_add_f32 v6, v6, v8
    v_add_f32 v7, v7, v9
    v_lshlrev_b32 v8, 16, v60
    v_and_b32 v9, 0xffff0000, v60
    v_add_f32 v6, v6, v8
    v_add_f32 v7, v7, v9
    v_lshlrev_b32 v8, 16, v61
    v_and_b32 v9, 0xffff0000, v61
    v_add_f32 v6, v6, v8
    v_add_f32 v7, v7, v9
    v_lshlrev_b32 v8, 16, v62
    v_and_b32 v9, 0xffff0000, v62
    v_add_f32 v6, v6, v8
    v_add_f32 v7, v7, v9
    v_lshlrev_b32 v8, 16, v63
    v_and_b32 v9, 0xffff0000, v63
    v_add_f32 v6, v6, v8
    v_add_f32 v7, v7, v9
    v_lshlrev_b32 v8, 16, v64
    v_and_b32 v9, 0xffff0000, v64
    v_add_f32 v6, v6, v8
    v_add_f32 v7, v7, v9
    v_lshlrev_b32 v8, 16, v65
    v_and_b32 v9, 0xffff0000, v65
    v_add_f32 v6, v6, v8
    v_add_f32 v7, v7, v9
    v_lshlrev_b32 v8, 16, v66
    v_and_b32 v9, 0xffff0000, v66
    v_add_f32 v6, v6, v8
    v_add_f32 v7, v7, v9
    v_lshlrev_b32 v8, 16, v67
    v_and_b32 v9, 0xffff0000, v67
    v_add_f32 v6, v6, v8
    v_add_f32 v7, v7, v9
    v_lshlrev_b32 v8, 16, v68
    v_and_b32 v9, 0xffff0000, v68
    v_add_f32 v6, v6, v8
    v_add_f32 v7, v7, v9
    v_lshlrev_b32 v8, 16, v69
    v_and_b32 v9, 0xffff0000, v69
    v_add_f32 v6, v6, v8
    v_add_f32 v7, v7, v9
    v_lshlrev_b32 v8, 16, v70
    v_and_b32 v9, 0xffff0000, v70
    v_add_f32 v6, v6, v8
    v_add_f32 v7, v7, v9
    v_lshlrev_b32 v8, 16, v71
    v_and_b32 v9, 0xffff0000, v71
    v_add_f32 v6, v6, v8
    v_add_f32 v7, v7, v9
    v_lshlrev_b32 v8, 16, v72
    v_and_b32 v9, 0xffff0000, v72
    v_add_f32 v6, v6, v8
    v_add_f32 v7, v7, v9
    v_lshlrev_b32 v8, 16, v73
    v_and_b32 v9, 0xffff0000, v73
    v_add_f32 v6, v6, v8
    v_add_f32 v7, v7, v9
    v_lshlrev_b32 v8, 16, v74
    v_and_b32 v9, 0xffff0000, v74
    v_add_f32 v6, v6, v8
    v_add_f32 v7, v7, v9
    v_lshlrev_b32 v8, 16, v75
    v_and_b32 v9, 0xffff0000, v75
    v_add_f32 v6, v6, v8
    v_add_f32 v7, v7, v9
    v_lshlrev_b32 v8, 16, v76
    v_and_b32 v9, 0xffff0000, v76
    v_add_f32 v6, v6, v8
    v_add_f32 v7, v7, v9
    v_lshlrev_b32 v8, 16, v77
    v_and_b32 v9, 0xffff0000, v77
    v_add_f32 v6, v6, v8
    v_add_f32 v7, v7, v9
    v_lshlrev_b32 v8, 16, v78
    v_and_b32 v9, 0xffff0000, v78
    v_add_f32 v6, v6, v8
    v_add_f32 v7, v7, v9
    v_lshlrev_b32 v8, 16, v79
    v_and_b32 v9, 0xffff0000, v79
    v_add_f32 v6, v6, v8
    v_add_f32 v7, v7, v9
    v_lshlrev_b32 v8, 16, v80
    v_and_b32 v9, 0xffff0000, v80
    v_add_f32 v6, v6, v8
    v_add_f32 v7, v7, v9
    v_lshlrev_b32 v8, 16, v81
    v_and_b32 v9, 0xffff0000, v81
    v_add_f32 v6, v6, v8
    v_add_f32 v7, v7, v9
    v_lshlrev_b32 v8, 16, v82
    v_and_b32 v9, 0xffff0000, v82
    v_add_f32 v6, v6, v8
    v_add_f32 v7, v7, v9
    v_lshlrev_b32 v8, 16, v83
    v_and_b32 v9, 0xffff0000, v83
    v_add_f32 v6, v6, v8
    v_add_f32 v7, v7, v9
    v_lshlrev_b32 v8, 16, v84
    v_and_b32 v9, 0xffff0000, v84
    v_add_f32 v6, v6, v8
    v_add_f32 v7, v7, v9
    v_lshlrev_b32 v8, 16, v85
    v_and_b32 v9, 0xffff0000, v85
    v_add_f32 v6, v6, v8
    v_add_f32 v7, v7, v9
    v_lshlrev_b32 v8, 16, v86
    v_and_b32 v9, 0xffff0000, v86
    v_add_f32 v6, v6, v8
    v_add_f32 v7, v7, v9
    v_lshlrev_b32 v8, 16, v87
    v_and_b32 v9, 0xffff0000, v87
    v_add_f32 v6, v6, v8
    v_add_f32 v7, v7, v9
    v_lshlrev_b32 v8, 16, v88
    v_and_b32 v9, 0xffff0000, v88
    v_add_f32 v6, v6, v8
    v_add_f32 v7, v7, v9
    v_lshlrev_b32 v8, 16, v89
    v_and_b32 v9, 0xffff0000, v89
    v_add_f32 v6, v6, v8
    v_add_f32 v7, v7, v9
    v_lshlrev_b32 v8, 16, v90
    v_and_b32 v9, 0xffff0000, v90
    v_add_f32 v6, v6, v8
    v_add_f32 v7, v7, v9
    v_lshlrev_b32 v8, 16, v91
    v_and_b32 v9, 0xffff0000, v91
    v_add_f32 v6, v6, v8
    v_add_f32 v7, v7, v9
    v_lshlrev_b32 v8, 16, v92
    v_and_b32 v9, 0xffff0000, v92
    v_add_f32 v6, v6, v8
    v_add_f32 v7, v7, v9
    v_lshlrev_b32 v8, 16, v93
    v_and_b32 v9, 0xffff0000, v93
    v_add_f32 v6, v6, v8
    v_add_f32 v7, v7, v9
    v_lshlrev_b32 v8, 16, v94
    v_and_b32 v9, 0xffff0000, v94
    v_add_f32 v6, v6, v8
    v_add_f32 v7, v7, v9
    v_lshlrev_b32 v8, 16, v95
    v_and_b32 v9, 0xffff0000, v95
    v_add_f32 v6, v6, v8
    v_add_f32 v7, v7, v9
    v_lshlrev_b32 v8, 16, v96
    v_and_b32 v9, 0xffff0000, v96
    v_add_f32 v6, v6, v8
    v_add_f32 v7, v7, v9
    v_lshlrev_b32 v8, 16, v97
    v_and_b32 v9, 0xffff0000, v97
    v_add_f32 v6, v6, v8
    v_add_f32 v7, v7, v9
    v_lshlrev_b32 v8, 16, v98
    v_and_b32 v9, 0xffff0000, v98
    v_add_f32 v6, v6, v8
    v_add_f32 v7, v7, v9
    v_lshlrev_b32 v8, 16, v99
    v_and_b32 v9, 0xffff0000, v99
    v_add_f32 v6, v6, v8
    v_add_f32 v7, v7, v9
    v_lshlrev_b32 v8, 16, v100
    v_and_b32 v9, 0xffff0000, v100
    v_add_f32 v6, v6, v8
    v_add_f32 v7, v7, v9
    v_lshlrev_b32 v8, 16, v101
    v_and_b32 v9, 0xffff0000, v101
    v_add_f32 v6, v6, v8
    v_add_f32 v7, v7, v9
    v_lshlrev_b32 v8, 16, v102
    v_and_b32 v9, 0xffff0000, v102
    v_add_f32 v6, v6, v8
    v_add_f32 v7, v7, v9
    v_lshlrev_b32 v8, 16, v103
    v_and_b32 v9, 0xffff0000, v103
    v_add_f32 v6, v6, v8
    v_add_f32 v7, v7, v9
    v_lshlrev_b32 v8, 16, v104
    v_and_b32 v9, 0xffff0000, v104
    v_add_f32 v6, v6, v8
    v_add_f32 v7, v7, v9
    v_lshlrev_b32 v8, 16, v105
    v_and_b32 v9, 0xffff0000, v105
    v_add_f32 v6, v6, v8
    v_add_f32 v7, v7, v9
    v_lshlrev_b32 v8, 16, v106
    v_and_b32 v9, 0xffff0000, v106
    v_add_f32 v6, v6, v8
    v_add_f32 v7, v7, v9
    v_lshlrev_b32 v8, 16, v107
    v_and_b32 v9, 0xffff0000, v107
    v_add_f32 v6, v6, v8
    v_add_f32 v7, v7, v9
    v_lshlrev_b32 v8, 16, v108
    v_and_b32 v9, 0xffff0000, v108
    v_add_f32 v6, v6, v8
    v_add_f32 v7, v7, v9
    v_lshlrev_b32 v8, 16, v109
    v_and_b32 v9, 0xffff0000, v109
    v_add_f32 v6, v6, v8
    v_add_f32 v7, v7, v9
    v_lshlrev_b32 v8, 16, v110
    v_and_b32 v9, 0xffff0000, v110
    v_add_f32 v6, v6, v8
    v_add_f32 v7, v7, v9
    v_lshlrev_b32 v8, 16, v111
    v_and_b32 v9, 0xffff0000, v111
    v_add_f32 v6, v6, v8
    v_add_f32 v7, v7, v9
    v_lshlrev_b32 v8, 16, v112
    v_and_b32 v9, 0xffff0000, v112
    v_add_f32 v6, v6, v8
    v_add_f32 v7, v7, v9
    v_lshlrev_b32 v8, 16, v113
    v_and_b32 v9, 0xffff0000, v113
    v_add_f32 v6, v6, v8
    v_add_f32 v7, v7, v9
    v_lshlrev_b32 v8, 16, v114
    v_and_b32 v9, 0xffff0000, v114
    v_add_f32 v6, v6, v8
    v_add_f32 v7, v7, v9
    v_lshlrev_b32 v8, 16, v115
    v_and_b32 v9, 0xffff0000, v115
    v_add_f32 v6, v6, v8
    v_add_f32 v7, v7, v9
    v_lshlrev_b32 v8, 16, v116
    v_and_b32 v9, 0xffff0000, v116
    v_add_f32 v6, v6, v8
    v_add_f32 v7, v7, v9
    v_lshlrev_b32 v8, 16, v117
    v_and_b32 v9, 0xffff0000, v117
    v_add_f32 v6, v6, v8
    v_add_f32 v7, v7, v9
    v_lshlrev_b32 v8, 16, v118
    v_and_b32 v9, 0xffff0000, v118
    v_add_f32 v6, v6, v8
    v_add_f32 v7, v7, v9
    v_lshlrev_b32 v8, 16, v119
    v_and_b32 v9, 0xffff0000, v119
    v_add_f32 v6, v6, v8
    v_add_f32 v7, v7, v9
    v_add_f32 v6, v6, v7
    v_mov_b32 v7, v6
    s_nop 1
    v_permlane16_swap_b32 v6, v7
    s_nop 1
    v_add_f32 v6, v6, v7
    v_mov_b32 v7, v6
    s_nop 1
    v_permlane32_swap_b32 v6, v7
    s_nop 1
    v_add_f32 v6, v6, v7
    v_mul_f32 v6, 0x3acccccd, v6
    v_mov_b32 v10, 0
    v_mov_b32 v11, 0
    v_lshlrev_b32 v8, 16, v40
    v_and_b32 v9, 0xffff0000, v40
    v_sub_f32 v8, v8, v6
    v_sub_f32 v9, v9, v6
    v_fmac_f32 v10, v8, v8
    v_fmac_f32 v11, v9, v9
    v_lshlrev_b32 v8, 16, v41
    v_and_b32 v9, 0xffff0000, v41
    v_sub_f32 v8, v8, v6
    v_sub_f32 v9, v9, v6
    v_fmac_f32 v10, v8, v8
    v_fmac_f32 v11, v9, v9
    v_lshlrev_b32 v8, 16, v42
    v_and_b32 v9, 0xffff0000, v42
    v_sub_f32 v8, v8, v6
    v_sub_f32 v9, v9, v6
    v_fmac_f32 v10, v8, v8
    v_fmac_f32 v11, v9, v9
    v_lshlrev_b32 v8, 16, v43
    v_and_b32 v9, 0xffff0000, v43
    v_sub_f32 v8, v8, v6
    v_sub_f32 v9, v9, v6
    v_fmac_f32 v10, v8, v8
    v_fmac_f32 v11, v9, v9
    v_lshlrev_b32 v8, 16, v44
    v_and_b32 v9, 0xffff0000, v44
    v_sub_f32 v8, v8, v6
    v_sub_f32 v9, v9, v6
    v_fmac_f32 v10, v8, v8
    v_fmac_f32 v11, v9, v9
    v_lshlrev_b32 v8, 16, v45
    v_and_b32 v9, 0xffff0000, v45
    v_sub_f32 v8, v8, v6
    v_sub_f32 v9, v9, v6
    v_fmac_f32 v10, v8, v8
    v_fmac_f32 v11, v9, v9
    v_lshlrev_b32 v8, 16, v46
    v_and_b32 v9, 0xffff0000, v46
    v_sub_f32 v8, v8, v6
    v_sub_f32 v9, v9, v6
    v_fmac_f32 v10, v8, v8
    v_fmac_f32 v11, v9, v9
    v_lshlrev_b32 v8, 16, v47
    v_and_b32 v9, 0xffff0000, v47
    v_sub_f32 v8, v8, v6
    v_sub_f32 v9, v9, v6
    v_fmac_f32 v10, v8, v8
    v_fmac_f32 v11, v9, v9
    v_lshlrev_b32 v8, 16, v48
    v_and_b32 v9, 0xffff0000, v48
    v_sub_f32 v8, v8, v6
    v_sub_f32 v9, v9, v6
    v_fmac_f32 v10, v8, v8
    v_fmac_f32 v11, v9, v9
    v_lshlrev_b32 v8, 16, v49
    v_and_b32 v9, 0xffff0000, v49
    v_sub_f32 v8, v8, v6
    v_sub_f32 v9, v9, v6
    v_fmac_f32 v10, v8, v8
    v_fmac_f32 v11, v9, v9
    v_lshlrev_b32 v8, 16, v50
    v_and_b32 v9, 0xffff0000, v50
    v_sub_f32 v8, v8, v6
    v_sub_f32 v9, v9, v6
    v_fmac_f32 v10, v8, v8
    v_fmac_f32 v11, v9, v9
    v_lshlrev_b32 v8, 16, v51
    v_and_b32 v9, 0xffff0000, v51
    v_sub_f32 v8, v8, v6
    v_sub_f32 v9, v9, v6
    v_fmac_f32 v10, v8, v8
    v_fmac_f32 v11, v9, v9
    v_lshlrev_b32 v8, 16, v52
    v_and_b32 v9, 0xffff0000, v52
    v_sub_f32 v8, v8, v6
    v_sub_f32 v9, v9, v6
    v_fmac_f32 v10, v8, v8
    v_fmac_f32 v11, v9, v9
    v_lshlrev_b32 v8, 16, v53
    v_and_b32 v9, 0xffff0000, v53
    v_sub_f32 v8, v8, v6
    v_sub_f32 v9, v9, v6
    v_fmac_f32 v10, v8, v8
    v_fmac_f32 v11, v9, v9
    v_lshlrev_b32 v8, 16, v54
    v_and_b32 v9, 0xffff0000, v54
    v_sub_f32 v8, v8, v6
    v_sub_f32 v9, v9, v6
    v_fmac_f32 v10, v8, v8
    v_fmac_f32 v11, v9, v9
    v_lshlrev_b32 v8, 16, v55
    v_and_b32 v9, 0xffff0000, v55
    v_sub_f32 v8, v8, v6
    v_sub_f32 v9, v9, v6
    v_fmac_f32 v10, v8, v8
    v_fmac_f32 v11, v9, v9
    v_lshlrev_b32 v8, 16, v56
    v_and_b32 v9, 0xffff0000, v56
    v_sub_f32 v8, v8, v6
    v_sub_f32 v9, v9, v6
    v_fmac_f32 v10, v8, v8
    v_fmac_f32 v11, v9, v9
    v_lshlrev_b32 v8, 16, v57
    v_and_b32 v9, 0xffff0000, v57
    v_sub_f32 v8, v8, v6
    v_sub_f32 v9, v9, v6
    v_fmac_f32 v10, v8, v8
    v_fmac_f32 v11, v9, v9
    v_lshlrev_b32 v8, 16, v58
    v_and_b32 v9, 0xffff0000, v58
    v_sub_f32 v8, v8, v6
    v_sub_f32 v9, v9, v6
    v_fmac_f32 v10, v8, v8
    v_fmac_f32 v11, v9, v9
    v_lshlrev_b32 v8, 16, v59
    v_and_b32 v9, 0xffff0000, v59
    v_sub_f32 v8, v8, v6
    v_sub_f32 v9, v9, v6
    v_fmac_f32 v10, v8, v8
    v_fmac_f32 v11, v9, v9
    v_lshlrev_b32 v8, 16, v60
    v_and_b32 v9, 0xffff0000, v60
    v_sub_f32 v8, v8, v6
    v_sub_f32 v9, v9, v6
    v_fmac_f32 v10, v8, v8
    v_fmac_f32 v11, v9, v9
    v_lshlrev_b32 v8, 16, v61
    v_and_b32 v9, 0xffff0000, v61
    v_sub_f32 v8, v8, v6
    v_sub_f32 v9, v9, v6
    v_fmac_f32 v10, v8, v8
    v_fmac_f32 v11, v9, v9
    v_lshlrev_b32 v8, 16, v62
    v_and_b32 v9, 0xffff0000, v62
    v_sub_f32 v8, v8, v6
    v_sub_f32 v9, v9, v6
    v_fmac_f32 v10, v8, v8
    v_fmac_f32 v11, v9, v9
    v_lshlrev_b32 v8, 16, v63
    v_and_b32 v9, 0xffff0000, v63
    v_sub_f32 v8, v8, v6
    v_sub_f32 v9, v9, v6
    v_fmac_f32 v10, v8, v8
    v_fmac_f32 v11, v9, v9
    v_lshlrev_b32 v8, 16, v64
    v_and_b32 v9, 0xffff0000, v64
    v_sub_f32 v8, v8, v6
    v_sub_f32 v9, v9, v6
    v_fmac_f32 v10, v8, v8
    v_fmac_f32 v11, v9, v9
    v_lshlrev_b32 v8, 16, v65
    v_and_b32 v9, 0xffff0000, v65
    v_sub_f32 v8, v8, v6
    v_sub_f32 v9, v9, v6
    v_fmac_f32 v10, v8, v8
    v_fmac_f32 v11, v9, v9
    v_lshlrev_b32 v8, 16, v66
    v_and_b32 v9, 0xffff0000, v66
    v_sub_f32 v8, v8, v6
    v_sub_f32 v9, v9, v6
    v_fmac_f32 v10, v8, v8
    v_fmac_f32 v11, v9, v9
    v_lshlrev_b32 v8, 16, v67
    v_and_b32 v9, 0xffff0000, v67
    v_sub_f32 v8, v8, v6
    v_sub_f32 v9, v9, v6
    v_fmac_f32 v10, v8, v8
    v_fmac_f32 v11, v9, v9
    v_lshlrev_b32 v8, 16, v68
    v_and_b32 v9, 0xffff0000, v68
    v_sub_f32 v8, v8, v6
    v_sub_f32 v9, v9, v6
    v_fmac_f32 v10, v8, v8
    v_fmac_f32 v11, v9, v9
    v_lshlrev_b32 v8, 16, v69
    v_and_b32 v9, 0xffff0000, v69
    v_sub_f32 v8, v8, v6
    v_sub_f32 v9, v9, v6
    v_fmac_f32 v10, v8, v8
    v_fmac_f32 v11, v9, v9
    v_lshlrev_b32 v8, 16, v70
    v_and_b32 v9, 0xffff0000, v70
    v_sub_f32 v8, v8, v6
    v_sub_f32 v9, v9, v6
    v_fmac_f32 v10, v8, v8
    v_fmac_f32 v11, v9, v9
    v_lshlrev_b32 v8, 16, v71
    v_and_b32 v9, 0xffff0000, v71
    v_sub_f32 v8, v8, v6
    v_sub_f32 v9, v9, v6
    v_fmac_f32 v10, v8, v8
    v_fmac_f32 v11, v9, v9
    v_lshlrev_b32 v8, 16, v72
    v_and_b32 v9, 0xffff0000, v72
    v_sub_f32 v8, v8, v6
    v_sub_f32 v9, v9, v6
    v_fmac_f32 v10, v8, v8
    v_fmac_f32 v11, v9, v9
    v_lshlrev_b32 v8, 16, v73
    v_and_b32 v9, 0xffff0000, v73
    v_sub_f32 v8, v8, v6
    v_sub_f32 v9, v9, v6
    v_fmac_f32 v10, v8, v8
    v_fmac_f32 v11, v9, v9
    v_lshlrev_b32 v8, 16, v74
    v_and_b32 v9, 0xffff0000, v74
    v_sub_f32 v8, v8, v6
    v_sub_f32 v9, v9, v6
    v_fmac_f32 v10, v8, v8
    v_fmac_f32 v11, v9, v9
    v_lshlrev_b32 v8, 16, v75
    v_and_b32 v9, 0xffff0000, v75
    v_sub_f32 v8, v8, v6
    v_sub_f32 v9, v9, v6
    v_fmac_f32 v10, v8, v8
    v_fmac_f32 v11, v9, v9
    v_lshlrev_b32 v8, 16, v76
    v_and_b32 v9, 0xffff0000, v76
    v_sub_f32 v8, v8, v6
    v_sub_f32 v9, v9, v6
    v_fmac_f32 v10, v8, v8
    v_fmac_f32 v11, v9, v9
    v_lshlrev_b32 v8, 16, v77
    v_and_b32 v9, 0xffff0000, v77
    v_sub_f32 v8, v8, v6
    v_sub_f32 v9, v9, v6
    v_fmac_f32 v10, v8, v8
    v_fmac_f32 v11, v9, v9
    v_lshlrev_b32 v8, 16, v78
    v_and_b32 v9, 0xffff0000, v78
    v_sub_f32 v8, v8, v6
    v_sub_f32 v9, v9, v6
    v_fmac_f32 v10, v8, v8
    v_fmac_f32 v11, v9, v9
    v_lshlrev_b32 v8, 16, v79
    v_and_b32 v9, 0xffff0000, v79
    v_sub_f32 v8, v8, v6
    v_sub_f32 v9, v9, v6
    v_fmac_f32 v10, v8, v8
    v_fmac_f32 v11, v9, v9
    v_lshlrev_b32 v8, 16, v80
    v_and_b32 v9, 0xffff0000, v80
    v_sub_f32 v8, v8, v6
    v_sub_f32 v9, v9, v6
    v_fmac_f32 v10, v8, v8
    v_fmac_f32 v11, v9, v9
    v_lshlrev_b32 v8, 16, v81
    v_and_b32 v9, 0xffff0000, v81
    v_sub_f32 v8, v8, v6
    v_sub_f32 v9, v9, v6
    v_fmac_f32 v10, v8, v8
    v_fmac_f32 v11, v9, v9
    v_lshlrev_b32 v8, 16, v82
    v_and_b32 v9, 0xffff0000, v82
    v_sub_f32 v8, v8, v6
    v_sub_f32 v9, v9, v6
    v_fmac_f32 v10, v8, v8
    v_fmac_f32 v11, v9, v9
    v_lshlrev_b32 v8, 16, v83
    v_and_b32 v9, 0xffff0000, v83
    v_sub_f32 v8, v8, v6
    v_sub_f32 v9, v9, v6
    v_fmac_f32 v10, v8, v8
    v_fmac_f32 v11, v9, v9
    v_lshlrev_b32 v8, 16, v84
    v_and_b32 v9, 0xffff0000, v84
    v_sub_f32 v8, v8, v6
    v_sub_f32 v9, v9, v6
    v_fmac_f32 v10, v8, v8
    v_fmac_f32 v11, v9, v9
    v_lshlrev_b32 v8, 16, v85
    v_and_b32 v9, 0xffff0000, v85
    v_sub_f32 v8, v8, v6
    v_sub_f32 v9, v9, v6
    v_fmac_f32 v10, v8, v8
    v_fmac_f32 v11, v9, v9
    v_lshlrev_b32 v8, 16, v86
    v_and_b32 v9, 0xffff0000, v86
    v_sub_f32 v8, v8, v6
    v_sub_f32 v9, v9, v6
    v_fmac_f32 v10, v8, v8
    v_fmac_f32 v11, v9, v9
    v_lshlrev_b32 v8, 16, v87
    v_and_b32 v9, 0xffff0000, v87
    v_sub_f32 v8, v8, v6
    v_sub_f32 v9, v9, v6
    v_fmac_f32 v10, v8, v8
    v_fmac_f32 v11, v9, v9
    v_lshlrev_b32 v8, 16, v88
    v_and_b32 v9, 0xffff0000, v88
    v_sub_f32 v8, v8, v6
    v_sub_f32 v9, v9, v6
    v_fmac_f32 v10, v8, v8
    v_fmac_f32 v11, v9, v9
    v_lshlrev_b32 v8, 16, v89
    v_and_b32 v9, 0xffff0000, v89
    v_sub_f32 v8, v8, v6
    v_sub_f32 v9, v9, v6
    v_fmac_f32 v10, v8, v8
    v_fmac_f32 v11, v9, v9
    v_lshlrev_b32 v8, 16, v90
    v_and_b32 v9, 0xffff0000, v90
    v_sub_f32 v8, v8, v6
    v_sub_f32 v9, v9, v6
    v_fmac_f32 v10, v8, v8
    v_fmac_f32 v11, v9, v9
    v_lshlrev_b32 v8, 16, v91
    v_and_b32 v9, 0xffff0000, v91
    v_sub_f32 v8, v8, v6
    v_sub_f32 v9, v9, v6
    v_fmac_f32 v10, v8, v8
    v_fmac_f32 v11, v9, v9
    v_lshlrev_b32 v8, 16, v92
    v_and_b32 v9, 0xffff0000, v92
    v_sub_f32 v8, v8, v6
    v_sub_f32 v9, v9, v6
    v_fmac_f32 v10, v8, v8
    v_fmac_f32 v11, v9, v9
    v_lshlrev_b32 v8, 16, v93
    v_and_b32 v9, 0xffff0000, v93
    v_sub_f32 v8, v8, v6
    v_sub_f32 v9, v9, v6
    v_fmac_f32 v10, v8, v8
    v_fmac_f32 v11, v9, v9
    v_lshlrev_b32 v8, 16, v94
    v_and_b32 v9, 0xffff0000, v94
    v_sub_f32 v8, v8, v6
    v_sub_f32 v9, v9, v6
    v_fmac_f32 v10, v8, v8
    v_fmac_f32 v11, v9, v9
    v_lshlrev_b32 v8, 16, v95
    v_and_b32 v9, 0xffff0000, v95
    v_sub_f32 v8, v8, v6
    v_sub_f32 v9, v9, v6
    v_fmac_f32 v10, v8, v8
    v_fmac_f32 v11, v9, v9
    v_lshlrev_b32 v8, 16, v96
    v_and_b32 v9, 0xffff0000, v96
    v_sub_f32 v8, v8, v6
    v_sub_f32 v9, v9, v6
    v_fmac_f32 v10, v8, v8
    v_fmac_f32 v11, v9, v9
    v_lshlrev_b32 v8, 16, v97
    v_and_b32 v9, 0xffff0000, v97
    v_sub_f32 v8, v8, v6
    v_sub_f32 v9, v9, v6
    v_fmac_f32 v10, v8, v8
    v_fmac_f32 v11, v9, v9
    v_lshlrev_b32 v8, 16, v98
    v_and_b32 v9, 0xffff0000, v98
    v_sub_f32 v8, v8, v6
    v_sub_f32 v9, v9, v6
    v_fmac_f32 v10, v8, v8
    v_fmac_f32 v11, v9, v9
    v_lshlrev_b32 v8, 16, v99
    v_and_b32 v9, 0xffff0000, v99
    v_sub_f32 v8, v8, v6
    v_sub_f32 v9, v9, v6
    v_fmac_f32 v10, v8, v8
    v_fmac_f32 v11, v9, v9
    v_lshlrev_b32 v8, 16, v100
    v_and_b32 v9, 0xffff0000, v100
    v_sub_f32 v8, v8, v6
    v_sub_f32 v9, v9, v6
    v_fmac_f32 v10, v8, v8
    v_fmac_f32 v11, v9, v9
    v_lshlrev_b32 v8, 16, v101
    v_and_b32 v9, 0xffff0000, v101
    v_sub_f32 v8, v8, v6
    v_sub_f32 v9, v9, v6
    v_fmac_f32 v10, v8, v8
    v_fmac_f32 v11, v9, v9
    v_lshlrev_b32 v8, 16, v102
    v_and_b32 v9, 0xffff0000, v102
    v_sub_f32 v8, v8, v6
    v_sub_f32 v9, v9, v6
    v_fmac_f32 v10, v8, v8
    v_fmac_f32 v11, v9, v9
    v_lshlrev_b32 v8, 16, v103
    v_and_b32 v9, 0xffff0000, v103
    v_sub_f32 v8, v8, v6
    v_sub_f32 v9, v9, v6
    v_fmac_f32 v10, v8, v8
    v_fmac_f32 v11, v9, v9
    v_lshlrev_b32 v8, 16, v104
    v_and_b32 v9, 0xffff0000, v104
    v_sub_f32 v8, v8, v6
    v_sub_f32 v9, v9, v6
    v_fmac_f32 v10, v8, v8
    v_fmac_f32 v11, v9, v9
    v_lshlrev_b32 v8, 16, v105
    v_and_b32 v9, 0xffff0000, v105
    v_sub_f32 v8, v8, v6
    v_sub_f32 v9, v9, v6
    v_fmac_f32 v10, v8, v8
    v_fmac_f32 v11, v9, v9
    v_lshlrev_b32 v8, 16, v106
    v_and_b32 v9, 0xffff0000, v106
    v_sub_f32 v8, v8, v6
    v_sub_f32 v9, v9, v6
    v_fmac_f32 v10, v8, v8
    v_fmac_f32 v11, v9, v9
    v_lshlrev_b32 v8, 16, v107
    v_and_b32 v9, 0xffff0000, v107
    v_sub_f32 v8, v8, v6
    v_sub_f32 v9, v9, v6
    v_fmac_f32 v10, v8, v8
    v_fmac_f32 v11, v9, v9
    v_lshlrev_b32 v8, 16, v108
    v_and_b32 v9, 0xffff0000, v108
    v_sub_f32 v8, v8, v6
    v_sub_f32 v9, v9, v6
    v_fmac_f32 v10, v8, v8
    v_fmac_f32 v11, v9, v9
    v_lshlrev_b32 v8, 16, v109
    v_and_b32 v9, 0xffff0000, v109
    v_sub_f32 v8, v8, v6
    v_sub_f32 v9, v9, v6
    v_fmac_f32 v10, v8, v8
    v_fmac_f32 v11, v9, v9
    v_lshlrev_b32 v8, 16, v110
    v_and_b32 v9, 0xffff0000, v110
    v_sub_f32 v8, v8, v6
    v_sub_f32 v9, v9, v6
    v_fmac_f32 v10, v8, v8
    v_fmac_f32 v11, v9, v9
    v_lshlrev_b32 v8, 16, v111
    v_and_b32 v9, 0xffff0000, v111
    v_sub_f32 v8, v8, v6
    v_sub_f32 v9, v9, v6
    v_fmac_f32 v10, v8, v8
    v_fmac_f32 v11, v9, v9
    v_lshlrev_b32 v8, 16, v112
    v_and_b32 v9, 0xffff0000, v112
    v_sub_f32 v8, v8, v6
    v_sub_f32 v9, v9, v6
    v_fmac_f32 v10, v8, v8
    v_fmac_f32 v11, v9, v9
    v_lshlrev_b32 v8, 16, v113
    v_and_b32 v9, 0xffff0000, v113
    v_sub_f32 v8, v8, v6
    v_sub_f32 v9, v9, v6
    v_fmac_f32 v10, v8, v8
    v_fmac_f32 v11, v9, v9
    v_lshlrev_b32 v8, 16, v114
    v_and_b32 v9, 0xffff0000, v114
    v_sub_f32 v8, v8, v6
    v_sub_f32 v9, v9, v6
    v_fmac_f32 v10, v8, v8
    v_fmac_f32 v11, v9, v9
    v_lshlrev_b32 v8, 16, v115
    v_and_b32 v9, 0xffff0000, v115
    v_sub_f32 v8, v8, v6
    v_sub_f32 v9, v9, v6
    v_fmac_f32 v10, v8, v8
    v_fmac_f32 v11, v9, v9
    v_lshlrev_b32 v8, 16, v116
    v_and_b32 v9, 0xffff0000, v116
    v_sub_f32 v8, v8, v6
    v_sub_f32 v9, v9, v6
    v_fmac_f32 v10, v8, v8
    v_fmac_f32 v11, v9, v9
    v_lshlrev_b32 v8, 16, v117
    v_and_b32 v9, 0xffff0000, v117
    v_sub_f32 v8, v8, v6
    v_sub_f32 v9, v9, v6
    v_fmac_f32 v10, v8, v8
    v_fmac_f32 v11, v9, v9
    v_lshlrev_b32 v8, 16, v118
    v_and_b32 v9, 0xffff0000, v118
    v_sub_f32 v8, v8, v6
    v_sub_f32 v9, v9, v6
    v_fmac_f32 v10, v8, v8
    v_fmac_f32 v11, v9, v9
    v_lshlrev_b32 v8, 16, v119
    v_and_b32 v9, 0xffff0000, v119
    v_sub_f32 v8, v8, v6
    v_sub_f32 v9, v9, v6
    v_fmac_f32 v10, v8, v8
    v_fmac_f32 v11, v9, v9
    v_add_f32 v10, v10, v11
    v_mov_b32 v11, v10
    s_nop 1
    v_permlane16_swap_b32 v10, v11
    s_nop 1
    v_add_f32 v10, v10, v11
    v_mov_b32 v11, v10
    s_nop 1
    v_permlane32_swap_b32 v10, v11
    s_nop 1
    v_add_f32 v10, v10, v11
    v_mov_b32 v11, 0x3727c5ac
    v_fmac_f32 v11, 0x3acccccd, v10
    v_rsq_f32 v11, v11
mega_kernel_ln1s12:
    v_mov_b32 v30, v6
    v_mov_b32 v31, v11
    s_mul_i32 s11, s2, 94208
    s_add_u32 s11, s11, 167264256
    v_lshlrev_b32 v1, 4, v0
    v_add_u32 v1, s11, v1
    v_mov_b32 v8, -1
    v_mov_b32 v9, -1
    v_mov_b32 v10, -1
    v_mov_b32 v11, -1
    s_mov_b32 s64, s60
    s_mov_b32 s65, s61
    s_mov_b32 s66, 190867456
    s_mov_b32 s67, 0x00020000
    s_mov_b32 s10, 190201856
    s_mov_b32 s12, 0
mega_kernel_clr13:
    v_subrev_u32 v5, s10, v1
    v_cmp_le_u32 vcc, 0x2800, v5
    s_and_b64 exec, exec, vcc
    buffer_store_dwordx4 v[8:11], v1, s[64:67], 0 offen sc1
    s_mov_b64 exec, -1
    v_add_u32 v1, 0x1000, v1
    s_add_u32 s12, s12, 1
    s_cmp_lt_u32 s12, 23
    s_cbranch_scc1 mega_kernel_clr13
    s_mov_b32 s66, 210792448
    s_mul_i32 s11, s2, 20480
    s_add_u32 s11, s11, 205549568
    v_lshlrev_b32 v1, 4, v0
    v_mov_b32 v8, 0
    v_mov_b32 v9, 0
    v_mov_b32 v10, 0
    v_mov_b32 v11, 0
    buffer_store_dwordx4 v[8:11], v1, s[64:67], s11 offen sc1
    s_add_u32 s11, s11, 4096
    buffer_store_dwordx4 v[8:11], v1, s[64:67], s11 offen sc1
    s_add_u32 s11, s11, 4096
    buffer_store_dwordx4 v[8:11], v1, s[64:67], s11 offen sc1
    s_add_u32 s11, s11, 4096
    buffer_store_dwordx4 v[8:11], v1, s[64:67], s11 offen sc1
    s_add_u32 s11, s11, 4096
    buffer_store_dwordx4 v[8:11], v1, s[64:67], s11 offen sc1
    s_add_u32 s11, s11, 4096
    s_cmp_lg_u32 s2, 0
    s_cbranch_scc1 mega_kernel_clr014
    s_mov_b32 s11, 204500992
    buffer_store_dwordx4 v[8:11], v1, s[60:63], s11 offen sc1
    s_load_dwordx2 s[6:7], s[0:1], 8
    s_waitcnt lgkmcnt(0)
    s_mov_b32 s64, s6
    s_and_b32 s65, s7, 0xffff
    s_mov_b32 s66, 10240
    s_mov_b32 s67, 0x00020000
    v_add_u32 v8, 0, v0
    v_lshlrev_b32 v9, 4, v8
    buffer_load_dwordx4 v[12:15], v9, s[64:67], 0 offen
    v_mul_u32_u24 v10, 205, v8
    v_lshrrev_b32 v10, 14, v10
    v_mul_u32_u24 v11, 80, v10
    v_sub_u32 v11, v8, v11
    v_lshrrev_b32 v16, 1, v11
    v_and_b32 v17, 1, v11
    v_lshlrev_b32 v16, 8, v16
    v_lshl_add_u32 v16, v10, 5, v16
    v_lshl_add_u32 v16, v17, 4, v16
    v_cmp_gt_u32 vcc, 640, v8
    s_and_b64 exec, exec, vcc
    s_waitcnt vmcnt(0)
    buffer_store_dwordx4 v[12:15], v16, s[60:63], s10 offen sc1
    s_mov_b64 exec, -1
    s_nop 1
    v_add_u32 v8, 256, v0
    v_lshlrev_b32 v9, 4, v8
    buffer_load_dwordx4 v[12:15], v9, s[64:67], 0 offen
    v_mul_u32_u24 v10, 205, v8
    v_lshrrev_b32 v10, 14, v10
    v_mul_u32_u24 v11, 80, v10
    v_sub_u32 v11, v8, v11
    v_lshrrev_b32 v16, 1, v11
    v_and_b32 v17, 1, v11
    v_lshlrev_b32 v16, 8, v16
    v_lshl_add_u32 v16, v10, 5, v16
    v_lshl_add_u32 v16, v17, 4, v16
    v_cmp_gt_u32 vcc, 640, v8
    s_and_b64 exec, exec, vcc
    s_waitcnt vmcnt(0)
    buffer_store_dwordx4 v[12:15], v16, s[60:63], s10 offen sc1
    s_mov_b64 exec, -1
    s_nop 1
    v_add_u32 v8, 512, v0
    v_lshlrev_b32 v9, 4, v8
    buffer_load_dwordx4 v[12:15], v9, s[64:67], 0 offen
    v_mul_u32_u24 v10, 205, v8
    v_lshrrev_b32 v10, 14, v10
    v_mul_u32_u24 v11, 80, v10
    v_sub_u32 v11, v8, v11
    v_lshrrev_b32 v16, 1, v11
    v_and_b32 v17, 1, v11
    v_lshlrev_b32 v16, 8, v16
    v_lshl_add_u32 v16, v10, 5, v16
    v_lshl_add_u32 v16, v17, 4, v16
    v_cmp_gt_u32 vcc, 640, v8
    s_and_b64 exec, exec, vcc
    s_waitcnt vmcnt(0)
    buffer_store_dwordx4 v[12:15], v16, s[60:63], s10 offen sc1
    s_mov_b64 exec, -1
    s_nop 1
mega_kernel_clr014:
    s_waitcnt vmcnt(0)
    s_barrier
    s_cmp_lg_u32 s74, 0
    s_cbranch_scc1 mega_kernel_ca15
    v_mov_b32 v5, 1
    v_mov_b32 v6, 192
    s_mov_b64 exec, 1
    buffer_atomic_add v5, v6, s[88:91], 0 offen sc1
    s_mov_b64 exec, -1
mega_kernel_ca15:
    v_mov_b32 v6, v30
    v_mov_b32 v11, v31
    s_cmp_ge_u32 s98, 128
    s_cbranch_scc1 mega_kernel_ln1s216
    v_mov_b32 v15, 128
    s_mov_b32 s69, 0
mega_kernel_cw17:
    buffer_load_dword v14, v15, s[88:91], 0 offen sc1
    s_add_u32 s69, s69, 1
    s_cmp_ge_u32 s69, 1048576
    s_cbranch_scc1 mega_kernel_cwo18
    s_waitcnt vmcnt(0)
    v_cmp_gt_u32 vcc, 30, v14
    s_cbranch_vccz mega_kernel_cwo18
    s_sleep 8
    s_branch mega_kernel_cw17
mega_kernel_cwo18:
    v_lshlrev_b32 v12, 5, v4
    s_mul_i32 s3, s98, 20480
    s_add_u32 s3, s3, 16384
    v_lshlrev_b32 v13, 4, v2
    buffer_load_dwordx4 a[0:3], v12, s[60:63], 0 offen offset:0
    buffer_load_dwordx4 a[4:7], v12, s[60:63], 0 offen offset:16
    s_mov_b32 s71, 2560
    buffer_load_dwordx4 a[8:11], v12, s[60:63], s71 offen
    buffer_load_dwordx4 a[12:15], v12, s[60:63], s71 offen offset:16
    buffer_load_dwordx4 a[16:19], v12, s[60:63], 0 offen offset:128
    buffer_load_dwordx4 a[20:23], v12, s[60:63], 0 offen offset:144
    s_mov_b32 s71, 2688
    buffer_load_dwordx4 a[24:27], v12, s[60:63], s71 offen
    buffer_load_dwordx4 a[28:31], v12, s[60:63], s71 offen offset:16
    buffer_load_dwordx4 a[32:35], v12, s[60:63], 0 offen offset:256
    buffer_load_dwordx4 a[36:39], v12, s[60:63], 0 offen offset:272
    s_mov_b32 s71, 2816
    buffer_load_dwordx4 a[40:43], v12, s[60:63], s71 offen
    buffer_load_dwordx4 a[44:47], v12, s[60:63], s71 offen offset:16
    buffer_load_dwordx4 a[48:51], v12, s[60:63], 0 offen offset:384
    buffer_load_dwordx4 a[52:55], v12, s[60:63], 0 offen offset:400
    s_mov_b32 s71, 2944
    buffer_load_dwordx4 a[56:59], v12, s[60:63], s71 offen
    buffer_load_dwordx4 a[60:63], v12, s[60:63], s71 offen offset:16
    buffer_load_dwordx4 a[64:67], v12, s[60:63], 0 offen offset:512
    buffer_load_dwordx4 a[68:71], v12, s[60:63], 0 offen offset:528
    s_mov_b32 s71, 3072
    buffer_load_dwordx4 a[72:75], v12, s[60:63], s71 offen
    buffer_load_dwordx4 a[76:79], v12, s[60:63], s71 offen offset:16
    buffer_load_dwordx4 a[80:83], v12, s[60:63], 0 offen offset:640
    buffer_load_dwordx4 a[84:87], v12, s[60:63], 0 offen offset:656
    s_mov_b32 s71, 3200
    buffer_load_dwordx4 a[88:91], v12, s[60:63], s71 offen
    buffer_load_dwordx4 a[92:95], v12, s[60:63], s71 offen offset:16
    buffer_load_dwordx4 a[96:99], v12, s[60:63], 0 offen offset:768
    buffer_load_dwordx4 a[100:103], v12, s[60:63], 0 offen offset:784
    s_mov_b32 s71, 3328
    buffer_load_dwordx4 a[104:107], v12, s[60:63], s71 offen
    buffer_load_dwordx4 a[108:111], v12, s[60:63], s71 offen offset:16
    buffer_load_dwordx4 a[112:115], v12, s[60:63], 0 offen offset:896
    buffer_load_dwordx4 a[116:119], v12, s[60:63], 0 offen offset:912
    s_mov_b32 s71, 3456
    buffer_load_dwordx4 a[120:123], v12, s[60:63], s71 offen
    buffer_load_dwordx4 a[124:127], v12, s[60:63], s71 offen offset:16
    buffer_load_dwordx4 a[128:131], v12, s[60:63], 0 offen offset:1024
    buffer_load_dwordx4 a[132:135], v12, s[60:63], 0 offen offset:1040
    s_mov_b32 s71, 3584
    buffer_load_dwordx4 a[136:139], v12, s[60:63], s71 offen
    buffer_load_dwordx4 a[140:143], v12, s[60:63], s71 offen offset:16
    buffer_load_dwordx4 a[144:147], v12, s[60:63], 0 offen offset:1152
    buffer_load_dwordx4 a[148:151], v12, s[60:63], 0 offen offset:1168
    s_mov_b32 s71, 3712
    buffer_load_dwordx4 a[152:155], v12, s[60:63], s71 offen
    buffer_load_dwordx4 a[156:159], v12, s[60:63], s71 offen offset:16
    buffer_load_dwordx4 a[160:163], v12, s[60:63], 0 offen offset:1280
    buffer_load_dwordx4 a[164:167], v12, s[60:63], 0 offen offset:1296
    s_mov_b32 s71, 3840
    buffer_load_dwordx4 a[168:171], v12, s[60:63], s71 offen
    buffer_load_dwordx4 a[172:175], v12, s[60:63], s71 offen offset:16
    buffer_load_dwordx4 a[176:179], v12, s[60:63], 0 offen offset:1408
    buffer_load_dwordx4 a[180:183], v12, s[60:63], 0 offen offset:1424
    s_mov_b32 s71, 3968
    buffer_load_dwordx4 a[184:187], v12, s[60:63], s71 offen
    buffer_load_dwordx4 a[188:191], v12, s[60:63], s71 offen offset:16
    buffer_load_dwordx4 a[192:195], v12, s[60:63], 0 offen offset:1536
    buffer_load_dwordx4 a[196:199], v12, s[60:63], 0 offen offset:1552
    s_mov_b32 s71, 4096
    buffer_load_dwordx4 a[200:203], v12, s[60:63], s71 offen
    buffer_load_dwordx4 a[204:207], v12, s[60:63], s71 offen offset:16
    buffer_load_dwordx4 a[208:211], v12, s[60:63], 0 offen offset:1664
    buffer_load_dwordx4 a[212:215], v12, s[60:63], 0 offen offset:1680
    s_mov_b32 s71, 4224
    buffer_load_dwordx4 a[216:219], v12, s[60:63], s71 offen
    buffer_load_dwordx4 a[220:223], v12, s[60:63], s71 offen offset:16
    buffer_load_dwordx4 a[224:227], v12, s[60:63], 0 offen offset:1792
    buffer_load_dwordx4 a[228:231], v12, s[60:63], 0 offen offset:1808
    s_mov_b32 s71, 4352
    buffer_load_dwordx4 a[232:235], v12, s[60:63], s71 offen
    buffer_load_dwordx4 a[236:239], v12, s[60:63], s71 offen offset:16
    buffer_load_dwordx4 a[240:243], v12, s[60:63], 0 offen offset:1920
    buffer_load_dwordx4 a[244:247], v12, s[60:63], 0 offen offset:1936
    s_mov_b32 s71, 4480
    buffer_load_dwordx4 a[248:251], v12, s[60:63], s71 offen
    buffer_load_dwordx4 a[252:255], v12, s[60:63], s71 offen offset:16
    buffer_load_dwordx4 v[120:123], v12, s[60:63], 0 offen offset:2048
    buffer_load_dwordx4 v[124:127], v12, s[60:63], 0 offen offset:2064
    s_mov_b32 s71, 4608
    buffer_load_dwordx4 v[128:131], v12, s[60:63], s71 offen
    buffer_load_dwordx4 v[132:135], v12, s[60:63], s71 offen offset:16
    buffer_load_dwordx4 v[136:139], v12, s[60:63], 0 offen offset:2176
    buffer_load_dwordx4 v[140:143], v12, s[60:63], 0 offen offset:2192
    s_mov_b32 s71, 4736
    buffer_load_dwordx4 v[144:147], v12, s[60:63], s71 offen
    buffer_load_dwordx4 v[148:151], v12, s[60:63], s71 offen offset:16
    buffer_load_dwordx4 v[152:155], v12, s[60:63], 0 offen offset:2304
    buffer_load_dwordx4 v[156:159], v12, s[60:63], 0 offen offset:2320
    s_mov_b32 s71, 4864
    buffer_load_dwordx4 v[160:163], v12, s[60:63], s71 offen
    buffer_load_dwordx4 v[164:167], v12, s[60:63], s71 offen offset:16
    buffer_load_dwordx4 v[168:171], v12, s[60:63], 0 offen offset:2432
    buffer_load_dwordx4 v[172:175], v12, s[60:63], 0 offen offset:2448
    s_mov_b32 s71, 4992
    buffer_load_dwordx4 v[176:179], v12, s[60:63], s71 offen
    buffer_load_dwordx4 v[180:183], v12, s[60:63], s71 offen offset:16
    s_waitcnt vmcnt(0)
    v_lshlrev_b32 v8, 16, v40
    v_and_b32 v9, 0xffff0000, v40
    v_accvgpr_read_b32 v16, a0
    v_accvgpr_read_b32 v17, a1
    v_accvgpr_read_b32 v18, a8
    v_accvgpr_read_b32 v19, a9
    v_sub_f32 v8, v8, v6
    v_sub_f32 v9, v9, v6
    v_mul_f32 v8, v8, v11
    v_mul_f32 v9, v9, v11
    v_fma_f32 v8, v8, v18, v16
    v_fma_f32 v9, v9, v19, v17
    v_cvt_pk_bf16_f32 v40, v8, v9
    v_lshlrev_b32 v8, 16, v41
    v_and_b32 v9, 0xffff0000, v41
    v_accvgpr_read_b32 v16, a2
    v_accvgpr_read_b32 v17, a3
    v_accvgpr_read_b32 v18, a10
    v_accvgpr_read_b32 v19, a11
    v_sub_f32 v8, v8, v6
    v_sub_f32 v9, v9, v6
    v_mul_f32 v8, v8, v11
    v_mul_f32 v9, v9, v11
    v_fma_f32 v8, v8, v18, v16
    v_fma_f32 v9, v9, v19, v17
    v_cvt_pk_bf16_f32 v41, v8, v9
    v_lshlrev_b32 v8, 16, v42
    v_and_b32 v9, 0xffff0000, v42
    v_accvgpr_read_b32 v16, a4
    v_accvgpr_read_b32 v17, a5
    v_accvgpr_read_b32 v18, a12
    v_accvgpr_read_b32 v19, a13
    v_sub_f32 v8, v8, v6
    v_sub_f32 v9, v9, v6
    v_mul_f32 v8, v8, v11
    v_mul_f32 v9, v9, v11
    v_fma_f32 v8, v8, v18, v16
    v_fma_f32 v9, v9, v19, v17
    v_cvt_pk_bf16_f32 v42, v8, v9
    v_lshlrev_b32 v8, 16, v43
    v_and_b32 v9, 0xffff0000, v43
    v_accvgpr_read_b32 v16, a6
    v_accvgpr_read_b32 v17, a7
    v_accvgpr_read_b32 v18, a14
    v_accvgpr_read_b32 v19, a15
    v_sub_f32 v8, v8, v6
    v_sub_f32 v9, v9, v6
    v_mul_f32 v8, v8, v11
    v_mul_f32 v9, v9, v11
    v_fma_f32 v8, v8, v18, v16
    v_fma_f32 v9, v9, v19, v17
    v_cvt_pk_bf16_f32 v43, v8, v9
    buffer_store_dwordx4 v[40:43], v13, s[60:63], s3 offen sc1
    s_add_u32 s3, s3, 1024
    v_lshlrev_b32 v8, 16, v44
    v_and_b32 v9, 0xffff0000, v44
    v_accvgpr_read_b32 v16, a16
    v_accvgpr_read_b32 v17, a17
    v_accvgpr_read_b32 v18, a24
    v_accvgpr_read_b32 v19, a25
    v_sub_f32 v8, v8, v6
    v_sub_f32 v9, v9, v6
    v_mul_f32 v8, v8, v11
    v_mul_f32 v9, v9, v11
    v_fma_f32 v8, v8, v18, v16
    v_fma_f32 v9, v9, v19, v17
    v_cvt_pk_bf16_f32 v44, v8, v9
    v_lshlrev_b32 v8, 16, v45
    v_and_b32 v9, 0xffff0000, v45
    v_accvgpr_read_b32 v16, a18
    v_accvgpr_read_b32 v17, a19
    v_accvgpr_read_b32 v18, a26
    v_accvgpr_read_b32 v19, a27
    v_sub_f32 v8, v8, v6
    v_sub_f32 v9, v9, v6
    v_mul_f32 v8, v8, v11
    v_mul_f32 v9, v9, v11
    v_fma_f32 v8, v8, v18, v16
    v_fma_f32 v9, v9, v19, v17
    v_cvt_pk_bf16_f32 v45, v8, v9
    v_lshlrev_b32 v8, 16, v46
    v_and_b32 v9, 0xffff0000, v46
    v_accvgpr_read_b32 v16, a20
    v_accvgpr_read_b32 v17, a21
    v_accvgpr_read_b32 v18, a28
    v_accvgpr_read_b32 v19, a29
    v_sub_f32 v8, v8, v6
    v_sub_f32 v9, v9, v6
    v_mul_f32 v8, v8, v11
    v_mul_f32 v9, v9, v11
    v_fma_f32 v8, v8, v18, v16
    v_fma_f32 v9, v9, v19, v17
    v_cvt_pk_bf16_f32 v46, v8, v9
    v_lshlrev_b32 v8, 16, v47
    v_and_b32 v9, 0xffff0000, v47
    v_accvgpr_read_b32 v16, a22
    v_accvgpr_read_b32 v17, a23
    v_accvgpr_read_b32 v18, a30
    v_accvgpr_read_b32 v19, a31
    v_sub_f32 v8, v8, v6
    v_sub_f32 v9, v9, v6
    v_mul_f32 v8, v8, v11
    v_mul_f32 v9, v9, v11
    v_fma_f32 v8, v8, v18, v16
    v_fma_f32 v9, v9, v19, v17
    v_cvt_pk_bf16_f32 v47, v8, v9
    buffer_store_dwordx4 v[44:47], v13, s[60:63], s3 offen sc1
    s_add_u32 s3, s3, 1024
    v_lshlrev_b32 v8, 16, v48
    v_and_b32 v9, 0xffff0000, v48
    v_accvgpr_read_b32 v16, a32
    v_accvgpr_read_b32 v17, a33
    v_accvgpr_read_b32 v18, a40
    v_accvgpr_read_b32 v19, a41
    v_sub_f32 v8, v8, v6
    v_sub_f32 v9, v9, v6
    v_mul_f32 v8, v8, v11
    v_mul_f32 v9, v9, v11
    v_fma_f32 v8, v8, v18, v16
    v_fma_f32 v9, v9, v19, v17
    v_cvt_pk_bf16_f32 v48, v8, v9
    v_lshlrev_b32 v8, 16, v49
    v_and_b32 v9, 0xffff0000, v49
    v_accvgpr_read_b32 v16, a34
    v_accvgpr_read_b32 v17, a35
    v_accvgpr_read_b32 v18, a42
    v_accvgpr_read_b32 v19, a43
    v_sub_f32 v8, v8, v6
    v_sub_f32 v9, v9, v6
    v_mul_f32 v8, v8, v11
    v_mul_f32 v9, v9, v11
    v_fma_f32 v8, v8, v18, v16
    v_fma_f32 v9, v9, v19, v17
    v_cvt_pk_bf16_f32 v49, v8, v9
    v_lshlrev_b32 v8, 16, v50
    v_and_b32 v9, 0xffff0000, v50
    v_accvgpr_read_b32 v16, a36
    v_accvgpr_read_b32 v17, a37
    v_accvgpr_read_b32 v18, a44
    v_accvgpr_read_b32 v19, a45
    v_sub_f32 v8, v8, v6
    v_sub_f32 v9, v9, v6
    v_mul_f32 v8, v8, v11
    v_mul_f32 v9, v9, v11
    v_fma_f32 v8, v8, v18, v16
    v_fma_f32 v9, v9, v19, v17
    v_cvt_pk_bf16_f32 v50, v8, v9
    v_lshlrev_b32 v8, 16, v51
    v_and_b32 v9, 0xffff0000, v51
    v_accvgpr_read_b32 v16, a38
    v_accvgpr_read_b32 v17, a39
    v_accvgpr_read_b32 v18, a46
    v_accvgpr_read_b32 v19, a47
    v_sub_f32 v8, v8, v6
    v_sub_f32 v9, v9, v6
    v_mul_f32 v8, v8, v11
    v_mul_f32 v9, v9, v11
    v_fma_f32 v8, v8, v18, v16
    v_fma_f32 v9, v9, v19, v17
    v_cvt_pk_bf16_f32 v51, v8, v9
    buffer_store_dwordx4 v[48:51], v13, s[60:63], s3 offen sc1
    s_add_u32 s3, s3, 1024
    v_lshlrev_b32 v8, 16, v52
    v_and_b32 v9, 0xffff0000, v52
    v_accvgpr_read_b32 v16, a48
    v_accvgpr_read_b32 v17, a49
    v_accvgpr_read_b32 v18, a56
    v_accvgpr_read_b32 v19, a57
    v_sub_f32 v8, v8, v6
    v_sub_f32 v9, v9, v6
    v_mul_f32 v8, v8, v11
    v_mul_f32 v9, v9, v11
    v_fma_f32 v8, v8, v18, v16
    v_fma_f32 v9, v9, v19, v17
    v_cvt_pk_bf16_f32 v52, v8, v9
    v_lshlrev_b32 v8, 16, v53
    v_and_b32 v9, 0xffff0000, v53
    v_accvgpr_read_b32 v16, a50
    v_accvgpr_read_b32 v17, a51
    v_accvgpr_read_b32 v18, a58
    v_accvgpr_read_b32 v19, a59
    v_sub_f32 v8, v8, v6
    v_sub_f32 v9, v9, v6
    v_mul_f32 v8, v8, v11
    v_mul_f32 v9, v9, v11
    v_fma_f32 v8, v8, v18, v16
    v_fma_f32 v9, v9, v19, v17
    v_cvt_pk_bf16_f32 v53, v8, v9
    v_lshlrev_b32 v8, 16, v54
    v_and_b32 v9, 0xffff0000, v54
    v_accvgpr_read_b32 v16, a52
    v_accvgpr_read_b32 v17, a53
    v_accvgpr_read_b32 v18, a60
    v_accvgpr_read_b32 v19, a61
    v_sub_f32 v8, v8, v6
    v_sub_f32 v9, v9, v6
    v_mul_f32 v8, v8, v11
    v_mul_f32 v9, v9, v11
    v_fma_f32 v8, v8, v18, v16
    v_fma_f32 v9, v9, v19, v17
    v_cvt_pk_bf16_f32 v54, v8, v9
    v_lshlrev_b32 v8, 16, v55
    v_and_b32 v9, 0xffff0000, v55
    v_accvgpr_read_b32 v16, a54
    v_accvgpr_read_b32 v17, a55
    v_accvgpr_read_b32 v18, a62
    v_accvgpr_read_b32 v19, a63
    v_sub_f32 v8, v8, v6
    v_sub_f32 v9, v9, v6
    v_mul_f32 v8, v8, v11
    v_mul_f32 v9, v9, v11
    v_fma_f32 v8, v8, v18, v16
    v_fma_f32 v9, v9, v19, v17
    v_cvt_pk_bf16_f32 v55, v8, v9
    buffer_store_dwordx4 v[52:55], v13, s[60:63], s3 offen sc1
    s_add_u32 s3, s3, 1024
    v_lshlrev_b32 v8, 16, v56
    v_and_b32 v9, 0xffff0000, v56
    v_accvgpr_read_b32 v16, a64
    v_accvgpr_read_b32 v17, a65
    v_accvgpr_read_b32 v18, a72
    v_accvgpr_read_b32 v19, a73
    v_sub_f32 v8, v8, v6
    v_sub_f32 v9, v9, v6
    v_mul_f32 v8, v8, v11
    v_mul_f32 v9, v9, v11
    v_fma_f32 v8, v8, v18, v16
    v_fma_f32 v9, v9, v19, v17
    v_cvt_pk_bf16_f32 v56, v8, v9
    v_lshlrev_b32 v8, 16, v57
    v_and_b32 v9, 0xffff0000, v57
    v_accvgpr_read_b32 v16, a66
    v_accvgpr_read_b32 v17, a67
    v_accvgpr_read_b32 v18, a74
    v_accvgpr_read_b32 v19, a75
    v_sub_f32 v8, v8, v6
    v_sub_f32 v9, v9, v6
    v_mul_f32 v8, v8, v11
    v_mul_f32 v9, v9, v11
    v_fma_f32 v8, v8, v18, v16
    v_fma_f32 v9, v9, v19, v17
    v_cvt_pk_bf16_f32 v57, v8, v9
    v_lshlrev_b32 v8, 16, v58
    v_and_b32 v9, 0xffff0000, v58
    v_accvgpr_read_b32 v16, a68
    v_accvgpr_read_b32 v17, a69
    v_accvgpr_read_b32 v18, a76
    v_accvgpr_read_b32 v19, a77
    v_sub_f32 v8, v8, v6
    v_sub_f32 v9, v9, v6
    v_mul_f32 v8, v8, v11
    v_mul_f32 v9, v9, v11
    v_fma_f32 v8, v8, v18, v16
    v_fma_f32 v9, v9, v19, v17
    v_cvt_pk_bf16_f32 v58, v8, v9
    v_lshlrev_b32 v8, 16, v59
    v_and_b32 v9, 0xffff0000, v59
    v_accvgpr_read_b32 v16, a70
    v_accvgpr_read_b32 v17, a71
    v_accvgpr_read_b32 v18, a78
    v_accvgpr_read_b32 v19, a79
    v_sub_f32 v8, v8, v6
    v_sub_f32 v9, v9, v6
    v_mul_f32 v8, v8, v11
    v_mul_f32 v9, v9, v11
    v_fma_f32 v8, v8, v18, v16
    v_fma_f32 v9, v9, v19, v17
    v_cvt_pk_bf16_f32 v59, v8, v9
    buffer_store_dwordx4 v[56:59], v13, s[60:63], s3 offen sc1
    s_add_u32 s3, s3, 1024
    v_lshlrev_b32 v8, 16, v60
    v_and_b32 v9, 0xffff0000, v60
    v_accvgpr_read_b32 v16, a80
    v_accvgpr_read_b32 v17, a81
    v_accvgpr_read_b32 v18, a88
    v_accvgpr_read_b32 v19, a89
    v_sub_f32 v8, v8, v6
    v_sub_f32 v9, v9, v6
    v_mul_f32 v8, v8, v11
    v_mul_f32 v9, v9, v11
    v_fma_f32 v8, v8, v18, v16
    v_fma_f32 v9, v9, v19, v17
    v_cvt_pk_bf16_f32 v60, v8, v9
    v_lshlrev_b32 v8, 16, v61
    v_and_b32 v9, 0xffff0000, v61
    v_accvgpr_read_b32 v16, a82
    v_accvgpr_read_b32 v17, a83
    v_accvgpr_read_b32 v18, a90
    v_accvgpr_read_b32 v19, a91
    v_sub_f32 v8, v8, v6
    v_sub_f32 v9, v9, v6
    v_mul_f32 v8, v8, v11
    v_mul_f32 v9, v9, v11
    v_fma_f32 v8, v8, v18, v16
    v_fma_f32 v9, v9, v19, v17
    v_cvt_pk_bf16_f32 v61, v8, v9
    v_lshlrev_b32 v8, 16, v62
    v_and_b32 v9, 0xffff0000, v62
    v_accvgpr_read_b32 v16, a84
    v_accvgpr_read_b32 v17, a85
    v_accvgpr_read_b32 v18, a92
    v_accvgpr_read_b32 v19, a93
    v_sub_f32 v8, v8, v6
    v_sub_f32 v9, v9, v6
    v_mul_f32 v8, v8, v11
    v_mul_f32 v9, v9, v11
    v_fma_f32 v8, v8, v18, v16
    v_fma_f32 v9, v9, v19, v17
    v_cvt_pk_bf16_f32 v62, v8, v9
    v_lshlrev_b32 v8, 16, v63
    v_and_b32 v9, 0xffff0000, v63
    v_accvgpr_read_b32 v16, a86
    v_accvgpr_read_b32 v17, a87
    v_accvgpr_read_b32 v18, a94
    v_accvgpr_read_b32 v19, a95
    v_sub_f32 v8, v8, v6
    v_sub_f32 v9, v9, v6
    v_mul_f32 v8, v8, v11
    v_mul_f32 v9, v9, v11
    v_fma_f32 v8, v8, v18, v16
    v_fma_f32 v9, v9, v19, v17
    v_cvt_pk_bf16_f32 v63, v8, v9
    buffer_store_dwordx4 v[60:63], v13, s[60:63], s3 offen sc1
    s_add_u32 s3, s3, 1024
    v_lshlrev_b32 v8, 16, v64
    v_and_b32 v9, 0xffff0000, v64
    v_accvgpr_read_b32 v16, a96
    v_accvgpr_read_b32 v17, a97
    v_accvgpr_read_b32 v18, a104
    v_accvgpr_read_b32 v19, a105
    v_sub_f32 v8, v8, v6
    v_sub_f32 v9, v9, v6
    v_mul_f32 v8, v8, v11
    v_mul_f32 v9, v9, v11
    v_fma_f32 v8, v8, v18, v16
    v_fma_f32 v9, v9, v19, v17
    v_cvt_pk_bf16_f32 v64, v8, v9
    v_lshlrev_b32 v8, 16, v65
    v_and_b32 v9, 0xffff0000, v65
    v_accvgpr_read_b32 v16, a98
    v_accvgpr_read_b32 v17, a99
    v_accvgpr_read_b32 v18, a106
    v_accvgpr_read_b32 v19, a107
    v_sub_f32 v8, v8, v6
    v_sub_f32 v9, v9, v6
    v_mul_f32 v8, v8, v11
    v_mul_f32 v9, v9, v11
    v_fma_f32 v8, v8, v18, v16
    v_fma_f32 v9, v9, v19, v17
    v_cvt_pk_bf16_f32 v65, v8, v9
    v_lshlrev_b32 v8, 16, v66
    v_and_b32 v9, 0xffff0000, v66
    v_accvgpr_read_b32 v16, a100
    v_accvgpr_read_b32 v17, a101
    v_accvgpr_read_b32 v18, a108
    v_accvgpr_read_b32 v19, a109
    v_sub_f32 v8, v8, v6
    v_sub_f32 v9, v9, v6
    v_mul_f32 v8, v8, v11
    v_mul_f32 v9, v9, v11
    v_fma_f32 v8, v8, v18, v16
    v_fma_f32 v9, v9, v19, v17
    v_cvt_pk_bf16_f32 v66, v8, v9
    v_lshlrev_b32 v8, 16, v67
    v_and_b32 v9, 0xffff0000, v67
    v_accvgpr_read_b32 v16, a102
    v_accvgpr_read_b32 v17, a103
    v_accvgpr_read_b32 v18, a110
    v_accvgpr_read_b32 v19, a111
    v_sub_f32 v8, v8, v6
    v_sub_f32 v9, v9, v6
    v_mul_f32 v8, v8, v11
    v_mul_f32 v9, v9, v11
    v_fma_f32 v8, v8, v18, v16
    v_fma_f32 v9, v9, v19, v17
    v_cvt_pk_bf16_f32 v67, v8, v9
    buffer_store_dwordx4 v[64:67], v13, s[60:63], s3 offen sc1
    s_add_u32 s3, s3, 1024
    v_lshlrev_b32 v8, 16, v68
    v_and_b32 v9, 0xffff0000, v68
    v_accvgpr_read_b32 v16, a112
    v_accvgpr_read_b32 v17, a113
    v_accvgpr_read_b32 v18, a120
    v_accvgpr_read_b32 v19, a121
    v_sub_f32 v8, v8, v6
    v_sub_f32 v9, v9, v6
    v_mul_f32 v8, v8, v11
    v_mul_f32 v9, v9, v11
    v_fma_f32 v8, v8, v18, v16
    v_fma_f32 v9, v9, v19, v17
    v_cvt_pk_bf16_f32 v68, v8, v9
    v_lshlrev_b32 v8, 16, v69
    v_and_b32 v9, 0xffff0000, v69
    v_accvgpr_read_b32 v16, a114
    v_accvgpr_read_b32 v17, a115
    v_accvgpr_read_b32 v18, a122
    v_accvgpr_read_b32 v19, a123
    v_sub_f32 v8, v8, v6
    v_sub_f32 v9, v9, v6
    v_mul_f32 v8, v8, v11
    v_mul_f32 v9, v9, v11
    v_fma_f32 v8, v8, v18, v16
    v_fma_f32 v9, v9, v19, v17
    v_cvt_pk_bf16_f32 v69, v8, v9
    v_lshlrev_b32 v8, 16, v70
    v_and_b32 v9, 0xffff0000, v70
    v_accvgpr_read_b32 v16, a116
    v_accvgpr_read_b32 v17, a117
    v_accvgpr_read_b32 v18, a124
    v_accvgpr_read_b32 v19, a125
    v_sub_f32 v8, v8, v6
    v_sub_f32 v9, v9, v6
    v_mul_f32 v8, v8, v11
    v_mul_f32 v9, v9, v11
    v_fma_f32 v8, v8, v18, v16
    v_fma_f32 v9, v9, v19, v17
    v_cvt_pk_bf16_f32 v70, v8, v9
    v_lshlrev_b32 v8, 16, v71
    v_and_b32 v9, 0xffff0000, v71
    v_accvgpr_read_b32 v16, a118
    v_accvgpr_read_b32 v17, a119
    v_accvgpr_read_b32 v18, a126
    v_accvgpr_read_b32 v19, a127
    v_sub_f32 v8, v8, v6
    v_sub_f32 v9, v9, v6
    v_mul_f32 v8, v8, v11
    v_mul_f32 v9, v9, v11
    v_fma_f32 v8, v8, v18, v16
    v_fma_f32 v9, v9, v19, v17
    v_cvt_pk_bf16_f32 v71, v8, v9
    buffer_store_dwordx4 v[68:71], v13, s[60:63], s3 offen sc1
    s_add_u32 s3, s3, 1024
    v_lshlrev_b32 v8, 16, v72
    v_and_b32 v9, 0xffff0000, v72
    v_accvgpr_read_b32 v16, a128
    v_accvgpr_read_b32 v17, a129
    v_accvgpr_read_b32 v18, a136
    v_accvgpr_read_b32 v19, a137
    v_sub_f32 v8, v8, v6
    v_sub_f32 v9, v9, v6
    v_mul_f32 v8, v8, v11
    v_mul_f32 v9, v9, v11
    v_fma_f32 v8, v8, v18, v16
    v_fma_f32 v9, v9, v19, v17
    v_cvt_pk_bf16_f32 v72, v8, v9
    v_lshlrev_b32 v8, 16, v73
    v_and_b32 v9, 0xffff0000, v73
    v_accvgpr_read_b32 v16, a130
    v_accvgpr_read_b32 v17, a131
    v_accvgpr_read_b32 v18, a138
    v_accvgpr_read_b32 v19, a139
    v_sub_f32 v8, v8, v6
    v_sub_f32 v9, v9, v6
    v_mul_f32 v8, v8, v11
    v_mul_f32 v9, v9, v11
    v_fma_f32 v8, v8, v18, v16
    v_fma_f32 v9, v9, v19, v17
    v_cvt_pk_bf16_f32 v73, v8, v9
    v_lshlrev_b32 v8, 16, v74
    v_and_b32 v9, 0xffff0000, v74
    v_accvgpr_read_b32 v16, a132
    v_accvgpr_read_b32 v17, a133
    v_accvgpr_read_b32 v18, a140
    v_accvgpr_read_b32 v19, a141
    v_sub_f32 v8, v8, v6
    v_sub_f32 v9, v9, v6
    v_mul_f32 v8, v8, v11
    v_mul_f32 v9, v9, v11
    v_fma_f32 v8, v8, v18, v16
    v_fma_f32 v9, v9, v19, v17
    v_cvt_pk_bf16_f32 v74, v8, v9
    v_lshlrev_b32 v8, 16, v75
    v_and_b32 v9, 0xffff0000, v75
    v_accvgpr_read_b32 v16, a134
    v_accvgpr_read_b32 v17, a135
    v_accvgpr_read_b32 v18, a142
    v_accvgpr_read_b32 v19, a143
    v_sub_f32 v8, v8, v6
    v_sub_f32 v9, v9, v6
    v_mul_f32 v8, v8, v11
    v_mul_f32 v9, v9, v11
    v_fma_f32 v8, v8, v18, v16
    v_fma_f32 v9, v9, v19, v17
    v_cvt_pk_bf16_f32 v75, v8, v9
    buffer_store_dwordx4 v[72:75], v13, s[60:63], s3 offen sc1
    s_add_u32 s3, s3, 1024
    v_lshlrev_b32 v8, 16, v76
    v_and_b32 v9, 0xffff0000, v76
    v_accvgpr_read_b32 v16, a144
    v_accvgpr_read_b32 v17, a145
    v_accvgpr_read_b32 v18, a152
    v_accvgpr_read_b32 v19, a153
    v_sub_f32 v8, v8, v6
    v_sub_f32 v9, v9, v6
    v_mul_f32 v8, v8, v11
    v_mul_f32 v9, v9, v11
    v_fma_f32 v8, v8, v18, v16
    v_fma_f32 v9, v9, v19, v17
    v_cvt_pk_bf16_f32 v76, v8, v9
    v_lshlrev_b32 v8, 16, v77
    v_and_b32 v9, 0xffff0000, v77
    v_accvgpr_read_b32 v16, a146
    v_accvgpr_read_b32 v17, a147
    v_accvgpr_read_b32 v18, a154
    v_accvgpr_read_b32 v19, a155
    v_sub_f32 v8, v8, v6
    v_sub_f32 v9, v9, v6
    v_mul_f32 v8, v8, v11
    v_mul_f32 v9, v9, v11
    v_fma_f32 v8, v8, v18, v16
    v_fma_f32 v9, v9, v19, v17
    v_cvt_pk_bf16_f32 v77, v8, v9
    v_lshlrev_b32 v8, 16, v78
    v_and_b32 v9, 0xffff0000, v78
    v_accvgpr_read_b32 v16, a148
    v_accvgpr_read_b32 v17, a149
    v_accvgpr_read_b32 v18, a156
    v_accvgpr_read_b32 v19, a157
    v_sub_f32 v8, v8, v6
    v_sub_f32 v9, v9, v6
    v_mul_f32 v8, v8, v11
    v_mul_f32 v9, v9, v11
    v_fma_f32 v8, v8, v18, v16
    v_fma_f32 v9, v9, v19, v17
    v_cvt_pk_bf16_f32 v78, v8, v9
    v_lshlrev_b32 v8, 16, v79
    v_and_b32 v9, 0xffff0000, v79
    v_accvgpr_read_b32 v16, a150
    v_accvgpr_read_b32 v17, a151
    v_accvgpr_read_b32 v18, a158
    v_accvgpr_read_b32 v19, a159
    v_sub_f32 v8, v8, v6
    v_sub_f32 v9, v9, v6
    v_mul_f32 v8, v8, v11
    v_mul_f32 v9, v9, v11
    v_fma_f32 v8, v8, v18, v16
    v_fma_f32 v9, v9, v19, v17
    v_cvt_pk_bf16_f32 v79, v8, v9
    buffer_store_dwordx4 v[76:79], v13, s[60:63], s3 offen sc1
    s_add_u32 s3, s3, 1024
    v_lshlrev_b32 v8, 16, v80
    v_and_b32 v9, 0xffff0000, v80
    v_accvgpr_read_b32 v16, a160
    v_accvgpr_read_b32 v17, a161
    v_accvgpr_read_b32 v18, a168
    v_accvgpr_read_b32 v19, a169
    v_sub_f32 v8, v8, v6
    v_sub_f32 v9, v9, v6
    v_mul_f32 v8, v8, v11
    v_mul_f32 v9, v9, v11
    v_fma_f32 v8, v8, v18, v16
    v_fma_f32 v9, v9, v19, v17
    v_cvt_pk_bf16_f32 v80, v8, v9
    v_lshlrev_b32 v8, 16, v81
    v_and_b32 v9, 0xffff0000, v81
    v_accvgpr_read_b32 v16, a162
    v_accvgpr_read_b32 v17, a163
    v_accvgpr_read_b32 v18, a170
    v_accvgpr_read_b32 v19, a171
    v_sub_f32 v8, v8, v6
    v_sub_f32 v9, v9, v6
    v_mul_f32 v8, v8, v11
    v_mul_f32 v9, v9, v11
    v_fma_f32 v8, v8, v18, v16
    v_fma_f32 v9, v9, v19, v17
    v_cvt_pk_bf16_f32 v81, v8, v9
    v_lshlrev_b32 v8, 16, v82
    v_and_b32 v9, 0xffff0000, v82
    v_accvgpr_read_b32 v16, a164
    v_accvgpr_read_b32 v17, a165
    v_accvgpr_read_b32 v18, a172
    v_accvgpr_read_b32 v19, a173
    v_sub_f32 v8, v8, v6
    v_sub_f32 v9, v9, v6
    v_mul_f32 v8, v8, v11
    v_mul_f32 v9, v9, v11
    v_fma_f32 v8, v8, v18, v16
    v_fma_f32 v9, v9, v19, v17
    v_cvt_pk_bf16_f32 v82, v8, v9
    v_lshlrev_b32 v8, 16, v83
    v_and_b32 v9, 0xffff0000, v83
    v_accvgpr_read_b32 v16, a166
    v_accvgpr_read_b32 v17, a167
    v_accvgpr_read_b32 v18, a174
    v_accvgpr_read_b32 v19, a175
    v_sub_f32 v8, v8, v6
    v_sub_f32 v9, v9, v6
    v_mul_f32 v8, v8, v11
    v_mul_f32 v9, v9, v11
    v_fma_f32 v8, v8, v18, v16
    v_fma_f32 v9, v9, v19, v17
    v_cvt_pk_bf16_f32 v83, v8, v9
    buffer_store_dwordx4 v[80:83], v13, s[60:63], s3 offen sc1
    s_add_u32 s3, s3, 1024
    v_lshlrev_b32 v8, 16, v84
    v_and_b32 v9, 0xffff0000, v84
    v_accvgpr_read_b32 v16, a176
    v_accvgpr_read_b32 v17, a177
    v_accvgpr_read_b32 v18, a184
    v_accvgpr_read_b32 v19, a185
    v_sub_f32 v8, v8, v6
    v_sub_f32 v9, v9, v6
    v_mul_f32 v8, v8, v11
    v_mul_f32 v9, v9, v11
    v_fma_f32 v8, v8, v18, v16
    v_fma_f32 v9, v9, v19, v17
    v_cvt_pk_bf16_f32 v84, v8, v9
    v_lshlrev_b32 v8, 16, v85
    v_and_b32 v9, 0xffff0000, v85
    v_accvgpr_read_b32 v16, a178
    v_accvgpr_read_b32 v17, a179
    v_accvgpr_read_b32 v18, a186
    v_accvgpr_read_b32 v19, a187
    v_sub_f32 v8, v8, v6
    v_sub_f32 v9, v9, v6
    v_mul_f32 v8, v8, v11
    v_mul_f32 v9, v9, v11
    v_fma_f32 v8, v8, v18, v16
    v_fma_f32 v9, v9, v19, v17
    v_cvt_pk_bf16_f32 v85, v8, v9
    v_lshlrev_b32 v8, 16, v86
    v_and_b32 v9, 0xffff0000, v86
    v_accvgpr_read_b32 v16, a180
    v_accvgpr_read_b32 v17, a181
    v_accvgpr_read_b32 v18, a188
    v_accvgpr_read_b32 v19, a189
    v_sub_f32 v8, v8, v6
    v_sub_f32 v9, v9, v6
    v_mul_f32 v8, v8, v11
    v_mul_f32 v9, v9, v11
    v_fma_f32 v8, v8, v18, v16
    v_fma_f32 v9, v9, v19, v17
    v_cvt_pk_bf16_f32 v86, v8, v9
    v_lshlrev_b32 v8, 16, v87
    v_and_b32 v9, 0xffff0000, v87
    v_accvgpr_read_b32 v16, a182
    v_accvgpr_read_b32 v17, a183
    v_accvgpr_read_b32 v18, a190
    v_accvgpr_read_b32 v19, a191
    v_sub_f32 v8, v8, v6
    v_sub_f32 v9, v9, v6
    v_mul_f32 v8, v8, v11
    v_mul_f32 v9, v9, v11
    v_fma_f32 v8, v8, v18, v16
    v_fma_f32 v9, v9, v19, v17
    v_cvt_pk_bf16_f32 v87, v8, v9
    buffer_store_dwordx4 v[84:87], v13, s[60:63], s3 offen sc1
    s_add_u32 s3, s3, 1024
    v_lshlrev_b32 v8, 16, v88
    v_and_b32 v9, 0xffff0000, v88
    v_accvgpr_read_b32 v16, a192
    v_accvgpr_read_b32 v17, a193
    v_accvgpr_read_b32 v18, a200
    v_accvgpr_read_b32 v19, a201
    v_sub_f32 v8, v8, v6
    v_sub_f32 v9, v9, v6
    v_mul_f32 v8, v8, v11
    v_mul_f32 v9, v9, v11
    v_fma_f32 v8, v8, v18, v16
    v_fma_f32 v9, v9, v19, v17
    v_cvt_pk_bf16_f32 v88, v8, v9
    v_lshlrev_b32 v8, 16, v89
    v_and_b32 v9, 0xffff0000, v89
    v_accvgpr_read_b32 v16, a194
    v_accvgpr_read_b32 v17, a195
    v_accvgpr_read_b32 v18, a202
    v_accvgpr_read_b32 v19, a203
    v_sub_f32 v8, v8, v6
    v_sub_f32 v9, v9, v6
    v_mul_f32 v8, v8, v11
    v_mul_f32 v9, v9, v11
    v_fma_f32 v8, v8, v18, v16
    v_fma_f32 v9, v9, v19, v17
    v_cvt_pk_bf16_f32 v89, v8, v9
    v_lshlrev_b32 v8, 16, v90
    v_and_b32 v9, 0xffff0000, v90
    v_accvgpr_read_b32 v16, a196
    v_accvgpr_read_b32 v17, a197
    v_accvgpr_read_b32 v18, a204
    v_accvgpr_read_b32 v19, a205
    v_sub_f32 v8, v8, v6
    v_sub_f32 v9, v9, v6
    v_mul_f32 v8, v8, v11
    v_mul_f32 v9, v9, v11
    v_fma_f32 v8, v8, v18, v16
    v_fma_f32 v9, v9, v19, v17
    v_cvt_pk_bf16_f32 v90, v8, v9
    v_lshlrev_b32 v8, 16, v91
    v_and_b32 v9, 0xffff0000, v91
    v_accvgpr_read_b32 v16, a198
    v_accvgpr_read_b32 v17, a199
    v_accvgpr_read_b32 v18, a206
    v_accvgpr_read_b32 v19, a207
    v_sub_f32 v8, v8, v6
    v_sub_f32 v9, v9, v6
    v_mul_f32 v8, v8, v11
    v_mul_f32 v9, v9, v11
    v_fma_f32 v8, v8, v18, v16
    v_fma_f32 v9, v9, v19, v17
    v_cvt_pk_bf16_f32 v91, v8, v9
    buffer_store_dwordx4 v[88:91], v13, s[60:63], s3 offen sc1
    s_add_u32 s3, s3, 1024
    v_lshlrev_b32 v8, 16, v92
    v_and_b32 v9, 0xffff0000, v92
    v_accvgpr_read_b32 v16, a208
    v_accvgpr_read_b32 v17, a209
    v_accvgpr_read_b32 v18, a216
    v_accvgpr_read_b32 v19, a217
    v_sub_f32 v8, v8, v6
    v_sub_f32 v9, v9, v6
    v_mul_f32 v8, v8, v11
    v_mul_f32 v9, v9, v11
    v_fma_f32 v8, v8, v18, v16
    v_fma_f32 v9, v9, v19, v17
    v_cvt_pk_bf16_f32 v92, v8, v9
    v_lshlrev_b32 v8, 16, v93
    v_and_b32 v9, 0xffff0000, v93
    v_accvgpr_read_b32 v16, a210
    v_accvgpr_read_b32 v17, a211
    v_accvgpr_read_b32 v18, a218
    v_accvgpr_read_b32 v19, a219
    v_sub_f32 v8, v8, v6
    v_sub_f32 v9, v9, v6
    v_mul_f32 v8, v8, v11
    v_mul_f32 v9, v9, v11
    v_fma_f32 v8, v8, v18, v16
    v_fma_f32 v9, v9, v19, v17
    v_cvt_pk_bf16_f32 v93, v8, v9
    v_lshlrev_b32 v8, 16, v94
    v_and_b32 v9, 0xffff0000, v94
    v_accvgpr_read_b32 v16, a212
    v_accvgpr_read_b32 v17, a213
    v_accvgpr_read_b32 v18, a220
    v_accvgpr_read_b32 v19, a221
    v_sub_f32 v8, v8, v6
    v_sub_f32 v9, v9, v6
    v_mul_f32 v8, v8, v11
    v_mul_f32 v9, v9, v11
    v_fma_f32 v8, v8, v18, v16
    v_fma_f32 v9, v9, v19, v17
    v_cvt_pk_bf16_f32 v94, v8, v9
    v_lshlrev_b32 v8, 16, v95
    v_and_b32 v9, 0xffff0000, v95
    v_accvgpr_read_b32 v16, a214
    v_accvgpr_read_b32 v17, a215
    v_accvgpr_read_b32 v18, a222
    v_accvgpr_read_b32 v19, a223
    v_sub_f32 v8, v8, v6
    v_sub_f32 v9, v9, v6
    v_mul_f32 v8, v8, v11
    v_mul_f32 v9, v9, v11
    v_fma_f32 v8, v8, v18, v16
    v_fma_f32 v9, v9, v19, v17
    v_cvt_pk_bf16_f32 v95, v8, v9
    buffer_store_dwordx4 v[92:95], v13, s[60:63], s3 offen sc1
    s_add_u32 s3, s3, 1024
    v_lshlrev_b32 v8, 16, v96
    v_and_b32 v9, 0xffff0000, v96
    v_accvgpr_read_b32 v16, a224
    v_accvgpr_read_b32 v17, a225
    v_accvgpr_read_b32 v18, a232
    v_accvgpr_read_b32 v19, a233
    v_sub_f32 v8, v8, v6
    v_sub_f32 v9, v9, v6
    v_mul_f32 v8, v8, v11
    v_mul_f32 v9, v9, v11
    v_fma_f32 v8, v8, v18, v16
    v_fma_f32 v9, v9, v19, v17
    v_cvt_pk_bf16_f32 v96, v8, v9
    v_lshlrev_b32 v8, 16, v97
    v_and_b32 v9, 0xffff0000, v97
    v_accvgpr_read_b32 v16, a226
    v_accvgpr_read_b32 v17, a227
    v_accvgpr_read_b32 v18, a234
    v_accvgpr_read_b32 v19, a235
    v_sub_f32 v8, v8, v6
    v_sub_f32 v9, v9, v6
    v_mul_f32 v8, v8, v11
    v_mul_f32 v9, v9, v11
    v_fma_f32 v8, v8, v18, v16
    v_fma_f32 v9, v9, v19, v17
    v_cvt_pk_bf16_f32 v97, v8, v9
    v_lshlrev_b32 v8, 16, v98
    v_and_b32 v9, 0xffff0000, v98
    v_accvgpr_read_b32 v16, a228
    v_accvgpr_read_b32 v17, a229
    v_accvgpr_read_b32 v18, a236
    v_accvgpr_read_b32 v19, a237
    v_sub_f32 v8, v8, v6
    v_sub_f32 v9, v9, v6
    v_mul_f32 v8, v8, v11
    v_mul_f32 v9, v9, v11
    v_fma_f32 v8, v8, v18, v16
    v_fma_f32 v9, v9, v19, v17
    v_cvt_pk_bf16_f32 v98, v8, v9
    v_lshlrev_b32 v8, 16, v99
    v_and_b32 v9, 0xffff0000, v99
    v_accvgpr_read_b32 v16, a230
    v_accvgpr_read_b32 v17, a231
    v_accvgpr_read_b32 v18, a238
    v_accvgpr_read_b32 v19, a239
    v_sub_f32 v8, v8, v6
    v_sub_f32 v9, v9, v6
    v_mul_f32 v8, v8, v11
    v_mul_f32 v9, v9, v11
    v_fma_f32 v8, v8, v18, v16
    v_fma_f32 v9, v9, v19, v17
    v_cvt_pk_bf16_f32 v99, v8, v9
    buffer_store_dwordx4 v[96:99], v13, s[60:63], s3 offen sc1
    s_add_u32 s3, s3, 1024
    v_lshlrev_b32 v8, 16, v100
    v_and_b32 v9, 0xffff0000, v100
    v_accvgpr_read_b32 v16, a240
    v_accvgpr_read_b32 v17, a241
    v_accvgpr_read_b32 v18, a248
    v_accvgpr_read_b32 v19, a249
    v_sub_f32 v8, v8, v6
    v_sub_f32 v9, v9, v6
    v_mul_f32 v8, v8, v11
    v_mul_f32 v9, v9, v11
    v_fma_f32 v8, v8, v18, v16
    v_fma_f32 v9, v9, v19, v17
    v_cvt_pk_bf16_f32 v100, v8, v9
    v_lshlrev_b32 v8, 16, v101
    v_and_b32 v9, 0xffff0000, v101
    v_accvgpr_read_b32 v16, a242
    v_accvgpr_read_b32 v17, a243
    v_accvgpr_read_b32 v18, a250
    v_accvgpr_read_b32 v19, a251
    v_sub_f32 v8, v8, v6
    v_sub_f32 v9, v9, v6
    v_mul_f32 v8, v8, v11
    v_mul_f32 v9, v9, v11
    v_fma_f32 v8, v8, v18, v16
    v_fma_f32 v9, v9, v19, v17
    v_cvt_pk_bf16_f32 v101, v8, v9
    v_lshlrev_b32 v8, 16, v102
    v_and_b32 v9, 0xffff0000, v102
    v_accvgpr_read_b32 v16, a244
    v_accvgpr_read_b32 v17, a245
    v_accvgpr_read_b32 v18, a252
    v_accvgpr_read_b32 v19, a253
    v_sub_f32 v8, v8, v6
    v_sub_f32 v9, v9, v6
    v_mul_f32 v8, v8, v11
    v_mul_f32 v9, v9, v11
    v_fma_f32 v8, v8, v18, v16
    v_fma_f32 v9, v9, v19, v17
    v_cvt_pk_bf16_f32 v102, v8, v9
    v_lshlrev_b32 v8, 16, v103
    v_and_b32 v9, 0xffff0000, v103
    v_accvgpr_read_b32 v16, a246
    v_accvgpr_read_b32 v17, a247
    v_accvgpr_read_b32 v18, a254
    v_accvgpr_read_b32 v19, a255
    v_sub_f32 v8, v8, v6
    v_sub_f32 v9, v9, v6
    v_mul_f32 v8, v8, v11
    v_mul_f32 v9, v9, v11
    v_fma_f32 v8, v8, v18, v16
    v_fma_f32 v9, v9, v19, v17
    v_cvt_pk_bf16_f32 v103, v8, v9
    buffer_store_dwordx4 v[100:103], v13, s[60:63], s3 offen sc1
    s_add_u32 s3, s3, 1024
    v_lshlrev_b32 v8, 16, v104
    v_and_b32 v9, 0xffff0000, v104
    v_mov_b32 v16, v120
    v_mov_b32 v17, v121
    v_mov_b32 v18, v128
    v_mov_b32 v19, v129
    v_sub_f32 v8, v8, v6
    v_sub_f32 v9, v9, v6
    v_mul_f32 v8, v8, v11
    v_mul_f32 v9, v9, v11
    v_fma_f32 v8, v8, v18, v16
    v_fma_f32 v9, v9, v19, v17
    v_cvt_pk_bf16_f32 v104, v8, v9
    v_lshlrev_b32 v8, 16, v105
    v_and_b32 v9, 0xffff0000, v105
    v_mov_b32 v16, v122
    v_mov_b32 v17, v123
    v_mov_b32 v18, v130
    v_mov_b32 v19, v131
    v_sub_f32 v8, v8, v6
    v_sub_f32 v9, v9, v6
    v_mul_f32 v8, v8, v11
    v_mul_f32 v9, v9, v11
    v_fma_f32 v8, v8, v18, v16
    v_fma_f32 v9, v9, v19, v17
    v_cvt_pk_bf16_f32 v105, v8, v9
    v_lshlrev_b32 v8, 16, v106
    v_and_b32 v9, 0xffff0000, v106
    v_mov_b32 v16, v124
    v_mov_b32 v17, v125
    v_mov_b32 v18, v132
    v_mov_b32 v19, v133
    v_sub_f32 v8, v8, v6
    v_sub_f32 v9, v9, v6
    v_mul_f32 v8, v8, v11
    v_mul_f32 v9, v9, v11
    v_fma_f32 v8, v8, v18, v16
    v_fma_f32 v9, v9, v19, v17
    v_cvt_pk_bf16_f32 v106, v8, v9
    v_lshlrev_b32 v8, 16, v107
    v_and_b32 v9, 0xffff0000, v107
    v_mov_b32 v16, v126
    v_mov_b32 v17, v127
    v_mov_b32 v18, v134
    v_mov_b32 v19, v135
    v_sub_f32 v8, v8, v6
    v_sub_f32 v9, v9, v6
    v_mul_f32 v8, v8, v11
    v_mul_f32 v9, v9, v11
    v_fma_f32 v8, v8, v18, v16
    v_fma_f32 v9, v9, v19, v17
    v_cvt_pk_bf16_f32 v107, v8, v9
    buffer_store_dwordx4 v[104:107], v13, s[60:63], s3 offen sc1
    s_add_u32 s3, s3, 1024
    v_lshlrev_b32 v8, 16, v108
    v_and_b32 v9, 0xffff0000, v108
    v_mov_b32 v16, v136
    v_mov_b32 v17, v137
    v_mov_b32 v18, v144
    v_mov_b32 v19, v145
    v_sub_f32 v8, v8, v6
    v_sub_f32 v9, v9, v6
    v_mul_f32 v8, v8, v11
    v_mul_f32 v9, v9, v11
    v_fma_f32 v8, v8, v18, v16
    v_fma_f32 v9, v9, v19, v17
    v_cvt_pk_bf16_f32 v108, v8, v9
    v_lshlrev_b32 v8, 16, v109
    v_and_b32 v9, 0xffff0000, v109
    v_mov_b32 v16, v138
    v_mov_b32 v17, v139
    v_mov_b32 v18, v146
    v_mov_b32 v19, v147
    v_sub_f32 v8, v8, v6
    v_sub_f32 v9, v9, v6
    v_mul_f32 v8, v8, v11
    v_mul_f32 v9, v9, v11
    v_fma_f32 v8, v8, v18, v16
    v_fma_f32 v9, v9, v19, v17
    v_cvt_pk_bf16_f32 v109, v8, v9
    v_lshlrev_b32 v8, 16, v110
    v_and_b32 v9, 0xffff0000, v110
    v_mov_b32 v16, v140
    v_mov_b32 v17, v141
    v_mov_b32 v18, v148
    v_mov_b32 v19, v149
    v_sub_f32 v8, v8, v6
    v_sub_f32 v9, v9, v6
    v_mul_f32 v8, v8, v11
    v_mul_f32 v9, v9, v11
    v_fma_f32 v8, v8, v18, v16
    v_fma_f32 v9, v9, v19, v17
    v_cvt_pk_bf16_f32 v110, v8, v9
    v_lshlrev_b32 v8, 16, v111
    v_and_b32 v9, 0xffff0000, v111
    v_mov_b32 v16, v142
    v_mov_b32 v17, v143
    v_mov_b32 v18, v150
    v_mov_b32 v19, v151
    v_sub_f32 v8, v8, v6
    v_sub_f32 v9, v9, v6
    v_mul_f32 v8, v8, v11
    v_mul_f32 v9, v9, v11
    v_fma_f32 v8, v8, v18, v16
    v_fma_f32 v9, v9, v19, v17
    v_cvt_pk_bf16_f32 v111, v8, v9
    buffer_store_dwordx4 v[108:111], v13, s[60:63], s3 offen sc1
    s_add_u32 s3, s3, 1024
    v_lshlrev_b32 v8, 16, v112
    v_and_b32 v9, 0xffff0000, v112
    v_mov_b32 v16, v152
    v_mov_b32 v17, v153
    v_mov_b32 v18, v160
    v_mov_b32 v19, v161
    v_sub_f32 v8, v8, v6
    v_sub_f32 v9, v9, v6
    v_mul_f32 v8, v8, v11
    v_mul_f32 v9, v9, v11
    v_fma_f32 v8, v8, v18, v16
    v_fma_f32 v9, v9, v19, v17
    v_cvt_pk_bf16_f32 v112, v8, v9
    v_lshlrev_b32 v8, 16, v113
    v_and_b32 v9, 0xffff0000, v113
    v_mov_b32 v16, v154
    v_mov_b32 v17, v155
    v_mov_b32 v18, v162
    v_mov_b32 v19, v163
    v_sub_f32 v8, v8, v6
    v_sub_f32 v9, v9, v6
    v_mul_f32 v8, v8, v11
    v_mul_f32 v9, v9, v11
    v_fma_f32 v8, v8, v18, v16
    v_fma_f32 v9, v9, v19, v17
    v_cvt_pk_bf16_f32 v113, v8, v9
    v_lshlrev_b32 v8, 16, v114
    v_and_b32 v9, 0xffff0000, v114
    v_mov_b32 v16, v156
    v_mov_b32 v17, v157
    v_mov_b32 v18, v164
    v_mov_b32 v19, v165
    v_sub_f32 v8, v8, v6
    v_sub_f32 v9, v9, v6
    v_mul_f32 v8, v8, v11
    v_mul_f32 v9, v9, v11
    v_fma_f32 v8, v8, v18, v16
    v_fma_f32 v9, v9, v19, v17
    v_cvt_pk_bf16_f32 v114, v8, v9
    v_lshlrev_b32 v8, 16, v115
    v_and_b32 v9, 0xffff0000, v115
    v_mov_b32 v16, v158
    v_mov_b32 v17, v159
    v_mov_b32 v18, v166
    v_mov_b32 v19, v167
    v_sub_f32 v8, v8, v6
    v_sub_f32 v9, v9, v6
    v_mul_f32 v8, v8, v11
    v_mul_f32 v9, v9, v11
    v_fma_f32 v8, v8, v18, v16
    v_fma_f32 v9, v9, v19, v17
    v_cvt_pk_bf16_f32 v115, v8, v9
    buffer_store_dwordx4 v[112:115], v13, s[60:63], s3 offen sc1
    s_add_u32 s3, s3, 1024
    v_lshlrev_b32 v8, 16, v116
    v_and_b32 v9, 0xffff0000, v116
    v_mov_b32 v16, v168
    v_mov_b32 v17, v169
    v_mov_b32 v18, v176
    v_mov_b32 v19, v177
    v_sub_f32 v8, v8, v6
    v_sub_f32 v9, v9, v6
    v_mul_f32 v8, v8, v11
    v_mul_f32 v9, v9, v11
    v_fma_f32 v8, v8, v18, v16
    v_fma_f32 v9, v9, v19, v17
    v_cvt_pk_bf16_f32 v116, v8, v9
    v_lshlrev_b32 v8, 16, v117
    v_and_b32 v9, 0xffff0000, v117
    v_mov_b32 v16, v170
    v_mov_b32 v17, v171
    v_mov_b32 v18, v178
    v_mov_b32 v19, v179
    v_sub_f32 v8, v8, v6
    v_sub_f32 v9, v9, v6
    v_mul_f32 v8, v8, v11
    v_mul_f32 v9, v9, v11
    v_fma_f32 v8, v8, v18, v16
    v_fma_f32 v9, v9, v19, v17
    v_cvt_pk_bf16_f32 v117, v8, v9
    v_lshlrev_b32 v8, 16, v118
    v_and_b32 v9, 0xffff0000, v118
    v_mov_b32 v16, v172
    v_mov_b32 v17, v173
    v_mov_b32 v18, v180
    v_mov_b32 v19, v181
    v_sub_f32 v8, v8, v6
    v_sub_f32 v9, v9, v6
    v_mul_f32 v8, v8, v11
    v_mul_f32 v9, v9, v11
    v_fma_f32 v8, v8, v18, v16
    v_fma_f32 v9, v9, v19, v17
    v_cvt_pk_bf16_f32 v118, v8, v9
    v_lshlrev_b32 v8, 16, v119
    v_and_b32 v9, 0xffff0000, v119
    v_mov_b32 v16, v174
    v_mov_b32 v17, v175
    v_mov_b32 v18, v182
    v_mov_b32 v19, v183
    v_sub_f32 v8, v8, v6
    v_sub_f32 v9, v9, v6
    v_mul_f32 v8, v8, v11
    v_mul_f32 v9, v9, v11
    v_fma_f32 v8, v8, v18, v16
    v_fma_f32 v9, v9, v19, v17
    v_cvt_pk_bf16_f32 v119, v8, v9
    buffer_store_dwordx4 v[116:119], v13, s[60:63], s3 offen sc1
    s_add_u32 s3, s3, 1024
    s_waitcnt vmcnt(0)
    v_mov_b32 v5, 1
    v_mov_b32 v6, 160
    s_mov_b64 exec, 1
    buffer_atomic_add v5, v6, s[88:91], 0 offen sc1
    s_mov_b64 exec, -1
mega_kernel_ln1s216:
    s_branch mega_kernel_nboot319
mega_kernel_nboot29:
    s_mul_i32 s11, s2, 94208
    s_add_u32 s11, s11, 167264256
    v_lshlrev_b32 v1, 4, v0
    v_add_u32 v1, s11, v1
    v_mov_b32 v8, -1
    v_mov_b32 v9, -1
    v_mov_b32 v10, -1
    v_mov_b32 v11, -1
    s_mov_b32 s64, s60
    s_mov_b32 s65, s61
    s_mov_b32 s66, 190867456
    s_mov_b32 s67, 0x00020000
    s_mov_b32 s10, 190201856
    s_mov_b32 s12, 0
mega_kernel_clr20:
    v_subrev_u32 v5, s10, v1
    v_cmp_le_u32 vcc, 0x2800, v5
    s_and_b64 exec, exec, vcc
    buffer_store_dwordx4 v[8:11], v1, s[64:67], 0 offen sc1
    s_mov_b64 exec, -1
    v_add_u32 v1, 0x1000, v1
    s_add_u32 s12, s12, 1
    s_cmp_lt_u32 s12, 23
    s_cbranch_scc1 mega_kernel_clr20
    s_mov_b32 s66, 210792448
    s_mul_i32 s11, s2, 20480
    s_add_u32 s11, s11, 205549568
    v_lshlrev_b32 v1, 4, v0
    v_mov_b32 v8, 0
    v_mov_b32 v9, 0
    v_mov_b32 v10, 0
    v_mov_b32 v11, 0
    buffer_store_dwordx4 v[8:11], v1, s[64:67], s11 offen sc1
    s_add_u32 s11, s11, 4096
    buffer_store_dwordx4 v[8:11], v1, s[64:67], s11 offen sc1
    s_add_u32 s11, s11, 4096
    buffer_store_dwordx4 v[8:11], v1, s[64:67], s11 offen sc1
    s_add_u32 s11, s11, 4096
    buffer_store_dwordx4 v[8:11], v1, s[64:67], s11 offen sc1
    s_add_u32 s11, s11, 4096
    buffer_store_dwordx4 v[8:11], v1, s[64:67], s11 offen sc1
    s_add_u32 s11, s11, 4096
    s_cmp_lg_u32 s2, 0
    s_cbranch_scc1 mega_kernel_clr021
    s_mov_b32 s11, 204500992
    buffer_store_dwordx4 v[8:11], v1, s[60:63], s11 offen sc1
    s_load_dwordx2 s[6:7], s[0:1], 8
    s_waitcnt lgkmcnt(0)
    s_mov_b32 s64, s6
    s_and_b32 s65, s7, 0xffff
    s_mov_b32 s66, 10240
    s_mov_b32 s67, 0x00020000
    v_add_u32 v8, 0, v0
    v_lshlrev_b32 v9, 4, v8
    buffer_load_dwordx4 v[12:15], v9, s[64:67], 0 offen
    v_mul_u32_u24 v10, 205, v8
    v_lshrrev_b32 v10, 14, v10
    v_mul_u32_u24 v11, 80, v10
    v_sub_u32 v11, v8, v11
    v_lshrrev_b32 v16, 1, v11
    v_and_b32 v17, 1, v11
    v_lshlrev_b32 v16, 8, v16
    v_lshl_add_u32 v16, v10, 5, v16
    v_lshl_add_u32 v16, v17, 4, v16
    v_cmp_gt_u32 vcc, 640, v8
    s_and_b64 exec, exec, vcc
    s_waitcnt vmcnt(0)
    buffer_store_dwordx4 v[12:15], v16, s[60:63], s10 offen sc1
    s_mov_b64 exec, -1
    s_nop 1
    v_add_u32 v8, 256, v0
    v_lshlrev_b32 v9, 4, v8
    buffer_load_dwordx4 v[12:15], v9, s[64:67], 0 offen
    v_mul_u32_u24 v10, 205, v8
    v_lshrrev_b32 v10, 14, v10
    v_mul_u32_u24 v11, 80, v10
    v_sub_u32 v11, v8, v11
    v_lshrrev_b32 v16, 1, v11
    v_and_b32 v17, 1, v11
    v_lshlrev_b32 v16, 8, v16
    v_lshl_add_u32 v16, v10, 5, v16
    v_lshl_add_u32 v16, v17, 4, v16
    v_cmp_gt_u32 vcc, 640, v8
    s_and_b64 exec, exec, vcc
    s_waitcnt vmcnt(0)
    buffer_store_dwordx4 v[12:15], v16, s[60:63], s10 offen sc1
    s_mov_b64 exec, -1
    s_nop 1
    v_add_u32 v8, 512, v0
    v_lshlrev_b32 v9, 4, v8
    buffer_load_dwordx4 v[12:15], v9, s[64:67], 0 offen
    v_mul_u32_u24 v10, 205, v8
    v_lshrrev_b32 v10, 14, v10
    v_mul_u32_u24 v11, 80, v10
    v_sub_u32 v11, v8, v11
    v_lshrrev_b32 v16, 1, v11
    v_and_b32 v17, 1, v11
    v_lshlrev_b32 v16, 8, v16
    v_lshl_add_u32 v16, v10, 5, v16
    v_lshl_add_u32 v16, v17, 4, v16
    v_cmp_gt_u32 vcc, 640, v8
    s_and_b64 exec, exec, vcc
    s_waitcnt vmcnt(0)
    buffer_store_dwordx4 v[12:15], v16, s[60:63], s10 offen sc1
    s_mov_b64 exec, -1
    s_nop 1
mega_kernel_clr021:
    s_waitcnt vmcnt(0)
    s_barrier
    s_cmp_lg_u32 s74, 0
    s_cbranch_scc1 mega_kernel_ca22
    v_mov_b32 v5, 1
    v_mov_b32 v6, 192
    s_mov_b64 exec, 1
    buffer_atomic_add v5, v6, s[88:91], 0 offen sc1
    s_mov_b64 exec, -1
mega_kernel_ca22:
mega_kernel_nboot319:
    s_cmp_ge_u32 s2, 252
    s_cbranch_scc1 mega_T0_LA
    s_cmp_ge_u32 s2, 232
    s_cbranch_scc1 mega_T0_LD
    s_cmp_ge_u32 s2, 208
    s_cbranch_scc1 mega_T0_LU
    s_cmp_ge_u32 s2, 176
    s_cbranch_scc1 mega_T0_LV
    s_cmp_ge_u32 s2, 104
    s_cbranch_scc1 mega_T0_LQ
    s_load_dwordx4 s[12:15], s[0:1], 16
    s_load_dwordx4 s[16:19], s[0:1], 32
    v_and_b32 v5, 7, v0
    v_cmp_gt_u32 s[80:81], 8, v3
    v_cmp_gt_u32 s[82:83], 32, v2
    s_nop 1
    s_and_b64 s[82:83], s[82:83], s[80:81]
    v_cmp_le_u32 s[84:85], 32, v2
    s_waitcnt lgkmcnt(0)
    s_cmp_ge_u32 s2, 64
    s_cbranch_scc1 mega_kernel_roleY24
    s_and_b32 s20, s2, 31
    v_add_u32 v6, 0, v2
    v_min_u32 v6, 159, v6
    v_lshlrev_b32 v10, 4, v6
    v_bfe_u32 v7, v6, 1, 3
    s_movk_i32 s3, 1296
    v_mul_lo_u32 v7, v7, s3
    v_lshrrev_b32 v8, 4, v6
    s_mul_i32 s3, s74, 10
    v_add_u32 v8, s3, v8
    v_lshl_add_u32 v7, v8, 5, v7
    v_and_b32 v8, 1, v6
    v_lshl_add_u32 v7, v8, 4, v7
    v_add_u32 v13, 135168, v7
    v_add_u32 v6, 64, v2
    v_min_u32 v6, 159, v6
    v_lshlrev_b32 v11, 4, v6
    v_bfe_u32 v7, v6, 1, 3
    s_movk_i32 s3, 1296
    v_mul_lo_u32 v7, v7, s3
    v_lshrrev_b32 v8, 4, v6
    s_mul_i32 s3, s74, 10
    v_add_u32 v8, s3, v8
    v_lshl_add_u32 v7, v8, 5, v7
    v_and_b32 v8, 1, v6
    v_lshl_add_u32 v7, v8, 4, v7
    v_add_u32 v14, 135168, v7
    v_add_u32 v6, 128, v2
    v_min_u32 v6, 159, v6
    v_lshlrev_b32 v12, 4, v6
    v_bfe_u32 v7, v6, 1, 3
    s_movk_i32 s3, 1296
    v_mul_lo_u32 v7, v7, s3
    v_lshrrev_b32 v8, 4, v6
    s_mul_i32 s3, s74, 10
    v_add_u32 v8, s3, v8
    v_lshl_add_u32 v7, v8, 5, v7
    v_and_b32 v8, 1, v6
    v_lshl_add_u32 v7, v8, 4, v7
    v_add_u32 v15, 135168, v7
    v_min_u32 v9, 9, v2
    v_lshlrev_b32 v9, 8, v9
    v_add_u32 v9, 252, v9
    s_movk_i32 s3, 1296
    v_mul_lo_u32 v16, v5, s3
    v_lshl_add_u32 v16, v4, 4, v16
    v_add_u32 v16, 135168, v16
    s_mul_i32 s3, s74, 33792
    v_lshlrev_b32 v18, 4, v2
    v_add_u32 v18, s3, v18
    v_mov_b32 v19, v18
    s_movk_i32 s3, 400
    v_mul_lo_u32 v17, v5, s3
    v_add_u32 v17, 145536, v17
    s_mul_i32 s30, s74, 2560
    s_add_u32 s30, s30, 190201856
    s_mov_b32 s29, 0
    s_cmp_ge_u32 s2, 32
    s_cbranch_scc1 mega_kernel_roleB23
    s_cmp_ge_u32 s74, 2
    s_cselect_b32 s12, s14, s12
    s_cselect_b32 s13, s15, s13
    s_mov_b32 s64, s12
    s_and_b32 s65, s13, 0xffff
    s_mov_b32 s66, 7864320
    s_mov_b32 s67, 0x00020000
    s_and_b32 s3, s74, 1
    s_mul_i32 s3, s3, 192
    s_mul_i32 s21, s20, 384
    s_add_u32 s21, s21, s3
    s_mov_b32 s3, 98304
    v_mul_lo_u32 v6, v4, s3
    v_lshl_add_u32 v6, v3, 2, v6
    s_add_u32 s22, s21, 0
    s_add_u32 s71, s22, 0
    buffer_load_dword v32, v6, s[64:67], s71 offen
    s_add_u32 s71, s22, 12288
    buffer_load_dword v33, v6, s[64:67], s71 offen
    s_add_u32 s71, s22, 24576
    buffer_load_dword v34, v6, s[64:67], s71 offen
    s_add_u32 s71, s22, 36864
    buffer_load_dword v35, v6, s[64:67], s71 offen
    s_add_u32 s71, s22, 49152
    buffer_load_dword v36, v6, s[64:67], s71 offen
    s_add_u32 s71, s22, 61440
    buffer_load_dword v37, v6, s[64:67], s71 offen
    s_add_u32 s71, s22, 73728
    buffer_load_dword v38, v6, s[64:67], s71 offen
    s_add_u32 s71, s22, 86016
    buffer_load_dword v39, v6, s[64:67], s71 offen
    s_add_u32 s71, s22, 393216
    buffer_load_dword v40, v6, s[64:67], s71 offen
    s_add_u32 s71, s22, 405504
    buffer_load_dword v41, v6, s[64:67], s71 offen
    s_add_u32 s71, s22, 417792
    buffer_load_dword v42, v6, s[64:67], s71 offen
    s_add_u32 s71, s22, 430080
    buffer_load_dword v43, v6, s[64:67], s71 offen
    s_add_u32 s71, s22, 442368
    buffer_load_dword v44, v6, s[64:67], s71 offen
    s_add_u32 s71, s22, 454656
    buffer_load_dword v45, v6, s[64:67], s71 offen
    s_add_u32 s71, s22, 466944
    buffer_load_dword v46, v6, s[64:67], s71 offen
    s_add_u32 s71, s22, 479232
    buffer_load_dword v47, v6, s[64:67], s71 offen
    s_add_u32 s71, s22, 786432
    buffer_load_dword v48, v6, s[64:67], s71 offen
    s_add_u32 s71, s22, 798720
    buffer_load_dword v49, v6, s[64:67], s71 offen
    s_add_u32 s71, s22, 811008
    buffer_load_dword v50, v6, s[64:67], s71 offen
    s_add_u32 s71, s22, 823296
    buffer_load_dword v51, v6, s[64:67], s71 offen
    s_add_u32 s71, s22, 835584
    buffer_load_dword v52, v6, s[64:67], s71 offen
    s_add_u32 s71, s22, 847872
    buffer_load_dword v53, v6, s[64:67], s71 offen
    s_add_u32 s71, s22, 860160
    buffer_load_dword v54, v6, s[64:67], s71 offen
    s_add_u32 s71, s22, 872448
    buffer_load_dword v55, v6, s[64:67], s71 offen
    s_add_u32 s71, s22, 1179648
    buffer_load_dword v56, v6, s[64:67], s71 offen
    s_add_u32 s71, s22, 1191936
    buffer_load_dword v57, v6, s[64:67], s71 offen
    s_add_u32 s71, s22, 1204224
    buffer_load_dword v58, v6, s[64:67], s71 offen
    s_add_u32 s71, s22, 1216512
    buffer_load_dword v59, v6, s[64:67], s71 offen
    s_add_u32 s71, s22, 1228800
    buffer_load_dword v60, v6, s[64:67], s71 offen
    s_add_u32 s71, s22, 1241088
    buffer_load_dword v61, v6, s[64:67], s71 offen
    s_add_u32 s71, s22, 1253376
    buffer_load_dword v62, v6, s[64:67], s71 offen
    s_add_u32 s71, s22, 1265664
    buffer_load_dword v63, v6, s[64:67], s71 offen
    s_add_u32 s71, s22, 1572864
    buffer_load_dword v64, v6, s[64:67], s71 offen
    s_add_u32 s71, s22, 1585152
    buffer_load_dword v65, v6, s[64:67], s71 offen
    s_add_u32 s71, s22, 1597440
    buffer_load_dword v66, v6, s[64:67], s71 offen
    s_add_u32 s71, s22, 1609728
    buffer_load_dword v67, v6, s[64:67], s71 offen
    s_add_u32 s71, s22, 1622016
    buffer_load_dword v68, v6, s[64:67], s71 offen
    s_add_u32 s71, s22, 1634304
    buffer_load_dword v69, v6, s[64:67], s71 offen
    s_add_u32 s71, s22, 1646592
    buffer_load_dword v70, v6, s[64:67], s71 offen
    s_add_u32 s71, s22, 1658880
    buffer_load_dword v71, v6, s[64:67], s71 offen
    s_add_u32 s71, s22, 1966080
    buffer_load_dword v72, v6, s[64:67], s71 offen
    s_add_u32 s71, s22, 1978368
    buffer_load_dword v73, v6, s[64:67], s71 offen
    s_add_u32 s71, s22, 1990656
    buffer_load_dword v74, v6, s[64:67], s71 offen
    s_add_u32 s71, s22, 2002944
    buffer_load_dword v75, v6, s[64:67], s71 offen
    s_add_u32 s71, s22, 2015232
    buffer_load_dword v76, v6, s[64:67], s71 offen
    s_add_u32 s71, s22, 2027520
    buffer_load_dword v77, v6, s[64:67], s71 offen
    s_add_u32 s71, s22, 2039808
    buffer_load_dword v78, v6, s[64:67], s71 offen
    s_add_u32 s71, s22, 2052096
    buffer_load_dword v79, v6, s[64:67], s71 offen
    s_add_u32 s71, s22, 2359296
    buffer_load_dword v80, v6, s[64:67], s71 offen
    s_add_u32 s71, s22, 2371584
    buffer_load_dword v81, v6, s[64:67], s71 offen
    s_add_u32 s71, s22, 2383872
    buffer_load_dword v82, v6, s[64:67], s71 offen
    s_add_u32 s71, s22, 2396160
    buffer_load_dword v83, v6, s[64:67], s71 offen
    s_add_u32 s71, s22, 2408448
    buffer_load_dword v84, v6, s[64:67], s71 offen
    s_add_u32 s71, s22, 2420736
    buffer_load_dword v85, v6, s[64:67], s71 offen
    s_add_u32 s71, s22, 2433024
    buffer_load_dword v86, v6, s[64:67], s71 offen
    s_add_u32 s71, s22, 2445312
    buffer_load_dword v87, v6, s[64:67], s71 offen
    s_add_u32 s71, s22, 2752512
    buffer_load_dword v88, v6, s[64:67], s71 offen
    s_add_u32 s71, s22, 2764800
    buffer_load_dword v89, v6, s[64:67], s71 offen
    s_add_u32 s71, s22, 2777088
    buffer_load_dword v90, v6, s[64:67], s71 offen
    s_add_u32 s71, s22, 2789376
    buffer_load_dword v91, v6, s[64:67], s71 offen
    s_add_u32 s71, s22, 2801664
    buffer_load_dword v92, v6, s[64:67], s71 offen
    s_add_u32 s71, s22, 2813952
    buffer_load_dword v93, v6, s[64:67], s71 offen
    s_add_u32 s71, s22, 2826240
    buffer_load_dword v94, v6, s[64:67], s71 offen
    s_add_u32 s71, s22, 2838528
    buffer_load_dword v95, v6, s[64:67], s71 offen
    s_add_u32 s71, s22, 3145728
    buffer_load_dword v96, v6, s[64:67], s71 offen
    s_add_u32 s71, s22, 3158016
    buffer_load_dword v97, v6, s[64:67], s71 offen
    s_add_u32 s71, s22, 3170304
    buffer_load_dword v98, v6, s[64:67], s71 offen
    s_add_u32 s71, s22, 3182592
    buffer_load_dword v99, v6, s[64:67], s71 offen
    s_add_u32 s71, s22, 3194880
    buffer_load_dword v100, v6, s[64:67], s71 offen
    s_add_u32 s71, s22, 3207168
    buffer_load_dword v101, v6, s[64:67], s71 offen
    s_add_u32 s71, s22, 3219456
    buffer_load_dword v102, v6, s[64:67], s71 offen
    s_add_u32 s71, s22, 3231744
    buffer_load_dword v103, v6, s[64:67], s71 offen
    s_add_u32 s71, s22, 3538944
    buffer_load_dword v104, v6, s[64:67], s71 offen
    s_add_u32 s71, s22, 3551232
    buffer_load_dword v105, v6, s[64:67], s71 offen
    s_add_u32 s71, s22, 3563520
    buffer_load_dword v106, v6, s[64:67], s71 offen
    s_add_u32 s71, s22, 3575808
    buffer_load_dword v107, v6, s[64:67], s71 offen
    s_add_u32 s71, s22, 3588096
    buffer_load_dword v108, v6, s[64:67], s71 offen
    s_add_u32 s71, s22, 3600384
    buffer_load_dword v109, v6, s[64:67], s71 offen
    s_add_u32 s71, s22, 3612672
    buffer_load_dword v110, v6, s[64:67], s71 offen
    s_add_u32 s71, s22, 3624960
    buffer_load_dword v111, v6, s[64:67], s71 offen
    s_add_u32 s71, s22, 3932160
    buffer_load_dword v112, v6, s[64:67], s71 offen
    s_add_u32 s71, s22, 3944448
    buffer_load_dword v113, v6, s[64:67], s71 offen
    s_add_u32 s71, s22, 3956736
    buffer_load_dword v114, v6, s[64:67], s71 offen
    s_add_u32 s71, s22, 3969024
    buffer_load_dword v115, v6, s[64:67], s71 offen
    s_add_u32 s71, s22, 3981312
    buffer_load_dword v116, v6, s[64:67], s71 offen
    s_add_u32 s71, s22, 3993600
    buffer_load_dword v117, v6, s[64:67], s71 offen
    s_add_u32 s71, s22, 4005888
    buffer_load_dword v118, v6, s[64:67], s71 offen
    s_add_u32 s71, s22, 4018176
    buffer_load_dword v119, v6, s[64:67], s71 offen
    s_add_u32 s71, s22, 4325376
    buffer_load_dword v120, v6, s[64:67], s71 offen
    s_add_u32 s71, s22, 4337664
    buffer_load_dword v121, v6, s[64:67], s71 offen
    s_add_u32 s71, s22, 4349952
    buffer_load_dword v122, v6, s[64:67], s71 offen
    s_add_u32 s71, s22, 4362240
    buffer_load_dword v123, v6, s[64:67], s71 offen
    s_add_u32 s71, s22, 4374528
    buffer_load_dword v124, v6, s[64:67], s71 offen
    s_add_u32 s71, s22, 4386816
    buffer_load_dword v125, v6, s[64:67], s71 offen
    s_add_u32 s71, s22, 4399104
    buffer_load_dword v126, v6, s[64:67], s71 offen
    s_add_u32 s71, s22, 4411392
    buffer_load_dword v127, v6, s[64:67], s71 offen
    s_waitcnt vmcnt(63)
    v_perm_b32 v132, v33, v32, s72
    v_perm_b32 v133, v35, v34, s72
    v_perm_b32 v134, v37, v36, s72
    v_perm_b32 v135, v39, v38, s72
    v_accvgpr_write_b32 a0, v132
    v_accvgpr_write_b32 a1, v133
    v_accvgpr_write_b32 a2, v134
    v_accvgpr_write_b32 a3, v135
    v_perm_b32 v136, v33, v32, s73
    v_perm_b32 v137, v35, v34, s73
    v_perm_b32 v138, v37, v36, s73
    v_perm_b32 v139, v39, v38, s73
    v_accvgpr_write_b32 a4, v136
    v_accvgpr_write_b32 a5, v137
    v_accvgpr_write_b32 a6, v138
    v_accvgpr_write_b32 a7, v139
    v_perm_b32 v140, v41, v40, s72
    v_perm_b32 v141, v43, v42, s72
    v_perm_b32 v142, v45, v44, s72
    v_perm_b32 v143, v47, v46, s72
    v_accvgpr_write_b32 a24, v140
    v_accvgpr_write_b32 a25, v141
    v_accvgpr_write_b32 a26, v142
    v_accvgpr_write_b32 a27, v143
    v_perm_b32 v144, v41, v40, s73
    v_perm_b32 v145, v43, v42, s73
    v_perm_b32 v146, v45, v44, s73
    v_perm_b32 v147, v47, v46, s73
    v_accvgpr_write_b32 a28, v144
    v_accvgpr_write_b32 a29, v145
    v_accvgpr_write_b32 a30, v146
    v_accvgpr_write_b32 a31, v147
    v_perm_b32 v132, v49, v48, s72
    v_perm_b32 v133, v51, v50, s72
    v_perm_b32 v134, v53, v52, s72
    v_perm_b32 v135, v55, v54, s72
    v_accvgpr_write_b32 a48, v132
    v_accvgpr_write_b32 a49, v133
    v_accvgpr_write_b32 a50, v134
    v_accvgpr_write_b32 a51, v135
    v_perm_b32 v136, v49, v48, s73
    v_perm_b32 v137, v51, v50, s73
    v_perm_b32 v138, v53, v52, s73
    v_perm_b32 v139, v55, v54, s73
    v_accvgpr_write_b32 a52, v136
    v_accvgpr_write_b32 a53, v137
    v_accvgpr_write_b32 a54, v138
    v_accvgpr_write_b32 a55, v139
    v_perm_b32 v140, v57, v56, s72
    v_perm_b32 v141, v59, v58, s72
    v_perm_b32 v142, v61, v60, s72
    v_perm_b32 v143, v63, v62, s72
    v_accvgpr_write_b32 a72, v140
    v_accvgpr_write_b32 a73, v141
    v_accvgpr_write_b32 a74, v142
    v_accvgpr_write_b32 a75, v143
    v_perm_b32 v144, v57, v56, s73
    v_perm_b32 v145, v59, v58, s73
    v_perm_b32 v146, v61, v60, s73
    v_perm_b32 v147, v63, v62, s73
    v_accvgpr_write_b32 a76, v144
    v_accvgpr_write_b32 a77, v145
    v_accvgpr_write_b32 a78, v146
    v_accvgpr_write_b32 a79, v147
    s_waitcnt lgkmcnt(0)
    s_add_u32 s71, s22, 4718592
    buffer_load_dword v32, v6, s[64:67], s71 offen
    s_add_u32 s71, s22, 4730880
    buffer_load_dword v33, v6, s[64:67], s71 offen
    s_add_u32 s71, s22, 4743168
    buffer_load_dword v34, v6, s[64:67], s71 offen
    s_add_u32 s71, s22, 4755456
    buffer_load_dword v35, v6, s[64:67], s71 offen
    s_add_u32 s71, s22, 4767744
    buffer_load_dword v36, v6, s[64:67], s71 offen
    s_add_u32 s71, s22, 4780032
    buffer_load_dword v37, v6, s[64:67], s71 offen
    s_add_u32 s71, s22, 4792320
    buffer_load_dword v38, v6, s[64:67], s71 offen
    s_add_u32 s71, s22, 4804608
    buffer_load_dword v39, v6, s[64:67], s71 offen
    s_add_u32 s71, s22, 5111808
    buffer_load_dword v40, v6, s[64:67], s71 offen
    s_add_u32 s71, s22, 5124096
    buffer_load_dword v41, v6, s[64:67], s71 offen
    s_add_u32 s71, s22, 5136384
    buffer_load_dword v42, v6, s[64:67], s71 offen
    s_add_u32 s71, s22, 5148672
    buffer_load_dword v43, v6, s[64:67], s71 offen
    s_add_u32 s71, s22, 5160960
    buffer_load_dword v44, v6, s[64:67], s71 offen
    s_add_u32 s71, s22, 5173248
    buffer_load_dword v45, v6, s[64:67], s71 offen
    s_add_u32 s71, s22, 5185536
    buffer_load_dword v46, v6, s[64:67], s71 offen
    s_add_u32 s71, s22, 5197824
    buffer_load_dword v47, v6, s[64:67], s71 offen
    s_add_u32 s71, s22, 5505024
    buffer_load_dword v48, v6, s[64:67], s71 offen
    s_add_u32 s71, s22, 5517312
    buffer_load_dword v49, v6, s[64:67], s71 offen
    s_add_u32 s71, s22, 5529600
    buffer_load_dword v50, v6, s[64:67], s71 offen
    s_add_u32 s71, s22, 5541888
    buffer_load_dword v51, v6, s[64:67], s71 offen
    s_add_u32 s71, s22, 5554176
    buffer_load_dword v52, v6, s[64:67], s71 offen
    s_add_u32 s71, s22, 5566464
    buffer_load_dword v53, v6, s[64:67], s71 offen
    s_add_u32 s71, s22, 5578752
    buffer_load_dword v54, v6, s[64:67], s71 offen
    s_add_u32 s71, s22, 5591040
    buffer_load_dword v55, v6, s[64:67], s71 offen
    s_add_u32 s71, s22, 5898240
    buffer_load_dword v56, v6, s[64:67], s71 offen
    s_add_u32 s71, s22, 5910528
    buffer_load_dword v57, v6, s[64:67], s71 offen
    s_add_u32 s71, s22, 5922816
    buffer_load_dword v58, v6, s[64:67], s71 offen
    s_add_u32 s71, s22, 5935104
    buffer_load_dword v59, v6, s[64:67], s71 offen
    s_add_u32 s71, s22, 5947392
    buffer_load_dword v60, v6, s[64:67], s71 offen
    s_add_u32 s71, s22, 5959680
    buffer_load_dword v61, v6, s[64:67], s71 offen
    s_add_u32 s71, s22, 5971968
    buffer_load_dword v62, v6, s[64:67], s71 offen
    s_add_u32 s71, s22, 5984256
    buffer_load_dword v63, v6, s[64:67], s71 offen
    s_waitcnt vmcnt(63)
    v_perm_b32 v132, v65, v64, s72
    v_perm_b32 v133, v67, v66, s72
    v_perm_b32 v134, v69, v68, s72
    v_perm_b32 v135, v71, v70, s72
    v_accvgpr_write_b32 a96, v132
    v_accvgpr_write_b32 a97, v133
    v_accvgpr_write_b32 a98, v134
    v_accvgpr_write_b32 a99, v135
    v_perm_b32 v136, v65, v64, s73
    v_perm_b32 v137, v67, v66, s73
    v_perm_b32 v138, v69, v68, s73
    v_perm_b32 v139, v71, v70, s73
    v_accvgpr_write_b32 a100, v136
    v_accvgpr_write_b32 a101, v137
    v_accvgpr_write_b32 a102, v138
    v_accvgpr_write_b32 a103, v139
    v_perm_b32 v140, v73, v72, s72
    v_perm_b32 v141, v75, v74, s72
    v_perm_b32 v142, v77, v76, s72
    v_perm_b32 v143, v79, v78, s72
    v_accvgpr_write_b32 a120, v140
    v_accvgpr_write_b32 a121, v141
    v_accvgpr_write_b32 a122, v142
    v_accvgpr_write_b32 a123, v143
    v_perm_b32 v144, v73, v72, s73
    v_perm_b32 v145, v75, v74, s73
    v_perm_b32 v146, v77, v76, s73
    v_perm_b32 v147, v79, v78, s73
    v_accvgpr_write_b32 a124, v144
    v_accvgpr_write_b32 a125, v145
    v_accvgpr_write_b32 a126, v146
    v_accvgpr_write_b32 a127, v147
    v_perm_b32 v132, v81, v80, s72
    v_perm_b32 v133, v83, v82, s72
    v_perm_b32 v134, v85, v84, s72
    v_perm_b32 v135, v87, v86, s72
    v_accvgpr_write_b32 a144, v132
    v_accvgpr_write_b32 a145, v133
    v_accvgpr_write_b32 a146, v134
    v_accvgpr_write_b32 a147, v135
    v_perm_b32 v136, v81, v80, s73
    v_perm_b32 v137, v83, v82, s73
    v_perm_b32 v138, v85, v84, s73
    v_perm_b32 v139, v87, v86, s73
    v_accvgpr_write_b32 a148, v136
    v_accvgpr_write_b32 a149, v137
    v_accvgpr_write_b32 a150, v138
    v_accvgpr_write_b32 a151, v139
    v_perm_b32 v140, v89, v88, s72
    v_perm_b32 v141, v91, v90, s72
    v_perm_b32 v142, v93, v92, s72
    v_perm_b32 v143, v95, v94, s72
    v_accvgpr_write_b32 a168, v140
    v_accvgpr_write_b32 a169, v141
    v_accvgpr_write_b32 a170, v142
    v_accvgpr_write_b32 a171, v143
    v_perm_b32 v144, v89, v88, s73
    v_perm_b32 v145, v91, v90, s73
    v_perm_b32 v146, v93, v92, s73
    v_perm_b32 v147, v95, v94, s73
    v_accvgpr_write_b32 a172, v144
    v_accvgpr_write_b32 a173, v145
    v_accvgpr_write_b32 a174, v146
    v_accvgpr_write_b32 a175, v147
    s_waitcnt lgkmcnt(0)
    s_add_u32 s71, s22, 6291456
    buffer_load_dword v64, v6, s[64:67], s71 offen
    s_add_u32 s71, s22, 6303744
    buffer_load_dword v65, v6, s[64:67], s71 offen
    s_add_u32 s71, s22, 6316032
    buffer_load_dword v66, v6, s[64:67], s71 offen
    s_add_u32 s71, s22, 6328320
    buffer_load_dword v67, v6, s[64:67], s71 offen
    s_add_u32 s71, s22, 6340608
    buffer_load_dword v68, v6, s[64:67], s71 offen
    s_add_u32 s71, s22, 6352896
    buffer_load_dword v69, v6, s[64:67], s71 offen
    s_add_u32 s71, s22, 6365184
    buffer_load_dword v70, v6, s[64:67], s71 offen
    s_add_u32 s71, s22, 6377472
    buffer_load_dword v71, v6, s[64:67], s71 offen
    s_add_u32 s71, s22, 6684672
    buffer_load_dword v72, v6, s[64:67], s71 offen
    s_add_u32 s71, s22, 6696960
    buffer_load_dword v73, v6, s[64:67], s71 offen
    s_add_u32 s71, s22, 6709248
    buffer_load_dword v74, v6, s[64:67], s71 offen
    s_add_u32 s71, s22, 6721536
    buffer_load_dword v75, v6, s[64:67], s71 offen
    s_add_u32 s71, s22, 6733824
    buffer_load_dword v76, v6, s[64:67], s71 offen
    s_add_u32 s71, s22, 6746112
    buffer_load_dword v77, v6, s[64:67], s71 offen
    s_add_u32 s71, s22, 6758400
    buffer_load_dword v78, v6, s[64:67], s71 offen
    s_add_u32 s71, s22, 6770688
    buffer_load_dword v79, v6, s[64:67], s71 offen
    s_add_u32 s71, s22, 7077888
    buffer_load_dword v80, v6, s[64:67], s71 offen
    s_add_u32 s71, s22, 7090176
    buffer_load_dword v81, v6, s[64:67], s71 offen
    s_add_u32 s71, s22, 7102464
    buffer_load_dword v82, v6, s[64:67], s71 offen
    s_add_u32 s71, s22, 7114752
    buffer_load_dword v83, v6, s[64:67], s71 offen
    s_add_u32 s71, s22, 7127040
    buffer_load_dword v84, v6, s[64:67], s71 offen
    s_add_u32 s71, s22, 7139328
    buffer_load_dword v85, v6, s[64:67], s71 offen
    s_add_u32 s71, s22, 7151616
    buffer_load_dword v86, v6, s[64:67], s71 offen
    s_add_u32 s71, s22, 7163904
    buffer_load_dword v87, v6, s[64:67], s71 offen
    s_add_u32 s71, s22, 7471104
    buffer_load_dword v88, v6, s[64:67], s71 offen
    s_add_u32 s71, s22, 7483392
    buffer_load_dword v89, v6, s[64:67], s71 offen
    s_add_u32 s71, s22, 7495680
    buffer_load_dword v90, v6, s[64:67], s71 offen
    s_add_u32 s71, s22, 7507968
    buffer_load_dword v91, v6, s[64:67], s71 offen
    s_add_u32 s71, s22, 7520256
    buffer_load_dword v92, v6, s[64:67], s71 offen
    s_add_u32 s71, s22, 7532544
    buffer_load_dword v93, v6, s[64:67], s71 offen
    s_add_u32 s71, s22, 7544832
    buffer_load_dword v94, v6, s[64:67], s71 offen
    s_add_u32 s71, s22, 7557120
    buffer_load_dword v95, v6, s[64:67], s71 offen
    s_waitcnt vmcnt(63)
    v_perm_b32 v132, v97, v96, s72
    v_perm_b32 v133, v99, v98, s72
    v_perm_b32 v134, v101, v100, s72
    v_perm_b32 v135, v103, v102, s72
    v_accvgpr_write_b32 a192, v132
    v_accvgpr_write_b32 a193, v133
    v_accvgpr_write_b32 a194, v134
    v_accvgpr_write_b32 a195, v135
    v_perm_b32 v136, v97, v96, s73
    v_perm_b32 v137, v99, v98, s73
    v_perm_b32 v138, v101, v100, s73
    v_perm_b32 v139, v103, v102, s73
    v_accvgpr_write_b32 a196, v136
    v_accvgpr_write_b32 a197, v137
    v_accvgpr_write_b32 a198, v138
    v_accvgpr_write_b32 a199, v139
    v_perm_b32 v140, v105, v104, s72
    v_perm_b32 v141, v107, v106, s72
    v_perm_b32 v142, v109, v108, s72
    v_perm_b32 v143, v111, v110, s72
    v_accvgpr_write_b32 a216, v140
    v_accvgpr_write_b32 a217, v141
    v_accvgpr_write_b32 a218, v142
    v_accvgpr_write_b32 a219, v143
    v_perm_b32 v144, v105, v104, s73
    v_perm_b32 v145, v107, v106, s73
    v_perm_b32 v146, v109, v108, s73
    v_perm_b32 v147, v111, v110, s73
    v_accvgpr_write_b32 a220, v144
    v_accvgpr_write_b32 a221, v145
    v_accvgpr_write_b32 a222, v146
    v_accvgpr_write_b32 a223, v147
    v_perm_b32 v132, v113, v112, s72
    v_perm_b32 v133, v115, v114, s72
    v_perm_b32 v134, v117, v116, s72
    v_perm_b32 v135, v119, v118, s72
    v_accvgpr_write_b32 a240, v132
    v_accvgpr_write_b32 a241, v133
    v_accvgpr_write_b32 a242, v134
    v_accvgpr_write_b32 a243, v135
    v_perm_b32 v136, v113, v112, s73
    v_perm_b32 v137, v115, v114, s73
    v_perm_b32 v138, v117, v116, s73
    v_perm_b32 v139, v119, v118, s73
    v_accvgpr_write_b32 a244, v136
    v_accvgpr_write_b32 a245, v137
    v_accvgpr_write_b32 a246, v138
    v_accvgpr_write_b32 a247, v139
    v_perm_b32 v140, v121, v120, s72
    v_perm_b32 v141, v123, v122, s72
    v_perm_b32 v142, v125, v124, s72
    v_perm_b32 v143, v127, v126, s72
    v_mov_b32 v172, v140
    v_mov_b32 v173, v141
    v_mov_b32 v174, v142
    v_mov_b32 v175, v143
    v_perm_b32 v144, v121, v120, s73
    v_perm_b32 v145, v123, v122, s73
    v_perm_b32 v146, v125, v124, s73
    v_perm_b32 v147, v127, v126, s73
    v_mov_b32 v176, v144
    v_mov_b32 v177, v145
    v_mov_b32 v178, v146
    v_mov_b32 v179, v147
    s_waitcnt lgkmcnt(0)
    s_waitcnt vmcnt(32)
    v_perm_b32 v132, v33, v32, s72
    v_perm_b32 v133, v35, v34, s72
    v_perm_b32 v134, v37, v36, s72
    v_perm_b32 v135, v39, v38, s72
    v_mov_b32 v196, v132
    v_mov_b32 v197, v133
    v_mov_b32 v198, v134
    v_mov_b32 v199, v135
    v_perm_b32 v136, v33, v32, s73
    v_perm_b32 v137, v35, v34, s73
    v_perm_b32 v138, v37, v36, s73
    v_perm_b32 v139, v39, v38, s73
    v_mov_b32 v200, v136
    v_mov_b32 v201, v137
    v_mov_b32 v202, v138
    v_mov_b32 v203, v139
    v_perm_b32 v140, v41, v40, s72
    v_perm_b32 v141, v43, v42, s72
    v_perm_b32 v142, v45, v44, s72
    v_perm_b32 v143, v47, v46, s72
    v_mov_b32 v220, v140
    v_mov_b32 v221, v141
    v_mov_b32 v222, v142
    v_mov_b32 v223, v143
    v_perm_b32 v144, v41, v40, s73
    v_perm_b32 v145, v43, v42, s73
    v_perm_b32 v146, v45, v44, s73
    v_perm_b32 v147, v47, v46, s73
    v_mov_b32 v224, v144
    v_mov_b32 v225, v145
    v_mov_b32 v226, v146
    v_mov_b32 v227, v147
    v_perm_b32 v132, v49, v48, s72
    v_perm_b32 v133, v51, v50, s72
    v_perm_b32 v134, v53, v52, s72
    v_perm_b32 v135, v55, v54, s72
    v_mov_b32 v244, v132
    v_mov_b32 v245, v133
    v_mov_b32 v246, v134
    v_mov_b32 v247, v135
    v_perm_b32 v136, v49, v48, s73
    v_perm_b32 v137, v51, v50, s73
    v_perm_b32 v138, v53, v52, s73
    v_perm_b32 v139, v55, v54, s73
    v_mov_b32 v248, v136
    v_mov_b32 v249, v137
    v_mov_b32 v250, v138
    v_mov_b32 v251, v139
    v_perm_b32 v140, v57, v56, s72
    v_perm_b32 v141, v59, v58, s72
    v_perm_b32 v142, v61, v60, s72
    v_perm_b32 v143, v63, v62, s72
    ds_write_b128 v19, v[140:143] offset:3072
    v_perm_b32 v144, v57, v56, s73
    v_perm_b32 v145, v59, v58, s73
    v_perm_b32 v146, v61, v60, s73
    v_perm_b32 v147, v63, v62, s73
    ds_write_b128 v19, v[144:147] offset:4096
    s_waitcnt lgkmcnt(0)
    s_waitcnt vmcnt(0)
    v_perm_b32 v132, v65, v64, s72
    v_perm_b32 v133, v67, v66, s72
    v_perm_b32 v134, v69, v68, s72
    v_perm_b32 v135, v71, v70, s72
    ds_write_b128 v19, v[132:135] offset:9216
    v_perm_b32 v136, v65, v64, s73
    v_perm_b32 v137, v67, v66, s73
    v_perm_b32 v138, v69, v68, s73
    v_perm_b32 v139, v71, v70, s73
    ds_write_b128 v19, v[136:139] offset:10240
    v_perm_b32 v140, v73, v72, s72
    v_perm_b32 v141, v75, v74, s72
    v_perm_b32 v142, v77, v76, s72
    v_perm_b32 v143, v79, v78, s72
    ds_write_b128 v19, v[140:143] offset:15360
    v_perm_b32 v144, v73, v72, s73
    v_perm_b32 v145, v75, v74, s73
    v_perm_b32 v146, v77, v76, s73
    v_perm_b32 v147, v79, v78, s73
    ds_write_b128 v19, v[144:147] offset:16384
    v_perm_b32 v132, v81, v80, s72
    v_perm_b32 v133, v83, v82, s72
    v_perm_b32 v134, v85, v84, s72
    v_perm_b32 v135, v87, v86, s72
    ds_write_b128 v19, v[132:135] offset:21504
    v_perm_b32 v136, v81, v80, s73
    v_perm_b32 v137, v83, v82, s73
    v_perm_b32 v138, v85, v84, s73
    v_perm_b32 v139, v87, v86, s73
    ds_write_b128 v19, v[136:139] offset:22528
    v_perm_b32 v140, v89, v88, s72
    v_perm_b32 v141, v91, v90, s72
    v_perm_b32 v142, v93, v92, s72
    v_perm_b32 v143, v95, v94, s72
    ds_write_b128 v19, v[140:143] offset:27648
    v_perm_b32 v144, v89, v88, s73
    v_perm_b32 v145, v91, v90, s73
    v_perm_b32 v146, v93, v92, s73
    v_perm_b32 v147, v95, v94, s73
    ds_write_b128 v19, v[144:147] offset:28672
    s_waitcnt lgkmcnt(0)
    s_add_u32 s22, s21, 64
    s_add_u32 s71, s22, 0
    buffer_load_dword v32, v6, s[64:67], s71 offen
    s_add_u32 s71, s22, 12288
    buffer_load_dword v33, v6, s[64:67], s71 offen
    s_add_u32 s71, s22, 24576
    buffer_load_dword v34, v6, s[64:67], s71 offen
    s_add_u32 s71, s22, 36864
    buffer_load_dword v35, v6, s[64:67], s71 offen
    s_add_u32 s71, s22, 49152
    buffer_load_dword v36, v6, s[64:67], s71 offen
    s_add_u32 s71, s22, 61440
    buffer_load_dword v37, v6, s[64:67], s71 offen
    s_add_u32 s71, s22, 73728
    buffer_load_dword v38, v6, s[64:67], s71 offen
    s_add_u32 s71, s22, 86016
    buffer_load_dword v39, v6, s[64:67], s71 offen
    s_add_u32 s71, s22, 393216
    buffer_load_dword v40, v6, s[64:67], s71 offen
    s_add_u32 s71, s22, 405504
    buffer_load_dword v41, v6, s[64:67], s71 offen
    s_add_u32 s71, s22, 417792
    buffer_load_dword v42, v6, s[64:67], s71 offen
    s_add_u32 s71, s22, 430080
    buffer_load_dword v43, v6, s[64:67], s71 offen
    s_add_u32 s71, s22, 442368
    buffer_load_dword v44, v6, s[64:67], s71 offen
    s_add_u32 s71, s22, 454656
    buffer_load_dword v45, v6, s[64:67], s71 offen
    s_add_u32 s71, s22, 466944
    buffer_load_dword v46, v6, s[64:67], s71 offen
    s_add_u32 s71, s22, 479232
    buffer_load_dword v47, v6, s[64:67], s71 offen
    s_add_u32 s71, s22, 786432
    buffer_load_dword v48, v6, s[64:67], s71 offen
    s_add_u32 s71, s22, 798720
    buffer_load_dword v49, v6, s[64:67], s71 offen
    s_add_u32 s71, s22, 811008
    buffer_load_dword v50, v6, s[64:67], s71 offen
    s_add_u32 s71, s22, 823296
    buffer_load_dword v51, v6, s[64:67], s71 offen
    s_add_u32 s71, s22, 835584
    buffer_load_dword v52, v6, s[64:67], s71 offen
    s_add_u32 s71, s22, 847872
    buffer_load_dword v53, v6, s[64:67], s71 offen
    s_add_u32 s71, s22, 860160
    buffer_load_dword v54, v6, s[64:67], s71 offen
    s_add_u32 s71, s22, 872448
    buffer_load_dword v55, v6, s[64:67], s71 offen
    s_add_u32 s71, s22, 1179648
    buffer_load_dword v56, v6, s[64:67], s71 offen
    s_add_u32 s71, s22, 1191936
    buffer_load_dword v57, v6, s[64:67], s71 offen
    s_add_u32 s71, s22, 1204224
    buffer_load_dword v58, v6, s[64:67], s71 offen
    s_add_u32 s71, s22, 1216512
    buffer_load_dword v59, v6, s[64:67], s71 offen
    s_add_u32 s71, s22, 1228800
    buffer_load_dword v60, v6, s[64:67], s71 offen
    s_add_u32 s71, s22, 1241088
    buffer_load_dword v61, v6, s[64:67], s71 offen
    s_add_u32 s71, s22, 1253376
    buffer_load_dword v62, v6, s[64:67], s71 offen
    s_add_u32 s71, s22, 1265664
    buffer_load_dword v63, v6, s[64:67], s71 offen
    s_add_u32 s71, s22, 1572864
    buffer_load_dword v64, v6, s[64:67], s71 offen
    s_add_u32 s71, s22, 1585152
    buffer_load_dword v65, v6, s[64:67], s71 offen
    s_add_u32 s71, s22, 1597440
    buffer_load_dword v66, v6, s[64:67], s71 offen
    s_add_u32 s71, s22, 1609728
    buffer_load_dword v67, v6, s[64:67], s71 offen
    s_add_u32 s71, s22, 1622016
    buffer_load_dword v68, v6, s[64:67], s71 offen
    s_add_u32 s71, s22, 1634304
    buffer_load_dword v69, v6, s[64:67], s71 offen
    s_add_u32 s71, s22, 1646592
    buffer_load_dword v70, v6, s[64:67], s71 offen
    s_add_u32 s71, s22, 1658880
    buffer_load_dword v71, v6, s[64:67], s71 offen
    s_add_u32 s71, s22, 1966080
    buffer_load_dword v72, v6, s[64:67], s71 offen
    s_add_u32 s71, s22, 1978368
    buffer_load_dword v73, v6, s[64:67], s71 offen
    s_add_u32 s71, s22, 1990656
    buffer_load_dword v74, v6, s[64:67], s71 offen
    s_add_u32 s71, s22, 2002944
    buffer_load_dword v75, v6, s[64:67], s71 offen
    s_add_u32 s71, s22, 2015232
    buffer_load_dword v76, v6, s[64:67], s71 offen
    s_add_u32 s71, s22, 2027520
    buffer_load_dword v77, v6, s[64:67], s71 offen
    s_add_u32 s71, s22, 2039808
    buffer_load_dword v78, v6, s[64:67], s71 offen
    s_add_u32 s71, s22, 2052096
    buffer_load_dword v79, v6, s[64:67], s71 offen
    s_add_u32 s71, s22, 2359296
    buffer_load_dword v80, v6, s[64:67], s71 offen
    s_add_u32 s71, s22, 2371584
    buffer_load_dword v81, v6, s[64:67], s71 offen
    s_add_u32 s71, s22, 2383872
    buffer_load_dword v82, v6, s[64:67], s71 offen
    s_add_u32 s71, s22, 2396160
    buffer_load_dword v83, v6, s[64:67], s71 offen
    s_add_u32 s71, s22, 2408448
    buffer_load_dword v84, v6, s[64:67], s71 offen
    s_add_u32 s71, s22, 2420736
    buffer_load_dword v85, v6, s[64:67], s71 offen
    s_add_u32 s71, s22, 2433024
    buffer_load_dword v86, v6, s[64:67], s71 offen
    s_add_u32 s71, s22, 2445312
    buffer_load_dword v87, v6, s[64:67], s71 offen
    s_add_u32 s71, s22, 2752512
    buffer_load_dword v88, v6, s[64:67], s71 offen
    s_add_u32 s71, s22, 2764800
    buffer_load_dword v89, v6, s[64:67], s71 offen
    s_add_u32 s71, s22, 2777088
    buffer_load_dword v90, v6, s[64:67], s71 offen
    s_add_u32 s71, s22, 2789376
    buffer_load_dword v91, v6, s[64:67], s71 offen
    s_add_u32 s71, s22, 2801664
    buffer_load_dword v92, v6, s[64:67], s71 offen
    s_add_u32 s71, s22, 2813952
    buffer_load_dword v93, v6, s[64:67], s71 offen
    s_add_u32 s71, s22, 2826240
    buffer_load_dword v94, v6, s[64:67], s71 offen
    s_add_u32 s71, s22, 2838528
    buffer_load_dword v95, v6, s[64:67], s71 offen
    s_add_u32 s71, s22, 3145728
    buffer_load_dword v96, v6, s[64:67], s71 offen
    s_add_u32 s71, s22, 3158016
    buffer_load_dword v97, v6, s[64:67], s71 offen
    s_add_u32 s71, s22, 3170304
    buffer_load_dword v98, v6, s[64:67], s71 offen
    s_add_u32 s71, s22, 3182592
    buffer_load_dword v99, v6, s[64:67], s71 offen
    s_add_u32 s71, s22, 3194880
    buffer_load_dword v100, v6, s[64:67], s71 offen
    s_add_u32 s71, s22, 3207168
    buffer_load_dword v101, v6, s[64:67], s71 offen
    s_add_u32 s71, s22, 3219456
    buffer_load_dword v102, v6, s[64:67], s71 offen
    s_add_u32 s71, s22, 3231744
    buffer_load_dword v103, v6, s[64:67], s71 offen
    s_add_u32 s71, s22, 3538944
    buffer_load_dword v104, v6, s[64:67], s71 offen
    s_add_u32 s71, s22, 3551232
    buffer_load_dword v105, v6, s[64:67], s71 offen
    s_add_u32 s71, s22, 3563520
    buffer_load_dword v106, v6, s[64:67], s71 offen
    s_add_u32 s71, s22, 3575808
    buffer_load_dword v107, v6, s[64:67], s71 offen
    s_add_u32 s71, s22, 3588096
    buffer_load_dword v108, v6, s[64:67], s71 offen
    s_add_u32 s71, s22, 3600384
    buffer_load_dword v109, v6, s[64:67], s71 offen
    s_add_u32 s71, s22, 3612672
    buffer_load_dword v110, v6, s[64:67], s71 offen
    s_add_u32 s71, s22, 3624960
    buffer_load_dword v111, v6, s[64:67], s71 offen
    s_add_u32 s71, s22, 3932160
    buffer_load_dword v112, v6, s[64:67], s71 offen
    s_add_u32 s71, s22, 3944448
    buffer_load_dword v113, v6, s[64:67], s71 offen
    s_add_u32 s71, s22, 3956736
    buffer_load_dword v114, v6, s[64:67], s71 offen
    s_add_u32 s71, s22, 3969024
    buffer_load_dword v115, v6, s[64:67], s71 offen
    s_add_u32 s71, s22, 3981312
    buffer_load_dword v116, v6, s[64:67], s71 offen
    s_add_u32 s71, s22, 3993600
    buffer_load_dword v117, v6, s[64:67], s71 offen
    s_add_u32 s71, s22, 4005888
    buffer_load_dword v118, v6, s[64:67], s71 offen
    s_add_u32 s71, s22, 4018176
    buffer_load_dword v119, v6, s[64:67], s71 offen
    s_add_u32 s71, s22, 4325376
    buffer_load_dword v120, v6, s[64:67], s71 offen
    s_add_u32 s71, s22, 4337664
    buffer_load_dword v121, v6, s[64:67], s71 offen
    s_add_u32 s71, s22, 4349952
    buffer_load_dword v122, v6, s[64:67], s71 offen
    s_add_u32 s71, s22, 4362240
    buffer_load_dword v123, v6, s[64:67], s71 offen
    s_add_u32 s71, s22, 4374528
    buffer_load_dword v124, v6, s[64:67], s71 offen
    s_add_u32 s71, s22, 4386816
    buffer_load_dword v125, v6, s[64:67], s71 offen
    s_add_u32 s71, s22, 4399104
    buffer_load_dword v126, v6, s[64:67], s71 offen
    s_add_u32 s71, s22, 4411392
    buffer_load_dword v127, v6, s[64:67], s71 offen
    s_waitcnt vmcnt(63)
    v_perm_b32 v132, v33, v32, s72
    v_perm_b32 v133, v35, v34, s72
    v_perm_b32 v134, v37, v36, s72
    v_perm_b32 v135, v39, v38, s72
    v_accvgpr_write_b32 a8, v132
    v_accvgpr_write_b32 a9, v133
    v_accvgpr_write_b32 a10, v134
    v_accvgpr_write_b32 a11, v135
    v_perm_b32 v136, v33, v32, s73
    v_perm_b32 v137, v35, v34, s73
    v_perm_b32 v138, v37, v36, s73
    v_perm_b32 v139, v39, v38, s73
    v_accvgpr_write_b32 a12, v136
    v_accvgpr_write_b32 a13, v137
    v_accvgpr_write_b32 a14, v138
    v_accvgpr_write_b32 a15, v139
    v_perm_b32 v140, v41, v40, s72
    v_perm_b32 v141, v43, v42, s72
    v_perm_b32 v142, v45, v44, s72
    v_perm_b32 v143, v47, v46, s72
    v_accvgpr_write_b32 a32, v140
    v_accvgpr_write_b32 a33, v141
    v_accvgpr_write_b32 a34, v142
    v_accvgpr_write_b32 a35, v143
    v_perm_b32 v144, v41, v40, s73
    v_perm_b32 v145, v43, v42, s73
    v_perm_b32 v146, v45, v44, s73
    v_perm_b32 v147, v47, v46, s73
    v_accvgpr_write_b32 a36, v144
    v_accvgpr_write_b32 a37, v145
    v_accvgpr_write_b32 a38, v146
    v_accvgpr_write_b32 a39, v147
    v_perm_b32 v132, v49, v48, s72
    v_perm_b32 v133, v51, v50, s72
    v_perm_b32 v134, v53, v52, s72
    v_perm_b32 v135, v55, v54, s72
    v_accvgpr_write_b32 a56, v132
    v_accvgpr_write_b32 a57, v133
    v_accvgpr_write_b32 a58, v134
    v_accvgpr_write_b32 a59, v135
    v_perm_b32 v136, v49, v48, s73
    v_perm_b32 v137, v51, v50, s73
    v_perm_b32 v138, v53, v52, s73
    v_perm_b32 v139, v55, v54, s73
    v_accvgpr_write_b32 a60, v136
    v_accvgpr_write_b32 a61, v137
    v_accvgpr_write_b32 a62, v138
    v_accvgpr_write_b32 a63, v139
    v_perm_b32 v140, v57, v56, s72
    v_perm_b32 v141, v59, v58, s72
    v_perm_b32 v142, v61, v60, s72
    v_perm_b32 v143, v63, v62, s72
    v_accvgpr_write_b32 a80, v140
    v_accvgpr_write_b32 a81, v141
    v_accvgpr_write_b32 a82, v142
    v_accvgpr_write_b32 a83, v143
    v_perm_b32 v144, v57, v56, s73
    v_perm_b32 v145, v59, v58, s73
    v_perm_b32 v146, v61, v60, s73
    v_perm_b32 v147, v63, v62, s73
    v_accvgpr_write_b32 a84, v144
    v_accvgpr_write_b32 a85, v145
    v_accvgpr_write_b32 a86, v146
    v_accvgpr_write_b32 a87, v147
    s_waitcnt lgkmcnt(0)
    s_add_u32 s71, s22, 4718592
    buffer_load_dword v32, v6, s[64:67], s71 offen
    s_add_u32 s71, s22, 4730880
    buffer_load_dword v33, v6, s[64:67], s71 offen
    s_add_u32 s71, s22, 4743168
    buffer_load_dword v34, v6, s[64:67], s71 offen
    s_add_u32 s71, s22, 4755456
    buffer_load_dword v35, v6, s[64:67], s71 offen
    s_add_u32 s71, s22, 4767744
    buffer_load_dword v36, v6, s[64:67], s71 offen
    s_add_u32 s71, s22, 4780032
    buffer_load_dword v37, v6, s[64:67], s71 offen
    s_add_u32 s71, s22, 4792320
    buffer_load_dword v38, v6, s[64:67], s71 offen
    s_add_u32 s71, s22, 4804608
    buffer_load_dword v39, v6, s[64:67], s71 offen
    s_add_u32 s71, s22, 5111808
    buffer_load_dword v40, v6, s[64:67], s71 offen
    s_add_u32 s71, s22, 5124096
    buffer_load_dword v41, v6, s[64:67], s71 offen
    s_add_u32 s71, s22, 5136384
    buffer_load_dword v42, v6, s[64:67], s71 offen
    s_add_u32 s71, s22, 5148672
    buffer_load_dword v43, v6, s[64:67], s71 offen
    s_add_u32 s71, s22, 5160960
    buffer_load_dword v44, v6, s[64:67], s71 offen
    s_add_u32 s71, s22, 5173248
    buffer_load_dword v45, v6, s[64:67], s71 offen
    s_add_u32 s71, s22, 5185536
    buffer_load_dword v46, v6, s[64:67], s71 offen
    s_add_u32 s71, s22, 5197824
    buffer_load_dword v47, v6, s[64:67], s71 offen
    s_add_u32 s71, s22, 5505024
    buffer_load_dword v48, v6, s[64:67], s71 offen
    s_add_u32 s71, s22, 5517312
    buffer_load_dword v49, v6, s[64:67], s71 offen
    s_add_u32 s71, s22, 5529600
    buffer_load_dword v50, v6, s[64:67], s71 offen
    s_add_u32 s71, s22, 5541888
    buffer_load_dword v51, v6, s[64:67], s71 offen
    s_add_u32 s71, s22, 5554176
    buffer_load_dword v52, v6, s[64:67], s71 offen
    s_add_u32 s71, s22, 5566464
    buffer_load_dword v53, v6, s[64:67], s71 offen
    s_add_u32 s71, s22, 5578752
    buffer_load_dword v54, v6, s[64:67], s71 offen
    s_add_u32 s71, s22, 5591040
    buffer_load_dword v55, v6, s[64:67], s71 offen
    s_add_u32 s71, s22, 5898240
    buffer_load_dword v56, v6, s[64:67], s71 offen
    s_add_u32 s71, s22, 5910528
    buffer_load_dword v57, v6, s[64:67], s71 offen
    s_add_u32 s71, s22, 5922816
    buffer_load_dword v58, v6, s[64:67], s71 offen
    s_add_u32 s71, s22, 5935104
    buffer_load_dword v59, v6, s[64:67], s71 offen
    s_add_u32 s71, s22, 5947392
    buffer_load_dword v60, v6, s[64:67], s71 offen
    s_add_u32 s71, s22, 5959680
    buffer_load_dword v61, v6, s[64:67], s71 offen
    s_add_u32 s71, s22, 5971968
    buffer_load_dword v62, v6, s[64:67], s71 offen
    s_add_u32 s71, s22, 5984256
    buffer_load_dword v63, v6, s[64:67], s71 offen
    s_waitcnt vmcnt(63)
    v_perm_b32 v132, v65, v64, s72
    v_perm_b32 v133, v67, v66, s72
    v_perm_b32 v134, v69, v68, s72
    v_perm_b32 v135, v71, v70, s72
    v_accvgpr_write_b32 a104, v132
    v_accvgpr_write_b32 a105, v133
    v_accvgpr_write_b32 a106, v134
    v_accvgpr_write_b32 a107, v135
    v_perm_b32 v136, v65, v64, s73
    v_perm_b32 v137, v67, v66, s73
    v_perm_b32 v138, v69, v68, s73
    v_perm_b32 v139, v71, v70, s73
    v_accvgpr_write_b32 a108, v136
    v_accvgpr_write_b32 a109, v137
    v_accvgpr_write_b32 a110, v138
    v_accvgpr_write_b32 a111, v139
    v_perm_b32 v140, v73, v72, s72
    v_perm_b32 v141, v75, v74, s72
    v_perm_b32 v142, v77, v76, s72
    v_perm_b32 v143, v79, v78, s72
    v_accvgpr_write_b32 a128, v140
    v_accvgpr_write_b32 a129, v141
    v_accvgpr_write_b32 a130, v142
    v_accvgpr_write_b32 a131, v143
    v_perm_b32 v144, v73, v72, s73
    v_perm_b32 v145, v75, v74, s73
    v_perm_b32 v146, v77, v76, s73
    v_perm_b32 v147, v79, v78, s73
    v_accvgpr_write_b32 a132, v144
    v_accvgpr_write_b32 a133, v145
    v_accvgpr_write_b32 a134, v146
    v_accvgpr_write_b32 a135, v147
    v_perm_b32 v132, v81, v80, s72
    v_perm_b32 v133, v83, v82, s72
    v_perm_b32 v134, v85, v84, s72
    v_perm_b32 v135, v87, v86, s72
    v_accvgpr_write_b32 a152, v132
    v_accvgpr_write_b32 a153, v133
    v_accvgpr_write_b32 a154, v134
    v_accvgpr_write_b32 a155, v135
    v_perm_b32 v136, v81, v80, s73
    v_perm_b32 v137, v83, v82, s73
    v_perm_b32 v138, v85, v84, s73
    v_perm_b32 v139, v87, v86, s73
    v_accvgpr_write_b32 a156, v136
    v_accvgpr_write_b32 a157, v137
    v_accvgpr_write_b32 a158, v138
    v_accvgpr_write_b32 a159, v139
    v_perm_b32 v140, v89, v88, s72
    v_perm_b32 v141, v91, v90, s72
    v_perm_b32 v142, v93, v92, s72
    v_perm_b32 v143, v95, v94, s72
    v_accvgpr_write_b32 a176, v140
    v_accvgpr_write_b32 a177, v141
    v_accvgpr_write_b32 a178, v142
    v_accvgpr_write_b32 a179, v143
    v_perm_b32 v144, v89, v88, s73
    v_perm_b32 v145, v91, v90, s73
    v_perm_b32 v146, v93, v92, s73
    v_perm_b32 v147, v95, v94, s73
    v_accvgpr_write_b32 a180, v144
    v_accvgpr_write_b32 a181, v145
    v_accvgpr_write_b32 a182, v146
    v_accvgpr_write_b32 a183, v147
    s_waitcnt lgkmcnt(0)
    s_add_u32 s71, s22, 6291456
    buffer_load_dword v64, v6, s[64:67], s71 offen
    s_add_u32 s71, s22, 6303744
    buffer_load_dword v65, v6, s[64:67], s71 offen
    s_add_u32 s71, s22, 6316032
    buffer_load_dword v66, v6, s[64:67], s71 offen
    s_add_u32 s71, s22, 6328320
    buffer_load_dword v67, v6, s[64:67], s71 offen
    s_add_u32 s71, s22, 6340608
    buffer_load_dword v68, v6, s[64:67], s71 offen
    s_add_u32 s71, s22, 6352896
    buffer_load_dword v69, v6, s[64:67], s71 offen
    s_add_u32 s71, s22, 6365184
    buffer_load_dword v70, v6, s[64:67], s71 offen
    s_add_u32 s71, s22, 6377472
    buffer_load_dword v71, v6, s[64:67], s71 offen
    s_add_u32 s71, s22, 6684672
    buffer_load_dword v72, v6, s[64:67], s71 offen
    s_add_u32 s71, s22, 6696960
    buffer_load_dword v73, v6, s[64:67], s71 offen
    s_add_u32 s71, s22, 6709248
    buffer_load_dword v74, v6, s[64:67], s71 offen
    s_add_u32 s71, s22, 6721536
    buffer_load_dword v75, v6, s[64:67], s71 offen
    s_add_u32 s71, s22, 6733824
    buffer_load_dword v76, v6, s[64:67], s71 offen
    s_add_u32 s71, s22, 6746112
    buffer_load_dword v77, v6, s[64:67], s71 offen
    s_add_u32 s71, s22, 6758400
    buffer_load_dword v78, v6, s[64:67], s71 offen
    s_add_u32 s71, s22, 6770688
    buffer_load_dword v79, v6, s[64:67], s71 offen
    s_add_u32 s71, s22, 7077888
    buffer_load_dword v80, v6, s[64:67], s71 offen
    s_add_u32 s71, s22, 7090176
    buffer_load_dword v81, v6, s[64:67], s71 offen
    s_add_u32 s71, s22, 7102464
    buffer_load_dword v82, v6, s[64:67], s71 offen
    s_add_u32 s71, s22, 7114752
    buffer_load_dword v83, v6, s[64:67], s71 offen
    s_add_u32 s71, s22, 7127040
    buffer_load_dword v84, v6, s[64:67], s71 offen
    s_add_u32 s71, s22, 7139328
    buffer_load_dword v85, v6, s[64:67], s71 offen
    s_add_u32 s71, s22, 7151616
    buffer_load_dword v86, v6, s[64:67], s71 offen
    s_add_u32 s71, s22, 7163904
    buffer_load_dword v87, v6, s[64:67], s71 offen
    s_add_u32 s71, s22, 7471104
    buffer_load_dword v88, v6, s[64:67], s71 offen
    s_add_u32 s71, s22, 7483392
    buffer_load_dword v89, v6, s[64:67], s71 offen
    s_add_u32 s71, s22, 7495680
    buffer_load_dword v90, v6, s[64:67], s71 offen
    s_add_u32 s71, s22, 7507968
    buffer_load_dword v91, v6, s[64:67], s71 offen
    s_add_u32 s71, s22, 7520256
    buffer_load_dword v92, v6, s[64:67], s71 offen
    s_add_u32 s71, s22, 7532544
    buffer_load_dword v93, v6, s[64:67], s71 offen
    s_add_u32 s71, s22, 7544832
    buffer_load_dword v94, v6, s[64:67], s71 offen
    s_add_u32 s71, s22, 7557120
    buffer_load_dword v95, v6, s[64:67], s71 offen
    s_waitcnt vmcnt(63)
    v_perm_b32 v132, v97, v96, s72
    v_perm_b32 v133, v99, v98, s72
    v_perm_b32 v134, v101, v100, s72
    v_perm_b32 v135, v103, v102, s72
    v_accvgpr_write_b32 a200, v132
    v_accvgpr_write_b32 a201, v133
    v_accvgpr_write_b32 a202, v134
    v_accvgpr_write_b32 a203, v135
    v_perm_b32 v136, v97, v96, s73
    v_perm_b32 v137, v99, v98, s73
    v_perm_b32 v138, v101, v100, s73
    v_perm_b32 v139, v103, v102, s73
    v_accvgpr_write_b32 a204, v136
    v_accvgpr_write_b32 a205, v137
    v_accvgpr_write_b32 a206, v138
    v_accvgpr_write_b32 a207, v139
    v_perm_b32 v140, v105, v104, s72
    v_perm_b32 v141, v107, v106, s72
    v_perm_b32 v142, v109, v108, s72
    v_perm_b32 v143, v111, v110, s72
    v_accvgpr_write_b32 a224, v140
    v_accvgpr_write_b32 a225, v141
    v_accvgpr_write_b32 a226, v142
    v_accvgpr_write_b32 a227, v143
    v_perm_b32 v144, v105, v104, s73
    v_perm_b32 v145, v107, v106, s73
    v_perm_b32 v146, v109, v108, s73
    v_perm_b32 v147, v111, v110, s73
    v_accvgpr_write_b32 a228, v144
    v_accvgpr_write_b32 a229, v145
    v_accvgpr_write_b32 a230, v146
    v_accvgpr_write_b32 a231, v147
    v_perm_b32 v132, v113, v112, s72
    v_perm_b32 v133, v115, v114, s72
    v_perm_b32 v134, v117, v116, s72
    v_perm_b32 v135, v119, v118, s72
    v_accvgpr_write_b32 a248, v132
    v_accvgpr_write_b32 a249, v133
    v_accvgpr_write_b32 a250, v134
    v_accvgpr_write_b32 a251, v135
    v_perm_b32 v136, v113, v112, s73
    v_perm_b32 v137, v115, v114, s73
    v_perm_b32 v138, v117, v116, s73
    v_perm_b32 v139, v119, v118, s73
    v_accvgpr_write_b32 a252, v136
    v_accvgpr_write_b32 a253, v137
    v_accvgpr_write_b32 a254, v138
    v_accvgpr_write_b32 a255, v139
    v_perm_b32 v140, v121, v120, s72
    v_perm_b32 v141, v123, v122, s72
    v_perm_b32 v142, v125, v124, s72
    v_perm_b32 v143, v127, v126, s72
    v_mov_b32 v180, v140
    v_mov_b32 v181, v141
    v_mov_b32 v182, v142
    v_mov_b32 v183, v143
    v_perm_b32 v144, v121, v120, s73
    v_perm_b32 v145, v123, v122, s73
    v_perm_b32 v146, v125, v124, s73
    v_perm_b32 v147, v127, v126, s73
    v_mov_b32 v184, v144
    v_mov_b32 v185, v145
    v_mov_b32 v186, v146
    v_mov_b32 v187, v147
    s_waitcnt lgkmcnt(0)
    s_waitcnt vmcnt(32)
    v_perm_b32 v132, v33, v32, s72
    v_perm_b32 v133, v35, v34, s72
    v_perm_b32 v134, v37, v36, s72
    v_perm_b32 v135, v39, v38, s72
    v_mov_b32 v204, v132
    v_mov_b32 v205, v133
    v_mov_b32 v206, v134
    v_mov_b32 v207, v135
    v_perm_b32 v136, v33, v32, s73
    v_perm_b32 v137, v35, v34, s73
    v_perm_b32 v138, v37, v36, s73
    v_perm_b32 v139, v39, v38, s73
    v_mov_b32 v208, v136
    v_mov_b32 v209, v137
    v_mov_b32 v210, v138
    v_mov_b32 v211, v139
    v_perm_b32 v140, v41, v40, s72
    v_perm_b32 v141, v43, v42, s72
    v_perm_b32 v142, v45, v44, s72
    v_perm_b32 v143, v47, v46, s72
    v_mov_b32 v228, v140
    v_mov_b32 v229, v141
    v_mov_b32 v230, v142
    v_mov_b32 v231, v143
    v_perm_b32 v144, v41, v40, s73
    v_perm_b32 v145, v43, v42, s73
    v_perm_b32 v146, v45, v44, s73
    v_perm_b32 v147, v47, v46, s73
    v_mov_b32 v232, v144
    v_mov_b32 v233, v145
    v_mov_b32 v234, v146
    v_mov_b32 v235, v147
    v_perm_b32 v132, v49, v48, s72
    v_perm_b32 v133, v51, v50, s72
    v_perm_b32 v134, v53, v52, s72
    v_perm_b32 v135, v55, v54, s72
    v_mov_b32 v252, v132
    v_mov_b32 v253, v133
    v_mov_b32 v254, v134
    v_mov_b32 v255, v135
    v_perm_b32 v136, v49, v48, s73
    v_perm_b32 v137, v51, v50, s73
    v_perm_b32 v138, v53, v52, s73
    v_perm_b32 v139, v55, v54, s73
    ds_write_b128 v19, v[136:139] offset:0
    v_perm_b32 v140, v57, v56, s72
    v_perm_b32 v141, v59, v58, s72
    v_perm_b32 v142, v61, v60, s72
    v_perm_b32 v143, v63, v62, s72
    ds_write_b128 v19, v[140:143] offset:5120
    v_perm_b32 v144, v57, v56, s73
    v_perm_b32 v145, v59, v58, s73
    v_perm_b32 v146, v61, v60, s73
    v_perm_b32 v147, v63, v62, s73
    ds_write_b128 v19, v[144:147] offset:6144
    s_waitcnt lgkmcnt(0)
    s_waitcnt vmcnt(0)
    v_perm_b32 v132, v65, v64, s72
    v_perm_b32 v133, v67, v66, s72
    v_perm_b32 v134, v69, v68, s72
    v_perm_b32 v135, v71, v70, s72
    ds_write_b128 v19, v[132:135] offset:11264
    v_perm_b32 v136, v65, v64, s73
    v_perm_b32 v137, v67, v66, s73
    v_perm_b32 v138, v69, v68, s73
    v_perm_b32 v139, v71, v70, s73
    ds_write_b128 v19, v[136:139] offset:12288
    v_perm_b32 v140, v73, v72, s72
    v_perm_b32 v141, v75, v74, s72
    v_perm_b32 v142, v77, v76, s72
    v_perm_b32 v143, v79, v78, s72
    ds_write_b128 v19, v[140:143] offset:17408
    v_perm_b32 v144, v73, v72, s73
    v_perm_b32 v145, v75, v74, s73
    v_perm_b32 v146, v77, v76, s73
    v_perm_b32 v147, v79, v78, s73
    ds_write_b128 v19, v[144:147] offset:18432
    v_perm_b32 v132, v81, v80, s72
    v_perm_b32 v133, v83, v82, s72
    v_perm_b32 v134, v85, v84, s72
    v_perm_b32 v135, v87, v86, s72
    ds_write_b128 v19, v[132:135] offset:23552
    v_perm_b32 v136, v81, v80, s73
    v_perm_b32 v137, v83, v82, s73
    v_perm_b32 v138, v85, v84, s73
    v_perm_b32 v139, v87, v86, s73
    ds_write_b128 v19, v[136:139] offset:24576
    v_perm_b32 v140, v89, v88, s72
    v_perm_b32 v141, v91, v90, s72
    v_perm_b32 v142, v93, v92, s72
    v_perm_b32 v143, v95, v94, s72
    ds_write_b128 v19, v[140:143] offset:29696
    v_perm_b32 v144, v89, v88, s73
    v_perm_b32 v145, v91, v90, s73
    v_perm_b32 v146, v93, v92, s73
    v_perm_b32 v147, v95, v94, s73
    ds_write_b128 v19, v[144:147] offset:30720
    s_waitcnt lgkmcnt(0)
    s_add_u32 s22, s21, 128
    s_add_u32 s71, s22, 0
    buffer_load_dword v32, v6, s[64:67], s71 offen
    s_add_u32 s71, s22, 12288
    buffer_load_dword v33, v6, s[64:67], s71 offen
    s_add_u32 s71, s22, 24576
    buffer_load_dword v34, v6, s[64:67], s71 offen
    s_add_u32 s71, s22, 36864
    buffer_load_dword v35, v6, s[64:67], s71 offen
    s_add_u32 s71, s22, 49152
    buffer_load_dword v36, v6, s[64:67], s71 offen
    s_add_u32 s71, s22, 61440
    buffer_load_dword v37, v6, s[64:67], s71 offen
    s_add_u32 s71, s22, 73728
    buffer_load_dword v38, v6, s[64:67], s71 offen
    s_add_u32 s71, s22, 86016
    buffer_load_dword v39, v6, s[64:67], s71 offen
    s_add_u32 s71, s22, 393216
    buffer_load_dword v40, v6, s[64:67], s71 offen
    s_add_u32 s71, s22, 405504
    buffer_load_dword v41, v6, s[64:67], s71 offen
    s_add_u32 s71, s22, 417792
    buffer_load_dword v42, v6, s[64:67], s71 offen
    s_add_u32 s71, s22, 430080
    buffer_load_dword v43, v6, s[64:67], s71 offen
    s_add_u32 s71, s22, 442368
    buffer_load_dword v44, v6, s[64:67], s71 offen
    s_add_u32 s71, s22, 454656
    buffer_load_dword v45, v6, s[64:67], s71 offen
    s_add_u32 s71, s22, 466944
    buffer_load_dword v46, v6, s[64:67], s71 offen
    s_add_u32 s71, s22, 479232
    buffer_load_dword v47, v6, s[64:67], s71 offen
    s_add_u32 s71, s22, 786432
    buffer_load_dword v48, v6, s[64:67], s71 offen
    s_add_u32 s71, s22, 798720
    buffer_load_dword v49, v6, s[64:67], s71 offen
    s_add_u32 s71, s22, 811008
    buffer_load_dword v50, v6, s[64:67], s71 offen
    s_add_u32 s71, s22, 823296
    buffer_load_dword v51, v6, s[64:67], s71 offen
    s_add_u32 s71, s22, 835584
    buffer_load_dword v52, v6, s[64:67], s71 offen
    s_add_u32 s71, s22, 847872
    buffer_load_dword v53, v6, s[64:67], s71 offen
    s_add_u32 s71, s22, 860160
    buffer_load_dword v54, v6, s[64:67], s71 offen
    s_add_u32 s71, s22, 872448
    buffer_load_dword v55, v6, s[64:67], s71 offen
    s_add_u32 s71, s22, 1179648
    buffer_load_dword v56, v6, s[64:67], s71 offen
    s_add_u32 s71, s22, 1191936
    buffer_load_dword v57, v6, s[64:67], s71 offen
    s_add_u32 s71, s22, 1204224
    buffer_load_dword v58, v6, s[64:67], s71 offen
    s_add_u32 s71, s22, 1216512
    buffer_load_dword v59, v6, s[64:67], s71 offen
    s_add_u32 s71, s22, 1228800
    buffer_load_dword v60, v6, s[64:67], s71 offen
    s_add_u32 s71, s22, 1241088
    buffer_load_dword v61, v6, s[64:67], s71 offen
    s_add_u32 s71, s22, 1253376
    buffer_load_dword v62, v6, s[64:67], s71 offen
    s_add_u32 s71, s22, 1265664
    buffer_load_dword v63, v6, s[64:67], s71 offen
    s_add_u32 s71, s22, 1572864
    buffer_load_dword v64, v6, s[64:67], s71 offen
    s_add_u32 s71, s22, 1585152
    buffer_load_dword v65, v6, s[64:67], s71 offen
    s_add_u32 s71, s22, 1597440
    buffer_load_dword v66, v6, s[64:67], s71 offen
    s_add_u32 s71, s22, 1609728
    buffer_load_dword v67, v6, s[64:67], s71 offen
    s_add_u32 s71, s22, 1622016
    buffer_load_dword v68, v6, s[64:67], s71 offen
    s_add_u32 s71, s22, 1634304
    buffer_load_dword v69, v6, s[64:67], s71 offen
    s_add_u32 s71, s22, 1646592
    buffer_load_dword v70, v6, s[64:67], s71 offen
    s_add_u32 s71, s22, 1658880
    buffer_load_dword v71, v6, s[64:67], s71 offen
    s_add_u32 s71, s22, 1966080
    buffer_load_dword v72, v6, s[64:67], s71 offen
    s_add_u32 s71, s22, 1978368
    buffer_load_dword v73, v6, s[64:67], s71 offen
    s_add_u32 s71, s22, 1990656
    buffer_load_dword v74, v6, s[64:67], s71 offen
    s_add_u32 s71, s22, 2002944
    buffer_load_dword v75, v6, s[64:67], s71 offen
    s_add_u32 s71, s22, 2015232
    buffer_load_dword v76, v6, s[64:67], s71 offen
    s_add_u32 s71, s22, 2027520
    buffer_load_dword v77, v6, s[64:67], s71 offen
    s_add_u32 s71, s22, 2039808
    buffer_load_dword v78, v6, s[64:67], s71 offen
    s_add_u32 s71, s22, 2052096
    buffer_load_dword v79, v6, s[64:67], s71 offen
    s_add_u32 s71, s22, 2359296
    buffer_load_dword v80, v6, s[64:67], s71 offen
    s_add_u32 s71, s22, 2371584
    buffer_load_dword v81, v6, s[64:67], s71 offen
    s_add_u32 s71, s22, 2383872
    buffer_load_dword v82, v6, s[64:67], s71 offen
    s_add_u32 s71, s22, 2396160
    buffer_load_dword v83, v6, s[64:67], s71 offen
    s_add_u32 s71, s22, 2408448
    buffer_load_dword v84, v6, s[64:67], s71 offen
    s_add_u32 s71, s22, 2420736
    buffer_load_dword v85, v6, s[64:67], s71 offen
    s_add_u32 s71, s22, 2433024
    buffer_load_dword v86, v6, s[64:67], s71 offen
    s_add_u32 s71, s22, 2445312
    buffer_load_dword v87, v6, s[64:67], s71 offen
    s_add_u32 s71, s22, 2752512
    buffer_load_dword v88, v6, s[64:67], s71 offen
    s_add_u32 s71, s22, 2764800
    buffer_load_dword v89, v6, s[64:67], s71 offen
    s_add_u32 s71, s22, 2777088
    buffer_load_dword v90, v6, s[64:67], s71 offen
    s_add_u32 s71, s22, 2789376
    buffer_load_dword v91, v6, s[64:67], s71 offen
    s_add_u32 s71, s22, 2801664
    buffer_load_dword v92, v6, s[64:67], s71 offen
    s_add_u32 s71, s22, 2813952
    buffer_load_dword v93, v6, s[64:67], s71 offen
    s_add_u32 s71, s22, 2826240
    buffer_load_dword v94, v6, s[64:67], s71 offen
    s_add_u32 s71, s22, 2838528
    buffer_load_dword v95, v6, s[64:67], s71 offen
    s_add_u32 s71, s22, 3145728
    buffer_load_dword v96, v6, s[64:67], s71 offen
    s_add_u32 s71, s22, 3158016
    buffer_load_dword v97, v6, s[64:67], s71 offen
    s_add_u32 s71, s22, 3170304
    buffer_load_dword v98, v6, s[64:67], s71 offen
    s_add_u32 s71, s22, 3182592
    buffer_load_dword v99, v6, s[64:67], s71 offen
    s_add_u32 s71, s22, 3194880
    buffer_load_dword v100, v6, s[64:67], s71 offen
    s_add_u32 s71, s22, 3207168
    buffer_load_dword v101, v6, s[64:67], s71 offen
    s_add_u32 s71, s22, 3219456
    buffer_load_dword v102, v6, s[64:67], s71 offen
    s_add_u32 s71, s22, 3231744
    buffer_load_dword v103, v6, s[64:67], s71 offen
    s_add_u32 s71, s22, 3538944
    buffer_load_dword v104, v6, s[64:67], s71 offen
    s_add_u32 s71, s22, 3551232
    buffer_load_dword v105, v6, s[64:67], s71 offen
    s_add_u32 s71, s22, 3563520
    buffer_load_dword v106, v6, s[64:67], s71 offen
    s_add_u32 s71, s22, 3575808
    buffer_load_dword v107, v6, s[64:67], s71 offen
    s_add_u32 s71, s22, 3588096
    buffer_load_dword v108, v6, s[64:67], s71 offen
    s_add_u32 s71, s22, 3600384
    buffer_load_dword v109, v6, s[64:67], s71 offen
    s_add_u32 s71, s22, 3612672
    buffer_load_dword v110, v6, s[64:67], s71 offen
    s_add_u32 s71, s22, 3624960
    buffer_load_dword v111, v6, s[64:67], s71 offen
    s_add_u32 s71, s22, 3932160
    buffer_load_dword v112, v6, s[64:67], s71 offen
    s_add_u32 s71, s22, 3944448
    buffer_load_dword v113, v6, s[64:67], s71 offen
    s_add_u32 s71, s22, 3956736
    buffer_load_dword v114, v6, s[64:67], s71 offen
    s_add_u32 s71, s22, 3969024
    buffer_load_dword v115, v6, s[64:67], s71 offen
    s_add_u32 s71, s22, 3981312
    buffer_load_dword v116, v6, s[64:67], s71 offen
    s_add_u32 s71, s22, 3993600
    buffer_load_dword v117, v6, s[64:67], s71 offen
    s_add_u32 s71, s22, 4005888
    buffer_load_dword v118, v6, s[64:67], s71 offen
    s_add_u32 s71, s22, 4018176
    buffer_load_dword v119, v6, s[64:67], s71 offen
    s_add_u32 s71, s22, 4325376
    buffer_load_dword v120, v6, s[64:67], s71 offen
    s_add_u32 s71, s22, 4337664
    buffer_load_dword v121, v6, s[64:67], s71 offen
    s_add_u32 s71, s22, 4349952
    buffer_load_dword v122, v6, s[64:67], s71 offen
    s_add_u32 s71, s22, 4362240
    buffer_load_dword v123, v6, s[64:67], s71 offen
    s_add_u32 s71, s22, 4374528
    buffer_load_dword v124, v6, s[64:67], s71 offen
    s_add_u32 s71, s22, 4386816
    buffer_load_dword v125, v6, s[64:67], s71 offen
    s_add_u32 s71, s22, 4399104
    buffer_load_dword v126, v6, s[64:67], s71 offen
    s_add_u32 s71, s22, 4411392
    buffer_load_dword v127, v6, s[64:67], s71 offen
    s_waitcnt vmcnt(63)
    v_perm_b32 v132, v33, v32, s72
    v_perm_b32 v133, v35, v34, s72
    v_perm_b32 v134, v37, v36, s72
    v_perm_b32 v135, v39, v38, s72
    v_accvgpr_write_b32 a16, v132
    v_accvgpr_write_b32 a17, v133
    v_accvgpr_write_b32 a18, v134
    v_accvgpr_write_b32 a19, v135
    v_perm_b32 v136, v33, v32, s73
    v_perm_b32 v137, v35, v34, s73
    v_perm_b32 v138, v37, v36, s73
    v_perm_b32 v139, v39, v38, s73
    v_accvgpr_write_b32 a20, v136
    v_accvgpr_write_b32 a21, v137
    v_accvgpr_write_b32 a22, v138
    v_accvgpr_write_b32 a23, v139
    v_perm_b32 v140, v41, v40, s72
    v_perm_b32 v141, v43, v42, s72
    v_perm_b32 v142, v45, v44, s72
    v_perm_b32 v143, v47, v46, s72
    v_accvgpr_write_b32 a40, v140
    v_accvgpr_write_b32 a41, v141
    v_accvgpr_write_b32 a42, v142
    v_accvgpr_write_b32 a43, v143
    v_perm_b32 v144, v41, v40, s73
    v_perm_b32 v145, v43, v42, s73
    v_perm_b32 v146, v45, v44, s73
    v_perm_b32 v147, v47, v46, s73
    v_accvgpr_write_b32 a44, v144
    v_accvgpr_write_b32 a45, v145
    v_accvgpr_write_b32 a46, v146
    v_accvgpr_write_b32 a47, v147
    v_perm_b32 v132, v49, v48, s72
    v_perm_b32 v133, v51, v50, s72
    v_perm_b32 v134, v53, v52, s72
    v_perm_b32 v135, v55, v54, s72
    v_accvgpr_write_b32 a64, v132
    v_accvgpr_write_b32 a65, v133
    v_accvgpr_write_b32 a66, v134
    v_accvgpr_write_b32 a67, v135
    v_perm_b32 v136, v49, v48, s73
    v_perm_b32 v137, v51, v50, s73
    v_perm_b32 v138, v53, v52, s73
    v_perm_b32 v139, v55, v54, s73
    v_accvgpr_write_b32 a68, v136
    v_accvgpr_write_b32 a69, v137
    v_accvgpr_write_b32 a70, v138
    v_accvgpr_write_b32 a71, v139
    v_perm_b32 v140, v57, v56, s72
    v_perm_b32 v141, v59, v58, s72
    v_perm_b32 v142, v61, v60, s72
    v_perm_b32 v143, v63, v62, s72
    v_accvgpr_write_b32 a88, v140
    v_accvgpr_write_b32 a89, v141
    v_accvgpr_write_b32 a90, v142
    v_accvgpr_write_b32 a91, v143
    v_perm_b32 v144, v57, v56, s73
    v_perm_b32 v145, v59, v58, s73
    v_perm_b32 v146, v61, v60, s73
    v_perm_b32 v147, v63, v62, s73
    v_accvgpr_write_b32 a92, v144
    v_accvgpr_write_b32 a93, v145
    v_accvgpr_write_b32 a94, v146
    v_accvgpr_write_b32 a95, v147
    s_waitcnt lgkmcnt(0)
    s_add_u32 s71, s22, 4718592
    buffer_load_dword v32, v6, s[64:67], s71 offen
    s_add_u32 s71, s22, 4730880
    buffer_load_dword v33, v6, s[64:67], s71 offen
    s_add_u32 s71, s22, 4743168
    buffer_load_dword v34, v6, s[64:67], s71 offen
    s_add_u32 s71, s22, 4755456
    buffer_load_dword v35, v6, s[64:67], s71 offen
    s_add_u32 s71, s22, 4767744
    buffer_load_dword v36, v6, s[64:67], s71 offen
    s_add_u32 s71, s22, 4780032
    buffer_load_dword v37, v6, s[64:67], s71 offen
    s_add_u32 s71, s22, 4792320
    buffer_load_dword v38, v6, s[64:67], s71 offen
    s_add_u32 s71, s22, 4804608
    buffer_load_dword v39, v6, s[64:67], s71 offen
    s_add_u32 s71, s22, 5111808
    buffer_load_dword v40, v6, s[64:67], s71 offen
    s_add_u32 s71, s22, 5124096
    buffer_load_dword v41, v6, s[64:67], s71 offen
    s_add_u32 s71, s22, 5136384
    buffer_load_dword v42, v6, s[64:67], s71 offen
    s_add_u32 s71, s22, 5148672
    buffer_load_dword v43, v6, s[64:67], s71 offen
    s_add_u32 s71, s22, 5160960
    buffer_load_dword v44, v6, s[64:67], s71 offen
    s_add_u32 s71, s22, 5173248
    buffer_load_dword v45, v6, s[64:67], s71 offen
    s_add_u32 s71, s22, 5185536
    buffer_load_dword v46, v6, s[64:67], s71 offen
    s_add_u32 s71, s22, 5197824
    buffer_load_dword v47, v6, s[64:67], s71 offen
    s_add_u32 s71, s22, 5505024
    buffer_load_dword v48, v6, s[64:67], s71 offen
    s_add_u32 s71, s22, 5517312
    buffer_load_dword v49, v6, s[64:67], s71 offen
    s_add_u32 s71, s22, 5529600
    buffer_load_dword v50, v6, s[64:67], s71 offen
    s_add_u32 s71, s22, 5541888
    buffer_load_dword v51, v6, s[64:67], s71 offen
    s_add_u32 s71, s22, 5554176
    buffer_load_dword v52, v6, s[64:67], s71 offen
    s_add_u32 s71, s22, 5566464
    buffer_load_dword v53, v6, s[64:67], s71 offen
    s_add_u32 s71, s22, 5578752
    buffer_load_dword v54, v6, s[64:67], s71 offen
    s_add_u32 s71, s22, 5591040
    buffer_load_dword v55, v6, s[64:67], s71 offen
    s_add_u32 s71, s22, 5898240
    buffer_load_dword v56, v6, s[64:67], s71 offen
    s_add_u32 s71, s22, 5910528
    buffer_load_dword v57, v6, s[64:67], s71 offen
    s_add_u32 s71, s22, 5922816
    buffer_load_dword v58, v6, s[64:67], s71 offen
    s_add_u32 s71, s22, 5935104
    buffer_load_dword v59, v6, s[64:67], s71 offen
    s_add_u32 s71, s22, 5947392
    buffer_load_dword v60, v6, s[64:67], s71 offen
    s_add_u32 s71, s22, 5959680
    buffer_load_dword v61, v6, s[64:67], s71 offen
    s_add_u32 s71, s22, 5971968
    buffer_load_dword v62, v6, s[64:67], s71 offen
    s_add_u32 s71, s22, 5984256
    buffer_load_dword v63, v6, s[64:67], s71 offen
    s_waitcnt vmcnt(63)
    v_perm_b32 v132, v65, v64, s72
    v_perm_b32 v133, v67, v66, s72
    v_perm_b32 v134, v69, v68, s72
    v_perm_b32 v135, v71, v70, s72
    v_accvgpr_write_b32 a112, v132
    v_accvgpr_write_b32 a113, v133
    v_accvgpr_write_b32 a114, v134
    v_accvgpr_write_b32 a115, v135
    v_perm_b32 v136, v65, v64, s73
    v_perm_b32 v137, v67, v66, s73
    v_perm_b32 v138, v69, v68, s73
    v_perm_b32 v139, v71, v70, s73
    v_accvgpr_write_b32 a116, v136
    v_accvgpr_write_b32 a117, v137
    v_accvgpr_write_b32 a118, v138
    v_accvgpr_write_b32 a119, v139
    v_perm_b32 v140, v73, v72, s72
    v_perm_b32 v141, v75, v74, s72
    v_perm_b32 v142, v77, v76, s72
    v_perm_b32 v143, v79, v78, s72
    v_accvgpr_write_b32 a136, v140
    v_accvgpr_write_b32 a137, v141
    v_accvgpr_write_b32 a138, v142
    v_accvgpr_write_b32 a139, v143
    v_perm_b32 v144, v73, v72, s73
    v_perm_b32 v145, v75, v74, s73
    v_perm_b32 v146, v77, v76, s73
    v_perm_b32 v147, v79, v78, s73
    v_accvgpr_write_b32 a140, v144
    v_accvgpr_write_b32 a141, v145
    v_accvgpr_write_b32 a142, v146
    v_accvgpr_write_b32 a143, v147
    v_perm_b32 v132, v81, v80, s72
    v_perm_b32 v133, v83, v82, s72
    v_perm_b32 v134, v85, v84, s72
    v_perm_b32 v135, v87, v86, s72
    v_accvgpr_write_b32 a160, v132
    v_accvgpr_write_b32 a161, v133
    v_accvgpr_write_b32 a162, v134
    v_accvgpr_write_b32 a163, v135
    v_perm_b32 v136, v81, v80, s73
    v_perm_b32 v137, v83, v82, s73
    v_perm_b32 v138, v85, v84, s73
    v_perm_b32 v139, v87, v86, s73
    v_accvgpr_write_b32 a164, v136
    v_accvgpr_write_b32 a165, v137
    v_accvgpr_write_b32 a166, v138
    v_accvgpr_write_b32 a167, v139
    v_perm_b32 v140, v89, v88, s72
    v_perm_b32 v141, v91, v90, s72
    v_perm_b32 v142, v93, v92, s72
    v_perm_b32 v143, v95, v94, s72
    v_accvgpr_write_b32 a184, v140
    v_accvgpr_write_b32 a185, v141
    v_accvgpr_write_b32 a186, v142
    v_accvgpr_write_b32 a187, v143
    v_perm_b32 v144, v89, v88, s73
    v_perm_b32 v145, v91, v90, s73
    v_perm_b32 v146, v93, v92, s73
    v_perm_b32 v147, v95, v94, s73
    v_accvgpr_write_b32 a188, v144
    v_accvgpr_write_b32 a189, v145
    v_accvgpr_write_b32 a190, v146
    v_accvgpr_write_b32 a191, v147
    s_waitcnt lgkmcnt(0)
    s_add_u32 s71, s22, 6291456
    buffer_load_dword v64, v6, s[64:67], s71 offen
    s_add_u32 s71, s22, 6303744
    buffer_load_dword v65, v6, s[64:67], s71 offen
    s_add_u32 s71, s22, 6316032
    buffer_load_dword v66, v6, s[64:67], s71 offen
    s_add_u32 s71, s22, 6328320
    buffer_load_dword v67, v6, s[64:67], s71 offen
    s_add_u32 s71, s22, 6340608
    buffer_load_dword v68, v6, s[64:67], s71 offen
    s_add_u32 s71, s22, 6352896
    buffer_load_dword v69, v6, s[64:67], s71 offen
    s_add_u32 s71, s22, 6365184
    buffer_load_dword v70, v6, s[64:67], s71 offen
    s_add_u32 s71, s22, 6377472
    buffer_load_dword v71, v6, s[64:67], s71 offen
    s_add_u32 s71, s22, 6684672
    buffer_load_dword v72, v6, s[64:67], s71 offen
    s_add_u32 s71, s22, 6696960
    buffer_load_dword v73, v6, s[64:67], s71 offen
    s_add_u32 s71, s22, 6709248
    buffer_load_dword v74, v6, s[64:67], s71 offen
    s_add_u32 s71, s22, 6721536
    buffer_load_dword v75, v6, s[64:67], s71 offen
    s_add_u32 s71, s22, 6733824
    buffer_load_dword v76, v6, s[64:67], s71 offen
    s_add_u32 s71, s22, 6746112
    buffer_load_dword v77, v6, s[64:67], s71 offen
    s_add_u32 s71, s22, 6758400
    buffer_load_dword v78, v6, s[64:67], s71 offen
    s_add_u32 s71, s22, 6770688
    buffer_load_dword v79, v6, s[64:67], s71 offen
    s_add_u32 s71, s22, 7077888
    buffer_load_dword v80, v6, s[64:67], s71 offen
    s_add_u32 s71, s22, 7090176
    buffer_load_dword v81, v6, s[64:67], s71 offen
    s_add_u32 s71, s22, 7102464
    buffer_load_dword v82, v6, s[64:67], s71 offen
    s_add_u32 s71, s22, 7114752
    buffer_load_dword v83, v6, s[64:67], s71 offen
    s_add_u32 s71, s22, 7127040
    buffer_load_dword v84, v6, s[64:67], s71 offen
    s_add_u32 s71, s22, 7139328
    buffer_load_dword v85, v6, s[64:67], s71 offen
    s_add_u32 s71, s22, 7151616
    buffer_load_dword v86, v6, s[64:67], s71 offen
    s_add_u32 s71, s22, 7163904
    buffer_load_dword v87, v6, s[64:67], s71 offen
    s_add_u32 s71, s22, 7471104
    buffer_load_dword v88, v6, s[64:67], s71 offen
    s_add_u32 s71, s22, 7483392
    buffer_load_dword v89, v6, s[64:67], s71 offen
    s_add_u32 s71, s22, 7495680
    buffer_load_dword v90, v6, s[64:67], s71 offen
    s_add_u32 s71, s22, 7507968
    buffer_load_dword v91, v6, s[64:67], s71 offen
    s_add_u32 s71, s22, 7520256
    buffer_load_dword v92, v6, s[64:67], s71 offen
    s_add_u32 s71, s22, 7532544
    buffer_load_dword v93, v6, s[64:67], s71 offen
    s_add_u32 s71, s22, 7544832
    buffer_load_dword v94, v6, s[64:67], s71 offen
    s_add_u32 s71, s22, 7557120
    buffer_load_dword v95, v6, s[64:67], s71 offen
    s_waitcnt vmcnt(63)
    v_perm_b32 v132, v97, v96, s72
    v_perm_b32 v133, v99, v98, s72
    v_perm_b32 v134, v101, v100, s72
    v_perm_b32 v135, v103, v102, s72
    v_accvgpr_write_b32 a208, v132
    v_accvgpr_write_b32 a209, v133
    v_accvgpr_write_b32 a210, v134
    v_accvgpr_write_b32 a211, v135
    v_perm_b32 v136, v97, v96, s73
    v_perm_b32 v137, v99, v98, s73
    v_perm_b32 v138, v101, v100, s73
    v_perm_b32 v139, v103, v102, s73
    v_accvgpr_write_b32 a212, v136
    v_accvgpr_write_b32 a213, v137
    v_accvgpr_write_b32 a214, v138
    v_accvgpr_write_b32 a215, v139
    v_perm_b32 v140, v105, v104, s72
    v_perm_b32 v141, v107, v106, s72
    v_perm_b32 v142, v109, v108, s72
    v_perm_b32 v143, v111, v110, s72
    v_accvgpr_write_b32 a232, v140
    v_accvgpr_write_b32 a233, v141
    v_accvgpr_write_b32 a234, v142
    v_accvgpr_write_b32 a235, v143
    v_perm_b32 v144, v105, v104, s73
    v_perm_b32 v145, v107, v106, s73
    v_perm_b32 v146, v109, v108, s73
    v_perm_b32 v147, v111, v110, s73
    v_accvgpr_write_b32 a236, v144
    v_accvgpr_write_b32 a237, v145
    v_accvgpr_write_b32 a238, v146
    v_accvgpr_write_b32 a239, v147
    v_perm_b32 v132, v113, v112, s72
    v_perm_b32 v133, v115, v114, s72
    v_perm_b32 v134, v117, v116, s72
    v_perm_b32 v135, v119, v118, s72
    v_mov_b32 v164, v132
    v_mov_b32 v165, v133
    v_mov_b32 v166, v134
    v_mov_b32 v167, v135
    v_perm_b32 v136, v113, v112, s73
    v_perm_b32 v137, v115, v114, s73
    v_perm_b32 v138, v117, v116, s73
    v_perm_b32 v139, v119, v118, s73
    v_mov_b32 v168, v136
    v_mov_b32 v169, v137
    v_mov_b32 v170, v138
    v_mov_b32 v171, v139
    v_perm_b32 v140, v121, v120, s72
    v_perm_b32 v141, v123, v122, s72
    v_perm_b32 v142, v125, v124, s72
    v_perm_b32 v143, v127, v126, s72
    v_mov_b32 v188, v140
    v_mov_b32 v189, v141
    v_mov_b32 v190, v142
    v_mov_b32 v191, v143
    v_perm_b32 v144, v121, v120, s73
    v_perm_b32 v145, v123, v122, s73
    v_perm_b32 v146, v125, v124, s73
    v_perm_b32 v147, v127, v126, s73
    v_mov_b32 v192, v144
    v_mov_b32 v193, v145
    v_mov_b32 v194, v146
    v_mov_b32 v195, v147
    s_waitcnt lgkmcnt(0)
    s_waitcnt vmcnt(32)
    v_perm_b32 v132, v33, v32, s72
    v_perm_b32 v133, v35, v34, s72
    v_perm_b32 v134, v37, v36, s72
    v_perm_b32 v135, v39, v38, s72
    v_mov_b32 v212, v132
    v_mov_b32 v213, v133
    v_mov_b32 v214, v134
    v_mov_b32 v215, v135
    v_perm_b32 v136, v33, v32, s73
    v_perm_b32 v137, v35, v34, s73
    v_perm_b32 v138, v37, v36, s73
    v_perm_b32 v139, v39, v38, s73
    v_mov_b32 v216, v136
    v_mov_b32 v217, v137
    v_mov_b32 v218, v138
    v_mov_b32 v219, v139
    v_perm_b32 v140, v41, v40, s72
    v_perm_b32 v141, v43, v42, s72
    v_perm_b32 v142, v45, v44, s72
    v_perm_b32 v143, v47, v46, s72
    v_mov_b32 v236, v140
    v_mov_b32 v237, v141
    v_mov_b32 v238, v142
    v_mov_b32 v239, v143
    v_perm_b32 v144, v41, v40, s73
    v_perm_b32 v145, v43, v42, s73
    v_perm_b32 v146, v45, v44, s73
    v_perm_b32 v147, v47, v46, s73
    v_mov_b32 v240, v144
    v_mov_b32 v241, v145
    v_mov_b32 v242, v146
    v_mov_b32 v243, v147
    v_perm_b32 v132, v49, v48, s72
    v_perm_b32 v133, v51, v50, s72
    v_perm_b32 v134, v53, v52, s72
    v_perm_b32 v135, v55, v54, s72
    ds_write_b128 v19, v[132:135] offset:1024
    v_perm_b32 v136, v49, v48, s73
    v_perm_b32 v137, v51, v50, s73
    v_perm_b32 v138, v53, v52, s73
    v_perm_b32 v139, v55, v54, s73
    ds_write_b128 v19, v[136:139] offset:2048
    v_perm_b32 v140, v57, v56, s72
    v_perm_b32 v141, v59, v58, s72
    v_perm_b32 v142, v61, v60, s72
    v_perm_b32 v143, v63, v62, s72
    ds_write_b128 v19, v[140:143] offset:7168
    v_perm_b32 v144, v57, v56, s73
    v_perm_b32 v145, v59, v58, s73
    v_perm_b32 v146, v61, v60, s73
    v_perm_b32 v147, v63, v62, s73
    ds_write_b128 v19, v[144:147] offset:8192
    s_waitcnt lgkmcnt(0)
    s_waitcnt vmcnt(0)
    v_perm_b32 v132, v65, v64, s72
    v_perm_b32 v133, v67, v66, s72
    v_perm_b32 v134, v69, v68, s72
    v_perm_b32 v135, v71, v70, s72
    ds_write_b128 v19, v[132:135] offset:13312
    v_perm_b32 v136, v65, v64, s73
    v_perm_b32 v137, v67, v66, s73
    v_perm_b32 v138, v69, v68, s73
    v_perm_b32 v139, v71, v70, s73
    ds_write_b128 v19, v[136:139] offset:14336
    v_perm_b32 v140, v73, v72, s72
    v_perm_b32 v141, v75, v74, s72
    v_perm_b32 v142, v77, v76, s72
    v_perm_b32 v143, v79, v78, s72
    ds_write_b128 v19, v[140:143] offset:19456
    v_perm_b32 v144, v73, v72, s73
    v_perm_b32 v145, v75, v74, s73
    v_perm_b32 v146, v77, v76, s73
    v_perm_b32 v147, v79, v78, s73
    ds_write_b128 v19, v[144:147] offset:20480
    v_perm_b32 v132, v81, v80, s72
    v_perm_b32 v133, v83, v82, s72
    v_perm_b32 v134, v85, v84, s72
    v_perm_b32 v135, v87, v86, s72
    ds_write_b128 v19, v[132:135] offset:25600
    v_perm_b32 v136, v81, v80, s73
    v_perm_b32 v137, v83, v82, s73
    v_perm_b32 v138, v85, v84, s73
    v_perm_b32 v139, v87, v86, s73
    ds_write_b128 v19, v[136:139] offset:26624
    v_perm_b32 v140, v89, v88, s72
    v_perm_b32 v141, v91, v90, s72
    v_perm_b32 v142, v93, v92, s72
    v_perm_b32 v143, v95, v94, s72
    ds_write_b128 v19, v[140:143] offset:31744
    v_perm_b32 v144, v89, v88, s73
    v_perm_b32 v145, v91, v90, s73
    v_perm_b32 v146, v93, v92, s73
    v_perm_b32 v147, v95, v94, s73
    ds_write_b128 v19, v[144:147] offset:32768
    s_waitcnt lgkmcnt(0)
    s_lshr_b32 s3, s74, 1
    s_mul_i32 s3, s3, 3200
    s_and_b32 s22, s74, 1
    s_mul_i32 s22, s22, 192
    s_add_u32 s3, s3, s22
    v_lshl_add_u32 v20, v4, 4, v17
    v_add_u32 v20, s3, v20
    v_lshl_add_u32 v21, v4, 4, v17
    v_lshlrev_b32 v22, 4, v2
    s_mul_i32 s23, s20, 786432
    s_add_u32 s23, s23, 33046528
    v_lshlrev_b32 v24, 6, v3
    v_lshl_add_u32 v24, v4, 4, v24
    v_lshlrev_b32 v23, 4, v3
    v_lshl_add_u32 v23, v4, 3, v23
    v_add_u32 v23, 512, v23
    s_mul_i32 s24, s20, 640
    s_add_u32 s24, s24, 188891136
    v_mul_u32_u24 v25, 384, v3
    v_lshl_add_u32 v25, v4, 4, v25
    s_mul_i32 s25, s20, 3072
    s_add_u32 s25, s25, 190869504
    v_mov_b32 v26, 0xff800000
    s_mul_i32 s3, s20, 3
    s_lshr_b32 s3, s3, 2
    s_min_u32 s3, s3, 22
    s_add_u32 s3, s3, 24
    s_lshl_b32 s3, s3, 2
    v_mov_b32 v27, s3
    s_mov_b32 s43, 0
    v_mov_b32 v149, 192
    s_mov_b32 s69, 0
mega_kernel_cw25:
    buffer_load_dword v148, v149, s[88:91], 0 offen sc1
    s_add_u32 s69, s69, 1
    s_cmp_ge_u32 s69, 1048576
    s_cbranch_scc1 mega_kernel_cwo26
    s_waitcnt vmcnt(0)
    v_cmp_gt_u32 vcc, 256, v148
    s_cbranch_vccz mega_kernel_cwo26
    s_sleep 8
    s_branch mega_kernel_cw25
mega_kernel_cwo26:
    s_barrier
mega_kernel_Aloop27:
    s_cmp_lg_u32 s74, 0
    s_cbranch_scc1 mega_kernel_nokx30
    s_add_u32 s68, s29, 1
    s_cmp_ge_u32 s43, s68
    s_cbranch_scc1 mega_kernel_wf31
    s_mov_b32 s69, 0
mega_kernel_wfl32:
    s_mov_b32 s71, 204500992
    buffer_load_dwordx2 v[150:151], v27, s[60:63], s71 offen sc1
    s_waitcnt vmcnt(0)
    v_min_u32 v150, v150, v151
    s_nop 0
    v_readfirstlane_b32 s43, v150
    s_add_u32 s69, s69, 1
    s_cmp_ge_u32 s69, 262144
    s_cbranch_scc1 mega_kernel_wf31
    s_cmp_lt_u32 s43, s68
    s_cbranch_scc1 mega_kernel_wfl32
mega_kernel_wf31:
    s_add_u32 s71, s23, 0
    buffer_load_dwordx4 v[88:91], v22, s[60:63], s71 offen
    s_add_u32 s71, s23, 1024
    buffer_load_dwordx4 v[92:95], v22, s[60:63], s71 offen
    s_add_u32 s71, s23, 2048
    buffer_load_dwordx4 v[96:99], v22, s[60:63], s71 offen
    s_add_u32 s71, s23, 3072
    buffer_load_dwordx4 v[100:103], v22, s[60:63], s71 offen
    s_add_u32 s71, s23, 4096
    buffer_load_dwordx4 v[104:107], v22, s[60:63], s71 offen
    s_add_u32 s71, s23, 5120
    buffer_load_dwordx4 v[108:111], v22, s[60:63], s71 offen
    s_add_u32 s71, s23, 6144
    buffer_load_dwordx4 v[112:115], v22, s[60:63], s71 offen
    s_add_u32 s71, s23, 7168
    buffer_load_dwordx4 v[116:119], v22, s[60:63], s71 offen
    s_add_u32 s71, s23, 8192
    buffer_load_dwordx4 v[120:123], v22, s[60:63], s71 offen
    s_add_u32 s71, s23, 9216
    buffer_load_dwordx4 v[124:127], v22, s[60:63], s71 offen
    s_add_u32 s71, s23, 10240
    buffer_load_dwordx4 v[128:131], v22, s[60:63], s71 offen
    s_add_u32 s71, s23, 11264
    buffer_load_dwordx4 v[132:135], v22, s[60:63], s71 offen
mega_kernel_nokx30:
    s_mov_b32 s31, 0
mega_kernel_pm33:
    buffer_load_dwordx4 v[136:139], v10, s[60:63], s30 offen sc1
    buffer_load_dwordx4 v[140:143], v11, s[60:63], s30 offen sc1
    buffer_load_dwordx4 v[144:147], v12, s[60:63], s30 offen sc1
    s_waitcnt vmcnt(0)
    v_max3_u32 v148, v136, v137, v138
    v_max3_u32 v149, v139, v140, v141
    v_max3_u32 v150, v142, v143, v144
    v_max3_u32 v151, v145, v146, v147
    v_max3_u32 v148, v148, v149, v150
    v_max_u32 v148, v148, v151
    v_cmp_eq_u32 vcc, -1, v148
    s_cbranch_vccz mega_kernel_pmok34
    s_add_u32 s31, s31, 1
    s_cmp_lt_u32 s31, 65536
    s_cbranch_scc1 mega_kernel_pm33
mega_kernel_pmok34:
    ds_write_b128 v13, v[136:139]
    ds_write_b128 v14, v[140:143]
    ds_write_b128 v15, v[144:147]
    s_waitcnt lgkmcnt(0)
    s_barrier
    ds_read_b128 v[56:59], v16 offset:0
    ds_read_b128 v[60:63], v16 offset:64
    ds_read_b128 v[64:67], v16 offset:128
    s_waitcnt lgkmcnt(2)
    v_mfma_f32_16x16x32_bf16 v[32:35], a[0:3], v[56:59], 0
    v_mfma_f32_16x16x32_bf16 v[36:39], a[4:7], v[56:59], 0
    v_mfma_f32_16x16x32_bf16 v[40:43], a[8:11], v[56:59], 0
    v_mfma_f32_16x16x32_bf16 v[44:47], a[12:15], v[56:59], 0
    v_mfma_f32_16x16x32_bf16 v[48:51], a[16:19], v[56:59], 0
    v_mfma_f32_16x16x32_bf16 v[52:55], a[20:23], v[56:59], 0
    ds_read_b128 v[68:71], v16 offset:192
    s_waitcnt lgkmcnt(2)
    v_mfma_f32_16x16x32_bf16 v[32:35], a[24:27], v[60:63], v[32:35]
    v_mfma_f32_16x16x32_bf16 v[36:39], a[28:31], v[60:63], v[36:39]
    v_mfma_f32_16x16x32_bf16 v[40:43], a[32:35], v[60:63], v[40:43]
    v_mfma_f32_16x16x32_bf16 v[44:47], a[36:39], v[60:63], v[44:47]
    v_mfma_f32_16x16x32_bf16 v[48:51], a[40:43], v[60:63], v[48:51]
    v_mfma_f32_16x16x32_bf16 v[52:55], a[44:47], v[60:63], v[52:55]
    ds_read_b128 v[56:59], v16 offset:256
    s_waitcnt lgkmcnt(2)
    v_mfma_f32_16x16x32_bf16 v[32:35], a[48:51], v[64:67], v[32:35]
    v_mfma_f32_16x16x32_bf16 v[36:39], a[52:55], v[64:67], v[36:39]
    v_mfma_f32_16x16x32_bf16 v[40:43], a[56:59], v[64:67], v[40:43]
    v_mfma_f32_16x16x32_bf16 v[44:47], a[60:63], v[64:67], v[44:47]
    v_mfma_f32_16x16x32_bf16 v[48:51], a[64:67], v[64:67], v[48:51]
    v_mfma_f32_16x16x32_bf16 v[52:55], a[68:71], v[64:67], v[52:55]
    ds_read_b128 v[60:63], v16 offset:320
    s_waitcnt lgkmcnt(2)
    v_mfma_f32_16x16x32_bf16 v[32:35], a[72:75], v[68:71], v[32:35]
    v_mfma_f32_16x16x32_bf16 v[36:39], a[76:79], v[68:71], v[36:39]
    v_mfma_f32_16x16x32_bf16 v[40:43], a[80:83], v[68:71], v[40:43]
    v_mfma_f32_16x16x32_bf16 v[44:47], a[84:87], v[68:71], v[44:47]
    v_mfma_f32_16x16x32_bf16 v[48:51], a[88:91], v[68:71], v[48:51]
    v_mfma_f32_16x16x32_bf16 v[52:55], a[92:95], v[68:71], v[52:55]
    ds_read_b128 v[64:67], v16 offset:384
    s_waitcnt lgkmcnt(2)
    v_mfma_f32_16x16x32_bf16 v[32:35], a[96:99], v[56:59], v[32:35]
    v_mfma_f32_16x16x32_bf16 v[36:39], a[100:103], v[56:59], v[36:39]
    v_mfma_f32_16x16x32_bf16 v[40:43], a[104:107], v[56:59], v[40:43]
    v_mfma_f32_16x16x32_bf16 v[44:47], a[108:111], v[56:59], v[44:47]
    v_mfma_f32_16x16x32_bf16 v[48:51], a[112:115], v[56:59], v[48:51]
    v_mfma_f32_16x16x32_bf16 v[52:55], a[116:119], v[56:59], v[52:55]
    ds_read_b128 v[68:71], v16 offset:448
    s_waitcnt lgkmcnt(2)
    v_mfma_f32_16x16x32_bf16 v[32:35], a[120:123], v[60:63], v[32:35]
    v_mfma_f32_16x16x32_bf16 v[36:39], a[124:127], v[60:63], v[36:39]
    v_mfma_f32_16x16x32_bf16 v[40:43], a[128:131], v[60:63], v[40:43]
    v_mfma_f32_16x16x32_bf16 v[44:47], a[132:135], v[60:63], v[44:47]
    v_mfma_f32_16x16x32_bf16 v[48:51], a[136:139], v[60:63], v[48:51]
    v_mfma_f32_16x16x32_bf16 v[52:55], a[140:143], v[60:63], v[52:55]
    ds_read_b128 v[56:59], v16 offset:512
    s_waitcnt lgkmcnt(2)
    v_mfma_f32_16x16x32_bf16 v[32:35], a[144:147], v[64:67], v[32:35]
    v_mfma_f32_16x16x32_bf16 v[36:39], a[148:151], v[64:67], v[36:39]
    v_mfma_f32_16x16x32_bf16 v[40:43], a[152:155], v[64:67], v[40:43]
    v_mfma_f32_16x16x32_bf16 v[44:47], a[156:159], v[64:67], v[44:47]
    v_mfma_f32_16x16x32_bf16 v[48:51], a[160:163], v[64:67], v[48:51]
    v_mfma_f32_16x16x32_bf16 v[52:55], a[164:167], v[64:67], v[52:55]
    ds_read_b128 v[60:63], v16 offset:576
    s_waitcnt lgkmcnt(2)
    v_mfma_f32_16x16x32_bf16 v[32:35], a[168:171], v[68:71], v[32:35]
    v_mfma_f32_16x16x32_bf16 v[36:39], a[172:175], v[68:71], v[36:39]
    v_mfma_f32_16x16x32_bf16 v[40:43], a[176:179], v[68:71], v[40:43]
    v_mfma_f32_16x16x32_bf16 v[44:47], a[180:183], v[68:71], v[44:47]
    v_mfma_f32_16x16x32_bf16 v[48:51], a[184:187], v[68:71], v[48:51]
    v_mfma_f32_16x16x32_bf16 v[52:55], a[188:191], v[68:71], v[52:55]
    ds_read_b128 v[64:67], v16 offset:640
    s_waitcnt lgkmcnt(2)
    v_mfma_f32_16x16x32_bf16 v[32:35], a[192:195], v[56:59], v[32:35]
    v_mfma_f32_16x16x32_bf16 v[36:39], a[196:199], v[56:59], v[36:39]
    v_mfma_f32_16x16x32_bf16 v[40:43], a[200:203], v[56:59], v[40:43]
    v_mfma_f32_16x16x32_bf16 v[44:47], a[204:207], v[56:59], v[44:47]
    v_mfma_f32_16x16x32_bf16 v[48:51], a[208:211], v[56:59], v[48:51]
    v_mfma_f32_16x16x32_bf16 v[52:55], a[212:215], v[56:59], v[52:55]
    ds_read_b128 v[68:71], v16 offset:704
    s_waitcnt lgkmcnt(2)
    v_mfma_f32_16x16x32_bf16 v[32:35], a[216:219], v[60:63], v[32:35]
    v_mfma_f32_16x16x32_bf16 v[36:39], a[220:223], v[60:63], v[36:39]
    v_mfma_f32_16x16x32_bf16 v[40:43], a[224:227], v[60:63], v[40:43]
    v_mfma_f32_16x16x32_bf16 v[44:47], a[228:231], v[60:63], v[44:47]
    v_mfma_f32_16x16x32_bf16 v[48:51], a[232:235], v[60:63], v[48:51]
    v_mfma_f32_16x16x32_bf16 v[52:55], a[236:239], v[60:63], v[52:55]
    ds_read_b128 v[56:59], v16 offset:768
    s_waitcnt lgkmcnt(2)
    v_mfma_f32_16x16x32_bf16 v[32:35], a[240:243], v[64:67], v[32:35]
    v_mfma_f32_16x16x32_bf16 v[36:39], a[244:247], v[64:67], v[36:39]
    v_mfma_f32_16x16x32_bf16 v[40:43], a[248:251], v[64:67], v[40:43]
    v_mfma_f32_16x16x32_bf16 v[44:47], a[252:255], v[64:67], v[44:47]
    v_mfma_f32_16x16x32_bf16 v[48:51], v[164:167], v[64:67], v[48:51]
    v_mfma_f32_16x16x32_bf16 v[52:55], v[168:171], v[64:67], v[52:55]
    ds_read_b128 v[60:63], v16 offset:832
    s_waitcnt lgkmcnt(2)
    v_mfma_f32_16x16x32_bf16 v[32:35], v[172:175], v[68:71], v[32:35]
    v_mfma_f32_16x16x32_bf16 v[36:39], v[176:179], v[68:71], v[36:39]
    v_mfma_f32_16x16x32_bf16 v[40:43], v[180:183], v[68:71], v[40:43]
    v_mfma_f32_16x16x32_bf16 v[44:47], v[184:187], v[68:71], v[44:47]
    v_mfma_f32_16x16x32_bf16 v[48:51], v[188:191], v[68:71], v[48:51]
    v_mfma_f32_16x16x32_bf16 v[52:55], v[192:195], v[68:71], v[52:55]
    ds_read_b128 v[64:67], v16 offset:896
    s_waitcnt lgkmcnt(2)
    v_mfma_f32_16x16x32_bf16 v[32:35], v[196:199], v[56:59], v[32:35]
    v_mfma_f32_16x16x32_bf16 v[36:39], v[200:203], v[56:59], v[36:39]
    v_mfma_f32_16x16x32_bf16 v[40:43], v[204:207], v[56:59], v[40:43]
    v_mfma_f32_16x16x32_bf16 v[44:47], v[208:211], v[56:59], v[44:47]
    v_mfma_f32_16x16x32_bf16 v[48:51], v[212:215], v[56:59], v[48:51]
    v_mfma_f32_16x16x32_bf16 v[52:55], v[216:219], v[56:59], v[52:55]
    ds_read_b128 v[72:75], v18 offset:0
    s_waitcnt lgkmcnt(2)
    v_mfma_f32_16x16x32_bf16 v[32:35], v[220:223], v[60:63], v[32:35]
    v_mfma_f32_16x16x32_bf16 v[36:39], v[224:227], v[60:63], v[36:39]
    v_mfma_f32_16x16x32_bf16 v[40:43], v[228:231], v[60:63], v[40:43]
    v_mfma_f32_16x16x32_bf16 v[44:47], v[232:235], v[60:63], v[44:47]
    v_mfma_f32_16x16x32_bf16 v[48:51], v[236:239], v[60:63], v[48:51]
    v_mfma_f32_16x16x32_bf16 v[52:55], v[240:243], v[60:63], v[52:55]
    ds_read_b128 v[76:79], v18 offset:1024
    s_waitcnt lgkmcnt(2)
    v_mfma_f32_16x16x32_bf16 v[32:35], v[244:247], v[64:67], v[32:35]
    v_mfma_f32_16x16x32_bf16 v[36:39], v[248:251], v[64:67], v[36:39]
    v_mfma_f32_16x16x32_bf16 v[40:43], v[252:255], v[64:67], v[40:43]
    ds_read_b128 v[80:83], v18 offset:2048
    s_waitcnt lgkmcnt(2)
    v_mfma_f32_16x16x32_bf16 v[44:47], v[72:75], v[64:67], v[44:47]
    ds_read_b128 v[68:71], v16 offset:960
    s_waitcnt lgkmcnt(2)
    v_mfma_f32_16x16x32_bf16 v[48:51], v[76:79], v[64:67], v[48:51]
    ds_read_b128 v[84:87], v18 offset:3072
    s_waitcnt lgkmcnt(2)
    v_mfma_f32_16x16x32_bf16 v[52:55], v[80:83], v[64:67], v[52:55]
    ds_read_b128 v[72:75], v18 offset:4096
    s_waitcnt lgkmcnt(2)
    ds_read_b128 v[76:79], v18 offset:5120
    s_waitcnt lgkmcnt(2)
    v_mfma_f32_16x16x32_bf16 v[32:35], v[84:87], v[68:71], v[32:35]
    ds_read_b128 v[80:83], v18 offset:6144
    s_waitcnt lgkmcnt(2)
    v_mfma_f32_16x16x32_bf16 v[36:39], v[72:75], v[68:71], v[36:39]
    ds_read_b128 v[84:87], v18 offset:7168
    s_waitcnt lgkmcnt(2)
    v_mfma_f32_16x16x32_bf16 v[40:43], v[76:79], v[68:71], v[40:43]
    ds_read_b128 v[72:75], v18 offset:8192
    s_waitcnt lgkmcnt(2)
    v_mfma_f32_16x16x32_bf16 v[44:47], v[80:83], v[68:71], v[44:47]
    ds_read_b128 v[56:59], v16 offset:1024
    s_waitcnt lgkmcnt(2)
    v_mfma_f32_16x16x32_bf16 v[48:51], v[84:87], v[68:71], v[48:51]
    ds_read_b128 v[76:79], v18 offset:9216
    s_waitcnt lgkmcnt(2)
    v_mfma_f32_16x16x32_bf16 v[52:55], v[72:75], v[68:71], v[52:55]
    ds_read_b128 v[80:83], v18 offset:10240
    s_waitcnt lgkmcnt(2)
    ds_read_b128 v[84:87], v18 offset:11264
    s_waitcnt lgkmcnt(2)
    v_mfma_f32_16x16x32_bf16 v[32:35], v[76:79], v[56:59], v[32:35]
    ds_read_b128 v[72:75], v18 offset:12288
    s_waitcnt lgkmcnt(2)
    v_mfma_f32_16x16x32_bf16 v[36:39], v[80:83], v[56:59], v[36:39]
    ds_read_b128 v[76:79], v18 offset:13312
    s_waitcnt lgkmcnt(2)
    v_mfma_f32_16x16x32_bf16 v[40:43], v[84:87], v[56:59], v[40:43]
    ds_read_b128 v[80:83], v18 offset:14336
    s_waitcnt lgkmcnt(2)
    v_mfma_f32_16x16x32_bf16 v[44:47], v[72:75], v[56:59], v[44:47]
    ds_read_b128 v[60:63], v16 offset:1088
    s_waitcnt lgkmcnt(2)
    v_mfma_f32_16x16x32_bf16 v[48:51], v[76:79], v[56:59], v[48:51]
    ds_read_b128 v[84:87], v18 offset:15360
    s_waitcnt lgkmcnt(2)
    v_mfma_f32_16x16x32_bf16 v[52:55], v[80:83], v[56:59], v[52:55]
    ds_read_b128 v[72:75], v18 offset:16384
    s_waitcnt lgkmcnt(2)
    ds_read_b128 v[76:79], v18 offset:17408
    s_waitcnt lgkmcnt(2)
    v_mfma_f32_16x16x32_bf16 v[32:35], v[84:87], v[60:63], v[32:35]
    ds_read_b128 v[80:83], v18 offset:18432
    s_waitcnt lgkmcnt(2)
    v_mfma_f32_16x16x32_bf16 v[36:39], v[72:75], v[60:63], v[36:39]
    ds_read_b128 v[84:87], v18 offset:19456
    s_waitcnt lgkmcnt(2)
    v_mfma_f32_16x16x32_bf16 v[40:43], v[76:79], v[60:63], v[40:43]
    ds_read_b128 v[72:75], v18 offset:20480
    s_waitcnt lgkmcnt(2)
    v_mfma_f32_16x16x32_bf16 v[44:47], v[80:83], v[60:63], v[44:47]
    ds_read_b128 v[64:67], v16 offset:1152
    s_waitcnt lgkmcnt(2)
    v_mfma_f32_16x16x32_bf16 v[48:51], v[84:87], v[60:63], v[48:51]
    ds_read_b128 v[76:79], v18 offset:21504
    s_waitcnt lgkmcnt(2)
    v_mfma_f32_16x16x32_bf16 v[52:55], v[72:75], v[60:63], v[52:55]
    ds_read_b128 v[80:83], v18 offset:22528
    s_waitcnt lgkmcnt(2)
    ds_read_b128 v[84:87], v18 offset:23552
    s_waitcnt lgkmcnt(2)
    v_mfma_f32_16x16x32_bf16 v[32:35], v[76:79], v[64:67], v[32:35]
    ds_read_b128 v[72:75], v18 offset:24576
    s_waitcnt lgkmcnt(2)
    v_mfma_f32_16x16x32_bf16 v[36:39], v[80:83], v[64:67], v[36:39]
    ds_read_b128 v[76:79], v18 offset:25600
    s_waitcnt lgkmcnt(2)
    v_mfma_f32_16x16x32_bf16 v[40:43], v[84:87], v[64:67], v[40:43]
    ds_read_b128 v[80:83], v18 offset:26624
    s_waitcnt lgkmcnt(2)
    v_mfma_f32_16x16x32_bf16 v[44:47], v[72:75], v[64:67], v[44:47]
    ds_read_b128 v[68:71], v16 offset:1216
    s_waitcnt lgkmcnt(2)
    v_mfma_f32_16x16x32_bf16 v[48:51], v[76:79], v[64:67], v[48:51]
    ds_read_b128 v[84:87], v18 offset:27648
    s_waitcnt lgkmcnt(2)
    v_mfma_f32_16x16x32_bf16 v[52:55], v[80:83], v[64:67], v[52:55]
    ds_read_b128 v[72:75], v18 offset:28672
    s_waitcnt lgkmcnt(2)
    ds_read_b128 v[76:79], v18 offset:29696
    s_waitcnt lgkmcnt(2)
    v_mfma_f32_16x16x32_bf16 v[32:35], v[84:87], v[68:71], v[32:35]
    ds_read_b128 v[80:83], v18 offset:30720
    s_waitcnt lgkmcnt(2)
    v_mfma_f32_16x16x32_bf16 v[36:39], v[72:75], v[68:71], v[36:39]
    ds_read_b128 v[84:87], v18 offset:31744
    s_waitcnt lgkmcnt(2)
    v_mfma_f32_16x16x32_bf16 v[40:43], v[76:79], v[68:71], v[40:43]
    ds_read_b128 v[72:75], v18 offset:32768
    s_waitcnt lgkmcnt(2)
    v_mfma_f32_16x16x32_bf16 v[44:47], v[80:83], v[68:71], v[44:47]
    s_waitcnt lgkmcnt(1)
    v_mfma_f32_16x16x32_bf16 v[48:51], v[84:87], v[68:71], v[48:51]
    s_waitcnt lgkmcnt(0)
    v_mfma_f32_16x16x32_bf16 v[52:55], v[72:75], v[68:71], v[52:55]
    s_nop 7
    v_cvt_pk_bf16_f32 v148, v32, v36
    v_cvt_pk_bf16_f32 v149, v33, v37
    v_cvt_pk_bf16_f32 v150, v34, v38
    v_cvt_pk_bf16_f32 v151, v35, v39
    ds_write_b128 v20, v[148:151] offset:0
    v_cvt_pk_bf16_f32 v152, v40, v44
    v_cvt_pk_bf16_f32 v153, v41, v45
    v_cvt_pk_bf16_f32 v154, v42, v46
    v_cvt_pk_bf16_f32 v155, v43, v47
    ds_write_b128 v20, v[152:155] offset:64
    v_cvt_pk_bf16_f32 v156, v48, v52
    v_cvt_pk_bf16_f32 v157, v49, v53
    v_cvt_pk_bf16_f32 v158, v50, v54
    v_cvt_pk_bf16_f32 v159, v51, v55
    ds_write_b128 v20, v[156:159] offset:128
    s_waitcnt lgkmcnt(0)
    s_barrier
    s_cmp_lg_u32 s74, 0
    s_cbranch_scc1 mega_kernel_Anext29
    ds_read_b128 v[32:35], v21 offset:0
    ds_read_b128 v[56:59], v21 offset:3200
    ds_read_b128 v[36:39], v21 offset:64
    ds_read_b128 v[60:63], v21 offset:3264
    ds_read_b128 v[40:43], v21 offset:128
    ds_read_b128 v[64:67], v21 offset:3328
    ds_read_b128 v[44:47], v21 offset:192
    ds_read_b128 v[68:71], v21 offset:3392
    ds_read_b128 v[48:51], v21 offset:256
    ds_read_b128 v[72:75], v21 offset:3456
    ds_read_b128 v[52:55], v21 offset:320
    ds_read_b128 v[76:79], v21 offset:3520
    s_waitcnt lgkmcnt(10)
    v_mfma_f32_16x16x32_bf16 v[136:139], v[56:59], v[32:35], 0
    v_mfma_f32_16x16x32_bf16 v[140:143], v[88:91], v[32:35], 0
    v_mfma_f32_16x16x32_bf16 v[144:147], v[112:115], v[32:35], 0
    s_waitcnt lgkmcnt(8)
    v_mfma_f32_16x16x32_bf16 v[136:139], v[60:63], v[36:39], v[136:139]
    v_mfma_f32_16x16x32_bf16 v[140:143], v[92:95], v[36:39], v[140:143]
    v_mfma_f32_16x16x32_bf16 v[144:147], v[116:119], v[36:39], v[144:147]
    s_waitcnt lgkmcnt(6)
    v_mfma_f32_16x16x32_bf16 v[136:139], v[64:67], v[40:43], v[136:139]
    v_mfma_f32_16x16x32_bf16 v[140:143], v[96:99], v[40:43], v[140:143]
    v_mfma_f32_16x16x32_bf16 v[144:147], v[120:123], v[40:43], v[144:147]
    s_waitcnt lgkmcnt(4)
    v_mfma_f32_16x16x32_bf16 v[136:139], v[68:71], v[44:47], v[136:139]
    v_mfma_f32_16x16x32_bf16 v[140:143], v[100:103], v[44:47], v[140:143]
    v_mfma_f32_16x16x32_bf16 v[144:147], v[124:127], v[44:47], v[144:147]
    s_waitcnt lgkmcnt(2)
    v_mfma_f32_16x16x32_bf16 v[136:139], v[72:75], v[48:51], v[136:139]
    v_mfma_f32_16x16x32_bf16 v[140:143], v[104:107], v[48:51], v[140:143]
    v_mfma_f32_16x16x32_bf16 v[144:147], v[128:131], v[48:51], v[144:147]
    s_waitcnt lgkmcnt(0)
    v_mfma_f32_16x16x32_bf16 v[136:139], v[76:79], v[52:55], v[136:139]
    v_mfma_f32_16x16x32_bf16 v[140:143], v[108:111], v[52:55], v[140:143]
    v_mfma_f32_16x16x32_bf16 v[144:147], v[132:135], v[52:55], v[144:147]
    s_nop 7
    v_cndmask_b32 v136, v136, v26, s[84:85]
    v_cndmask_b32 v137, v137, v26, s[84:85]
    v_cndmask_b32 v138, v138, v26, s[84:85]
    v_cndmask_b32 v139, v139, v26, s[84:85]
    v_max3_f32 v148, v136, v137, v138
    v_max3_f32 v149, v139, v140, v141
    v_max3_f32 v150, v142, v143, v144
    v_max3_f32 v151, v145, v146, v147
    v_max3_f32 v148, v148, v149, v150
    v_max_f32 v148, v148, v151
    v_mov_b32 v149, v148
    s_nop 1
    v_permlane16_swap_b32 v148, v149
    s_nop 1
    v_max_f32 v148, v148, v149
    v_mov_b32 v149, v148
    s_nop 1
    v_permlane32_swap_b32 v148, v149
    s_nop 1
    v_max_f32 v148, v148, v149
    v_mul_f32 v148, 0xbdd53b95, v148
    s_mov_b32 s3, 0x3dd53b95
    v_fma_f32 v136, v136, s3, v148
    v_fma_f32 v137, v137, s3, v148
    v_fma_f32 v138, v138, s3, v148
    v_fma_f32 v139, v139, s3, v148
    v_fma_f32 v140, v140, s3, v148
    v_fma_f32 v141, v141, s3, v148
    v_fma_f32 v142, v142, s3, v148
    v_fma_f32 v143, v143, s3, v148
    v_fma_f32 v144, v144, s3, v148
    v_fma_f32 v145, v145, s3, v148
    v_fma_f32 v146, v146, s3, v148
    v_fma_f32 v147, v147, s3, v148
    v_exp_f32 v136, v136
    v_exp_f32 v137, v137
    v_exp_f32 v138, v138
    v_exp_f32 v139, v139
    v_exp_f32 v140, v140
    v_exp_f32 v141, v141
    v_exp_f32 v142, v142
    v_exp_f32 v143, v143
    v_exp_f32 v144, v144
    v_exp_f32 v145, v145
    v_exp_f32 v146, v146
    v_exp_f32 v147, v147
    s_nop 0
    v_add_f32 v149, v136, v137
    v_add_f32 v149, v149, v138
    v_add_f32 v149, v149, v139
    v_add_f32 v149, v149, v140
    v_add_f32 v149, v149, v141
    v_add_f32 v149, v149, v142
    v_add_f32 v149, v149, v143
    v_add_f32 v149, v149, v144
    v_add_f32 v149, v149, v145
    v_add_f32 v149, v149, v146
    v_add_f32 v149, v149, v147
    v_mov_b32 v150, v149
    s_nop 1
    v_permlane16_swap_b32 v149, v150
    s_nop 1
    v_add_f32 v149, v149, v150
    v_mov_b32 v150, v149
    s_nop 1
    v_permlane32_swap_b32 v149, v150
    s_nop 1
    v_add_f32 v149, v149, v150
    v_rcp_f32 v149, v149
    s_nop 0
    v_mul_f32 v136, v136, v149
    v_mul_f32 v137, v137, v149
    v_mul_f32 v138, v138, v149
    v_mul_f32 v139, v139, v149
    v_mul_f32 v140, v140, v149
    v_mul_f32 v141, v141, v149
    v_mul_f32 v142, v142, v149
    v_mul_f32 v143, v143, v149
    v_mul_f32 v144, v144, v149
    v_mul_f32 v145, v145, v149
    v_mul_f32 v146, v146, v149
    v_mul_f32 v147, v147, v149
    v_cvt_pk_bf16_f32 v152, v136, v137
    v_cvt_pk_bf16_f32 v153, v138, v139
    v_cvt_pk_bf16_f32 v154, v140, v141
    v_cvt_pk_bf16_f32 v155, v142, v143
    v_cvt_pk_bf16_f32 v156, v144, v145
    v_cvt_pk_bf16_f32 v157, v146, v147
    v_min_u32 v152, 0xfffffffe, v152
    v_min_u32 v153, 0xfffffffe, v153
    v_min_u32 v154, 0xfffffffe, v154
    v_min_u32 v155, 0xfffffffe, v155
    v_min_u32 v156, 0xfffffffe, v156
    v_min_u32 v157, 0xfffffffe, v157
    s_mov_b64 exec, s[80:81]
    buffer_store_dwordx4 v[154:157], v24, s[60:63], s24 offen sc1
    s_mov_b64 exec, s[82:83]
    buffer_store_dwordx2 v[152:153], v23, s[60:63], s24 offen sc1
    s_mov_b64 exec, s[80:81]
    buffer_store_dwordx4 v[56:59], v25, s[60:63], s25 offen offset:0 sc1
    buffer_store_dwordx4 v[60:63], v25, s[60:63], s25 offen offset:64 sc1
    buffer_store_dwordx4 v[64:67], v25, s[60:63], s25 offen offset:128 sc1
    buffer_store_dwordx4 v[68:71], v25, s[60:63], s25 offen offset:192 sc1
    buffer_store_dwordx4 v[72:75], v25, s[60:63], s25 offen offset:256 sc1
    buffer_store_dwordx4 v[76:79], v25, s[60:63], s25 offen offset:320 sc1
    s_mov_b64 exec, -1
mega_kernel_Anext29:
    s_add_u32 s29, s29, 1
    s_add_u32 s30, s30, 10240
    s_add_u32 s23, s23, 12288
    s_add_u32 s24, s24, 20480
    s_add_u32 s25, s25, 98304
    s_cmp_lt_u32 s29, 64
    s_cbranch_scc1 mega_kernel_Aloop27
    s_cmp_lg_u32 s74, 0
    s_cbranch_scc1 mega_T0_LA
    s_waitcnt vmcnt(0)
    v_mov_b32 v150, 1
    v_mov_b32 v151, 0
    s_mov_b64 exec, 1
    s_mov_b32 s71, 204501408
    buffer_atomic_add v150, v151, s[60:63], s71 offen sc1
    s_mov_b64 exec, -1
    s_branch mega_T0_LA
    s_branch mega_kernel_tsk37
mega_T0_LQ:
    s_branch mega_T1_LQ
mega_T0_LV:
    s_branch mega_T1_LV
mega_T0_LA:
    s_branch mega_T1_LA
mega_T0_LU:
    s_branch mega_T1_LU
mega_T0_LD:
    s_branch mega_T1_LD
mega_T0_done:
    s_branch mega_T1_done
mega_kernel_tsk37:
mega_kernel_roleB23:
    s_mov_b32 s64, s16
    s_and_b32 s65, s17, 0xffff
    s_mov_b32 s66, 7864320
    s_mov_b32 s67, 0x00020000
    s_mov_b32 s96, s18
    s_and_b32 s97, s19, 0xffff
    s_mov_b32 s98, 7864320
    s_mov_b32 s99, 0x00020000
    s_mov_b32 s3, 98304
    v_mul_lo_u32 v6, v4, s3
    v_lshl_add_u32 v6, v3, 2, v6
    s_mul_i32 s26, s74, 3
    s_lshr_b32 s26, s26, 1
    s_mul_i32 s21, s20, 384
    s_lshl_b32 s3, s26, 6
    s_add_u32 s21, s21, s3
    s_add_u32 s22, s21, 64
    s_bitcmp1_b32 s74, 0
    s_cbranch_scc1 mega_kernel_odd38
    s_add_u32 s71, s21, 0
    buffer_load_dword v32, v6, s[64:67], s71 offen
    s_add_u32 s71, s21, 12288
    buffer_load_dword v33, v6, s[64:67], s71 offen
    s_add_u32 s71, s21, 24576
    buffer_load_dword v34, v6, s[64:67], s71 offen
    s_add_u32 s71, s21, 36864
    buffer_load_dword v35, v6, s[64:67], s71 offen
    s_add_u32 s71, s21, 49152
    buffer_load_dword v36, v6, s[64:67], s71 offen
    s_add_u32 s71, s21, 61440
    buffer_load_dword v37, v6, s[64:67], s71 offen
    s_add_u32 s71, s21, 73728
    buffer_load_dword v38, v6, s[64:67], s71 offen
    s_add_u32 s71, s21, 86016
    buffer_load_dword v39, v6, s[64:67], s71 offen
    s_add_u32 s71, s21, 393216
    buffer_load_dword v40, v6, s[64:67], s71 offen
    s_add_u32 s71, s21, 405504
    buffer_load_dword v41, v6, s[64:67], s71 offen
    s_add_u32 s71, s21, 417792
    buffer_load_dword v42, v6, s[64:67], s71 offen
    s_add_u32 s71, s21, 430080
    buffer_load_dword v43, v6, s[64:67], s71 offen
    s_add_u32 s71, s21, 442368
    buffer_load_dword v44, v6, s[64:67], s71 offen
    s_add_u32 s71, s21, 454656
    buffer_load_dword v45, v6, s[64:67], s71 offen
    s_add_u32 s71, s21, 466944
    buffer_load_dword v46, v6, s[64:67], s71 offen
    s_add_u32 s71, s21, 479232
    buffer_load_dword v47, v6, s[64:67], s71 offen
    s_add_u32 s71, s21, 786432
    buffer_load_dword v48, v6, s[64:67], s71 offen
    s_add_u32 s71, s21, 798720
    buffer_load_dword v49, v6, s[64:67], s71 offen
    s_add_u32 s71, s21, 811008
    buffer_load_dword v50, v6, s[64:67], s71 offen
    s_add_u32 s71, s21, 823296
    buffer_load_dword v51, v6, s[64:67], s71 offen
    s_add_u32 s71, s21, 835584
    buffer_load_dword v52, v6, s[64:67], s71 offen
    s_add_u32 s71, s21, 847872
    buffer_load_dword v53, v6, s[64:67], s71 offen
    s_add_u32 s71, s21, 860160
    buffer_load_dword v54, v6, s[64:67], s71 offen
    s_add_u32 s71, s21, 872448
    buffer_load_dword v55, v6, s[64:67], s71 offen
    s_add_u32 s71, s21, 1179648
    buffer_load_dword v56, v6, s[64:67], s71 offen
    s_add_u32 s71, s21, 1191936
    buffer_load_dword v57, v6, s[64:67], s71 offen
    s_add_u32 s71, s21, 1204224
    buffer_load_dword v58, v6, s[64:67], s71 offen
    s_add_u32 s71, s21, 1216512
    buffer_load_dword v59, v6, s[64:67], s71 offen
    s_add_u32 s71, s21, 1228800
    buffer_load_dword v60, v6, s[64:67], s71 offen
    s_add_u32 s71, s21, 1241088
    buffer_load_dword v61, v6, s[64:67], s71 offen
    s_add_u32 s71, s21, 1253376
    buffer_load_dword v62, v6, s[64:67], s71 offen
    s_add_u32 s71, s21, 1265664
    buffer_load_dword v63, v6, s[64:67], s71 offen
    s_add_u32 s71, s21, 1572864
    buffer_load_dword v64, v6, s[64:67], s71 offen
    s_add_u32 s71, s21, 1585152
    buffer_load_dword v65, v6, s[64:67], s71 offen
    s_add_u32 s71, s21, 1597440
    buffer_load_dword v66, v6, s[64:67], s71 offen
    s_add_u32 s71, s21, 1609728
    buffer_load_dword v67, v6, s[64:67], s71 offen
    s_add_u32 s71, s21, 1622016
    buffer_load_dword v68, v6, s[64:67], s71 offen
    s_add_u32 s71, s21, 1634304
    buffer_load_dword v69, v6, s[64:67], s71 offen
    s_add_u32 s71, s21, 1646592
    buffer_load_dword v70, v6, s[64:67], s71 offen
    s_add_u32 s71, s21, 1658880
    buffer_load_dword v71, v6, s[64:67], s71 offen
    s_add_u32 s71, s21, 1966080
    buffer_load_dword v72, v6, s[64:67], s71 offen
    s_add_u32 s71, s21, 1978368
    buffer_load_dword v73, v6, s[64:67], s71 offen
    s_add_u32 s71, s21, 1990656
    buffer_load_dword v74, v6, s[64:67], s71 offen
    s_add_u32 s71, s21, 2002944
    buffer_load_dword v75, v6, s[64:67], s71 offen
    s_add_u32 s71, s21, 2015232
    buffer_load_dword v76, v6, s[64:67], s71 offen
    s_add_u32 s71, s21, 2027520
    buffer_load_dword v77, v6, s[64:67], s71 offen
    s_add_u32 s71, s21, 2039808
    buffer_load_dword v78, v6, s[64:67], s71 offen
    s_add_u32 s71, s21, 2052096
    buffer_load_dword v79, v6, s[64:67], s71 offen
    s_add_u32 s71, s21, 2359296
    buffer_load_dword v80, v6, s[64:67], s71 offen
    s_add_u32 s71, s21, 2371584
    buffer_load_dword v81, v6, s[64:67], s71 offen
    s_add_u32 s71, s21, 2383872
    buffer_load_dword v82, v6, s[64:67], s71 offen
    s_add_u32 s71, s21, 2396160
    buffer_load_dword v83, v6, s[64:67], s71 offen
    s_add_u32 s71, s21, 2408448
    buffer_load_dword v84, v6, s[64:67], s71 offen
    s_add_u32 s71, s21, 2420736
    buffer_load_dword v85, v6, s[64:67], s71 offen
    s_add_u32 s71, s21, 2433024
    buffer_load_dword v86, v6, s[64:67], s71 offen
    s_add_u32 s71, s21, 2445312
    buffer_load_dword v87, v6, s[64:67], s71 offen
    s_add_u32 s71, s21, 2752512
    buffer_load_dword v88, v6, s[64:67], s71 offen
    s_add_u32 s71, s21, 2764800
    buffer_load_dword v89, v6, s[64:67], s71 offen
    s_add_u32 s71, s21, 2777088
    buffer_load_dword v90, v6, s[64:67], s71 offen
    s_add_u32 s71, s21, 2789376
    buffer_load_dword v91, v6, s[64:67], s71 offen
    s_add_u32 s71, s21, 2801664
    buffer_load_dword v92, v6, s[64:67], s71 offen
    s_add_u32 s71, s21, 2813952
    buffer_load_dword v93, v6, s[64:67], s71 offen
    s_add_u32 s71, s21, 2826240
    buffer_load_dword v94, v6, s[64:67], s71 offen
    s_add_u32 s71, s21, 2838528
    buffer_load_dword v95, v6, s[64:67], s71 offen
    s_add_u32 s71, s21, 3145728
    buffer_load_dword v96, v6, s[64:67], s71 offen
    s_add_u32 s71, s21, 3158016
    buffer_load_dword v97, v6, s[64:67], s71 offen
    s_add_u32 s71, s21, 3170304
    buffer_load_dword v98, v6, s[64:67], s71 offen
    s_add_u32 s71, s21, 3182592
    buffer_load_dword v99, v6, s[64:67], s71 offen
    s_add_u32 s71, s21, 3194880
    buffer_load_dword v100, v6, s[64:67], s71 offen
    s_add_u32 s71, s21, 3207168
    buffer_load_dword v101, v6, s[64:67], s71 offen
    s_add_u32 s71, s21, 3219456
    buffer_load_dword v102, v6, s[64:67], s71 offen
    s_add_u32 s71, s21, 3231744
    buffer_load_dword v103, v6, s[64:67], s71 offen
    s_add_u32 s71, s21, 3538944
    buffer_load_dword v104, v6, s[64:67], s71 offen
    s_add_u32 s71, s21, 3551232
    buffer_load_dword v105, v6, s[64:67], s71 offen
    s_add_u32 s71, s21, 3563520
    buffer_load_dword v106, v6, s[64:67], s71 offen
    s_add_u32 s71, s21, 3575808
    buffer_load_dword v107, v6, s[64:67], s71 offen
    s_add_u32 s71, s21, 3588096
    buffer_load_dword v108, v6, s[64:67], s71 offen
    s_add_u32 s71, s21, 3600384
    buffer_load_dword v109, v6, s[64:67], s71 offen
    s_add_u32 s71, s21, 3612672
    buffer_load_dword v110, v6, s[64:67], s71 offen
    s_add_u32 s71, s21, 3624960
    buffer_load_dword v111, v6, s[64:67], s71 offen
    s_add_u32 s71, s21, 3932160
    buffer_load_dword v112, v6, s[64:67], s71 offen
    s_add_u32 s71, s21, 3944448
    buffer_load_dword v113, v6, s[64:67], s71 offen
    s_add_u32 s71, s21, 3956736
    buffer_load_dword v114, v6, s[64:67], s71 offen
    s_add_u32 s71, s21, 3969024
    buffer_load_dword v115, v6, s[64:67], s71 offen
    s_add_u32 s71, s21, 3981312
    buffer_load_dword v116, v6, s[64:67], s71 offen
    s_add_u32 s71, s21, 3993600
    buffer_load_dword v117, v6, s[64:67], s71 offen
    s_add_u32 s71, s21, 4005888
    buffer_load_dword v118, v6, s[64:67], s71 offen
    s_add_u32 s71, s21, 4018176
    buffer_load_dword v119, v6, s[64:67], s71 offen
    s_add_u32 s71, s21, 4325376
    buffer_load_dword v120, v6, s[64:67], s71 offen
    s_add_u32 s71, s21, 4337664
    buffer_load_dword v121, v6, s[64:67], s71 offen
    s_add_u32 s71, s21, 4349952
    buffer_load_dword v122, v6, s[64:67], s71 offen
    s_add_u32 s71, s21, 4362240
    buffer_load_dword v123, v6, s[64:67], s71 offen
    s_add_u32 s71, s21, 4374528
    buffer_load_dword v124, v6, s[64:67], s71 offen
    s_add_u32 s71, s21, 4386816
    buffer_load_dword v125, v6, s[64:67], s71 offen
    s_add_u32 s71, s21, 4399104
    buffer_load_dword v126, v6, s[64:67], s71 offen
    s_add_u32 s71, s21, 4411392
    buffer_load_dword v127, v6, s[64:67], s71 offen
    s_waitcnt vmcnt(63)
    v_perm_b32 v132, v33, v32, s72
    v_perm_b32 v133, v35, v34, s72
    v_perm_b32 v134, v37, v36, s72
    v_perm_b32 v135, v39, v38, s72
    v_accvgpr_write_b32 a0, v132
    v_accvgpr_write_b32 a1, v133
    v_accvgpr_write_b32 a2, v134
    v_accvgpr_write_b32 a3, v135
    v_perm_b32 v136, v33, v32, s73
    v_perm_b32 v137, v35, v34, s73
    v_perm_b32 v138, v37, v36, s73
    v_perm_b32 v139, v39, v38, s73
    v_accvgpr_write_b32 a4, v136
    v_accvgpr_write_b32 a5, v137
    v_accvgpr_write_b32 a6, v138
    v_accvgpr_write_b32 a7, v139
    v_perm_b32 v140, v41, v40, s72
    v_perm_b32 v141, v43, v42, s72
    v_perm_b32 v142, v45, v44, s72
    v_perm_b32 v143, v47, v46, s72
    v_accvgpr_write_b32 a12, v140
    v_accvgpr_write_b32 a13, v141
    v_accvgpr_write_b32 a14, v142
    v_accvgpr_write_b32 a15, v143
    v_perm_b32 v144, v41, v40, s73
    v_perm_b32 v145, v43, v42, s73
    v_perm_b32 v146, v45, v44, s73
    v_perm_b32 v147, v47, v46, s73
    v_accvgpr_write_b32 a16, v144
    v_accvgpr_write_b32 a17, v145
    v_accvgpr_write_b32 a18, v146
    v_accvgpr_write_b32 a19, v147
    v_perm_b32 v132, v49, v48, s72
    v_perm_b32 v133, v51, v50, s72
    v_perm_b32 v134, v53, v52, s72
    v_perm_b32 v135, v55, v54, s72
    v_accvgpr_write_b32 a24, v132
    v_accvgpr_write_b32 a25, v133
    v_accvgpr_write_b32 a26, v134
    v_accvgpr_write_b32 a27, v135
    v_perm_b32 v136, v49, v48, s73
    v_perm_b32 v137, v51, v50, s73
    v_perm_b32 v138, v53, v52, s73
    v_perm_b32 v139, v55, v54, s73
    v_accvgpr_write_b32 a28, v136
    v_accvgpr_write_b32 a29, v137
    v_accvgpr_write_b32 a30, v138
    v_accvgpr_write_b32 a31, v139
    v_perm_b32 v140, v57, v56, s72
    v_perm_b32 v141, v59, v58, s72
    v_perm_b32 v142, v61, v60, s72
    v_perm_b32 v143, v63, v62, s72
    v_accvgpr_write_b32 a36, v140
    v_accvgpr_write_b32 a37, v141
    v_accvgpr_write_b32 a38, v142
    v_accvgpr_write_b32 a39, v143
    v_perm_b32 v144, v57, v56, s73
    v_perm_b32 v145, v59, v58, s73
    v_perm_b32 v146, v61, v60, s73
    v_perm_b32 v147, v63, v62, s73
    v_accvgpr_write_b32 a40, v144
    v_accvgpr_write_b32 a41, v145
    v_accvgpr_write_b32 a42, v146
    v_accvgpr_write_b32 a43, v147
    s_waitcnt lgkmcnt(0)
    s_add_u32 s71, s21, 4718592
    buffer_load_dword v32, v6, s[64:67], s71 offen
    s_add_u32 s71, s21, 4730880
    buffer_load_dword v33, v6, s[64:67], s71 offen
    s_add_u32 s71, s21, 4743168
    buffer_load_dword v34, v6, s[64:67], s71 offen
    s_add_u32 s71, s21, 4755456
    buffer_load_dword v35, v6, s[64:67], s71 offen
    s_add_u32 s71, s21, 4767744
    buffer_load_dword v36, v6, s[64:67], s71 offen
    s_add_u32 s71, s21, 4780032
    buffer_load_dword v37, v6, s[64:67], s71 offen
    s_add_u32 s71, s21, 4792320
    buffer_load_dword v38, v6, s[64:67], s71 offen
    s_add_u32 s71, s21, 4804608
    buffer_load_dword v39, v6, s[64:67], s71 offen
    s_add_u32 s71, s21, 5111808
    buffer_load_dword v40, v6, s[64:67], s71 offen
    s_add_u32 s71, s21, 5124096
    buffer_load_dword v41, v6, s[64:67], s71 offen
    s_add_u32 s71, s21, 5136384
    buffer_load_dword v42, v6, s[64:67], s71 offen
    s_add_u32 s71, s21, 5148672
    buffer_load_dword v43, v6, s[64:67], s71 offen
    s_add_u32 s71, s21, 5160960
    buffer_load_dword v44, v6, s[64:67], s71 offen
    s_add_u32 s71, s21, 5173248
    buffer_load_dword v45, v6, s[64:67], s71 offen
    s_add_u32 s71, s21, 5185536
    buffer_load_dword v46, v6, s[64:67], s71 offen
    s_add_u32 s71, s21, 5197824
    buffer_load_dword v47, v6, s[64:67], s71 offen
    s_add_u32 s71, s21, 5505024
    buffer_load_dword v48, v6, s[64:67], s71 offen
    s_add_u32 s71, s21, 5517312
    buffer_load_dword v49, v6, s[64:67], s71 offen
    s_add_u32 s71, s21, 5529600
    buffer_load_dword v50, v6, s[64:67], s71 offen
    s_add_u32 s71, s21, 5541888
    buffer_load_dword v51, v6, s[64:67], s71 offen
    s_add_u32 s71, s21, 5554176
    buffer_load_dword v52, v6, s[64:67], s71 offen
    s_add_u32 s71, s21, 5566464
    buffer_load_dword v53, v6, s[64:67], s71 offen
    s_add_u32 s71, s21, 5578752
    buffer_load_dword v54, v6, s[64:67], s71 offen
    s_add_u32 s71, s21, 5591040
    buffer_load_dword v55, v6, s[64:67], s71 offen
    s_add_u32 s71, s21, 5898240
    buffer_load_dword v56, v6, s[64:67], s71 offen
    s_add_u32 s71, s21, 5910528
    buffer_load_dword v57, v6, s[64:67], s71 offen
    s_add_u32 s71, s21, 5922816
    buffer_load_dword v58, v6, s[64:67], s71 offen
    s_add_u32 s71, s21, 5935104
    buffer_load_dword v59, v6, s[64:67], s71 offen
    s_add_u32 s71, s21, 5947392
    buffer_load_dword v60, v6, s[64:67], s71 offen
    s_add_u32 s71, s21, 5959680
    buffer_load_dword v61, v6, s[64:67], s71 offen
    s_add_u32 s71, s21, 5971968
    buffer_load_dword v62, v6, s[64:67], s71 offen
    s_add_u32 s71, s21, 5984256
    buffer_load_dword v63, v6, s[64:67], s71 offen
    s_waitcnt vmcnt(63)
    v_perm_b32 v132, v65, v64, s72
    v_perm_b32 v133, v67, v66, s72
    v_perm_b32 v134, v69, v68, s72
    v_perm_b32 v135, v71, v70, s72
    v_accvgpr_write_b32 a48, v132
    v_accvgpr_write_b32 a49, v133
    v_accvgpr_write_b32 a50, v134
    v_accvgpr_write_b32 a51, v135
    v_perm_b32 v136, v65, v64, s73
    v_perm_b32 v137, v67, v66, s73
    v_perm_b32 v138, v69, v68, s73
    v_perm_b32 v139, v71, v70, s73
    v_accvgpr_write_b32 a52, v136
    v_accvgpr_write_b32 a53, v137
    v_accvgpr_write_b32 a54, v138
    v_accvgpr_write_b32 a55, v139
    v_perm_b32 v140, v73, v72, s72
    v_perm_b32 v141, v75, v74, s72
    v_perm_b32 v142, v77, v76, s72
    v_perm_b32 v143, v79, v78, s72
    v_accvgpr_write_b32 a60, v140
    v_accvgpr_write_b32 a61, v141
    v_accvgpr_write_b32 a62, v142
    v_accvgpr_write_b32 a63, v143
    v_perm_b32 v144, v73, v72, s73
    v_perm_b32 v145, v75, v74, s73
    v_perm_b32 v146, v77, v76, s73
    v_perm_b32 v147, v79, v78, s73
    v_accvgpr_write_b32 a64, v144
    v_accvgpr_write_b32 a65, v145
    v_accvgpr_write_b32 a66, v146
    v_accvgpr_write_b32 a67, v147
    v_perm_b32 v132, v81, v80, s72
    v_perm_b32 v133, v83, v82, s72
    v_perm_b32 v134, v85, v84, s72
    v_perm_b32 v135, v87, v86, s72
    v_accvgpr_write_b32 a72, v132
    v_accvgpr_write_b32 a73, v133
    v_accvgpr_write_b32 a74, v134
    v_accvgpr_write_b32 a75, v135
    v_perm_b32 v136, v81, v80, s73
    v_perm_b32 v137, v83, v82, s73
    v_perm_b32 v138, v85, v84, s73
    v_perm_b32 v139, v87, v86, s73
    v_accvgpr_write_b32 a76, v136
    v_accvgpr_write_b32 a77, v137
    v_accvgpr_write_b32 a78, v138
    v_accvgpr_write_b32 a79, v139
    v_perm_b32 v140, v89, v88, s72
    v_perm_b32 v141, v91, v90, s72
    v_perm_b32 v142, v93, v92, s72
    v_perm_b32 v143, v95, v94, s72
    v_accvgpr_write_b32 a84, v140
    v_accvgpr_write_b32 a85, v141
    v_accvgpr_write_b32 a86, v142
    v_accvgpr_write_b32 a87, v143
    v_perm_b32 v144, v89, v88, s73
    v_perm_b32 v145, v91, v90, s73
    v_perm_b32 v146, v93, v92, s73
    v_perm_b32 v147, v95, v94, s73
    v_accvgpr_write_b32 a88, v144
    v_accvgpr_write_b32 a89, v145
    v_accvgpr_write_b32 a90, v146
    v_accvgpr_write_b32 a91, v147
    s_waitcnt lgkmcnt(0)
    s_add_u32 s71, s21, 6291456
    buffer_load_dword v64, v6, s[64:67], s71 offen
    s_add_u32 s71, s21, 6303744
    buffer_load_dword v65, v6, s[64:67], s71 offen
    s_add_u32 s71, s21, 6316032
    buffer_load_dword v66, v6, s[64:67], s71 offen
    s_add_u32 s71, s21, 6328320
    buffer_load_dword v67, v6, s[64:67], s71 offen
    s_add_u32 s71, s21, 6340608
    buffer_load_dword v68, v6, s[64:67], s71 offen
    s_add_u32 s71, s21, 6352896
    buffer_load_dword v69, v6, s[64:67], s71 offen
    s_add_u32 s71, s21, 6365184
    buffer_load_dword v70, v6, s[64:67], s71 offen
    s_add_u32 s71, s21, 6377472
    buffer_load_dword v71, v6, s[64:67], s71 offen
    s_add_u32 s71, s21, 6684672
    buffer_load_dword v72, v6, s[64:67], s71 offen
    s_add_u32 s71, s21, 6696960
    buffer_load_dword v73, v6, s[64:67], s71 offen
    s_add_u32 s71, s21, 6709248
    buffer_load_dword v74, v6, s[64:67], s71 offen
    s_add_u32 s71, s21, 6721536
    buffer_load_dword v75, v6, s[64:67], s71 offen
    s_add_u32 s71, s21, 6733824
    buffer_load_dword v76, v6, s[64:67], s71 offen
    s_add_u32 s71, s21, 6746112
    buffer_load_dword v77, v6, s[64:67], s71 offen
    s_add_u32 s71, s21, 6758400
    buffer_load_dword v78, v6, s[64:67], s71 offen
    s_add_u32 s71, s21, 6770688
    buffer_load_dword v79, v6, s[64:67], s71 offen
    s_add_u32 s71, s21, 7077888
    buffer_load_dword v80, v6, s[64:67], s71 offen
    s_add_u32 s71, s21, 7090176
    buffer_load_dword v81, v6, s[64:67], s71 offen
    s_add_u32 s71, s21, 7102464
    buffer_load_dword v82, v6, s[64:67], s71 offen
    s_add_u32 s71, s21, 7114752
    buffer_load_dword v83, v6, s[64:67], s71 offen
    s_add_u32 s71, s21, 7127040
    buffer_load_dword v84, v6, s[64:67], s71 offen
    s_add_u32 s71, s21, 7139328
    buffer_load_dword v85, v6, s[64:67], s71 offen
    s_add_u32 s71, s21, 7151616
    buffer_load_dword v86, v6, s[64:67], s71 offen
    s_add_u32 s71, s21, 7163904
    buffer_load_dword v87, v6, s[64:67], s71 offen
    s_add_u32 s71, s21, 7471104
    buffer_load_dword v88, v6, s[64:67], s71 offen
    s_add_u32 s71, s21, 7483392
    buffer_load_dword v89, v6, s[64:67], s71 offen
    s_add_u32 s71, s21, 7495680
    buffer_load_dword v90, v6, s[64:67], s71 offen
    s_add_u32 s71, s21, 7507968
    buffer_load_dword v91, v6, s[64:67], s71 offen
    s_add_u32 s71, s21, 7520256
    buffer_load_dword v92, v6, s[64:67], s71 offen
    s_add_u32 s71, s21, 7532544
    buffer_load_dword v93, v6, s[64:67], s71 offen
    s_add_u32 s71, s21, 7544832
    buffer_load_dword v94, v6, s[64:67], s71 offen
    s_add_u32 s71, s21, 7557120
    buffer_load_dword v95, v6, s[64:67], s71 offen
    s_waitcnt vmcnt(63)
    v_perm_b32 v132, v97, v96, s72
    v_perm_b32 v133, v99, v98, s72
    v_perm_b32 v134, v101, v100, s72
    v_perm_b32 v135, v103, v102, s72
    v_accvgpr_write_b32 a96, v132
    v_accvgpr_write_b32 a97, v133
    v_accvgpr_write_b32 a98, v134
    v_accvgpr_write_b32 a99, v135
    v_perm_b32 v136, v97, v96, s73
    v_perm_b32 v137, v99, v98, s73
    v_perm_b32 v138, v101, v100, s73
    v_perm_b32 v139, v103, v102, s73
    v_accvgpr_write_b32 a100, v136
    v_accvgpr_write_b32 a101, v137
    v_accvgpr_write_b32 a102, v138
    v_accvgpr_write_b32 a103, v139
    v_perm_b32 v140, v105, v104, s72
    v_perm_b32 v141, v107, v106, s72
    v_perm_b32 v142, v109, v108, s72
    v_perm_b32 v143, v111, v110, s72
    v_accvgpr_write_b32 a108, v140
    v_accvgpr_write_b32 a109, v141
    v_accvgpr_write_b32 a110, v142
    v_accvgpr_write_b32 a111, v143
    v_perm_b32 v144, v105, v104, s73
    v_perm_b32 v145, v107, v106, s73
    v_perm_b32 v146, v109, v108, s73
    v_perm_b32 v147, v111, v110, s73
    v_accvgpr_write_b32 a112, v144
    v_accvgpr_write_b32 a113, v145
    v_accvgpr_write_b32 a114, v146
    v_accvgpr_write_b32 a115, v147
    v_perm_b32 v132, v113, v112, s72
    v_perm_b32 v133, v115, v114, s72
    v_perm_b32 v134, v117, v116, s72
    v_perm_b32 v135, v119, v118, s72
    v_accvgpr_write_b32 a120, v132
    v_accvgpr_write_b32 a121, v133
    v_accvgpr_write_b32 a122, v134
    v_accvgpr_write_b32 a123, v135
    v_perm_b32 v136, v113, v112, s73
    v_perm_b32 v137, v115, v114, s73
    v_perm_b32 v138, v117, v116, s73
    v_perm_b32 v139, v119, v118, s73
    v_accvgpr_write_b32 a124, v136
    v_accvgpr_write_b32 a125, v137
    v_accvgpr_write_b32 a126, v138
    v_accvgpr_write_b32 a127, v139
    v_perm_b32 v140, v121, v120, s72
    v_perm_b32 v141, v123, v122, s72
    v_perm_b32 v142, v125, v124, s72
    v_perm_b32 v143, v127, v126, s72
    v_accvgpr_write_b32 a132, v140
    v_accvgpr_write_b32 a133, v141
    v_accvgpr_write_b32 a134, v142
    v_accvgpr_write_b32 a135, v143
    v_perm_b32 v144, v121, v120, s73
    v_perm_b32 v145, v123, v122, s73
    v_perm_b32 v146, v125, v124, s73
    v_perm_b32 v147, v127, v126, s73
    v_accvgpr_write_b32 a136, v144
    v_accvgpr_write_b32 a137, v145
    v_accvgpr_write_b32 a138, v146
    v_accvgpr_write_b32 a139, v147
    s_waitcnt lgkmcnt(0)
    s_waitcnt vmcnt(32)
    v_perm_b32 v132, v33, v32, s72
    v_perm_b32 v133, v35, v34, s72
    v_perm_b32 v134, v37, v36, s72
    v_perm_b32 v135, v39, v38, s72
    v_accvgpr_write_b32 a144, v132
    v_accvgpr_write_b32 a145, v133
    v_accvgpr_write_b32 a146, v134
    v_accvgpr_write_b32 a147, v135
    v_perm_b32 v136, v33, v32, s73
    v_perm_b32 v137, v35, v34, s73
    v_perm_b32 v138, v37, v36, s73
    v_perm_b32 v139, v39, v38, s73
    v_accvgpr_write_b32 a148, v136
    v_accvgpr_write_b32 a149, v137
    v_accvgpr_write_b32 a150, v138
    v_accvgpr_write_b32 a151, v139
    v_perm_b32 v140, v41, v40, s72
    v_perm_b32 v141, v43, v42, s72
    v_perm_b32 v142, v45, v44, s72
    v_perm_b32 v143, v47, v46, s72
    v_accvgpr_write_b32 a156, v140
    v_accvgpr_write_b32 a157, v141
    v_accvgpr_write_b32 a158, v142
    v_accvgpr_write_b32 a159, v143
    v_perm_b32 v144, v41, v40, s73
    v_perm_b32 v145, v43, v42, s73
    v_perm_b32 v146, v45, v44, s73
    v_perm_b32 v147, v47, v46, s73
    v_accvgpr_write_b32 a160, v144
    v_accvgpr_write_b32 a161, v145
    v_accvgpr_write_b32 a162, v146
    v_accvgpr_write_b32 a163, v147
    v_perm_b32 v132, v49, v48, s72
    v_perm_b32 v133, v51, v50, s72
    v_perm_b32 v134, v53, v52, s72
    v_perm_b32 v135, v55, v54, s72
    v_accvgpr_write_b32 a168, v132
    v_accvgpr_write_b32 a169, v133
    v_accvgpr_write_b32 a170, v134
    v_accvgpr_write_b32 a171, v135
    v_perm_b32 v136, v49, v48, s73
    v_perm_b32 v137, v51, v50, s73
    v_perm_b32 v138, v53, v52, s73
    v_perm_b32 v139, v55, v54, s73
    v_accvgpr_write_b32 a172, v136
    v_accvgpr_write_b32 a173, v137
    v_accvgpr_write_b32 a174, v138
    v_accvgpr_write_b32 a175, v139
    v_perm_b32 v140, v57, v56, s72
    v_perm_b32 v141, v59, v58, s72
    v_perm_b32 v142, v61, v60, s72
    v_perm_b32 v143, v63, v62, s72
    v_accvgpr_write_b32 a180, v140
    v_accvgpr_write_b32 a181, v141
    v_accvgpr_write_b32 a182, v142
    v_accvgpr_write_b32 a183, v143
    v_perm_b32 v144, v57, v56, s73
    v_perm_b32 v145, v59, v58, s73
    v_perm_b32 v146, v61, v60, s73
    v_perm_b32 v147, v63, v62, s73
    v_accvgpr_write_b32 a184, v144
    v_accvgpr_write_b32 a185, v145
    v_accvgpr_write_b32 a186, v146
    v_accvgpr_write_b32 a187, v147
    s_waitcnt lgkmcnt(0)
    s_waitcnt vmcnt(0)
    v_perm_b32 v132, v65, v64, s72
    v_perm_b32 v133, v67, v66, s72
    v_perm_b32 v134, v69, v68, s72
    v_perm_b32 v135, v71, v70, s72
    v_accvgpr_write_b32 a192, v132
    v_accvgpr_write_b32 a193, v133
    v_accvgpr_write_b32 a194, v134
    v_accvgpr_write_b32 a195, v135
    v_perm_b32 v136, v65, v64, s73
    v_perm_b32 v137, v67, v66, s73
    v_perm_b32 v138, v69, v68, s73
    v_perm_b32 v139, v71, v70, s73
    v_accvgpr_write_b32 a196, v136
    v_accvgpr_write_b32 a197, v137
    v_accvgpr_write_b32 a198, v138
    v_accvgpr_write_b32 a199, v139
    v_perm_b32 v140, v73, v72, s72
    v_perm_b32 v141, v75, v74, s72
    v_perm_b32 v142, v77, v76, s72
    v_perm_b32 v143, v79, v78, s72
    v_accvgpr_write_b32 a204, v140
    v_accvgpr_write_b32 a205, v141
    v_accvgpr_write_b32 a206, v142
    v_accvgpr_write_b32 a207, v143
    v_perm_b32 v144, v73, v72, s73
    v_perm_b32 v145, v75, v74, s73
    v_perm_b32 v146, v77, v76, s73
    v_perm_b32 v147, v79, v78, s73
    v_accvgpr_write_b32 a208, v144
    v_accvgpr_write_b32 a209, v145
    v_accvgpr_write_b32 a210, v146
    v_accvgpr_write_b32 a211, v147
    v_perm_b32 v132, v81, v80, s72
    v_perm_b32 v133, v83, v82, s72
    v_perm_b32 v134, v85, v84, s72
    v_perm_b32 v135, v87, v86, s72
    v_accvgpr_write_b32 a216, v132
    v_accvgpr_write_b32 a217, v133
    v_accvgpr_write_b32 a218, v134
    v_accvgpr_write_b32 a219, v135
    v_perm_b32 v136, v81, v80, s73
    v_perm_b32 v137, v83, v82, s73
    v_perm_b32 v138, v85, v84, s73
    v_perm_b32 v139, v87, v86, s73
    v_accvgpr_write_b32 a220, v136
    v_accvgpr_write_b32 a221, v137
    v_accvgpr_write_b32 a222, v138
    v_accvgpr_write_b32 a223, v139
    v_perm_b32 v140, v89, v88, s72
    v_perm_b32 v141, v91, v90, s72
    v_perm_b32 v142, v93, v92, s72
    v_perm_b32 v143, v95, v94, s72
    v_accvgpr_write_b32 a228, v140
    v_accvgpr_write_b32 a229, v141
    v_accvgpr_write_b32 a230, v142
    v_accvgpr_write_b32 a231, v143
    v_perm_b32 v144, v89, v88, s73
    v_perm_b32 v145, v91, v90, s73
    v_perm_b32 v146, v93, v92, s73
    v_perm_b32 v147, v95, v94, s73
    v_accvgpr_write_b32 a232, v144
    v_accvgpr_write_b32 a233, v145
    v_accvgpr_write_b32 a234, v146
    v_accvgpr_write_b32 a235, v147
    s_waitcnt lgkmcnt(0)
    s_add_u32 s71, s22, 0
    buffer_load_dword v32, v6, s[64:67], s71 offen
    s_add_u32 s71, s22, 12288
    buffer_load_dword v33, v6, s[64:67], s71 offen
    s_add_u32 s71, s22, 24576
    buffer_load_dword v34, v6, s[64:67], s71 offen
    s_add_u32 s71, s22, 36864
    buffer_load_dword v35, v6, s[64:67], s71 offen
    s_add_u32 s71, s22, 49152
    buffer_load_dword v36, v6, s[64:67], s71 offen
    s_add_u32 s71, s22, 61440
    buffer_load_dword v37, v6, s[64:67], s71 offen
    s_add_u32 s71, s22, 73728
    buffer_load_dword v38, v6, s[64:67], s71 offen
    s_add_u32 s71, s22, 86016
    buffer_load_dword v39, v6, s[64:67], s71 offen
    s_add_u32 s71, s22, 393216
    buffer_load_dword v40, v6, s[64:67], s71 offen
    s_add_u32 s71, s22, 405504
    buffer_load_dword v41, v6, s[64:67], s71 offen
    s_add_u32 s71, s22, 417792
    buffer_load_dword v42, v6, s[64:67], s71 offen
    s_add_u32 s71, s22, 430080
    buffer_load_dword v43, v6, s[64:67], s71 offen
    s_add_u32 s71, s22, 442368
    buffer_load_dword v44, v6, s[64:67], s71 offen
    s_add_u32 s71, s22, 454656
    buffer_load_dword v45, v6, s[64:67], s71 offen
    s_add_u32 s71, s22, 466944
    buffer_load_dword v46, v6, s[64:67], s71 offen
    s_add_u32 s71, s22, 479232
    buffer_load_dword v47, v6, s[64:67], s71 offen
    s_add_u32 s71, s22, 786432
    buffer_load_dword v48, v6, s[64:67], s71 offen
    s_add_u32 s71, s22, 798720
    buffer_load_dword v49, v6, s[64:67], s71 offen
    s_add_u32 s71, s22, 811008
    buffer_load_dword v50, v6, s[64:67], s71 offen
    s_add_u32 s71, s22, 823296
    buffer_load_dword v51, v6, s[64:67], s71 offen
    s_add_u32 s71, s22, 835584
    buffer_load_dword v52, v6, s[64:67], s71 offen
    s_add_u32 s71, s22, 847872
    buffer_load_dword v53, v6, s[64:67], s71 offen
    s_add_u32 s71, s22, 860160
    buffer_load_dword v54, v6, s[64:67], s71 offen
    s_add_u32 s71, s22, 872448
    buffer_load_dword v55, v6, s[64:67], s71 offen
    s_add_u32 s71, s22, 1179648
    buffer_load_dword v56, v6, s[64:67], s71 offen
    s_add_u32 s71, s22, 1191936
    buffer_load_dword v57, v6, s[64:67], s71 offen
    s_add_u32 s71, s22, 1204224
    buffer_load_dword v58, v6, s[64:67], s71 offen
    s_add_u32 s71, s22, 1216512
    buffer_load_dword v59, v6, s[64:67], s71 offen
    s_add_u32 s71, s22, 1228800
    buffer_load_dword v60, v6, s[64:67], s71 offen
    s_add_u32 s71, s22, 1241088
    buffer_load_dword v61, v6, s[64:67], s71 offen
    s_add_u32 s71, s22, 1253376
    buffer_load_dword v62, v6, s[64:67], s71 offen
    s_add_u32 s71, s22, 1265664
    buffer_load_dword v63, v6, s[64:67], s71 offen
    s_add_u32 s71, s22, 1572864
    buffer_load_dword v64, v6, s[64:67], s71 offen
    s_add_u32 s71, s22, 1585152
    buffer_load_dword v65, v6, s[64:67], s71 offen
    s_add_u32 s71, s22, 1597440
    buffer_load_dword v66, v6, s[64:67], s71 offen
    s_add_u32 s71, s22, 1609728
    buffer_load_dword v67, v6, s[64:67], s71 offen
    s_add_u32 s71, s22, 1622016
    buffer_load_dword v68, v6, s[64:67], s71 offen
    s_add_u32 s71, s22, 1634304
    buffer_load_dword v69, v6, s[64:67], s71 offen
    s_add_u32 s71, s22, 1646592
    buffer_load_dword v70, v6, s[64:67], s71 offen
    s_add_u32 s71, s22, 1658880
    buffer_load_dword v71, v6, s[64:67], s71 offen
    s_add_u32 s71, s22, 1966080
    buffer_load_dword v72, v6, s[64:67], s71 offen
    s_add_u32 s71, s22, 1978368
    buffer_load_dword v73, v6, s[64:67], s71 offen
    s_add_u32 s71, s22, 1990656
    buffer_load_dword v74, v6, s[64:67], s71 offen
    s_add_u32 s71, s22, 2002944
    buffer_load_dword v75, v6, s[64:67], s71 offen
    s_add_u32 s71, s22, 2015232
    buffer_load_dword v76, v6, s[64:67], s71 offen
    s_add_u32 s71, s22, 2027520
    buffer_load_dword v77, v6, s[64:67], s71 offen
    s_add_u32 s71, s22, 2039808
    buffer_load_dword v78, v6, s[64:67], s71 offen
    s_add_u32 s71, s22, 2052096
    buffer_load_dword v79, v6, s[64:67], s71 offen
    s_add_u32 s71, s22, 2359296
    buffer_load_dword v80, v6, s[64:67], s71 offen
    s_add_u32 s71, s22, 2371584
    buffer_load_dword v81, v6, s[64:67], s71 offen
    s_add_u32 s71, s22, 2383872
    buffer_load_dword v82, v6, s[64:67], s71 offen
    s_add_u32 s71, s22, 2396160
    buffer_load_dword v83, v6, s[64:67], s71 offen
    s_add_u32 s71, s22, 2408448
    buffer_load_dword v84, v6, s[64:67], s71 offen
    s_add_u32 s71, s22, 2420736
    buffer_load_dword v85, v6, s[64:67], s71 offen
    s_add_u32 s71, s22, 2433024
    buffer_load_dword v86, v6, s[64:67], s71 offen
    s_add_u32 s71, s22, 2445312
    buffer_load_dword v87, v6, s[64:67], s71 offen
    s_add_u32 s71, s22, 2752512
    buffer_load_dword v88, v6, s[64:67], s71 offen
    s_add_u32 s71, s22, 2764800
    buffer_load_dword v89, v6, s[64:67], s71 offen
    s_add_u32 s71, s22, 2777088
    buffer_load_dword v90, v6, s[64:67], s71 offen
    s_add_u32 s71, s22, 2789376
    buffer_load_dword v91, v6, s[64:67], s71 offen
    s_add_u32 s71, s22, 2801664
    buffer_load_dword v92, v6, s[64:67], s71 offen
    s_add_u32 s71, s22, 2813952
    buffer_load_dword v93, v6, s[64:67], s71 offen
    s_add_u32 s71, s22, 2826240
    buffer_load_dword v94, v6, s[64:67], s71 offen
    s_add_u32 s71, s22, 2838528
    buffer_load_dword v95, v6, s[64:67], s71 offen
    s_add_u32 s71, s22, 3145728
    buffer_load_dword v96, v6, s[64:67], s71 offen
    s_add_u32 s71, s22, 3158016
    buffer_load_dword v97, v6, s[64:67], s71 offen
    s_add_u32 s71, s22, 3170304
    buffer_load_dword v98, v6, s[64:67], s71 offen
    s_add_u32 s71, s22, 3182592
    buffer_load_dword v99, v6, s[64:67], s71 offen
    s_add_u32 s71, s22, 3194880
    buffer_load_dword v100, v6, s[64:67], s71 offen
    s_add_u32 s71, s22, 3207168
    buffer_load_dword v101, v6, s[64:67], s71 offen
    s_add_u32 s71, s22, 3219456
    buffer_load_dword v102, v6, s[64:67], s71 offen
    s_add_u32 s71, s22, 3231744
    buffer_load_dword v103, v6, s[64:67], s71 offen
    s_add_u32 s71, s22, 3538944
    buffer_load_dword v104, v6, s[64:67], s71 offen
    s_add_u32 s71, s22, 3551232
    buffer_load_dword v105, v6, s[64:67], s71 offen
    s_add_u32 s71, s22, 3563520
    buffer_load_dword v106, v6, s[64:67], s71 offen
    s_add_u32 s71, s22, 3575808
    buffer_load_dword v107, v6, s[64:67], s71 offen
    s_add_u32 s71, s22, 3588096
    buffer_load_dword v108, v6, s[64:67], s71 offen
    s_add_u32 s71, s22, 3600384
    buffer_load_dword v109, v6, s[64:67], s71 offen
    s_add_u32 s71, s22, 3612672
    buffer_load_dword v110, v6, s[64:67], s71 offen
    s_add_u32 s71, s22, 3624960
    buffer_load_dword v111, v6, s[64:67], s71 offen
    s_add_u32 s71, s22, 3932160
    buffer_load_dword v112, v6, s[64:67], s71 offen
    s_add_u32 s71, s22, 3944448
    buffer_load_dword v113, v6, s[64:67], s71 offen
    s_add_u32 s71, s22, 3956736
    buffer_load_dword v114, v6, s[64:67], s71 offen
    s_add_u32 s71, s22, 3969024
    buffer_load_dword v115, v6, s[64:67], s71 offen
    s_add_u32 s71, s22, 3981312
    buffer_load_dword v116, v6, s[64:67], s71 offen
    s_add_u32 s71, s22, 3993600
    buffer_load_dword v117, v6, s[64:67], s71 offen
    s_add_u32 s71, s22, 4005888
    buffer_load_dword v118, v6, s[64:67], s71 offen
    s_add_u32 s71, s22, 4018176
    buffer_load_dword v119, v6, s[64:67], s71 offen
    s_add_u32 s71, s22, 4325376
    buffer_load_dword v120, v6, s[64:67], s71 offen
    s_add_u32 s71, s22, 4337664
    buffer_load_dword v121, v6, s[64:67], s71 offen
    s_add_u32 s71, s22, 4349952
    buffer_load_dword v122, v6, s[64:67], s71 offen
    s_add_u32 s71, s22, 4362240
    buffer_load_dword v123, v6, s[64:67], s71 offen
    s_add_u32 s71, s22, 4374528
    buffer_load_dword v124, v6, s[64:67], s71 offen
    s_add_u32 s71, s22, 4386816
    buffer_load_dword v125, v6, s[64:67], s71 offen
    s_add_u32 s71, s22, 4399104
    buffer_load_dword v126, v6, s[64:67], s71 offen
    s_add_u32 s71, s22, 4411392
    buffer_load_dword v127, v6, s[64:67], s71 offen
    s_waitcnt vmcnt(63)
    v_perm_b32 v132, v33, v32, s72
    v_perm_b32 v133, v35, v34, s72
    v_perm_b32 v134, v37, v36, s72
    v_perm_b32 v135, v39, v38, s72
    v_accvgpr_write_b32 a8, v132
    v_accvgpr_write_b32 a9, v133
    v_accvgpr_write_b32 a10, v134
    v_accvgpr_write_b32 a11, v135
    v_perm_b32 v140, v41, v40, s72
    v_perm_b32 v141, v43, v42, s72
    v_perm_b32 v142, v45, v44, s72
    v_perm_b32 v143, v47, v46, s72
    v_accvgpr_write_b32 a20, v140
    v_accvgpr_write_b32 a21, v141
    v_accvgpr_write_b32 a22, v142
    v_accvgpr_write_b32 a23, v143
    v_perm_b32 v132, v49, v48, s72
    v_perm_b32 v133, v51, v50, s72
    v_perm_b32 v134, v53, v52, s72
    v_perm_b32 v135, v55, v54, s72
    v_accvgpr_write_b32 a32, v132
    v_accvgpr_write_b32 a33, v133
    v_accvgpr_write_b32 a34, v134
    v_accvgpr_write_b32 a35, v135
    v_perm_b32 v140, v57, v56, s72
    v_perm_b32 v141, v59, v58, s72
    v_perm_b32 v142, v61, v60, s72
    v_perm_b32 v143, v63, v62, s72
    v_accvgpr_write_b32 a44, v140
    v_accvgpr_write_b32 a45, v141
    v_accvgpr_write_b32 a46, v142
    v_accvgpr_write_b32 a47, v143
    s_waitcnt lgkmcnt(0)
    s_add_u32 s71, s22, 4718592
    buffer_load_dword v32, v6, s[64:67], s71 offen
    s_add_u32 s71, s22, 4730880
    buffer_load_dword v33, v6, s[64:67], s71 offen
    s_add_u32 s71, s22, 4743168
    buffer_load_dword v34, v6, s[64:67], s71 offen
    s_add_u32 s71, s22, 4755456
    buffer_load_dword v35, v6, s[64:67], s71 offen
    s_add_u32 s71, s22, 4767744
    buffer_load_dword v36, v6, s[64:67], s71 offen
    s_add_u32 s71, s22, 4780032
    buffer_load_dword v37, v6, s[64:67], s71 offen
    s_add_u32 s71, s22, 4792320
    buffer_load_dword v38, v6, s[64:67], s71 offen
    s_add_u32 s71, s22, 4804608
    buffer_load_dword v39, v6, s[64:67], s71 offen
    s_add_u32 s71, s22, 5111808
    buffer_load_dword v40, v6, s[64:67], s71 offen
    s_add_u32 s71, s22, 5124096
    buffer_load_dword v41, v6, s[64:67], s71 offen
    s_add_u32 s71, s22, 5136384
    buffer_load_dword v42, v6, s[64:67], s71 offen
    s_add_u32 s71, s22, 5148672
    buffer_load_dword v43, v6, s[64:67], s71 offen
    s_add_u32 s71, s22, 5160960
    buffer_load_dword v44, v6, s[64:67], s71 offen
    s_add_u32 s71, s22, 5173248
    buffer_load_dword v45, v6, s[64:67], s71 offen
    s_add_u32 s71, s22, 5185536
    buffer_load_dword v46, v6, s[64:67], s71 offen
    s_add_u32 s71, s22, 5197824
    buffer_load_dword v47, v6, s[64:67], s71 offen
    s_add_u32 s71, s22, 5505024
    buffer_load_dword v48, v6, s[64:67], s71 offen
    s_add_u32 s71, s22, 5517312
    buffer_load_dword v49, v6, s[64:67], s71 offen
    s_add_u32 s71, s22, 5529600
    buffer_load_dword v50, v6, s[64:67], s71 offen
    s_add_u32 s71, s22, 5541888
    buffer_load_dword v51, v6, s[64:67], s71 offen
    s_add_u32 s71, s22, 5554176
    buffer_load_dword v52, v6, s[64:67], s71 offen
    s_add_u32 s71, s22, 5566464
    buffer_load_dword v53, v6, s[64:67], s71 offen
    s_add_u32 s71, s22, 5578752
    buffer_load_dword v54, v6, s[64:67], s71 offen
    s_add_u32 s71, s22, 5591040
    buffer_load_dword v55, v6, s[64:67], s71 offen
    s_add_u32 s71, s22, 5898240
    buffer_load_dword v56, v6, s[64:67], s71 offen
    s_add_u32 s71, s22, 5910528
    buffer_load_dword v57, v6, s[64:67], s71 offen
    s_add_u32 s71, s22, 5922816
    buffer_load_dword v58, v6, s[64:67], s71 offen
    s_add_u32 s71, s22, 5935104
    buffer_load_dword v59, v6, s[64:67], s71 offen
    s_add_u32 s71, s22, 5947392
    buffer_load_dword v60, v6, s[64:67], s71 offen
    s_add_u32 s71, s22, 5959680
    buffer_load_dword v61, v6, s[64:67], s71 offen
    s_add_u32 s71, s22, 5971968
    buffer_load_dword v62, v6, s[64:67], s71 offen
    s_add_u32 s71, s22, 5984256
    buffer_load_dword v63, v6, s[64:67], s71 offen
    s_waitcnt vmcnt(63)
    v_perm_b32 v132, v65, v64, s72
    v_perm_b32 v133, v67, v66, s72
    v_perm_b32 v134, v69, v68, s72
    v_perm_b32 v135, v71, v70, s72
    v_accvgpr_write_b32 a56, v132
    v_accvgpr_write_b32 a57, v133
    v_accvgpr_write_b32 a58, v134
    v_accvgpr_write_b32 a59, v135
    v_perm_b32 v140, v73, v72, s72
    v_perm_b32 v141, v75, v74, s72
    v_perm_b32 v142, v77, v76, s72
    v_perm_b32 v143, v79, v78, s72
    v_accvgpr_write_b32 a68, v140
    v_accvgpr_write_b32 a69, v141
    v_accvgpr_write_b32 a70, v142
    v_accvgpr_write_b32 a71, v143
    v_perm_b32 v132, v81, v80, s72
    v_perm_b32 v133, v83, v82, s72
    v_perm_b32 v134, v85, v84, s72
    v_perm_b32 v135, v87, v86, s72
    v_accvgpr_write_b32 a80, v132
    v_accvgpr_write_b32 a81, v133
    v_accvgpr_write_b32 a82, v134
    v_accvgpr_write_b32 a83, v135
    v_perm_b32 v140, v89, v88, s72
    v_perm_b32 v141, v91, v90, s72
    v_perm_b32 v142, v93, v92, s72
    v_perm_b32 v143, v95, v94, s72
    v_accvgpr_write_b32 a92, v140
    v_accvgpr_write_b32 a93, v141
    v_accvgpr_write_b32 a94, v142
    v_accvgpr_write_b32 a95, v143
    s_waitcnt lgkmcnt(0)
    s_add_u32 s71, s22, 6291456
    buffer_load_dword v64, v6, s[64:67], s71 offen
    s_add_u32 s71, s22, 6303744
    buffer_load_dword v65, v6, s[64:67], s71 offen
    s_add_u32 s71, s22, 6316032
    buffer_load_dword v66, v6, s[64:67], s71 offen
    s_add_u32 s71, s22, 6328320
    buffer_load_dword v67, v6, s[64:67], s71 offen
    s_add_u32 s71, s22, 6340608
    buffer_load_dword v68, v6, s[64:67], s71 offen
    s_add_u32 s71, s22, 6352896
    buffer_load_dword v69, v6, s[64:67], s71 offen
    s_add_u32 s71, s22, 6365184
    buffer_load_dword v70, v6, s[64:67], s71 offen
    s_add_u32 s71, s22, 6377472
    buffer_load_dword v71, v6, s[64:67], s71 offen
    s_add_u32 s71, s22, 6684672
    buffer_load_dword v72, v6, s[64:67], s71 offen
    s_add_u32 s71, s22, 6696960
    buffer_load_dword v73, v6, s[64:67], s71 offen
    s_add_u32 s71, s22, 6709248
    buffer_load_dword v74, v6, s[64:67], s71 offen
    s_add_u32 s71, s22, 6721536
    buffer_load_dword v75, v6, s[64:67], s71 offen
    s_add_u32 s71, s22, 6733824
    buffer_load_dword v76, v6, s[64:67], s71 offen
    s_add_u32 s71, s22, 6746112
    buffer_load_dword v77, v6, s[64:67], s71 offen
    s_add_u32 s71, s22, 6758400
    buffer_load_dword v78, v6, s[64:67], s71 offen
    s_add_u32 s71, s22, 6770688
    buffer_load_dword v79, v6, s[64:67], s71 offen
    s_add_u32 s71, s22, 7077888
    buffer_load_dword v80, v6, s[64:67], s71 offen
    s_add_u32 s71, s22, 7090176
    buffer_load_dword v81, v6, s[64:67], s71 offen
    s_add_u32 s71, s22, 7102464
    buffer_load_dword v82, v6, s[64:67], s71 offen
    s_add_u32 s71, s22, 7114752
    buffer_load_dword v83, v6, s[64:67], s71 offen
    s_add_u32 s71, s22, 7127040
    buffer_load_dword v84, v6, s[64:67], s71 offen
    s_add_u32 s71, s22, 7139328
    buffer_load_dword v85, v6, s[64:67], s71 offen
    s_add_u32 s71, s22, 7151616
    buffer_load_dword v86, v6, s[64:67], s71 offen
    s_add_u32 s71, s22, 7163904
    buffer_load_dword v87, v6, s[64:67], s71 offen
    s_add_u32 s71, s22, 7471104
    buffer_load_dword v88, v6, s[64:67], s71 offen
    s_add_u32 s71, s22, 7483392
    buffer_load_dword v89, v6, s[64:67], s71 offen
    s_add_u32 s71, s22, 7495680
    buffer_load_dword v90, v6, s[64:67], s71 offen
    s_add_u32 s71, s22, 7507968
    buffer_load_dword v91, v6, s[64:67], s71 offen
    s_add_u32 s71, s22, 7520256
    buffer_load_dword v92, v6, s[64:67], s71 offen
    s_add_u32 s71, s22, 7532544
    buffer_load_dword v93, v6, s[64:67], s71 offen
    s_add_u32 s71, s22, 7544832
    buffer_load_dword v94, v6, s[64:67], s71 offen
    s_add_u32 s71, s22, 7557120
    buffer_load_dword v95, v6, s[64:67], s71 offen
    s_waitcnt vmcnt(63)
    v_perm_b32 v132, v97, v96, s72
    v_perm_b32 v133, v99, v98, s72
    v_perm_b32 v134, v101, v100, s72
    v_perm_b32 v135, v103, v102, s72
    v_accvgpr_write_b32 a104, v132
    v_accvgpr_write_b32 a105, v133
    v_accvgpr_write_b32 a106, v134
    v_accvgpr_write_b32 a107, v135
    v_perm_b32 v140, v105, v104, s72
    v_perm_b32 v141, v107, v106, s72
    v_perm_b32 v142, v109, v108, s72
    v_perm_b32 v143, v111, v110, s72
    v_accvgpr_write_b32 a116, v140
    v_accvgpr_write_b32 a117, v141
    v_accvgpr_write_b32 a118, v142
    v_accvgpr_write_b32 a119, v143
    v_perm_b32 v132, v113, v112, s72
    v_perm_b32 v133, v115, v114, s72
    v_perm_b32 v134, v117, v116, s72
    v_perm_b32 v135, v119, v118, s72
    v_accvgpr_write_b32 a128, v132
    v_accvgpr_write_b32 a129, v133
    v_accvgpr_write_b32 a130, v134
    v_accvgpr_write_b32 a131, v135
    v_perm_b32 v140, v121, v120, s72
    v_perm_b32 v141, v123, v122, s72
    v_perm_b32 v142, v125, v124, s72
    v_perm_b32 v143, v127, v126, s72
    v_accvgpr_write_b32 a140, v140
    v_accvgpr_write_b32 a141, v141
    v_accvgpr_write_b32 a142, v142
    v_accvgpr_write_b32 a143, v143
    s_waitcnt lgkmcnt(0)
    s_waitcnt vmcnt(32)
    v_perm_b32 v132, v33, v32, s72
    v_perm_b32 v133, v35, v34, s72
    v_perm_b32 v134, v37, v36, s72
    v_perm_b32 v135, v39, v38, s72
    v_accvgpr_write_b32 a152, v132
    v_accvgpr_write_b32 a153, v133
    v_accvgpr_write_b32 a154, v134
    v_accvgpr_write_b32 a155, v135
    v_perm_b32 v140, v41, v40, s72
    v_perm_b32 v141, v43, v42, s72
    v_perm_b32 v142, v45, v44, s72
    v_perm_b32 v143, v47, v46, s72
    v_accvgpr_write_b32 a164, v140
    v_accvgpr_write_b32 a165, v141
    v_accvgpr_write_b32 a166, v142
    v_accvgpr_write_b32 a167, v143
    v_perm_b32 v132, v49, v48, s72
    v_perm_b32 v133, v51, v50, s72
    v_perm_b32 v134, v53, v52, s72
    v_perm_b32 v135, v55, v54, s72
    v_accvgpr_write_b32 a176, v132
    v_accvgpr_write_b32 a177, v133
    v_accvgpr_write_b32 a178, v134
    v_accvgpr_write_b32 a179, v135
    v_perm_b32 v140, v57, v56, s72
    v_perm_b32 v141, v59, v58, s72
    v_perm_b32 v142, v61, v60, s72
    v_perm_b32 v143, v63, v62, s72
    v_accvgpr_write_b32 a188, v140
    v_accvgpr_write_b32 a189, v141
    v_accvgpr_write_b32 a190, v142
    v_accvgpr_write_b32 a191, v143
    s_waitcnt lgkmcnt(0)
    s_waitcnt vmcnt(0)
    v_perm_b32 v132, v65, v64, s72
    v_perm_b32 v133, v67, v66, s72
    v_perm_b32 v134, v69, v68, s72
    v_perm_b32 v135, v71, v70, s72
    v_accvgpr_write_b32 a200, v132
    v_accvgpr_write_b32 a201, v133
    v_accvgpr_write_b32 a202, v134
    v_accvgpr_write_b32 a203, v135
    v_perm_b32 v140, v73, v72, s72
    v_perm_b32 v141, v75, v74, s72
    v_perm_b32 v142, v77, v76, s72
    v_perm_b32 v143, v79, v78, s72
    v_accvgpr_write_b32 a212, v140
    v_accvgpr_write_b32 a213, v141
    v_accvgpr_write_b32 a214, v142
    v_accvgpr_write_b32 a215, v143
    v_perm_b32 v132, v81, v80, s72
    v_perm_b32 v133, v83, v82, s72
    v_perm_b32 v134, v85, v84, s72
    v_perm_b32 v135, v87, v86, s72
    v_accvgpr_write_b32 a224, v132
    v_accvgpr_write_b32 a225, v133
    v_accvgpr_write_b32 a226, v134
    v_accvgpr_write_b32 a227, v135
    v_perm_b32 v140, v89, v88, s72
    v_perm_b32 v141, v91, v90, s72
    v_perm_b32 v142, v93, v92, s72
    v_perm_b32 v143, v95, v94, s72
    v_accvgpr_write_b32 a236, v140
    v_accvgpr_write_b32 a237, v141
    v_accvgpr_write_b32 a238, v142
    v_accvgpr_write_b32 a239, v143
    s_waitcnt lgkmcnt(0)
    s_lshl_b32 s40, s26, 6
    s_add_u32 s41, s40, 2
    s_add_u32 s42, s40, 64
    s_branch mega_kernel_wl239
mega_kernel_odd38:
    s_add_u32 s71, s21, 0
    buffer_load_dword v32, v6, s[64:67], s71 offen
    s_add_u32 s71, s21, 12288
    buffer_load_dword v33, v6, s[64:67], s71 offen
    s_add_u32 s71, s21, 24576
    buffer_load_dword v34, v6, s[64:67], s71 offen
    s_add_u32 s71, s21, 36864
    buffer_load_dword v35, v6, s[64:67], s71 offen
    s_add_u32 s71, s21, 49152
    buffer_load_dword v36, v6, s[64:67], s71 offen
    s_add_u32 s71, s21, 61440
    buffer_load_dword v37, v6, s[64:67], s71 offen
    s_add_u32 s71, s21, 73728
    buffer_load_dword v38, v6, s[64:67], s71 offen
    s_add_u32 s71, s21, 86016
    buffer_load_dword v39, v6, s[64:67], s71 offen
    s_add_u32 s71, s21, 393216
    buffer_load_dword v40, v6, s[64:67], s71 offen
    s_add_u32 s71, s21, 405504
    buffer_load_dword v41, v6, s[64:67], s71 offen
    s_add_u32 s71, s21, 417792
    buffer_load_dword v42, v6, s[64:67], s71 offen
    s_add_u32 s71, s21, 430080
    buffer_load_dword v43, v6, s[64:67], s71 offen
    s_add_u32 s71, s21, 442368
    buffer_load_dword v44, v6, s[64:67], s71 offen
    s_add_u32 s71, s21, 454656
    buffer_load_dword v45, v6, s[64:67], s71 offen
    s_add_u32 s71, s21, 466944
    buffer_load_dword v46, v6, s[64:67], s71 offen
    s_add_u32 s71, s21, 479232
    buffer_load_dword v47, v6, s[64:67], s71 offen
    s_add_u32 s71, s21, 786432
    buffer_load_dword v48, v6, s[64:67], s71 offen
    s_add_u32 s71, s21, 798720
    buffer_load_dword v49, v6, s[64:67], s71 offen
    s_add_u32 s71, s21, 811008
    buffer_load_dword v50, v6, s[64:67], s71 offen
    s_add_u32 s71, s21, 823296
    buffer_load_dword v51, v6, s[64:67], s71 offen
    s_add_u32 s71, s21, 835584
    buffer_load_dword v52, v6, s[64:67], s71 offen
    s_add_u32 s71, s21, 847872
    buffer_load_dword v53, v6, s[64:67], s71 offen
    s_add_u32 s71, s21, 860160
    buffer_load_dword v54, v6, s[64:67], s71 offen
    s_add_u32 s71, s21, 872448
    buffer_load_dword v55, v6, s[64:67], s71 offen
    s_add_u32 s71, s21, 1179648
    buffer_load_dword v56, v6, s[64:67], s71 offen
    s_add_u32 s71, s21, 1191936
    buffer_load_dword v57, v6, s[64:67], s71 offen
    s_add_u32 s71, s21, 1204224
    buffer_load_dword v58, v6, s[64:67], s71 offen
    s_add_u32 s71, s21, 1216512
    buffer_load_dword v59, v6, s[64:67], s71 offen
    s_add_u32 s71, s21, 1228800
    buffer_load_dword v60, v6, s[64:67], s71 offen
    s_add_u32 s71, s21, 1241088
    buffer_load_dword v61, v6, s[64:67], s71 offen
    s_add_u32 s71, s21, 1253376
    buffer_load_dword v62, v6, s[64:67], s71 offen
    s_add_u32 s71, s21, 1265664
    buffer_load_dword v63, v6, s[64:67], s71 offen
    s_add_u32 s71, s21, 1572864
    buffer_load_dword v64, v6, s[64:67], s71 offen
    s_add_u32 s71, s21, 1585152
    buffer_load_dword v65, v6, s[64:67], s71 offen
    s_add_u32 s71, s21, 1597440
    buffer_load_dword v66, v6, s[64:67], s71 offen
    s_add_u32 s71, s21, 1609728
    buffer_load_dword v67, v6, s[64:67], s71 offen
    s_add_u32 s71, s21, 1622016
    buffer_load_dword v68, v6, s[64:67], s71 offen
    s_add_u32 s71, s21, 1634304
    buffer_load_dword v69, v6, s[64:67], s71 offen
    s_add_u32 s71, s21, 1646592
    buffer_load_dword v70, v6, s[64:67], s71 offen
    s_add_u32 s71, s21, 1658880
    buffer_load_dword v71, v6, s[64:67], s71 offen
    s_add_u32 s71, s21, 1966080
    buffer_load_dword v72, v6, s[64:67], s71 offen
    s_add_u32 s71, s21, 1978368
    buffer_load_dword v73, v6, s[64:67], s71 offen
    s_add_u32 s71, s21, 1990656
    buffer_load_dword v74, v6, s[64:67], s71 offen
    s_add_u32 s71, s21, 2002944
    buffer_load_dword v75, v6, s[64:67], s71 offen
    s_add_u32 s71, s21, 2015232
    buffer_load_dword v76, v6, s[64:67], s71 offen
    s_add_u32 s71, s21, 2027520
    buffer_load_dword v77, v6, s[64:67], s71 offen
    s_add_u32 s71, s21, 2039808
    buffer_load_dword v78, v6, s[64:67], s71 offen
    s_add_u32 s71, s21, 2052096
    buffer_load_dword v79, v6, s[64:67], s71 offen
    s_add_u32 s71, s21, 2359296
    buffer_load_dword v80, v6, s[64:67], s71 offen
    s_add_u32 s71, s21, 2371584
    buffer_load_dword v81, v6, s[64:67], s71 offen
    s_add_u32 s71, s21, 2383872
    buffer_load_dword v82, v6, s[64:67], s71 offen
    s_add_u32 s71, s21, 2396160
    buffer_load_dword v83, v6, s[64:67], s71 offen
    s_add_u32 s71, s21, 2408448
    buffer_load_dword v84, v6, s[64:67], s71 offen
    s_add_u32 s71, s21, 2420736
    buffer_load_dword v85, v6, s[64:67], s71 offen
    s_add_u32 s71, s21, 2433024
    buffer_load_dword v86, v6, s[64:67], s71 offen
    s_add_u32 s71, s21, 2445312
    buffer_load_dword v87, v6, s[64:67], s71 offen
    s_add_u32 s71, s21, 2752512
    buffer_load_dword v88, v6, s[64:67], s71 offen
    s_add_u32 s71, s21, 2764800
    buffer_load_dword v89, v6, s[64:67], s71 offen
    s_add_u32 s71, s21, 2777088
    buffer_load_dword v90, v6, s[64:67], s71 offen
    s_add_u32 s71, s21, 2789376
    buffer_load_dword v91, v6, s[64:67], s71 offen
    s_add_u32 s71, s21, 2801664
    buffer_load_dword v92, v6, s[64:67], s71 offen
    s_add_u32 s71, s21, 2813952
    buffer_load_dword v93, v6, s[64:67], s71 offen
    s_add_u32 s71, s21, 2826240
    buffer_load_dword v94, v6, s[64:67], s71 offen
    s_add_u32 s71, s21, 2838528
    buffer_load_dword v95, v6, s[64:67], s71 offen
    s_add_u32 s71, s21, 3145728
    buffer_load_dword v96, v6, s[64:67], s71 offen
    s_add_u32 s71, s21, 3158016
    buffer_load_dword v97, v6, s[64:67], s71 offen
    s_add_u32 s71, s21, 3170304
    buffer_load_dword v98, v6, s[64:67], s71 offen
    s_add_u32 s71, s21, 3182592
    buffer_load_dword v99, v6, s[64:67], s71 offen
    s_add_u32 s71, s21, 3194880
    buffer_load_dword v100, v6, s[64:67], s71 offen
    s_add_u32 s71, s21, 3207168
    buffer_load_dword v101, v6, s[64:67], s71 offen
    s_add_u32 s71, s21, 3219456
    buffer_load_dword v102, v6, s[64:67], s71 offen
    s_add_u32 s71, s21, 3231744
    buffer_load_dword v103, v6, s[64:67], s71 offen
    s_add_u32 s71, s21, 3538944
    buffer_load_dword v104, v6, s[64:67], s71 offen
    s_add_u32 s71, s21, 3551232
    buffer_load_dword v105, v6, s[64:67], s71 offen
    s_add_u32 s71, s21, 3563520
    buffer_load_dword v106, v6, s[64:67], s71 offen
    s_add_u32 s71, s21, 3575808
    buffer_load_dword v107, v6, s[64:67], s71 offen
    s_add_u32 s71, s21, 3588096
    buffer_load_dword v108, v6, s[64:67], s71 offen
    s_add_u32 s71, s21, 3600384
    buffer_load_dword v109, v6, s[64:67], s71 offen
    s_add_u32 s71, s21, 3612672
    buffer_load_dword v110, v6, s[64:67], s71 offen
    s_add_u32 s71, s21, 3624960
    buffer_load_dword v111, v6, s[64:67], s71 offen
    s_add_u32 s71, s21, 3932160
    buffer_load_dword v112, v6, s[64:67], s71 offen
    s_add_u32 s71, s21, 3944448
    buffer_load_dword v113, v6, s[64:67], s71 offen
    s_add_u32 s71, s21, 3956736
    buffer_load_dword v114, v6, s[64:67], s71 offen
    s_add_u32 s71, s21, 3969024
    buffer_load_dword v115, v6, s[64:67], s71 offen
    s_add_u32 s71, s21, 3981312
    buffer_load_dword v116, v6, s[64:67], s71 offen
    s_add_u32 s71, s21, 3993600
    buffer_load_dword v117, v6, s[64:67], s71 offen
    s_add_u32 s71, s21, 4005888
    buffer_load_dword v118, v6, s[64:67], s71 offen
    s_add_u32 s71, s21, 4018176
    buffer_load_dword v119, v6, s[64:67], s71 offen
    s_add_u32 s71, s21, 4325376
    buffer_load_dword v120, v6, s[64:67], s71 offen
    s_add_u32 s71, s21, 4337664
    buffer_load_dword v121, v6, s[64:67], s71 offen
    s_add_u32 s71, s21, 4349952
    buffer_load_dword v122, v6, s[64:67], s71 offen
    s_add_u32 s71, s21, 4362240
    buffer_load_dword v123, v6, s[64:67], s71 offen
    s_add_u32 s71, s21, 4374528
    buffer_load_dword v124, v6, s[64:67], s71 offen
    s_add_u32 s71, s21, 4386816
    buffer_load_dword v125, v6, s[64:67], s71 offen
    s_add_u32 s71, s21, 4399104
    buffer_load_dword v126, v6, s[64:67], s71 offen
    s_add_u32 s71, s21, 4411392
    buffer_load_dword v127, v6, s[64:67], s71 offen
    s_waitcnt vmcnt(63)
    v_perm_b32 v136, v33, v32, s73
    v_perm_b32 v137, v35, v34, s73
    v_perm_b32 v138, v37, v36, s73
    v_perm_b32 v139, v39, v38, s73
    v_accvgpr_write_b32 a0, v136
    v_accvgpr_write_b32 a1, v137
    v_accvgpr_write_b32 a2, v138
    v_accvgpr_write_b32 a3, v139
    v_perm_b32 v144, v41, v40, s73
    v_perm_b32 v145, v43, v42, s73
    v_perm_b32 v146, v45, v44, s73
    v_perm_b32 v147, v47, v46, s73
    v_accvgpr_write_b32 a12, v144
    v_accvgpr_write_b32 a13, v145
    v_accvgpr_write_b32 a14, v146
    v_accvgpr_write_b32 a15, v147
    v_perm_b32 v136, v49, v48, s73
    v_perm_b32 v137, v51, v50, s73
    v_perm_b32 v138, v53, v52, s73
    v_perm_b32 v139, v55, v54, s73
    v_accvgpr_write_b32 a24, v136
    v_accvgpr_write_b32 a25, v137
    v_accvgpr_write_b32 a26, v138
    v_accvgpr_write_b32 a27, v139
    v_perm_b32 v144, v57, v56, s73
    v_perm_b32 v145, v59, v58, s73
    v_perm_b32 v146, v61, v60, s73
    v_perm_b32 v147, v63, v62, s73
    v_accvgpr_write_b32 a36, v144
    v_accvgpr_write_b32 a37, v145
    v_accvgpr_write_b32 a38, v146
    v_accvgpr_write_b32 a39, v147
    s_waitcnt lgkmcnt(0)
    s_add_u32 s71, s21, 4718592
    buffer_load_dword v32, v6, s[64:67], s71 offen
    s_add_u32 s71, s21, 4730880
    buffer_load_dword v33, v6, s[64:67], s71 offen
    s_add_u32 s71, s21, 4743168
    buffer_load_dword v34, v6, s[64:67], s71 offen
    s_add_u32 s71, s21, 4755456
    buffer_load_dword v35, v6, s[64:67], s71 offen
    s_add_u32 s71, s21, 4767744
    buffer_load_dword v36, v6, s[64:67], s71 offen
    s_add_u32 s71, s21, 4780032
    buffer_load_dword v37, v6, s[64:67], s71 offen
    s_add_u32 s71, s21, 4792320
    buffer_load_dword v38, v6, s[64:67], s71 offen
    s_add_u32 s71, s21, 4804608
    buffer_load_dword v39, v6, s[64:67], s71 offen
    s_add_u32 s71, s21, 5111808
    buffer_load_dword v40, v6, s[64:67], s71 offen
    s_add_u32 s71, s21, 5124096
    buffer_load_dword v41, v6, s[64:67], s71 offen
    s_add_u32 s71, s21, 5136384
    buffer_load_dword v42, v6, s[64:67], s71 offen
    s_add_u32 s71, s21, 5148672
    buffer_load_dword v43, v6, s[64:67], s71 offen
    s_add_u32 s71, s21, 5160960
    buffer_load_dword v44, v6, s[64:67], s71 offen
    s_add_u32 s71, s21, 5173248
    buffer_load_dword v45, v6, s[64:67], s71 offen
    s_add_u32 s71, s21, 5185536
    buffer_load_dword v46, v6, s[64:67], s71 offen
    s_add_u32 s71, s21, 5197824
    buffer_load_dword v47, v6, s[64:67], s71 offen
    s_add_u32 s71, s21, 5505024
    buffer_load_dword v48, v6, s[64:67], s71 offen
    s_add_u32 s71, s21, 5517312
    buffer_load_dword v49, v6, s[64:67], s71 offen
    s_add_u32 s71, s21, 5529600
    buffer_load_dword v50, v6, s[64:67], s71 offen
    s_add_u32 s71, s21, 5541888
    buffer_load_dword v51, v6, s[64:67], s71 offen
    s_add_u32 s71, s21, 5554176
    buffer_load_dword v52, v6, s[64:67], s71 offen
    s_add_u32 s71, s21, 5566464
    buffer_load_dword v53, v6, s[64:67], s71 offen
    s_add_u32 s71, s21, 5578752
    buffer_load_dword v54, v6, s[64:67], s71 offen
    s_add_u32 s71, s21, 5591040
    buffer_load_dword v55, v6, s[64:67], s71 offen
    s_add_u32 s71, s21, 5898240
    buffer_load_dword v56, v6, s[64:67], s71 offen
    s_add_u32 s71, s21, 5910528
    buffer_load_dword v57, v6, s[64:67], s71 offen
    s_add_u32 s71, s21, 5922816
    buffer_load_dword v58, v6, s[64:67], s71 offen
    s_add_u32 s71, s21, 5935104
    buffer_load_dword v59, v6, s[64:67], s71 offen
    s_add_u32 s71, s21, 5947392
    buffer_load_dword v60, v6, s[64:67], s71 offen
    s_add_u32 s71, s21, 5959680
    buffer_load_dword v61, v6, s[64:67], s71 offen
    s_add_u32 s71, s21, 5971968
    buffer_load_dword v62, v6, s[64:67], s71 offen
    s_add_u32 s71, s21, 5984256
    buffer_load_dword v63, v6, s[64:67], s71 offen
    s_waitcnt vmcnt(63)
    v_perm_b32 v136, v65, v64, s73
    v_perm_b32 v137, v67, v66, s73
    v_perm_b32 v138, v69, v68, s73
    v_perm_b32 v139, v71, v70, s73
    v_accvgpr_write_b32 a48, v136
    v_accvgpr_write_b32 a49, v137
    v_accvgpr_write_b32 a50, v138
    v_accvgpr_write_b32 a51, v139
    v_perm_b32 v144, v73, v72, s73
    v_perm_b32 v145, v75, v74, s73
    v_perm_b32 v146, v77, v76, s73
    v_perm_b32 v147, v79, v78, s73
    v_accvgpr_write_b32 a60, v144
    v_accvgpr_write_b32 a61, v145
    v_accvgpr_write_b32 a62, v146
    v_accvgpr_write_b32 a63, v147
    v_perm_b32 v136, v81, v80, s73
    v_perm_b32 v137, v83, v82, s73
    v_perm_b32 v138, v85, v84, s73
    v_perm_b32 v139, v87, v86, s73
    v_accvgpr_write_b32 a72, v136
    v_accvgpr_write_b32 a73, v137
    v_accvgpr_write_b32 a74, v138
    v_accvgpr_write_b32 a75, v139
    v_perm_b32 v144, v89, v88, s73
    v_perm_b32 v145, v91, v90, s73
    v_perm_b32 v146, v93, v92, s73
    v_perm_b32 v147, v95, v94, s73
    v_accvgpr_write_b32 a84, v144
    v_accvgpr_write_b32 a85, v145
    v_accvgpr_write_b32 a86, v146
    v_accvgpr_write_b32 a87, v147
    s_waitcnt lgkmcnt(0)
    s_add_u32 s71, s21, 6291456
    buffer_load_dword v64, v6, s[64:67], s71 offen
    s_add_u32 s71, s21, 6303744
    buffer_load_dword v65, v6, s[64:67], s71 offen
    s_add_u32 s71, s21, 6316032
    buffer_load_dword v66, v6, s[64:67], s71 offen
    s_add_u32 s71, s21, 6328320
    buffer_load_dword v67, v6, s[64:67], s71 offen
    s_add_u32 s71, s21, 6340608
    buffer_load_dword v68, v6, s[64:67], s71 offen
    s_add_u32 s71, s21, 6352896
    buffer_load_dword v69, v6, s[64:67], s71 offen
    s_add_u32 s71, s21, 6365184
    buffer_load_dword v70, v6, s[64:67], s71 offen
    s_add_u32 s71, s21, 6377472
    buffer_load_dword v71, v6, s[64:67], s71 offen
    s_add_u32 s71, s21, 6684672
    buffer_load_dword v72, v6, s[64:67], s71 offen
    s_add_u32 s71, s21, 6696960
    buffer_load_dword v73, v6, s[64:67], s71 offen
    s_add_u32 s71, s21, 6709248
    buffer_load_dword v74, v6, s[64:67], s71 offen
    s_add_u32 s71, s21, 6721536
    buffer_load_dword v75, v6, s[64:67], s71 offen
    s_add_u32 s71, s21, 6733824
    buffer_load_dword v76, v6, s[64:67], s71 offen
    s_add_u32 s71, s21, 6746112
    buffer_load_dword v77, v6, s[64:67], s71 offen
    s_add_u32 s71, s21, 6758400
    buffer_load_dword v78, v6, s[64:67], s71 offen
    s_add_u32 s71, s21, 6770688
    buffer_load_dword v79, v6, s[64:67], s71 offen
    s_add_u32 s71, s21, 7077888
    buffer_load_dword v80, v6, s[64:67], s71 offen
    s_add_u32 s71, s21, 7090176
    buffer_load_dword v81, v6, s[64:67], s71 offen
    s_add_u32 s71, s21, 7102464
    buffer_load_dword v82, v6, s[64:67], s71 offen
    s_add_u32 s71, s21, 7114752
    buffer_load_dword v83, v6, s[64:67], s71 offen
    s_add_u32 s71, s21, 7127040
    buffer_load_dword v84, v6, s[64:67], s71 offen
    s_add_u32 s71, s21, 7139328
    buffer_load_dword v85, v6, s[64:67], s71 offen
    s_add_u32 s71, s21, 7151616
    buffer_load_dword v86, v6, s[64:67], s71 offen
    s_add_u32 s71, s21, 7163904
    buffer_load_dword v87, v6, s[64:67], s71 offen
    s_add_u32 s71, s21, 7471104
    buffer_load_dword v88, v6, s[64:67], s71 offen
    s_add_u32 s71, s21, 7483392
    buffer_load_dword v89, v6, s[64:67], s71 offen
    s_add_u32 s71, s21, 7495680
    buffer_load_dword v90, v6, s[64:67], s71 offen
    s_add_u32 s71, s21, 7507968
    buffer_load_dword v91, v6, s[64:67], s71 offen
    s_add_u32 s71, s21, 7520256
    buffer_load_dword v92, v6, s[64:67], s71 offen
    s_add_u32 s71, s21, 7532544
    buffer_load_dword v93, v6, s[64:67], s71 offen
    s_add_u32 s71, s21, 7544832
    buffer_load_dword v94, v6, s[64:67], s71 offen
    s_add_u32 s71, s21, 7557120
    buffer_load_dword v95, v6, s[64:67], s71 offen
    s_waitcnt vmcnt(63)
    v_perm_b32 v136, v97, v96, s73
    v_perm_b32 v137, v99, v98, s73
    v_perm_b32 v138, v101, v100, s73
    v_perm_b32 v139, v103, v102, s73
    v_accvgpr_write_b32 a96, v136
    v_accvgpr_write_b32 a97, v137
    v_accvgpr_write_b32 a98, v138
    v_accvgpr_write_b32 a99, v139
    v_perm_b32 v144, v105, v104, s73
    v_perm_b32 v145, v107, v106, s73
    v_perm_b32 v146, v109, v108, s73
    v_perm_b32 v147, v111, v110, s73
    v_accvgpr_write_b32 a108, v144
    v_accvgpr_write_b32 a109, v145
    v_accvgpr_write_b32 a110, v146
    v_accvgpr_write_b32 a111, v147
    v_perm_b32 v136, v113, v112, s73
    v_perm_b32 v137, v115, v114, s73
    v_perm_b32 v138, v117, v116, s73
    v_perm_b32 v139, v119, v118, s73
    v_accvgpr_write_b32 a120, v136
    v_accvgpr_write_b32 a121, v137
    v_accvgpr_write_b32 a122, v138
    v_accvgpr_write_b32 a123, v139
    v_perm_b32 v144, v121, v120, s73
    v_perm_b32 v145, v123, v122, s73
    v_perm_b32 v146, v125, v124, s73
    v_perm_b32 v147, v127, v126, s73
    v_accvgpr_write_b32 a132, v144
    v_accvgpr_write_b32 a133, v145
    v_accvgpr_write_b32 a134, v146
    v_accvgpr_write_b32 a135, v147
    s_waitcnt lgkmcnt(0)
    s_waitcnt vmcnt(32)
    v_perm_b32 v136, v33, v32, s73
    v_perm_b32 v137, v35, v34, s73
    v_perm_b32 v138, v37, v36, s73
    v_perm_b32 v139, v39, v38, s73
    v_accvgpr_write_b32 a144, v136
    v_accvgpr_write_b32 a145, v137
    v_accvgpr_write_b32 a146, v138
    v_accvgpr_write_b32 a147, v139
    v_perm_b32 v144, v41, v40, s73
    v_perm_b32 v145, v43, v42, s73
    v_perm_b32 v146, v45, v44, s73
    v_perm_b32 v147, v47, v46, s73
    v_accvgpr_write_b32 a156, v144
    v_accvgpr_write_b32 a157, v145
    v_accvgpr_write_b32 a158, v146
    v_accvgpr_write_b32 a159, v147
    v_perm_b32 v136, v49, v48, s73
    v_perm_b32 v137, v51, v50, s73
    v_perm_b32 v138, v53, v52, s73
    v_perm_b32 v139, v55, v54, s73
    v_accvgpr_write_b32 a168, v136
    v_accvgpr_write_b32 a169, v137
    v_accvgpr_write_b32 a170, v138
    v_accvgpr_write_b32 a171, v139
    v_perm_b32 v144, v57, v56, s73
    v_perm_b32 v145, v59, v58, s73
    v_perm_b32 v146, v61, v60, s73
    v_perm_b32 v147, v63, v62, s73
    v_accvgpr_write_b32 a180, v144
    v_accvgpr_write_b32 a181, v145
    v_accvgpr_write_b32 a182, v146
    v_accvgpr_write_b32 a183, v147
    s_waitcnt lgkmcnt(0)
    s_waitcnt vmcnt(0)
    v_perm_b32 v136, v65, v64, s73
    v_perm_b32 v137, v67, v66, s73
    v_perm_b32 v138, v69, v68, s73
    v_perm_b32 v139, v71, v70, s73
    v_accvgpr_write_b32 a192, v136
    v_accvgpr_write_b32 a193, v137
    v_accvgpr_write_b32 a194, v138
    v_accvgpr_write_b32 a195, v139
    v_perm_b32 v144, v73, v72, s73
    v_perm_b32 v145, v75, v74, s73
    v_perm_b32 v146, v77, v76, s73
    v_perm_b32 v147, v79, v78, s73
    v_accvgpr_write_b32 a204, v144
    v_accvgpr_write_b32 a205, v145
    v_accvgpr_write_b32 a206, v146
    v_accvgpr_write_b32 a207, v147
    v_perm_b32 v136, v81, v80, s73
    v_perm_b32 v137, v83, v82, s73
    v_perm_b32 v138, v85, v84, s73
    v_perm_b32 v139, v87, v86, s73
    v_accvgpr_write_b32 a216, v136
    v_accvgpr_write_b32 a217, v137
    v_accvgpr_write_b32 a218, v138
    v_accvgpr_write_b32 a219, v139
    v_perm_b32 v144, v89, v88, s73
    v_perm_b32 v145, v91, v90, s73
    v_perm_b32 v146, v93, v92, s73
    v_perm_b32 v147, v95, v94, s73
    v_accvgpr_write_b32 a228, v144
    v_accvgpr_write_b32 a229, v145
    v_accvgpr_write_b32 a230, v146
    v_accvgpr_write_b32 a231, v147
    s_waitcnt lgkmcnt(0)
    s_add_u32 s71, s22, 0
    buffer_load_dword v32, v6, s[64:67], s71 offen
    s_add_u32 s71, s22, 12288
    buffer_load_dword v33, v6, s[64:67], s71 offen
    s_add_u32 s71, s22, 24576
    buffer_load_dword v34, v6, s[64:67], s71 offen
    s_add_u32 s71, s22, 36864
    buffer_load_dword v35, v6, s[64:67], s71 offen
    s_add_u32 s71, s22, 49152
    buffer_load_dword v36, v6, s[64:67], s71 offen
    s_add_u32 s71, s22, 61440
    buffer_load_dword v37, v6, s[64:67], s71 offen
    s_add_u32 s71, s22, 73728
    buffer_load_dword v38, v6, s[64:67], s71 offen
    s_add_u32 s71, s22, 86016
    buffer_load_dword v39, v6, s[64:67], s71 offen
    s_add_u32 s71, s22, 393216
    buffer_load_dword v40, v6, s[64:67], s71 offen
    s_add_u32 s71, s22, 405504
    buffer_load_dword v41, v6, s[64:67], s71 offen
    s_add_u32 s71, s22, 417792
    buffer_load_dword v42, v6, s[64:67], s71 offen
    s_add_u32 s71, s22, 430080
    buffer_load_dword v43, v6, s[64:67], s71 offen
    s_add_u32 s71, s22, 442368
    buffer_load_dword v44, v6, s[64:67], s71 offen
    s_add_u32 s71, s22, 454656
    buffer_load_dword v45, v6, s[64:67], s71 offen
    s_add_u32 s71, s22, 466944
    buffer_load_dword v46, v6, s[64:67], s71 offen
    s_add_u32 s71, s22, 479232
    buffer_load_dword v47, v6, s[64:67], s71 offen
    s_add_u32 s71, s22, 786432
    buffer_load_dword v48, v6, s[64:67], s71 offen
    s_add_u32 s71, s22, 798720
    buffer_load_dword v49, v6, s[64:67], s71 offen
    s_add_u32 s71, s22, 811008
    buffer_load_dword v50, v6, s[64:67], s71 offen
    s_add_u32 s71, s22, 823296
    buffer_load_dword v51, v6, s[64:67], s71 offen
    s_add_u32 s71, s22, 835584
    buffer_load_dword v52, v6, s[64:67], s71 offen
    s_add_u32 s71, s22, 847872
    buffer_load_dword v53, v6, s[64:67], s71 offen
    s_add_u32 s71, s22, 860160
    buffer_load_dword v54, v6, s[64:67], s71 offen
    s_add_u32 s71, s22, 872448
    buffer_load_dword v55, v6, s[64:67], s71 offen
    s_add_u32 s71, s22, 1179648
    buffer_load_dword v56, v6, s[64:67], s71 offen
    s_add_u32 s71, s22, 1191936
    buffer_load_dword v57, v6, s[64:67], s71 offen
    s_add_u32 s71, s22, 1204224
    buffer_load_dword v58, v6, s[64:67], s71 offen
    s_add_u32 s71, s22, 1216512
    buffer_load_dword v59, v6, s[64:67], s71 offen
    s_add_u32 s71, s22, 1228800
    buffer_load_dword v60, v6, s[64:67], s71 offen
    s_add_u32 s71, s22, 1241088
    buffer_load_dword v61, v6, s[64:67], s71 offen
    s_add_u32 s71, s22, 1253376
    buffer_load_dword v62, v6, s[64:67], s71 offen
    s_add_u32 s71, s22, 1265664
    buffer_load_dword v63, v6, s[64:67], s71 offen
    s_add_u32 s71, s22, 1572864
    buffer_load_dword v64, v6, s[64:67], s71 offen
    s_add_u32 s71, s22, 1585152
    buffer_load_dword v65, v6, s[64:67], s71 offen
    s_add_u32 s71, s22, 1597440
    buffer_load_dword v66, v6, s[64:67], s71 offen
    s_add_u32 s71, s22, 1609728
    buffer_load_dword v67, v6, s[64:67], s71 offen
    s_add_u32 s71, s22, 1622016
    buffer_load_dword v68, v6, s[64:67], s71 offen
    s_add_u32 s71, s22, 1634304
    buffer_load_dword v69, v6, s[64:67], s71 offen
    s_add_u32 s71, s22, 1646592
    buffer_load_dword v70, v6, s[64:67], s71 offen
    s_add_u32 s71, s22, 1658880
    buffer_load_dword v71, v6, s[64:67], s71 offen
    s_add_u32 s71, s22, 1966080
    buffer_load_dword v72, v6, s[64:67], s71 offen
    s_add_u32 s71, s22, 1978368
    buffer_load_dword v73, v6, s[64:67], s71 offen
    s_add_u32 s71, s22, 1990656
    buffer_load_dword v74, v6, s[64:67], s71 offen
    s_add_u32 s71, s22, 2002944
    buffer_load_dword v75, v6, s[64:67], s71 offen
    s_add_u32 s71, s22, 2015232
    buffer_load_dword v76, v6, s[64:67], s71 offen
    s_add_u32 s71, s22, 2027520
    buffer_load_dword v77, v6, s[64:67], s71 offen
    s_add_u32 s71, s22, 2039808
    buffer_load_dword v78, v6, s[64:67], s71 offen
    s_add_u32 s71, s22, 2052096
    buffer_load_dword v79, v6, s[64:67], s71 offen
    s_add_u32 s71, s22, 2359296
    buffer_load_dword v80, v6, s[64:67], s71 offen
    s_add_u32 s71, s22, 2371584
    buffer_load_dword v81, v6, s[64:67], s71 offen
    s_add_u32 s71, s22, 2383872
    buffer_load_dword v82, v6, s[64:67], s71 offen
    s_add_u32 s71, s22, 2396160
    buffer_load_dword v83, v6, s[64:67], s71 offen
    s_add_u32 s71, s22, 2408448
    buffer_load_dword v84, v6, s[64:67], s71 offen
    s_add_u32 s71, s22, 2420736
    buffer_load_dword v85, v6, s[64:67], s71 offen
    s_add_u32 s71, s22, 2433024
    buffer_load_dword v86, v6, s[64:67], s71 offen
    s_add_u32 s71, s22, 2445312
    buffer_load_dword v87, v6, s[64:67], s71 offen
    s_add_u32 s71, s22, 2752512
    buffer_load_dword v88, v6, s[64:67], s71 offen
    s_add_u32 s71, s22, 2764800
    buffer_load_dword v89, v6, s[64:67], s71 offen
    s_add_u32 s71, s22, 2777088
    buffer_load_dword v90, v6, s[64:67], s71 offen
    s_add_u32 s71, s22, 2789376
    buffer_load_dword v91, v6, s[64:67], s71 offen
    s_add_u32 s71, s22, 2801664
    buffer_load_dword v92, v6, s[64:67], s71 offen
    s_add_u32 s71, s22, 2813952
    buffer_load_dword v93, v6, s[64:67], s71 offen
    s_add_u32 s71, s22, 2826240
    buffer_load_dword v94, v6, s[64:67], s71 offen
    s_add_u32 s71, s22, 2838528
    buffer_load_dword v95, v6, s[64:67], s71 offen
    s_add_u32 s71, s22, 3145728
    buffer_load_dword v96, v6, s[64:67], s71 offen
    s_add_u32 s71, s22, 3158016
    buffer_load_dword v97, v6, s[64:67], s71 offen
    s_add_u32 s71, s22, 3170304
    buffer_load_dword v98, v6, s[64:67], s71 offen
    s_add_u32 s71, s22, 3182592
    buffer_load_dword v99, v6, s[64:67], s71 offen
    s_add_u32 s71, s22, 3194880
    buffer_load_dword v100, v6, s[64:67], s71 offen
    s_add_u32 s71, s22, 3207168
    buffer_load_dword v101, v6, s[64:67], s71 offen
    s_add_u32 s71, s22, 3219456
    buffer_load_dword v102, v6, s[64:67], s71 offen
    s_add_u32 s71, s22, 3231744
    buffer_load_dword v103, v6, s[64:67], s71 offen
    s_add_u32 s71, s22, 3538944
    buffer_load_dword v104, v6, s[64:67], s71 offen
    s_add_u32 s71, s22, 3551232
    buffer_load_dword v105, v6, s[64:67], s71 offen
    s_add_u32 s71, s22, 3563520
    buffer_load_dword v106, v6, s[64:67], s71 offen
    s_add_u32 s71, s22, 3575808
    buffer_load_dword v107, v6, s[64:67], s71 offen
    s_add_u32 s71, s22, 3588096
    buffer_load_dword v108, v6, s[64:67], s71 offen
    s_add_u32 s71, s22, 3600384
    buffer_load_dword v109, v6, s[64:67], s71 offen
    s_add_u32 s71, s22, 3612672
    buffer_load_dword v110, v6, s[64:67], s71 offen
    s_add_u32 s71, s22, 3624960
    buffer_load_dword v111, v6, s[64:67], s71 offen
    s_add_u32 s71, s22, 3932160
    buffer_load_dword v112, v6, s[64:67], s71 offen
    s_add_u32 s71, s22, 3944448
    buffer_load_dword v113, v6, s[64:67], s71 offen
    s_add_u32 s71, s22, 3956736
    buffer_load_dword v114, v6, s[64:67], s71 offen
    s_add_u32 s71, s22, 3969024
    buffer_load_dword v115, v6, s[64:67], s71 offen
    s_add_u32 s71, s22, 3981312
    buffer_load_dword v116, v6, s[64:67], s71 offen
    s_add_u32 s71, s22, 3993600
    buffer_load_dword v117, v6, s[64:67], s71 offen
    s_add_u32 s71, s22, 4005888
    buffer_load_dword v118, v6, s[64:67], s71 offen
    s_add_u32 s71, s22, 4018176
    buffer_load_dword v119, v6, s[64:67], s71 offen
    s_add_u32 s71, s22, 4325376
    buffer_load_dword v120, v6, s[64:67], s71 offen
    s_add_u32 s71, s22, 4337664
    buffer_load_dword v121, v6, s[64:67], s71 offen
    s_add_u32 s71, s22, 4349952
    buffer_load_dword v122, v6, s[64:67], s71 offen
    s_add_u32 s71, s22, 4362240
    buffer_load_dword v123, v6, s[64:67], s71 offen
    s_add_u32 s71, s22, 4374528
    buffer_load_dword v124, v6, s[64:67], s71 offen
    s_add_u32 s71, s22, 4386816
    buffer_load_dword v125, v6, s[64:67], s71 offen
    s_add_u32 s71, s22, 4399104
    buffer_load_dword v126, v6, s[64:67], s71 offen
    s_add_u32 s71, s22, 4411392
    buffer_load_dword v127, v6, s[64:67], s71 offen
    s_waitcnt vmcnt(63)
    v_perm_b32 v132, v33, v32, s72
    v_perm_b32 v133, v35, v34, s72
    v_perm_b32 v134, v37, v36, s72
    v_perm_b32 v135, v39, v38, s72
    v_accvgpr_write_b32 a4, v132
    v_accvgpr_write_b32 a5, v133
    v_accvgpr_write_b32 a6, v134
    v_accvgpr_write_b32 a7, v135
    v_perm_b32 v136, v33, v32, s73
    v_perm_b32 v137, v35, v34, s73
    v_perm_b32 v138, v37, v36, s73
    v_perm_b32 v139, v39, v38, s73
    v_accvgpr_write_b32 a8, v136
    v_accvgpr_write_b32 a9, v137
    v_accvgpr_write_b32 a10, v138
    v_accvgpr_write_b32 a11, v139
    v_perm_b32 v140, v41, v40, s72
    v_perm_b32 v141, v43, v42, s72
    v_perm_b32 v142, v45, v44, s72
    v_perm_b32 v143, v47, v46, s72
    v_accvgpr_write_b32 a16, v140
    v_accvgpr_write_b32 a17, v141
    v_accvgpr_write_b32 a18, v142
    v_accvgpr_write_b32 a19, v143
    v_perm_b32 v144, v41, v40, s73
    v_perm_b32 v145, v43, v42, s73
    v_perm_b32 v146, v45, v44, s73
    v_perm_b32 v147, v47, v46, s73
    v_accvgpr_write_b32 a20, v144
    v_accvgpr_write_b32 a21, v145
    v_accvgpr_write_b32 a22, v146
    v_accvgpr_write_b32 a23, v147
    v_perm_b32 v132, v49, v48, s72
    v_perm_b32 v133, v51, v50, s72
    v_perm_b32 v134, v53, v52, s72
    v_perm_b32 v135, v55, v54, s72
    v_accvgpr_write_b32 a28, v132
    v_accvgpr_write_b32 a29, v133
    v_accvgpr_write_b32 a30, v134
    v_accvgpr_write_b32 a31, v135
    v_perm_b32 v136, v49, v48, s73
    v_perm_b32 v137, v51, v50, s73
    v_perm_b32 v138, v53, v52, s73
    v_perm_b32 v139, v55, v54, s73
    v_accvgpr_write_b32 a32, v136
    v_accvgpr_write_b32 a33, v137
    v_accvgpr_write_b32 a34, v138
    v_accvgpr_write_b32 a35, v139
    v_perm_b32 v140, v57, v56, s72
    v_perm_b32 v141, v59, v58, s72
    v_perm_b32 v142, v61, v60, s72
    v_perm_b32 v143, v63, v62, s72
    v_accvgpr_write_b32 a40, v140
    v_accvgpr_write_b32 a41, v141
    v_accvgpr_write_b32 a42, v142
    v_accvgpr_write_b32 a43, v143
    v_perm_b32 v144, v57, v56, s73
    v_perm_b32 v145, v59, v58, s73
    v_perm_b32 v146, v61, v60, s73
    v_perm_b32 v147, v63, v62, s73
    v_accvgpr_write_b32 a44, v144
    v_accvgpr_write_b32 a45, v145
    v_accvgpr_write_b32 a46, v146
    v_accvgpr_write_b32 a47, v147
    s_waitcnt lgkmcnt(0)
    s_add_u32 s71, s22, 4718592
    buffer_load_dword v32, v6, s[64:67], s71 offen
    s_add_u32 s71, s22, 4730880
    buffer_load_dword v33, v6, s[64:67], s71 offen
    s_add_u32 s71, s22, 4743168
    buffer_load_dword v34, v6, s[64:67], s71 offen
    s_add_u32 s71, s22, 4755456
    buffer_load_dword v35, v6, s[64:67], s71 offen
    s_add_u32 s71, s22, 4767744
    buffer_load_dword v36, v6, s[64:67], s71 offen
    s_add_u32 s71, s22, 4780032
    buffer_load_dword v37, v6, s[64:67], s71 offen
    s_add_u32 s71, s22, 4792320
    buffer_load_dword v38, v6, s[64:67], s71 offen
    s_add_u32 s71, s22, 4804608
    buffer_load_dword v39, v6, s[64:67], s71 offen
    s_add_u32 s71, s22, 5111808
    buffer_load_dword v40, v6, s[64:67], s71 offen
    s_add_u32 s71, s22, 5124096
    buffer_load_dword v41, v6, s[64:67], s71 offen
    s_add_u32 s71, s22, 5136384
    buffer_load_dword v42, v6, s[64:67], s71 offen
    s_add_u32 s71, s22, 5148672
    buffer_load_dword v43, v6, s[64:67], s71 offen
    s_add_u32 s71, s22, 5160960
    buffer_load_dword v44, v6, s[64:67], s71 offen
    s_add_u32 s71, s22, 5173248
    buffer_load_dword v45, v6, s[64:67], s71 offen
    s_add_u32 s71, s22, 5185536
    buffer_load_dword v46, v6, s[64:67], s71 offen
    s_add_u32 s71, s22, 5197824
    buffer_load_dword v47, v6, s[64:67], s71 offen
    s_add_u32 s71, s22, 5505024
    buffer_load_dword v48, v6, s[64:67], s71 offen
    s_add_u32 s71, s22, 5517312
    buffer_load_dword v49, v6, s[64:67], s71 offen
    s_add_u32 s71, s22, 5529600
    buffer_load_dword v50, v6, s[64:67], s71 offen
    s_add_u32 s71, s22, 5541888
    buffer_load_dword v51, v6, s[64:67], s71 offen
    s_add_u32 s71, s22, 5554176
    buffer_load_dword v52, v6, s[64:67], s71 offen
    s_add_u32 s71, s22, 5566464
    buffer_load_dword v53, v6, s[64:67], s71 offen
    s_add_u32 s71, s22, 5578752
    buffer_load_dword v54, v6, s[64:67], s71 offen
    s_add_u32 s71, s22, 5591040
    buffer_load_dword v55, v6, s[64:67], s71 offen
    s_add_u32 s71, s22, 5898240
    buffer_load_dword v56, v6, s[64:67], s71 offen
    s_add_u32 s71, s22, 5910528
    buffer_load_dword v57, v6, s[64:67], s71 offen
    s_add_u32 s71, s22, 5922816
    buffer_load_dword v58, v6, s[64:67], s71 offen
    s_add_u32 s71, s22, 5935104
    buffer_load_dword v59, v6, s[64:67], s71 offen
    s_add_u32 s71, s22, 5947392
    buffer_load_dword v60, v6, s[64:67], s71 offen
    s_add_u32 s71, s22, 5959680
    buffer_load_dword v61, v6, s[64:67], s71 offen
    s_add_u32 s71, s22, 5971968
    buffer_load_dword v62, v6, s[64:67], s71 offen
    s_add_u32 s71, s22, 5984256
    buffer_load_dword v63, v6, s[64:67], s71 offen
    s_waitcnt vmcnt(63)
    v_perm_b32 v132, v65, v64, s72
    v_perm_b32 v133, v67, v66, s72
    v_perm_b32 v134, v69, v68, s72
    v_perm_b32 v135, v71, v70, s72
    v_accvgpr_write_b32 a52, v132
    v_accvgpr_write_b32 a53, v133
    v_accvgpr_write_b32 a54, v134
    v_accvgpr_write_b32 a55, v135
    v_perm_b32 v136, v65, v64, s73
    v_perm_b32 v137, v67, v66, s73
    v_perm_b32 v138, v69, v68, s73
    v_perm_b32 v139, v71, v70, s73
    v_accvgpr_write_b32 a56, v136
    v_accvgpr_write_b32 a57, v137
    v_accvgpr_write_b32 a58, v138
    v_accvgpr_write_b32 a59, v139
    v_perm_b32 v140, v73, v72, s72
    v_perm_b32 v141, v75, v74, s72
    v_perm_b32 v142, v77, v76, s72
    v_perm_b32 v143, v79, v78, s72
    v_accvgpr_write_b32 a64, v140
    v_accvgpr_write_b32 a65, v141
    v_accvgpr_write_b32 a66, v142
    v_accvgpr_write_b32 a67, v143
    v_perm_b32 v144, v73, v72, s73
    v_perm_b32 v145, v75, v74, s73
    v_perm_b32 v146, v77, v76, s73
    v_perm_b32 v147, v79, v78, s73
    v_accvgpr_write_b32 a68, v144
    v_accvgpr_write_b32 a69, v145
    v_accvgpr_write_b32 a70, v146
    v_accvgpr_write_b32 a71, v147
    v_perm_b32 v132, v81, v80, s72
    v_perm_b32 v133, v83, v82, s72
    v_perm_b32 v134, v85, v84, s72
    v_perm_b32 v135, v87, v86, s72
    v_accvgpr_write_b32 a76, v132
    v_accvgpr_write_b32 a77, v133
    v_accvgpr_write_b32 a78, v134
    v_accvgpr_write_b32 a79, v135
    v_perm_b32 v136, v81, v80, s73
    v_perm_b32 v137, v83, v82, s73
    v_perm_b32 v138, v85, v84, s73
    v_perm_b32 v139, v87, v86, s73
    v_accvgpr_write_b32 a80, v136
    v_accvgpr_write_b32 a81, v137
    v_accvgpr_write_b32 a82, v138
    v_accvgpr_write_b32 a83, v139
    v_perm_b32 v140, v89, v88, s72
    v_perm_b32 v141, v91, v90, s72
    v_perm_b32 v142, v93, v92, s72
    v_perm_b32 v143, v95, v94, s72
    v_accvgpr_write_b32 a88, v140
    v_accvgpr_write_b32 a89, v141
    v_accvgpr_write_b32 a90, v142
    v_accvgpr_write_b32 a91, v143
    v_perm_b32 v144, v89, v88, s73
    v_perm_b32 v145, v91, v90, s73
    v_perm_b32 v146, v93, v92, s73
    v_perm_b32 v147, v95, v94, s73
    v_accvgpr_write_b32 a92, v144
    v_accvgpr_write_b32 a93, v145
    v_accvgpr_write_b32 a94, v146
    v_accvgpr_write_b32 a95, v147
    s_waitcnt lgkmcnt(0)
    s_add_u32 s71, s22, 6291456
    buffer_load_dword v64, v6, s[64:67], s71 offen
    s_add_u32 s71, s22, 6303744
    buffer_load_dword v65, v6, s[64:67], s71 offen
    s_add_u32 s71, s22, 6316032
    buffer_load_dword v66, v6, s[64:67], s71 offen
    s_add_u32 s71, s22, 6328320
    buffer_load_dword v67, v6, s[64:67], s71 offen
    s_add_u32 s71, s22, 6340608
    buffer_load_dword v68, v6, s[64:67], s71 offen
    s_add_u32 s71, s22, 6352896
    buffer_load_dword v69, v6, s[64:67], s71 offen
    s_add_u32 s71, s22, 6365184
    buffer_load_dword v70, v6, s[64:67], s71 offen
    s_add_u32 s71, s22, 6377472
    buffer_load_dword v71, v6, s[64:67], s71 offen
    s_add_u32 s71, s22, 6684672
    buffer_load_dword v72, v6, s[64:67], s71 offen
    s_add_u32 s71, s22, 6696960
    buffer_load_dword v73, v6, s[64:67], s71 offen
    s_add_u32 s71, s22, 6709248
    buffer_load_dword v74, v6, s[64:67], s71 offen
    s_add_u32 s71, s22, 6721536
    buffer_load_dword v75, v6, s[64:67], s71 offen
    s_add_u32 s71, s22, 6733824
    buffer_load_dword v76, v6, s[64:67], s71 offen
    s_add_u32 s71, s22, 6746112
    buffer_load_dword v77, v6, s[64:67], s71 offen
    s_add_u32 s71, s22, 6758400
    buffer_load_dword v78, v6, s[64:67], s71 offen
    s_add_u32 s71, s22, 6770688
    buffer_load_dword v79, v6, s[64:67], s71 offen
    s_add_u32 s71, s22, 7077888
    buffer_load_dword v80, v6, s[64:67], s71 offen
    s_add_u32 s71, s22, 7090176
    buffer_load_dword v81, v6, s[64:67], s71 offen
    s_add_u32 s71, s22, 7102464
    buffer_load_dword v82, v6, s[64:67], s71 offen
    s_add_u32 s71, s22, 7114752
    buffer_load_dword v83, v6, s[64:67], s71 offen
    s_add_u32 s71, s22, 7127040
    buffer_load_dword v84, v6, s[64:67], s71 offen
    s_add_u32 s71, s22, 7139328
    buffer_load_dword v85, v6, s[64:67], s71 offen
    s_add_u32 s71, s22, 7151616
    buffer_load_dword v86, v6, s[64:67], s71 offen
    s_add_u32 s71, s22, 7163904
    buffer_load_dword v87, v6, s[64:67], s71 offen
    s_add_u32 s71, s22, 7471104
    buffer_load_dword v88, v6, s[64:67], s71 offen
    s_add_u32 s71, s22, 7483392
    buffer_load_dword v89, v6, s[64:67], s71 offen
    s_add_u32 s71, s22, 7495680
    buffer_load_dword v90, v6, s[64:67], s71 offen
    s_add_u32 s71, s22, 7507968
    buffer_load_dword v91, v6, s[64:67], s71 offen
    s_add_u32 s71, s22, 7520256
    buffer_load_dword v92, v6, s[64:67], s71 offen
    s_add_u32 s71, s22, 7532544
    buffer_load_dword v93, v6, s[64:67], s71 offen
    s_add_u32 s71, s22, 7544832
    buffer_load_dword v94, v6, s[64:67], s71 offen
    s_add_u32 s71, s22, 7557120
    buffer_load_dword v95, v6, s[64:67], s71 offen
    s_waitcnt vmcnt(63)
    v_perm_b32 v132, v97, v96, s72
    v_perm_b32 v133, v99, v98, s72
    v_perm_b32 v134, v101, v100, s72
    v_perm_b32 v135, v103, v102, s72
    v_accvgpr_write_b32 a100, v132
    v_accvgpr_write_b32 a101, v133
    v_accvgpr_write_b32 a102, v134
    v_accvgpr_write_b32 a103, v135
    v_perm_b32 v136, v97, v96, s73
    v_perm_b32 v137, v99, v98, s73
    v_perm_b32 v138, v101, v100, s73
    v_perm_b32 v139, v103, v102, s73
    v_accvgpr_write_b32 a104, v136
    v_accvgpr_write_b32 a105, v137
    v_accvgpr_write_b32 a106, v138
    v_accvgpr_write_b32 a107, v139
    v_perm_b32 v140, v105, v104, s72
    v_perm_b32 v141, v107, v106, s72
    v_perm_b32 v142, v109, v108, s72
    v_perm_b32 v143, v111, v110, s72
    v_accvgpr_write_b32 a112, v140
    v_accvgpr_write_b32 a113, v141
    v_accvgpr_write_b32 a114, v142
    v_accvgpr_write_b32 a115, v143
    v_perm_b32 v144, v105, v104, s73
    v_perm_b32 v145, v107, v106, s73
    v_perm_b32 v146, v109, v108, s73
    v_perm_b32 v147, v111, v110, s73
    v_accvgpr_write_b32 a116, v144
    v_accvgpr_write_b32 a117, v145
    v_accvgpr_write_b32 a118, v146
    v_accvgpr_write_b32 a119, v147
    v_perm_b32 v132, v113, v112, s72
    v_perm_b32 v133, v115, v114, s72
    v_perm_b32 v134, v117, v116, s72
    v_perm_b32 v135, v119, v118, s72
    v_accvgpr_write_b32 a124, v132
    v_accvgpr_write_b32 a125, v133
    v_accvgpr_write_b32 a126, v134
    v_accvgpr_write_b32 a127, v135
    v_perm_b32 v136, v113, v112, s73
    v_perm_b32 v137, v115, v114, s73
    v_perm_b32 v138, v117, v116, s73
    v_perm_b32 v139, v119, v118, s73
    v_accvgpr_write_b32 a128, v136
    v_accvgpr_write_b32 a129, v137
    v_accvgpr_write_b32 a130, v138
    v_accvgpr_write_b32 a131, v139
    v_perm_b32 v140, v121, v120, s72
    v_perm_b32 v141, v123, v122, s72
    v_perm_b32 v142, v125, v124, s72
    v_perm_b32 v143, v127, v126, s72
    v_accvgpr_write_b32 a136, v140
    v_accvgpr_write_b32 a137, v141
    v_accvgpr_write_b32 a138, v142
    v_accvgpr_write_b32 a139, v143
    v_perm_b32 v144, v121, v120, s73
    v_perm_b32 v145, v123, v122, s73
    v_perm_b32 v146, v125, v124, s73
    v_perm_b32 v147, v127, v126, s73
    v_accvgpr_write_b32 a140, v144
    v_accvgpr_write_b32 a141, v145
    v_accvgpr_write_b32 a142, v146
    v_accvgpr_write_b32 a143, v147
    s_waitcnt lgkmcnt(0)
    s_waitcnt vmcnt(32)
    v_perm_b32 v132, v33, v32, s72
    v_perm_b32 v133, v35, v34, s72
    v_perm_b32 v134, v37, v36, s72
    v_perm_b32 v135, v39, v38, s72
    v_accvgpr_write_b32 a148, v132
    v_accvgpr_write_b32 a149, v133
    v_accvgpr_write_b32 a150, v134
    v_accvgpr_write_b32 a151, v135
    v_perm_b32 v136, v33, v32, s73
    v_perm_b32 v137, v35, v34, s73
    v_perm_b32 v138, v37, v36, s73
    v_perm_b32 v139, v39, v38, s73
    v_accvgpr_write_b32 a152, v136
    v_accvgpr_write_b32 a153, v137
    v_accvgpr_write_b32 a154, v138
    v_accvgpr_write_b32 a155, v139
    v_perm_b32 v140, v41, v40, s72
    v_perm_b32 v141, v43, v42, s72
    v_perm_b32 v142, v45, v44, s72
    v_perm_b32 v143, v47, v46, s72
    v_accvgpr_write_b32 a160, v140
    v_accvgpr_write_b32 a161, v141
    v_accvgpr_write_b32 a162, v142
    v_accvgpr_write_b32 a163, v143
    v_perm_b32 v144, v41, v40, s73
    v_perm_b32 v145, v43, v42, s73
    v_perm_b32 v146, v45, v44, s73
    v_perm_b32 v147, v47, v46, s73
    v_accvgpr_write_b32 a164, v144
    v_accvgpr_write_b32 a165, v145
    v_accvgpr_write_b32 a166, v146
    v_accvgpr_write_b32 a167, v147
    v_perm_b32 v132, v49, v48, s72
    v_perm_b32 v133, v51, v50, s72
    v_perm_b32 v134, v53, v52, s72
    v_perm_b32 v135, v55, v54, s72
    v_accvgpr_write_b32 a172, v132
    v_accvgpr_write_b32 a173, v133
    v_accvgpr_write_b32 a174, v134
    v_accvgpr_write_b32 a175, v135
    v_perm_b32 v136, v49, v48, s73
    v_perm_b32 v137, v51, v50, s73
    v_perm_b32 v138, v53, v52, s73
    v_perm_b32 v139, v55, v54, s73
    v_accvgpr_write_b32 a176, v136
    v_accvgpr_write_b32 a177, v137
    v_accvgpr_write_b32 a178, v138
    v_accvgpr_write_b32 a179, v139
    v_perm_b32 v140, v57, v56, s72
    v_perm_b32 v141, v59, v58, s72
    v_perm_b32 v142, v61, v60, s72
    v_perm_b32 v143, v63, v62, s72
    v_accvgpr_write_b32 a184, v140
    v_accvgpr_write_b32 a185, v141
    v_accvgpr_write_b32 a186, v142
    v_accvgpr_write_b32 a187, v143
    v_perm_b32 v144, v57, v56, s73
    v_perm_b32 v145, v59, v58, s73
    v_perm_b32 v146, v61, v60, s73
    v_perm_b32 v147, v63, v62, s73
    v_accvgpr_write_b32 a188, v144
    v_accvgpr_write_b32 a189, v145
    v_accvgpr_write_b32 a190, v146
    v_accvgpr_write_b32 a191, v147
    s_waitcnt lgkmcnt(0)
    s_waitcnt vmcnt(0)
    v_perm_b32 v132, v65, v64, s72
    v_perm_b32 v133, v67, v66, s72
    v_perm_b32 v134, v69, v68, s72
    v_perm_b32 v135, v71, v70, s72
    v_accvgpr_write_b32 a196, v132
    v_accvgpr_write_b32 a197, v133
    v_accvgpr_write_b32 a198, v134
    v_accvgpr_write_b32 a199, v135
    v_perm_b32 v136, v65, v64, s73
    v_perm_b32 v137, v67, v66, s73
    v_perm_b32 v138, v69, v68, s73
    v_perm_b32 v139, v71, v70, s73
    v_accvgpr_write_b32 a200, v136
    v_accvgpr_write_b32 a201, v137
    v_accvgpr_write_b32 a202, v138
    v_accvgpr_write_b32 a203, v139
    v_perm_b32 v140, v73, v72, s72
    v_perm_b32 v141, v75, v74, s72
    v_perm_b32 v142, v77, v76, s72
    v_perm_b32 v143, v79, v78, s72
    v_accvgpr_write_b32 a208, v140
    v_accvgpr_write_b32 a209, v141
    v_accvgpr_write_b32 a210, v142
    v_accvgpr_write_b32 a211, v143
    v_perm_b32 v144, v73, v72, s73
    v_perm_b32 v145, v75, v74, s73
    v_perm_b32 v146, v77, v76, s73
    v_perm_b32 v147, v79, v78, s73
    v_accvgpr_write_b32 a212, v144
    v_accvgpr_write_b32 a213, v145
    v_accvgpr_write_b32 a214, v146
    v_accvgpr_write_b32 a215, v147
    v_perm_b32 v132, v81, v80, s72
    v_perm_b32 v133, v83, v82, s72
    v_perm_b32 v134, v85, v84, s72
    v_perm_b32 v135, v87, v86, s72
    v_accvgpr_write_b32 a220, v132
    v_accvgpr_write_b32 a221, v133
    v_accvgpr_write_b32 a222, v134
    v_accvgpr_write_b32 a223, v135
    v_perm_b32 v136, v81, v80, s73
    v_perm_b32 v137, v83, v82, s73
    v_perm_b32 v138, v85, v84, s73
    v_perm_b32 v139, v87, v86, s73
    v_accvgpr_write_b32 a224, v136
    v_accvgpr_write_b32 a225, v137
    v_accvgpr_write_b32 a226, v138
    v_accvgpr_write_b32 a227, v139
    v_perm_b32 v140, v89, v88, s72
    v_perm_b32 v141, v91, v90, s72
    v_perm_b32 v142, v93, v92, s72
    v_perm_b32 v143, v95, v94, s72
    v_accvgpr_write_b32 a232, v140
    v_accvgpr_write_b32 a233, v141
    v_accvgpr_write_b32 a234, v142
    v_accvgpr_write_b32 a235, v143
    v_perm_b32 v144, v89, v88, s73
    v_perm_b32 v145, v91, v90, s73
    v_perm_b32 v146, v93, v92, s73
    v_perm_b32 v147, v95, v94, s73
    v_accvgpr_write_b32 a236, v144
    v_accvgpr_write_b32 a237, v145
    v_accvgpr_write_b32 a238, v146
    v_accvgpr_write_b32 a239, v147
    s_waitcnt lgkmcnt(0)
    s_lshl_b32 s40, s26, 6
    s_add_u32 s40, s40, 2
    s_add_u32 s41, s40, 62
    s_add_u32 s42, s40, 64
mega_kernel_wl239:
    s_movk_i32 s3, 10240
    v_mul_lo_u32 v6, v4, s3
    v_lshl_add_u32 v7, v3, 2, v6
    v_lshl_add_u32 v6, v3, 3, v6
    s_mul_i32 s27, s74, 160
    s_mul_i32 s3, s20, 245760
    s_lshl_b32 s21, s27, 1
    s_add_u32 s21, s21, s3
    s_add_u32 s22, s21, 128
    s_add_u32 s23, s21, 256
    s_add_u32 s71, s21, 0
    buffer_load_dwordx2 v[32:33], v6, s[96:99], s71 offen
    s_add_u32 s71, s21, 1280
    buffer_load_dwordx2 v[34:35], v6, s[96:99], s71 offen
    s_add_u32 s71, s21, 2560
    buffer_load_dwordx2 v[36:37], v6, s[96:99], s71 offen
    s_add_u32 s71, s21, 3840
    buffer_load_dwordx2 v[38:39], v6, s[96:99], s71 offen
    s_add_u32 s71, s21, 5120
    buffer_load_dwordx2 v[40:41], v6, s[96:99], s71 offen
    s_add_u32 s71, s21, 6400
    buffer_load_dwordx2 v[42:43], v6, s[96:99], s71 offen
    s_add_u32 s71, s21, 7680
    buffer_load_dwordx2 v[44:45], v6, s[96:99], s71 offen
    s_add_u32 s71, s21, 8960
    buffer_load_dwordx2 v[46:47], v6, s[96:99], s71 offen
    s_add_u32 s71, s21, 40960
    buffer_load_dwordx2 v[48:49], v6, s[96:99], s71 offen
    s_add_u32 s71, s21, 42240
    buffer_load_dwordx2 v[50:51], v6, s[96:99], s71 offen
    s_add_u32 s71, s21, 43520
    buffer_load_dwordx2 v[52:53], v6, s[96:99], s71 offen
    s_add_u32 s71, s21, 44800
    buffer_load_dwordx2 v[54:55], v6, s[96:99], s71 offen
    s_add_u32 s71, s21, 46080
    buffer_load_dwordx2 v[56:57], v6, s[96:99], s71 offen
    s_add_u32 s71, s21, 47360
    buffer_load_dwordx2 v[58:59], v6, s[96:99], s71 offen
    s_add_u32 s71, s21, 48640
    buffer_load_dwordx2 v[60:61], v6, s[96:99], s71 offen
    s_add_u32 s71, s21, 49920
    buffer_load_dwordx2 v[62:63], v6, s[96:99], s71 offen
    s_add_u32 s71, s21, 81920
    buffer_load_dwordx2 v[64:65], v6, s[96:99], s71 offen
    s_add_u32 s71, s21, 83200
    buffer_load_dwordx2 v[66:67], v6, s[96:99], s71 offen
    s_add_u32 s71, s21, 84480
    buffer_load_dwordx2 v[68:69], v6, s[96:99], s71 offen
    s_add_u32 s71, s21, 85760
    buffer_load_dwordx2 v[70:71], v6, s[96:99], s71 offen
    s_add_u32 s71, s21, 87040
    buffer_load_dwordx2 v[72:73], v6, s[96:99], s71 offen
    s_add_u32 s71, s21, 88320
    buffer_load_dwordx2 v[74:75], v6, s[96:99], s71 offen
    s_add_u32 s71, s21, 89600
    buffer_load_dwordx2 v[76:77], v6, s[96:99], s71 offen
    s_add_u32 s71, s21, 90880
    buffer_load_dwordx2 v[78:79], v6, s[96:99], s71 offen
    s_add_u32 s71, s21, 122880
    buffer_load_dwordx2 v[80:81], v6, s[96:99], s71 offen
    s_add_u32 s71, s21, 124160
    buffer_load_dwordx2 v[82:83], v6, s[96:99], s71 offen
    s_add_u32 s71, s21, 125440
    buffer_load_dwordx2 v[84:85], v6, s[96:99], s71 offen
    s_add_u32 s71, s21, 126720
    buffer_load_dwordx2 v[86:87], v6, s[96:99], s71 offen
    s_add_u32 s71, s21, 128000
    buffer_load_dwordx2 v[88:89], v6, s[96:99], s71 offen
    s_add_u32 s71, s21, 129280
    buffer_load_dwordx2 v[90:91], v6, s[96:99], s71 offen
    s_add_u32 s71, s21, 130560
    buffer_load_dwordx2 v[92:93], v6, s[96:99], s71 offen
    s_add_u32 s71, s21, 131840
    buffer_load_dwordx2 v[94:95], v6, s[96:99], s71 offen
    s_add_u32 s71, s21, 163840
    buffer_load_dwordx2 v[96:97], v6, s[96:99], s71 offen
    s_add_u32 s71, s21, 165120
    buffer_load_dwordx2 v[98:99], v6, s[96:99], s71 offen
    s_add_u32 s71, s21, 166400
    buffer_load_dwordx2 v[100:101], v6, s[96:99], s71 offen
    s_add_u32 s71, s21, 167680
    buffer_load_dwordx2 v[102:103], v6, s[96:99], s71 offen
    s_add_u32 s71, s21, 168960
    buffer_load_dwordx2 v[104:105], v6, s[96:99], s71 offen
    s_add_u32 s71, s21, 170240
    buffer_load_dwordx2 v[106:107], v6, s[96:99], s71 offen
    s_add_u32 s71, s21, 171520
    buffer_load_dwordx2 v[108:109], v6, s[96:99], s71 offen
    s_add_u32 s71, s21, 172800
    buffer_load_dwordx2 v[110:111], v6, s[96:99], s71 offen
    s_add_u32 s71, s21, 204800
    buffer_load_dwordx2 v[112:113], v6, s[96:99], s71 offen
    s_add_u32 s71, s21, 206080
    buffer_load_dwordx2 v[114:115], v6, s[96:99], s71 offen
    s_add_u32 s71, s21, 207360
    buffer_load_dwordx2 v[116:117], v6, s[96:99], s71 offen
    s_add_u32 s71, s21, 208640
    buffer_load_dwordx2 v[118:119], v6, s[96:99], s71 offen
    s_add_u32 s71, s21, 209920
    buffer_load_dwordx2 v[120:121], v6, s[96:99], s71 offen
    s_add_u32 s71, s21, 211200
    buffer_load_dwordx2 v[122:123], v6, s[96:99], s71 offen
    s_add_u32 s71, s21, 212480
    buffer_load_dwordx2 v[124:125], v6, s[96:99], s71 offen
    s_add_u32 s71, s21, 213760
    buffer_load_dwordx2 v[126:127], v6, s[96:99], s71 offen
    s_waitcnt vmcnt(32)
    v_perm_b32 v132, v34, v32, s72
    v_perm_b32 v133, v38, v36, s72
    v_perm_b32 v134, v42, v40, s72
    v_perm_b32 v135, v46, v44, s72
    v_accvgpr_write_b32 a240, v132
    v_accvgpr_write_b32 a241, v133
    v_accvgpr_write_b32 a242, v134
    v_accvgpr_write_b32 a243, v135
    v_perm_b32 v136, v34, v32, s73
    v_perm_b32 v137, v38, v36, s73
    v_perm_b32 v138, v42, v40, s73
    v_perm_b32 v139, v46, v44, s73
    v_accvgpr_write_b32 a244, v136
    v_accvgpr_write_b32 a245, v137
    v_accvgpr_write_b32 a246, v138
    v_accvgpr_write_b32 a247, v139
    v_perm_b32 v140, v35, v33, s72
    v_perm_b32 v141, v39, v37, s72
    v_perm_b32 v142, v43, v41, s72
    v_perm_b32 v143, v47, v45, s72
    v_accvgpr_write_b32 a248, v140
    v_accvgpr_write_b32 a249, v141
    v_accvgpr_write_b32 a250, v142
    v_accvgpr_write_b32 a251, v143
    v_perm_b32 v144, v35, v33, s73
    v_perm_b32 v145, v39, v37, s73
    v_perm_b32 v146, v43, v41, s73
    v_perm_b32 v147, v47, v45, s73
    v_accvgpr_write_b32 a252, v144
    v_accvgpr_write_b32 a253, v145
    v_accvgpr_write_b32 a254, v146
    v_accvgpr_write_b32 a255, v147
    v_perm_b32 v132, v50, v48, s72
    v_perm_b32 v133, v54, v52, s72
    v_perm_b32 v134, v58, v56, s72
    v_perm_b32 v135, v62, v60, s72
    v_mov_b32 v188, v132
    v_mov_b32 v189, v133
    v_mov_b32 v190, v134
    v_mov_b32 v191, v135
    v_perm_b32 v136, v50, v48, s73
    v_perm_b32 v137, v54, v52, s73
    v_perm_b32 v138, v58, v56, s73
    v_perm_b32 v139, v62, v60, s73
    v_mov_b32 v192, v136
    v_mov_b32 v193, v137
    v_mov_b32 v194, v138
    v_mov_b32 v195, v139
    v_perm_b32 v140, v51, v49, s72
    v_perm_b32 v141, v55, v53, s72
    v_perm_b32 v142, v59, v57, s72
    v_perm_b32 v143, v63, v61, s72
    v_mov_b32 v196, v140
    v_mov_b32 v197, v141
    v_mov_b32 v198, v142
    v_mov_b32 v199, v143
    v_perm_b32 v144, v51, v49, s73
    v_perm_b32 v145, v55, v53, s73
    v_perm_b32 v146, v59, v57, s73
    v_perm_b32 v147, v63, v61, s73
    v_mov_b32 v200, v144
    v_mov_b32 v201, v145
    v_mov_b32 v202, v146
    v_mov_b32 v203, v147
    s_waitcnt lgkmcnt(0)
    s_waitcnt vmcnt(16)
    v_perm_b32 v132, v66, v64, s72
    v_perm_b32 v133, v70, v68, s72
    v_perm_b32 v134, v74, v72, s72
    v_perm_b32 v135, v78, v76, s72
    v_mov_b32 v228, v132
    v_mov_b32 v229, v133
    v_mov_b32 v230, v134
    v_mov_b32 v231, v135
    v_perm_b32 v136, v66, v64, s73
    v_perm_b32 v137, v70, v68, s73
    v_perm_b32 v138, v74, v72, s73
    v_perm_b32 v139, v78, v76, s73
    v_mov_b32 v232, v136
    v_mov_b32 v233, v137
    v_mov_b32 v234, v138
    v_mov_b32 v235, v139
    v_perm_b32 v140, v67, v65, s72
    v_perm_b32 v141, v71, v69, s72
    v_perm_b32 v142, v75, v73, s72
    v_perm_b32 v143, v79, v77, s72
    v_mov_b32 v236, v140
    v_mov_b32 v237, v141
    v_mov_b32 v238, v142
    v_mov_b32 v239, v143
    v_perm_b32 v144, v67, v65, s73
    v_perm_b32 v145, v71, v69, s73
    v_perm_b32 v146, v75, v73, s73
    v_perm_b32 v147, v79, v77, s73
    v_mov_b32 v240, v144
    v_mov_b32 v241, v145
    v_mov_b32 v242, v146
    v_mov_b32 v243, v147
    v_perm_b32 v132, v82, v80, s72
    v_perm_b32 v133, v86, v84, s72
    v_perm_b32 v134, v90, v88, s72
    v_perm_b32 v135, v94, v92, s72
    ds_write_b128 v19, v[132:135] offset:3072
    v_perm_b32 v136, v82, v80, s73
    v_perm_b32 v137, v86, v84, s73
    v_perm_b32 v138, v90, v88, s73
    v_perm_b32 v139, v94, v92, s73
    ds_write_b128 v19, v[136:139] offset:4096
    v_perm_b32 v140, v83, v81, s72
    v_perm_b32 v141, v87, v85, s72
    v_perm_b32 v142, v91, v89, s72
    v_perm_b32 v143, v95, v93, s72
    ds_write_b128 v19, v[140:143] offset:5120
    v_perm_b32 v144, v83, v81, s73
    v_perm_b32 v145, v87, v85, s73
    v_perm_b32 v146, v91, v89, s73
    v_perm_b32 v147, v95, v93, s73
    ds_write_b128 v19, v[144:147] offset:6144
    s_waitcnt lgkmcnt(0)
    s_waitcnt vmcnt(0)
    v_perm_b32 v132, v98, v96, s72
    v_perm_b32 v133, v102, v100, s72
    v_perm_b32 v134, v106, v104, s72
    v_perm_b32 v135, v110, v108, s72
    ds_write_b128 v19, v[132:135] offset:13312
    v_perm_b32 v136, v98, v96, s73
    v_perm_b32 v137, v102, v100, s73
    v_perm_b32 v138, v106, v104, s73
    v_perm_b32 v139, v110, v108, s73
    ds_write_b128 v19, v[136:139] offset:14336
    v_perm_b32 v140, v99, v97, s72
    v_perm_b32 v141, v103, v101, s72
    v_perm_b32 v142, v107, v105, s72
    v_perm_b32 v143, v111, v109, s72
    ds_write_b128 v19, v[140:143] offset:15360
    v_perm_b32 v144, v99, v97, s73
    v_perm_b32 v145, v103, v101, s73
    v_perm_b32 v146, v107, v105, s73
    v_perm_b32 v147, v111, v109, s73
    ds_write_b128 v19, v[144:147] offset:16384
    v_perm_b32 v132, v114, v112, s72
    v_perm_b32 v133, v118, v116, s72
    v_perm_b32 v134, v122, v120, s72
    v_perm_b32 v135, v126, v124, s72
    ds_write_b128 v19, v[132:135] offset:23552
    v_perm_b32 v136, v114, v112, s73
    v_perm_b32 v137, v118, v116, s73
    v_perm_b32 v138, v122, v120, s73
    v_perm_b32 v139, v126, v124, s73
    ds_write_b128 v19, v[136:139] offset:24576
    v_perm_b32 v140, v115, v113, s72
    v_perm_b32 v141, v119, v117, s72
    v_perm_b32 v142, v123, v121, s72
    v_perm_b32 v143, v127, v125, s72
    ds_write_b128 v19, v[140:143] offset:25600
    v_perm_b32 v144, v115, v113, s73
    v_perm_b32 v145, v119, v117, s73
    v_perm_b32 v146, v123, v121, s73
    v_perm_b32 v147, v127, v125, s73
    ds_write_b128 v19, v[144:147] offset:26624
    s_waitcnt lgkmcnt(0)
    s_add_u32 s71, s22, 0
    buffer_load_dwordx2 v[32:33], v6, s[96:99], s71 offen
    s_add_u32 s71, s22, 1280
    buffer_load_dwordx2 v[34:35], v6, s[96:99], s71 offen
    s_add_u32 s71, s22, 2560
    buffer_load_dwordx2 v[36:37], v6, s[96:99], s71 offen
    s_add_u32 s71, s22, 3840
    buffer_load_dwordx2 v[38:39], v6, s[96:99], s71 offen
    s_add_u32 s71, s22, 5120
    buffer_load_dwordx2 v[40:41], v6, s[96:99], s71 offen
    s_add_u32 s71, s22, 6400
    buffer_load_dwordx2 v[42:43], v6, s[96:99], s71 offen
    s_add_u32 s71, s22, 7680
    buffer_load_dwordx2 v[44:45], v6, s[96:99], s71 offen
    s_add_u32 s71, s22, 8960
    buffer_load_dwordx2 v[46:47], v6, s[96:99], s71 offen
    s_add_u32 s71, s22, 40960
    buffer_load_dwordx2 v[48:49], v6, s[96:99], s71 offen
    s_add_u32 s71, s22, 42240
    buffer_load_dwordx2 v[50:51], v6, s[96:99], s71 offen
    s_add_u32 s71, s22, 43520
    buffer_load_dwordx2 v[52:53], v6, s[96:99], s71 offen
    s_add_u32 s71, s22, 44800
    buffer_load_dwordx2 v[54:55], v6, s[96:99], s71 offen
    s_add_u32 s71, s22, 46080
    buffer_load_dwordx2 v[56:57], v6, s[96:99], s71 offen
    s_add_u32 s71, s22, 47360
    buffer_load_dwordx2 v[58:59], v6, s[96:99], s71 offen
    s_add_u32 s71, s22, 48640
    buffer_load_dwordx2 v[60:61], v6, s[96:99], s71 offen
    s_add_u32 s71, s22, 49920
    buffer_load_dwordx2 v[62:63], v6, s[96:99], s71 offen
    s_add_u32 s71, s22, 81920
    buffer_load_dwordx2 v[64:65], v6, s[96:99], s71 offen
    s_add_u32 s71, s22, 83200
    buffer_load_dwordx2 v[66:67], v6, s[96:99], s71 offen
    s_add_u32 s71, s22, 84480
    buffer_load_dwordx2 v[68:69], v6, s[96:99], s71 offen
    s_add_u32 s71, s22, 85760
    buffer_load_dwordx2 v[70:71], v6, s[96:99], s71 offen
    s_add_u32 s71, s22, 87040
    buffer_load_dwordx2 v[72:73], v6, s[96:99], s71 offen
    s_add_u32 s71, s22, 88320
    buffer_load_dwordx2 v[74:75], v6, s[96:99], s71 offen
    s_add_u32 s71, s22, 89600
    buffer_load_dwordx2 v[76:77], v6, s[96:99], s71 offen
    s_add_u32 s71, s22, 90880
    buffer_load_dwordx2 v[78:79], v6, s[96:99], s71 offen
    s_add_u32 s71, s22, 122880
    buffer_load_dwordx2 v[80:81], v6, s[96:99], s71 offen
    s_add_u32 s71, s22, 124160
    buffer_load_dwordx2 v[82:83], v6, s[96:99], s71 offen
    s_add_u32 s71, s22, 125440
    buffer_load_dwordx2 v[84:85], v6, s[96:99], s71 offen
    s_add_u32 s71, s22, 126720
    buffer_load_dwordx2 v[86:87], v6, s[96:99], s71 offen
    s_add_u32 s71, s22, 128000
    buffer_load_dwordx2 v[88:89], v6, s[96:99], s71 offen
    s_add_u32 s71, s22, 129280
    buffer_load_dwordx2 v[90:91], v6, s[96:99], s71 offen
    s_add_u32 s71, s22, 130560
    buffer_load_dwordx2 v[92:93], v6, s[96:99], s71 offen
    s_add_u32 s71, s22, 131840
    buffer_load_dwordx2 v[94:95], v6, s[96:99], s71 offen
    s_add_u32 s71, s22, 163840
    buffer_load_dwordx2 v[96:97], v6, s[96:99], s71 offen
    s_add_u32 s71, s22, 165120
    buffer_load_dwordx2 v[98:99], v6, s[96:99], s71 offen
    s_add_u32 s71, s22, 166400
    buffer_load_dwordx2 v[100:101], v6, s[96:99], s71 offen
    s_add_u32 s71, s22, 167680
    buffer_load_dwordx2 v[102:103], v6, s[96:99], s71 offen
    s_add_u32 s71, s22, 168960
    buffer_load_dwordx2 v[104:105], v6, s[96:99], s71 offen
    s_add_u32 s71, s22, 170240
    buffer_load_dwordx2 v[106:107], v6, s[96:99], s71 offen
    s_add_u32 s71, s22, 171520
    buffer_load_dwordx2 v[108:109], v6, s[96:99], s71 offen
    s_add_u32 s71, s22, 172800
    buffer_load_dwordx2 v[110:111], v6, s[96:99], s71 offen
    s_add_u32 s71, s22, 204800
    buffer_load_dwordx2 v[112:113], v6, s[96:99], s71 offen
    s_add_u32 s71, s22, 206080
    buffer_load_dwordx2 v[114:115], v6, s[96:99], s71 offen
    s_add_u32 s71, s22, 207360
    buffer_load_dwordx2 v[116:117], v6, s[96:99], s71 offen
    s_add_u32 s71, s22, 208640
    buffer_load_dwordx2 v[118:119], v6, s[96:99], s71 offen
    s_add_u32 s71, s22, 209920
    buffer_load_dwordx2 v[120:121], v6, s[96:99], s71 offen
    s_add_u32 s71, s22, 211200
    buffer_load_dwordx2 v[122:123], v6, s[96:99], s71 offen
    s_add_u32 s71, s22, 212480
    buffer_load_dwordx2 v[124:125], v6, s[96:99], s71 offen
    s_add_u32 s71, s22, 213760
    buffer_load_dwordx2 v[126:127], v6, s[96:99], s71 offen
    s_waitcnt vmcnt(32)
    v_perm_b32 v132, v34, v32, s72
    v_perm_b32 v133, v38, v36, s72
    v_perm_b32 v134, v42, v40, s72
    v_perm_b32 v135, v46, v44, s72
    v_mov_b32 v164, v132
    v_mov_b32 v165, v133
    v_mov_b32 v166, v134
    v_mov_b32 v167, v135
    v_perm_b32 v136, v34, v32, s73
    v_perm_b32 v137, v38, v36, s73
    v_perm_b32 v138, v42, v40, s73
    v_perm_b32 v139, v46, v44, s73
    v_mov_b32 v168, v136
    v_mov_b32 v169, v137
    v_mov_b32 v170, v138
    v_mov_b32 v171, v139
    v_perm_b32 v140, v35, v33, s72
    v_perm_b32 v141, v39, v37, s72
    v_perm_b32 v142, v43, v41, s72
    v_perm_b32 v143, v47, v45, s72
    v_mov_b32 v172, v140
    v_mov_b32 v173, v141
    v_mov_b32 v174, v142
    v_mov_b32 v175, v143
    v_perm_b32 v144, v35, v33, s73
    v_perm_b32 v145, v39, v37, s73
    v_perm_b32 v146, v43, v41, s73
    v_perm_b32 v147, v47, v45, s73
    v_mov_b32 v176, v144
    v_mov_b32 v177, v145
    v_mov_b32 v178, v146
    v_mov_b32 v179, v147
    v_perm_b32 v132, v50, v48, s72
    v_perm_b32 v133, v54, v52, s72
    v_perm_b32 v134, v58, v56, s72
    v_perm_b32 v135, v62, v60, s72
    v_mov_b32 v204, v132
    v_mov_b32 v205, v133
    v_mov_b32 v206, v134
    v_mov_b32 v207, v135
    v_perm_b32 v136, v50, v48, s73
    v_perm_b32 v137, v54, v52, s73
    v_perm_b32 v138, v58, v56, s73
    v_perm_b32 v139, v62, v60, s73
    v_mov_b32 v208, v136
    v_mov_b32 v209, v137
    v_mov_b32 v210, v138
    v_mov_b32 v211, v139
    v_perm_b32 v140, v51, v49, s72
    v_perm_b32 v141, v55, v53, s72
    v_perm_b32 v142, v59, v57, s72
    v_perm_b32 v143, v63, v61, s72
    v_mov_b32 v212, v140
    v_mov_b32 v213, v141
    v_mov_b32 v214, v142
    v_mov_b32 v215, v143
    v_perm_b32 v144, v51, v49, s73
    v_perm_b32 v145, v55, v53, s73
    v_perm_b32 v146, v59, v57, s73
    v_perm_b32 v147, v63, v61, s73
    v_mov_b32 v216, v144
    v_mov_b32 v217, v145
    v_mov_b32 v218, v146
    v_mov_b32 v219, v147
    s_waitcnt lgkmcnt(0)
    s_waitcnt vmcnt(16)
    v_perm_b32 v132, v66, v64, s72
    v_perm_b32 v133, v70, v68, s72
    v_perm_b32 v134, v74, v72, s72
    v_perm_b32 v135, v78, v76, s72
    v_mov_b32 v244, v132
    v_mov_b32 v245, v133
    v_mov_b32 v246, v134
    v_mov_b32 v247, v135
    v_perm_b32 v136, v66, v64, s73
    v_perm_b32 v137, v70, v68, s73
    v_perm_b32 v138, v74, v72, s73
    v_perm_b32 v139, v78, v76, s73
    v_mov_b32 v248, v136
    v_mov_b32 v249, v137
    v_mov_b32 v250, v138
    v_mov_b32 v251, v139
    v_perm_b32 v140, v67, v65, s72
    v_perm_b32 v141, v71, v69, s72
    v_perm_b32 v142, v75, v73, s72
    v_perm_b32 v143, v79, v77, s72
    v_mov_b32 v252, v140
    v_mov_b32 v253, v141
    v_mov_b32 v254, v142
    v_mov_b32 v255, v143
    v_perm_b32 v144, v67, v65, s73
    v_perm_b32 v145, v71, v69, s73
    v_perm_b32 v146, v75, v73, s73
    v_perm_b32 v147, v79, v77, s73
    ds_write_b128 v19, v[144:147] offset:0
    v_perm_b32 v132, v82, v80, s72
    v_perm_b32 v133, v86, v84, s72
    v_perm_b32 v134, v90, v88, s72
    v_perm_b32 v135, v94, v92, s72
    ds_write_b128 v19, v[132:135] offset:7168
    v_perm_b32 v136, v82, v80, s73
    v_perm_b32 v137, v86, v84, s73
    v_perm_b32 v138, v90, v88, s73
    v_perm_b32 v139, v94, v92, s73
    ds_write_b128 v19, v[136:139] offset:8192
    v_perm_b32 v140, v83, v81, s72
    v_perm_b32 v141, v87, v85, s72
    v_perm_b32 v142, v91, v89, s72
    v_perm_b32 v143, v95, v93, s72
    ds_write_b128 v19, v[140:143] offset:9216
    v_perm_b32 v144, v83, v81, s73
    v_perm_b32 v145, v87, v85, s73
    v_perm_b32 v146, v91, v89, s73
    v_perm_b32 v147, v95, v93, s73
    ds_write_b128 v19, v[144:147] offset:10240
    s_waitcnt lgkmcnt(0)
    s_waitcnt vmcnt(0)
    v_perm_b32 v132, v98, v96, s72
    v_perm_b32 v133, v102, v100, s72
    v_perm_b32 v134, v106, v104, s72
    v_perm_b32 v135, v110, v108, s72
    ds_write_b128 v19, v[132:135] offset:17408
    v_perm_b32 v136, v98, v96, s73
    v_perm_b32 v137, v102, v100, s73
    v_perm_b32 v138, v106, v104, s73
    v_perm_b32 v139, v110, v108, s73
    ds_write_b128 v19, v[136:139] offset:18432
    v_perm_b32 v140, v99, v97, s72
    v_perm_b32 v141, v103, v101, s72
    v_perm_b32 v142, v107, v105, s72
    v_perm_b32 v143, v111, v109, s72
    ds_write_b128 v19, v[140:143] offset:19456
    v_perm_b32 v144, v99, v97, s73
    v_perm_b32 v145, v103, v101, s73
    v_perm_b32 v146, v107, v105, s73
    v_perm_b32 v147, v111, v109, s73
    ds_write_b128 v19, v[144:147] offset:20480
    v_perm_b32 v132, v114, v112, s72
    v_perm_b32 v133, v118, v116, s72
    v_perm_b32 v134, v122, v120, s72
    v_perm_b32 v135, v126, v124, s72
    ds_write_b128 v19, v[132:135] offset:27648
    v_perm_b32 v136, v114, v112, s73
    v_perm_b32 v137, v118, v116, s73
    v_perm_b32 v138, v122, v120, s73
    v_perm_b32 v139, v126, v124, s73
    ds_write_b128 v19, v[136:139] offset:28672
    v_perm_b32 v140, v115, v113, s72
    v_perm_b32 v141, v119, v117, s72
    v_perm_b32 v142, v123, v121, s72
    v_perm_b32 v143, v127, v125, s72
    ds_write_b128 v19, v[140:143] offset:29696
    v_perm_b32 v144, v115, v113, s73
    v_perm_b32 v145, v119, v117, s73
    v_perm_b32 v146, v123, v121, s73
    v_perm_b32 v147, v127, v125, s73
    ds_write_b128 v19, v[144:147] offset:30720
    s_waitcnt lgkmcnt(0)
    s_add_u32 s71, s23, 0
    buffer_load_dword v32, v7, s[96:99], s71 offen
    s_add_u32 s71, s23, 1280
    buffer_load_dword v33, v7, s[96:99], s71 offen
    s_add_u32 s71, s23, 2560
    buffer_load_dword v34, v7, s[96:99], s71 offen
    s_add_u32 s71, s23, 3840
    buffer_load_dword v35, v7, s[96:99], s71 offen
    s_add_u32 s71, s23, 5120
    buffer_load_dword v36, v7, s[96:99], s71 offen
    s_add_u32 s71, s23, 6400
    buffer_load_dword v37, v7, s[96:99], s71 offen
    s_add_u32 s71, s23, 7680
    buffer_load_dword v38, v7, s[96:99], s71 offen
    s_add_u32 s71, s23, 8960
    buffer_load_dword v39, v7, s[96:99], s71 offen
    s_add_u32 s71, s23, 40960
    buffer_load_dword v40, v7, s[96:99], s71 offen
    s_add_u32 s71, s23, 42240
    buffer_load_dword v41, v7, s[96:99], s71 offen
    s_add_u32 s71, s23, 43520
    buffer_load_dword v42, v7, s[96:99], s71 offen
    s_add_u32 s71, s23, 44800
    buffer_load_dword v43, v7, s[96:99], s71 offen
    s_add_u32 s71, s23, 46080
    buffer_load_dword v44, v7, s[96:99], s71 offen
    s_add_u32 s71, s23, 47360
    buffer_load_dword v45, v7, s[96:99], s71 offen
    s_add_u32 s71, s23, 48640
    buffer_load_dword v46, v7, s[96:99], s71 offen
    s_add_u32 s71, s23, 49920
    buffer_load_dword v47, v7, s[96:99], s71 offen
    s_add_u32 s71, s23, 81920
    buffer_load_dword v48, v7, s[96:99], s71 offen
    s_add_u32 s71, s23, 83200
    buffer_load_dword v49, v7, s[96:99], s71 offen
    s_add_u32 s71, s23, 84480
    buffer_load_dword v50, v7, s[96:99], s71 offen
    s_add_u32 s71, s23, 85760
    buffer_load_dword v51, v7, s[96:99], s71 offen
    s_add_u32 s71, s23, 87040
    buffer_load_dword v52, v7, s[96:99], s71 offen
    s_add_u32 s71, s23, 88320
    buffer_load_dword v53, v7, s[96:99], s71 offen
    s_add_u32 s71, s23, 89600
    buffer_load_dword v54, v7, s[96:99], s71 offen
    s_add_u32 s71, s23, 90880
    buffer_load_dword v55, v7, s[96:99], s71 offen
    s_add_u32 s71, s23, 122880
    buffer_load_dword v56, v7, s[96:99], s71 offen
    s_add_u32 s71, s23, 124160
    buffer_load_dword v57, v7, s[96:99], s71 offen
    s_add_u32 s71, s23, 125440
    buffer_load_dword v58, v7, s[96:99], s71 offen
    s_add_u32 s71, s23, 126720
    buffer_load_dword v59, v7, s[96:99], s71 offen
    s_add_u32 s71, s23, 128000
    buffer_load_dword v60, v7, s[96:99], s71 offen
    s_add_u32 s71, s23, 129280
    buffer_load_dword v61, v7, s[96:99], s71 offen
    s_add_u32 s71, s23, 130560
    buffer_load_dword v62, v7, s[96:99], s71 offen
    s_add_u32 s71, s23, 131840
    buffer_load_dword v63, v7, s[96:99], s71 offen
    s_add_u32 s71, s23, 163840
    buffer_load_dword v64, v7, s[96:99], s71 offen
    s_add_u32 s71, s23, 165120
    buffer_load_dword v65, v7, s[96:99], s71 offen
    s_add_u32 s71, s23, 166400
    buffer_load_dword v66, v7, s[96:99], s71 offen
    s_add_u32 s71, s23, 167680
    buffer_load_dword v67, v7, s[96:99], s71 offen
    s_add_u32 s71, s23, 168960
    buffer_load_dword v68, v7, s[96:99], s71 offen
    s_add_u32 s71, s23, 170240
    buffer_load_dword v69, v7, s[96:99], s71 offen
    s_add_u32 s71, s23, 171520
    buffer_load_dword v70, v7, s[96:99], s71 offen
    s_add_u32 s71, s23, 172800
    buffer_load_dword v71, v7, s[96:99], s71 offen
    s_add_u32 s71, s23, 204800
    buffer_load_dword v72, v7, s[96:99], s71 offen
    s_add_u32 s71, s23, 206080
    buffer_load_dword v73, v7, s[96:99], s71 offen
    s_add_u32 s71, s23, 207360
    buffer_load_dword v74, v7, s[96:99], s71 offen
    s_add_u32 s71, s23, 208640
    buffer_load_dword v75, v7, s[96:99], s71 offen
    s_add_u32 s71, s23, 209920
    buffer_load_dword v76, v7, s[96:99], s71 offen
    s_add_u32 s71, s23, 211200
    buffer_load_dword v77, v7, s[96:99], s71 offen
    s_add_u32 s71, s23, 212480
    buffer_load_dword v78, v7, s[96:99], s71 offen
    s_add_u32 s71, s23, 213760
    buffer_load_dword v79, v7, s[96:99], s71 offen
    s_waitcnt vmcnt(16)
    v_perm_b32 v132, v33, v32, s72
    v_perm_b32 v133, v35, v34, s72
    v_perm_b32 v134, v37, v36, s72
    v_perm_b32 v135, v39, v38, s72
    v_mov_b32 v180, v132
    v_mov_b32 v181, v133
    v_mov_b32 v182, v134
    v_mov_b32 v183, v135
    v_perm_b32 v136, v33, v32, s73
    v_perm_b32 v137, v35, v34, s73
    v_perm_b32 v138, v37, v36, s73
    v_perm_b32 v139, v39, v38, s73
    v_mov_b32 v184, v136
    v_mov_b32 v185, v137
    v_mov_b32 v186, v138
    v_mov_b32 v187, v139
    v_perm_b32 v140, v41, v40, s72
    v_perm_b32 v141, v43, v42, s72
    v_perm_b32 v142, v45, v44, s72
    v_perm_b32 v143, v47, v46, s72
    v_mov_b32 v220, v140
    v_mov_b32 v221, v141
    v_mov_b32 v222, v142
    v_mov_b32 v223, v143
    v_perm_b32 v144, v41, v40, s73
    v_perm_b32 v145, v43, v42, s73
    v_perm_b32 v146, v45, v44, s73
    v_perm_b32 v147, v47, v46, s73
    v_mov_b32 v224, v144
    v_mov_b32 v225, v145
    v_mov_b32 v226, v146
    v_mov_b32 v227, v147
    v_perm_b32 v132, v49, v48, s72
    v_perm_b32 v133, v51, v50, s72
    v_perm_b32 v134, v53, v52, s72
    v_perm_b32 v135, v55, v54, s72
    ds_write_b128 v19, v[132:135] offset:1024
    v_perm_b32 v136, v49, v48, s73
    v_perm_b32 v137, v51, v50, s73
    v_perm_b32 v138, v53, v52, s73
    v_perm_b32 v139, v55, v54, s73
    ds_write_b128 v19, v[136:139] offset:2048
    v_perm_b32 v140, v57, v56, s72
    v_perm_b32 v141, v59, v58, s72
    v_perm_b32 v142, v61, v60, s72
    v_perm_b32 v143, v63, v62, s72
    ds_write_b128 v19, v[140:143] offset:11264
    v_perm_b32 v144, v57, v56, s73
    v_perm_b32 v145, v59, v58, s73
    v_perm_b32 v146, v61, v60, s73
    v_perm_b32 v147, v63, v62, s73
    ds_write_b128 v19, v[144:147] offset:12288
    s_waitcnt lgkmcnt(0)
    s_waitcnt vmcnt(0)
    v_perm_b32 v132, v65, v64, s72
    v_perm_b32 v133, v67, v66, s72
    v_perm_b32 v134, v69, v68, s72
    v_perm_b32 v135, v71, v70, s72
    ds_write_b128 v19, v[132:135] offset:21504
    v_perm_b32 v136, v65, v64, s73
    v_perm_b32 v137, v67, v66, s73
    v_perm_b32 v138, v69, v68, s73
    v_perm_b32 v139, v71, v70, s73
    ds_write_b128 v19, v[136:139] offset:22528
    v_perm_b32 v140, v73, v72, s72
    v_perm_b32 v141, v75, v74, s72
    v_perm_b32 v142, v77, v76, s72
    v_perm_b32 v143, v79, v78, s72
    ds_write_b128 v19, v[140:143] offset:31744
    v_perm_b32 v144, v73, v72, s73
    v_perm_b32 v145, v75, v74, s73
    v_perm_b32 v146, v77, v76, s73
    v_perm_b32 v147, v79, v78, s73
    ds_write_b128 v19, v[144:147] offset:32768
    s_waitcnt lgkmcnt(0)
    v_lshl_add_u32 v21, v4, 4, v17
    v_add_u32 v22, s40, v21
    v_add_u32 v23, s41, v21
    v_add_u32 v24, s42, v21
    v_lshlrev_b32 v25, 6, v3
    v_lshl_add_u32 v25, v4, 5, v25
    v_lshlrev_b32 v26, 5, v3
    v_lshl_add_u32 v26, v4, 4, v26
    s_mul_i32 s24, s20, 640
    s_add_u32 s24, s24, s27
    s_lshl_b32 s24, s24, 4
    s_add_u32 s45, s24, 188235776
    s_add_u32 s24, s24, 167264256
    v_mov_b32 v149, 192
    s_mov_b32 s69, 0
mega_kernel_cw40:
    buffer_load_dword v148, v149, s[88:91], 0 offen sc1
    s_add_u32 s69, s69, 1
    s_cmp_ge_u32 s69, 1048576
    s_cbranch_scc1 mega_kernel_cwo41
    s_waitcnt vmcnt(0)
    v_cmp_gt_u32 vcc, 256, v148
    s_cbranch_vccz mega_kernel_cwo41
    s_sleep 8
    s_branch mega_kernel_cw40
mega_kernel_cwo41:
    s_barrier
mega_kernel_Bloop42:
    s_mov_b32 s31, 0
mega_kernel_pm43:
    buffer_load_dwordx4 v[136:139], v10, s[60:63], s30 offen sc1
    buffer_load_dwordx4 v[140:143], v11, s[60:63], s30 offen sc1
    buffer_load_dwordx4 v[144:147], v12, s[60:63], s30 offen sc1
    s_waitcnt vmcnt(0)
    v_max3_u32 v148, v136, v137, v138
    v_max3_u32 v149, v139, v140, v141
    v_max3_u32 v150, v142, v143, v144
    v_max3_u32 v151, v145, v146, v147
    v_max3_u32 v148, v148, v149, v150
    v_max_u32 v148, v148, v151
    v_cmp_eq_u32 vcc, -1, v148
    s_cbranch_vccz mega_kernel_pmok44
    s_add_u32 s31, s31, 1
    s_cmp_lt_u32 s31, 65536
    s_cbranch_scc1 mega_kernel_pm43
mega_kernel_pmok44:
    ds_write_b128 v13, v[136:139]
    ds_write_b128 v14, v[140:143]
    ds_write_b128 v15, v[144:147]
    s_waitcnt lgkmcnt(0)
    s_barrier
    s_cmp_eq_u32 s29, s29
    s_cbranch_scc1 mega_kernel_nreset47
    s_add_u32 s3, s29, 1
    s_and_b32 s3, s3, 1
    s_mul_i32 s3, s3, 327680
    s_add_u32 s46, s45, s3
    v_mov_b32 v152, -1
    v_mov_b32 v153, -1
    v_mov_b32 v154, -1
    v_mov_b32 v155, -1
    s_mov_b32 exec_lo, -1
    s_mov_b32 exec_hi, 0
    buffer_store_dwordx4 v[152:155], v25, s[60:63], s46 offen offset:0 sc1
    buffer_store_dwordx4 v[152:155], v25, s[60:63], s46 offen offset:16 sc1
    buffer_store_dwordx4 v[152:155], v25, s[60:63], s46 offen offset:1024 sc1
    buffer_store_dwordx4 v[152:155], v25, s[60:63], s46 offen offset:1040 sc1
    buffer_store_dwordx4 v[152:155], v26, s[60:63], s46 offen offset:2048 sc1
    s_mov_b64 exec, -1
mega_kernel_nreset47:
    ds_read_b128 v[56:59], v16 offset:0
    ds_read_b128 v[60:63], v16 offset:64
    ds_read_b128 v[64:67], v16 offset:128
    s_waitcnt lgkmcnt(2)
    v_mfma_f32_16x16x32_bf16 v[32:35], a[0:3], v[56:59], 0
    v_mfma_f32_16x16x32_bf16 v[36:39], a[4:7], v[56:59], 0
    v_mfma_f32_16x16x32_bf16 v[40:43], a[8:11], v[56:59], 0
    ds_read_b128 v[68:71], v16 offset:192
    s_waitcnt lgkmcnt(2)
    v_mfma_f32_16x16x32_bf16 v[32:35], a[12:15], v[60:63], v[32:35]
    v_mfma_f32_16x16x32_bf16 v[36:39], a[16:19], v[60:63], v[36:39]
    v_mfma_f32_16x16x32_bf16 v[40:43], a[20:23], v[60:63], v[40:43]
    ds_read_b128 v[56:59], v16 offset:256
    s_waitcnt lgkmcnt(2)
    v_mfma_f32_16x16x32_bf16 v[32:35], a[24:27], v[64:67], v[32:35]
    v_mfma_f32_16x16x32_bf16 v[36:39], a[28:31], v[64:67], v[36:39]
    v_mfma_f32_16x16x32_bf16 v[40:43], a[32:35], v[64:67], v[40:43]
    ds_read_b128 v[60:63], v16 offset:320
    s_waitcnt lgkmcnt(2)
    v_mfma_f32_16x16x32_bf16 v[32:35], a[36:39], v[68:71], v[32:35]
    v_mfma_f32_16x16x32_bf16 v[36:39], a[40:43], v[68:71], v[36:39]
    v_mfma_f32_16x16x32_bf16 v[40:43], a[44:47], v[68:71], v[40:43]
    ds_read_b128 v[64:67], v16 offset:384
    s_waitcnt lgkmcnt(2)
    v_mfma_f32_16x16x32_bf16 v[32:35], a[48:51], v[56:59], v[32:35]
    v_mfma_f32_16x16x32_bf16 v[36:39], a[52:55], v[56:59], v[36:39]
    v_mfma_f32_16x16x32_bf16 v[40:43], a[56:59], v[56:59], v[40:43]
    ds_read_b128 v[68:71], v16 offset:448
    s_waitcnt lgkmcnt(2)
    v_mfma_f32_16x16x32_bf16 v[32:35], a[60:63], v[60:63], v[32:35]
    v_mfma_f32_16x16x32_bf16 v[36:39], a[64:67], v[60:63], v[36:39]
    v_mfma_f32_16x16x32_bf16 v[40:43], a[68:71], v[60:63], v[40:43]
    ds_read_b128 v[56:59], v16 offset:512
    s_waitcnt lgkmcnt(2)
    v_mfma_f32_16x16x32_bf16 v[32:35], a[72:75], v[64:67], v[32:35]
    v_mfma_f32_16x16x32_bf16 v[36:39], a[76:79], v[64:67], v[36:39]
    v_mfma_f32_16x16x32_bf16 v[40:43], a[80:83], v[64:67], v[40:43]
    ds_read_b128 v[60:63], v16 offset:576
    s_waitcnt lgkmcnt(2)
    v_mfma_f32_16x16x32_bf16 v[32:35], a[84:87], v[68:71], v[32:35]
    v_mfma_f32_16x16x32_bf16 v[36:39], a[88:91], v[68:71], v[36:39]
    v_mfma_f32_16x16x32_bf16 v[40:43], a[92:95], v[68:71], v[40:43]
    ds_read_b128 v[64:67], v16 offset:640
    s_waitcnt lgkmcnt(2)
    v_mfma_f32_16x16x32_bf16 v[32:35], a[96:99], v[56:59], v[32:35]
    v_mfma_f32_16x16x32_bf16 v[36:39], a[100:103], v[56:59], v[36:39]
    v_mfma_f32_16x16x32_bf16 v[40:43], a[104:107], v[56:59], v[40:43]
    ds_read_b128 v[68:71], v16 offset:704
    s_waitcnt lgkmcnt(2)
    v_mfma_f32_16x16x32_bf16 v[32:35], a[108:111], v[60:63], v[32:35]
    v_mfma_f32_16x16x32_bf16 v[36:39], a[112:115], v[60:63], v[36:39]
    v_mfma_f32_16x16x32_bf16 v[40:43], a[116:119], v[60:63], v[40:43]
    ds_read_b128 v[56:59], v16 offset:768
    s_waitcnt lgkmcnt(2)
    v_mfma_f32_16x16x32_bf16 v[32:35], a[120:123], v[64:67], v[32:35]
    v_mfma_f32_16x16x32_bf16 v[36:39], a[124:127], v[64:67], v[36:39]
    v_mfma_f32_16x16x32_bf16 v[40:43], a[128:131], v[64:67], v[40:43]
    ds_read_b128 v[60:63], v16 offset:832
    s_waitcnt lgkmcnt(2)
    v_mfma_f32_16x16x32_bf16 v[32:35], a[132:135], v[68:71], v[32:35]
    v_mfma_f32_16x16x32_bf16 v[36:39], a[136:139], v[68:71], v[36:39]
    v_mfma_f32_16x16x32_bf16 v[40:43], a[140:143], v[68:71], v[40:43]
    ds_read_b128 v[64:67], v16 offset:896
    s_waitcnt lgkmcnt(2)
    v_mfma_f32_16x16x32_bf16 v[32:35], a[144:147], v[56:59], v[32:35]
    v_mfma_f32_16x16x32_bf16 v[36:39], a[148:151], v[56:59], v[36:39]
    v_mfma_f32_16x16x32_bf16 v[40:43], a[152:155], v[56:59], v[40:43]
    ds_read_b128 v[68:71], v16 offset:960
    s_waitcnt lgkmcnt(2)
    v_mfma_f32_16x16x32_bf16 v[32:35], a[156:159], v[60:63], v[32:35]
    v_mfma_f32_16x16x32_bf16 v[36:39], a[160:163], v[60:63], v[36:39]
    v_mfma_f32_16x16x32_bf16 v[40:43], a[164:167], v[60:63], v[40:43]
    ds_read_b128 v[56:59], v16 offset:1024
    s_waitcnt lgkmcnt(2)
    v_mfma_f32_16x16x32_bf16 v[32:35], a[168:171], v[64:67], v[32:35]
    v_mfma_f32_16x16x32_bf16 v[36:39], a[172:175], v[64:67], v[36:39]
    v_mfma_f32_16x16x32_bf16 v[40:43], a[176:179], v[64:67], v[40:43]
    ds_read_b128 v[60:63], v16 offset:1088
    s_waitcnt lgkmcnt(2)
    v_mfma_f32_16x16x32_bf16 v[32:35], a[180:183], v[68:71], v[32:35]
    v_mfma_f32_16x16x32_bf16 v[36:39], a[184:187], v[68:71], v[36:39]
    v_mfma_f32_16x16x32_bf16 v[40:43], a[188:191], v[68:71], v[40:43]
    ds_read_b128 v[64:67], v16 offset:1152
    s_waitcnt lgkmcnt(2)
    v_mfma_f32_16x16x32_bf16 v[32:35], a[192:195], v[56:59], v[32:35]
    v_mfma_f32_16x16x32_bf16 v[36:39], a[196:199], v[56:59], v[36:39]
    v_mfma_f32_16x16x32_bf16 v[40:43], a[200:203], v[56:59], v[40:43]
    ds_read_b128 v[68:71], v16 offset:1216
    s_waitcnt lgkmcnt(2)
    v_mfma_f32_16x16x32_bf16 v[32:35], a[204:207], v[60:63], v[32:35]
    v_mfma_f32_16x16x32_bf16 v[36:39], a[208:211], v[60:63], v[36:39]
    v_mfma_f32_16x16x32_bf16 v[40:43], a[212:215], v[60:63], v[40:43]
    s_waitcnt lgkmcnt(1)
    v_mfma_f32_16x16x32_bf16 v[32:35], a[216:219], v[64:67], v[32:35]
    v_mfma_f32_16x16x32_bf16 v[36:39], a[220:223], v[64:67], v[36:39]
    v_mfma_f32_16x16x32_bf16 v[40:43], a[224:227], v[64:67], v[40:43]
    s_waitcnt lgkmcnt(0)
    v_mfma_f32_16x16x32_bf16 v[32:35], a[228:231], v[68:71], v[32:35]
    v_mfma_f32_16x16x32_bf16 v[36:39], a[232:235], v[68:71], v[36:39]
    v_mfma_f32_16x16x32_bf16 v[40:43], a[236:239], v[68:71], v[40:43]
    s_nop 7
    v_cvt_pk_bf16_f32 v148, v32, v32
    v_cvt_pk_bf16_f32 v149, v33, v33
    v_cvt_pk_bf16_f32 v150, v34, v34
    v_cvt_pk_bf16_f32 v151, v35, v35
    ds_write_b16 v22, v148 offset:0
    ds_write_b16 v22, v149 offset:4
    ds_write_b16 v22, v150 offset:8
    ds_write_b16 v22, v151 offset:12
    v_cvt_pk_bf16_f32 v148, v36, v36
    v_cvt_pk_bf16_f32 v149, v37, v37
    v_cvt_pk_bf16_f32 v150, v38, v38
    v_cvt_pk_bf16_f32 v151, v39, v39
    ds_write_b16 v23, v148 offset:0
    ds_write_b16 v23, v149 offset:4
    ds_write_b16 v23, v150 offset:8
    ds_write_b16 v23, v151 offset:12
    v_cvt_pk_bf16_f32 v148, v40, v40
    v_cvt_pk_bf16_f32 v149, v41, v41
    v_cvt_pk_bf16_f32 v150, v42, v42
    v_cvt_pk_bf16_f32 v151, v43, v43
    ds_write_b16 v24, v148 offset:0
    ds_write_b16 v24, v149 offset:4
    ds_write_b16 v24, v150 offset:8
    ds_write_b16 v24, v151 offset:12
    s_waitcnt lgkmcnt(0)
    s_barrier
    ds_read_b128 v[88:91], v21 offset:0
    ds_read_b128 v[92:95], v21 offset:64
    ds_read_b128 v[96:99], v21 offset:128
    ds_read_b128 v[100:103], v21 offset:192
    ds_read_b128 v[104:107], v21 offset:256
    ds_read_b128 v[108:111], v21 offset:320
    s_waitcnt lgkmcnt(0)
    ds_read_b128 v[72:75], v18 offset:0
    ds_read_b128 v[76:79], v18 offset:1024
    ds_read_b128 v[80:83], v18 offset:2048
    v_mfma_f32_16x16x32_bf16 v[112:115], v[88:91], a[240:243], 0
    v_mfma_f32_16x16x32_bf16 v[116:119], v[88:91], a[244:247], 0
    v_mfma_f32_16x16x32_bf16 v[120:123], v[88:91], a[248:251], 0
    v_mfma_f32_16x16x32_bf16 v[124:127], v[88:91], a[252:255], 0
    v_mfma_f32_16x16x32_bf16 v[128:131], v[88:91], v[164:167], 0
    v_mfma_f32_16x16x32_bf16 v[132:135], v[88:91], v[168:171], 0
    v_mfma_f32_16x16x32_bf16 v[136:139], v[88:91], v[172:175], 0
    v_mfma_f32_16x16x32_bf16 v[140:143], v[88:91], v[176:179], 0
    v_mfma_f32_16x16x32_bf16 v[144:147], v[88:91], v[180:183], 0
    v_mfma_f32_16x16x32_bf16 v[148:151], v[88:91], v[184:187], 0
    v_mfma_f32_16x16x32_bf16 v[112:115], v[92:95], v[188:191], v[112:115]
    v_mfma_f32_16x16x32_bf16 v[116:119], v[92:95], v[192:195], v[116:119]
    v_mfma_f32_16x16x32_bf16 v[120:123], v[92:95], v[196:199], v[120:123]
    v_mfma_f32_16x16x32_bf16 v[124:127], v[92:95], v[200:203], v[124:127]
    v_mfma_f32_16x16x32_bf16 v[128:131], v[92:95], v[204:207], v[128:131]
    v_mfma_f32_16x16x32_bf16 v[132:135], v[92:95], v[208:211], v[132:135]
    v_mfma_f32_16x16x32_bf16 v[136:139], v[92:95], v[212:215], v[136:139]
    v_mfma_f32_16x16x32_bf16 v[140:143], v[92:95], v[216:219], v[140:143]
    v_mfma_f32_16x16x32_bf16 v[144:147], v[92:95], v[220:223], v[144:147]
    v_mfma_f32_16x16x32_bf16 v[148:151], v[92:95], v[224:227], v[148:151]
    v_mfma_f32_16x16x32_bf16 v[112:115], v[96:99], v[228:231], v[112:115]
    v_mfma_f32_16x16x32_bf16 v[116:119], v[96:99], v[232:235], v[116:119]
    v_mfma_f32_16x16x32_bf16 v[120:123], v[96:99], v[236:239], v[120:123]
    v_mfma_f32_16x16x32_bf16 v[124:127], v[96:99], v[240:243], v[124:127]
    v_mfma_f32_16x16x32_bf16 v[128:131], v[96:99], v[244:247], v[128:131]
    v_mfma_f32_16x16x32_bf16 v[132:135], v[96:99], v[248:251], v[132:135]
    v_mfma_f32_16x16x32_bf16 v[136:139], v[96:99], v[252:255], v[136:139]
    s_waitcnt lgkmcnt(2)
    v_mfma_f32_16x16x32_bf16 v[140:143], v[96:99], v[72:75], v[140:143]
    ds_read_b128 v[84:87], v18 offset:3072
    s_waitcnt lgkmcnt(2)
    v_mfma_f32_16x16x32_bf16 v[144:147], v[96:99], v[76:79], v[144:147]
    ds_read_b128 v[72:75], v18 offset:4096
    s_waitcnt lgkmcnt(2)
    v_mfma_f32_16x16x32_bf16 v[148:151], v[96:99], v[80:83], v[148:151]
    ds_read_b128 v[76:79], v18 offset:5120
    s_waitcnt lgkmcnt(2)
    v_mfma_f32_16x16x32_bf16 v[112:115], v[100:103], v[84:87], v[112:115]
    ds_read_b128 v[80:83], v18 offset:6144
    s_waitcnt lgkmcnt(2)
    v_mfma_f32_16x16x32_bf16 v[116:119], v[100:103], v[72:75], v[116:119]
    ds_read_b128 v[84:87], v18 offset:7168
    s_waitcnt lgkmcnt(2)
    v_mfma_f32_16x16x32_bf16 v[120:123], v[100:103], v[76:79], v[120:123]
    ds_read_b128 v[72:75], v18 offset:8192
    s_waitcnt lgkmcnt(2)
    v_mfma_f32_16x16x32_bf16 v[124:127], v[100:103], v[80:83], v[124:127]
    ds_read_b128 v[76:79], v18 offset:9216
    s_waitcnt lgkmcnt(2)
    v_mfma_f32_16x16x32_bf16 v[128:131], v[100:103], v[84:87], v[128:131]
    ds_read_b128 v[80:83], v18 offset:10240
    s_waitcnt lgkmcnt(2)
    v_mfma_f32_16x16x32_bf16 v[132:135], v[100:103], v[72:75], v[132:135]
    ds_read_b128 v[84:87], v18 offset:11264
    s_waitcnt lgkmcnt(2)
    v_mfma_f32_16x16x32_bf16 v[136:139], v[100:103], v[76:79], v[136:139]
    ds_read_b128 v[72:75], v18 offset:12288
    s_waitcnt lgkmcnt(2)
    v_mfma_f32_16x16x32_bf16 v[140:143], v[100:103], v[80:83], v[140:143]
    ds_read_b128 v[76:79], v18 offset:13312
    s_waitcnt lgkmcnt(2)
    v_mfma_f32_16x16x32_bf16 v[144:147], v[100:103], v[84:87], v[144:147]
    ds_read_b128 v[80:83], v18 offset:14336
    s_waitcnt lgkmcnt(2)
    v_mfma_f32_16x16x32_bf16 v[148:151], v[100:103], v[72:75], v[148:151]
    ds_read_b128 v[84:87], v18 offset:15360
    s_waitcnt lgkmcnt(2)
    v_mfma_f32_16x16x32_bf16 v[112:115], v[104:107], v[76:79], v[112:115]
    ds_read_b128 v[72:75], v18 offset:16384
    s_waitcnt lgkmcnt(2)
    v_mfma_f32_16x16x32_bf16 v[116:119], v[104:107], v[80:83], v[116:119]
    ds_read_b128 v[76:79], v18 offset:17408
    s_waitcnt lgkmcnt(2)
    v_mfma_f32_16x16x32_bf16 v[120:123], v[104:107], v[84:87], v[120:123]
    ds_read_b128 v[80:83], v18 offset:18432
    s_waitcnt lgkmcnt(2)
    v_mfma_f32_16x16x32_bf16 v[124:127], v[104:107], v[72:75], v[124:127]
    ds_read_b128 v[84:87], v18 offset:19456
    s_waitcnt lgkmcnt(2)
    v_mfma_f32_16x16x32_bf16 v[128:131], v[104:107], v[76:79], v[128:131]
    ds_read_b128 v[72:75], v18 offset:20480
    s_waitcnt lgkmcnt(2)
    v_mfma_f32_16x16x32_bf16 v[132:135], v[104:107], v[80:83], v[132:135]
    ds_read_b128 v[76:79], v18 offset:21504
    s_waitcnt lgkmcnt(2)
    v_mfma_f32_16x16x32_bf16 v[136:139], v[104:107], v[84:87], v[136:139]
    ds_read_b128 v[80:83], v18 offset:22528
    s_waitcnt lgkmcnt(2)
    v_mfma_f32_16x16x32_bf16 v[140:143], v[104:107], v[72:75], v[140:143]
    ds_read_b128 v[84:87], v18 offset:23552
    s_waitcnt lgkmcnt(2)
    v_mfma_f32_16x16x32_bf16 v[144:147], v[104:107], v[76:79], v[144:147]
    ds_read_b128 v[72:75], v18 offset:24576
    s_waitcnt lgkmcnt(2)
    v_mfma_f32_16x16x32_bf16 v[148:151], v[104:107], v[80:83], v[148:151]
    ds_read_b128 v[76:79], v18 offset:25600
    s_waitcnt lgkmcnt(2)
    v_mfma_f32_16x16x32_bf16 v[112:115], v[108:111], v[84:87], v[112:115]
    ds_read_b128 v[80:83], v18 offset:26624
    s_waitcnt lgkmcnt(2)
    v_mfma_f32_16x16x32_bf16 v[116:119], v[108:111], v[72:75], v[116:119]
    ds_read_b128 v[84:87], v18 offset:27648
    s_waitcnt lgkmcnt(2)
    v_mfma_f32_16x16x32_bf16 v[120:123], v[108:111], v[76:79], v[120:123]
    ds_read_b128 v[72:75], v18 offset:28672
    s_waitcnt lgkmcnt(2)
    v_mfma_f32_16x16x32_bf16 v[124:127], v[108:111], v[80:83], v[124:127]
    ds_read_b128 v[76:79], v18 offset:29696
    s_waitcnt lgkmcnt(2)
    v_mfma_f32_16x16x32_bf16 v[128:131], v[108:111], v[84:87], v[128:131]
    ds_read_b128 v[80:83], v18 offset:30720
    s_waitcnt lgkmcnt(2)
    v_mfma_f32_16x16x32_bf16 v[132:135], v[108:111], v[72:75], v[132:135]
    ds_read_b128 v[84:87], v18 offset:31744
    s_waitcnt lgkmcnt(2)
    v_mfma_f32_16x16x32_bf16 v[136:139], v[108:111], v[76:79], v[136:139]
    ds_read_b128 v[72:75], v18 offset:32768
    s_waitcnt lgkmcnt(2)
    v_mfma_f32_16x16x32_bf16 v[140:143], v[108:111], v[80:83], v[140:143]
    s_waitcnt lgkmcnt(1)
    v_mfma_f32_16x16x32_bf16 v[144:147], v[108:111], v[84:87], v[144:147]
    s_waitcnt lgkmcnt(0)
    v_mfma_f32_16x16x32_bf16 v[148:151], v[108:111], v[72:75], v[148:151]
    s_nop 7
    v_cvt_pk_bf16_f32 v32, v112, v113
    v_cvt_pk_bf16_f32 v33, v114, v115
    v_cvt_pk_bf16_f32 v34, v120, v121
    v_cvt_pk_bf16_f32 v35, v122, v123
    v_min_u32 v32, 0xfffffffe, v32
    v_min_u32 v33, 0xfffffffe, v33
    v_min_u32 v34, 0xfffffffe, v34
    v_min_u32 v35, 0xfffffffe, v35
    v_cvt_pk_bf16_f32 v36, v116, v117
    v_cvt_pk_bf16_f32 v37, v118, v119
    v_cvt_pk_bf16_f32 v38, v124, v125
    v_cvt_pk_bf16_f32 v39, v126, v127
    v_min_u32 v36, 0xfffffffe, v36
    v_min_u32 v37, 0xfffffffe, v37
    v_min_u32 v38, 0xfffffffe, v38
    v_min_u32 v39, 0xfffffffe, v39
    v_cvt_pk_bf16_f32 v40, v128, v129
    v_cvt_pk_bf16_f32 v41, v130, v131
    v_cvt_pk_bf16_f32 v42, v136, v137
    v_cvt_pk_bf16_f32 v43, v138, v139
    v_min_u32 v40, 0xfffffffe, v40
    v_min_u32 v41, 0xfffffffe, v41
    v_min_u32 v42, 0xfffffffe, v42
    v_min_u32 v43, 0xfffffffe, v43
    v_cvt_pk_bf16_f32 v44, v132, v133
    v_cvt_pk_bf16_f32 v45, v134, v135
    v_cvt_pk_bf16_f32 v46, v140, v141
    v_cvt_pk_bf16_f32 v47, v142, v143
    v_min_u32 v44, 0xfffffffe, v44
    v_min_u32 v45, 0xfffffffe, v45
    v_min_u32 v46, 0xfffffffe, v46
    v_min_u32 v47, 0xfffffffe, v47
    v_cvt_pk_bf16_f32 v48, v144, v145
    v_cvt_pk_bf16_f32 v49, v146, v147
    v_cvt_pk_bf16_f32 v50, v148, v149
    v_cvt_pk_bf16_f32 v51, v150, v151
    v_min_u32 v48, 0xfffffffe, v48
    v_min_u32 v49, 0xfffffffe, v49
    v_min_u32 v50, 0xfffffffe, v50
    v_min_u32 v51, 0xfffffffe, v51
    s_nop 1
    v_permlane16_swap_b32 v32, v34
    v_permlane16_swap_b32 v33, v35
    v_permlane16_swap_b32 v36, v38
    v_permlane16_swap_b32 v37, v39
    v_permlane16_swap_b32 v40, v42
    v_permlane16_swap_b32 v41, v43
    v_permlane16_swap_b32 v44, v46
    v_permlane16_swap_b32 v45, v47
    v_permlane16_swap_b32 v48, v50
    v_permlane16_swap_b32 v49, v51
    s_and_b32 s3, s29, 1
    s_mul_i32 s3, s3, 327680
    s_add_u32 s46, s45, s3
    s_mov_b32 exec_lo, -1
    s_mov_b32 exec_hi, 0
    buffer_store_dwordx4 v[32:35], v25, s[60:63], s24 offen offset:0 sc1
    buffer_store_dwordx4 v[36:39], v25, s[60:63], s24 offen offset:16 sc1
    buffer_store_dwordx4 v[40:43], v25, s[60:63], s24 offen offset:1024 sc1
    buffer_store_dwordx4 v[44:47], v25, s[60:63], s24 offen offset:1040 sc1
    buffer_store_dwordx4 v[48:51], v26, s[60:63], s24 offen offset:2048 sc1
    s_mov_b64 exec, -1
    s_add_u32 s29, s29, 1
    s_add_u32 s30, s30, 10240
    s_add_u32 s24, s24, 327680
    s_cmp_lt_u32 s29, 64
    s_cbranch_scc1 mega_kernel_Bloop42
    s_waitcnt vmcnt(0)
    v_mov_b32 v150, 1
    v_mov_b32 v151, 0
    s_mov_b64 exec, 1
    s_mov_b32 s71, 204501408
    buffer_atomic_add v150, v151, s[60:63], s71 offen sc1
    s_mov_b64 exec, -1
    s_branch mega_T1_LA
    s_branch mega_kernel_tsk48
mega_T1_LQ:
    s_branch mega_T2_LQ
mega_T1_LV:
    s_branch mega_T2_LV
mega_T1_LA:
    s_branch mega_T2_LA
mega_T1_LU:
    s_branch mega_T2_LU
mega_T1_LD:
    s_branch mega_T2_LD
mega_T1_done:
    s_branch mega_T2_done
mega_kernel_tsk48:
mega_kernel_roleY24:
    s_sub_u32 s20, s2, 64
    s_mul_i32 s3, s74, 5120
    v_lshlrev_b32 v7, 6, v5
    v_lshl_add_u32 v7, v4, 4, v7
    v_add_u32 v7, s3, v7
    v_lshlrev_b32 v6, 4, v5
    v_add_u32 v6, 512, v6
    v_add_u32 v6, s3, v6
    v_mul_u32_u24 v8, 640, v4
    v_add_u32 v6, v8, v6
    s_lshl_b32 s21, s20, 4
    s_add_u32 s21, s21, s3
    v_add_u32 v9, s21, v3
    v_add_u32 v10, v8, v9
    v_lshlrev_b32 v10, 4, v10
    v_lshlrev_b32 v9, 6, v9
    v_lshl_add_u32 v9, v4, 4, v9
    s_mov_b32 s22, 188891136
    s_mov_b32 s23, 167264256
    s_mov_b32 s24, 83378176
    v_lshlrev_b32 v11, 4, v0
    v_lshlrev_b32 v12, 4, v2
    v_lshlrev_b32 v13, 5, v3
    v_lshl_add_u32 v13, v4, 3, v13
    s_lshl_b32 s25, s20, 8
    s_add_u32 s25, s25, 190212096
    s_mov_b32 s29, 0
    s_mov_b32 s43, 0
    v_and_b32 v17, 7, v2
    s_lshl_b32 s3, s74, 3
    v_add_u32 v17, s3, v17
    v_mul_u32_u24 v15, 640, v17
    v_add_u32 v15, 188891772, v15
    v_mul_u32_u24 v18, 640, v17
    s_lshl_b32 s3, s20, 4
    v_add_u32 v18, s3, v18
    v_lshlrev_b32 v18, 4, v18
    v_add_u32 v18, 167264508, v18
    v_cndmask_b32 v15, v18, v15, s[80:81]
    v_mov_b32 v16, 327680
    v_mov_b32 v18, 20480
    v_cndmask_b32 v16, v16, v18, s[80:81]
    v_and_b32 v14, 31, v2
    v_add_u32 v14, 72, v14
    v_lshlrev_b32 v14, 2, v14
    v_mov_b32 v149, 192
    s_mov_b32 s69, 0
mega_kernel_cw49:
    buffer_load_dword v148, v149, s[88:91], 0 offen sc1
    s_add_u32 s69, s69, 1
    s_cmp_ge_u32 s69, 1048576
    s_cbranch_scc1 mega_kernel_cwo50
    s_waitcnt vmcnt(0)
    v_cmp_gt_u32 vcc, 256, v148
    s_cbranch_vccz mega_kernel_cwo50
    s_sleep 8
    s_branch mega_kernel_cw49
mega_kernel_cwo50:
mega_kernel_Yloop51:
    s_add_u32 s68, s29, 1
    s_cmp_ge_u32 s43, s68
    s_cbranch_scc1 mega_kernel_wn55
    s_mov_b32 s69, 0
mega_kernel_wnl56:
    s_mov_b32 s71, 204500992
    buffer_load_dword v150, v14, s[60:63], s71 offen sc1
    s_add_u32 s69, s69, 1
    s_cmp_ge_u32 s69, 262144
    s_cbranch_scc1 mega_kernel_wnb57
    s_waitcnt vmcnt(0)
    v_cmp_gt_u32 vcc, s68, v150
    s_cbranch_vccnz mega_kernel_wnl56
mega_kernel_wnb57:
    s_mov_b32 s43, s68
    s_add_u32 s71, s68, 8
    v_cmp_gt_u32 vcc, s71, v150
    s_cbranch_vccnz mega_kernel_wn55
    s_mov_b32 s43, s71
mega_kernel_wn55:
    s_add_u32 s71, s24, 0
    buffer_load_dwordx4 v[48:51], v9, s[60:63], s71 offen
    s_add_u32 s71, s24, 40960
    buffer_load_dwordx4 v[52:55], v9, s[60:63], s71 offen
    s_add_u32 s71, s24, 81920
    buffer_load_dwordx4 v[56:59], v9, s[60:63], s71 offen
    s_add_u32 s71, s24, 122880
    buffer_load_dwordx4 v[60:63], v9, s[60:63], s71 offen
    s_add_u32 s71, s24, 163840
    buffer_load_dwordx4 v[64:67], v9, s[60:63], s71 offen
    s_add_u32 s71, s24, 204800
    buffer_load_dwordx4 v[68:71], v9, s[60:63], s71 offen
    s_add_u32 s71, s24, 245760
    buffer_load_dwordx4 v[72:75], v9, s[60:63], s71 offen
    s_add_u32 s71, s24, 286720
    buffer_load_dwordx4 v[76:79], v9, s[60:63], s71 offen
    s_mov_b32 s31, 0
mega_kernel_yppo59:
    v_add_u32 v15, v15, v16
    s_mov_b32 s31, 0
    s_mov_b32 s44, 0xfff
mega_kernel_Ypoll52:
    s_bitcmp1_b32 s44, 0
    s_cbranch_scc0 mega_kernel_yl60
    s_add_u32 s71, s23, 0
    buffer_load_dwordx4 v[40:43], v10, s[60:63], s71 offen sc1
mega_kernel_yl60:
    s_bitcmp1_b32 s44, 1
    s_cbranch_scc0 mega_kernel_yl61
    s_add_u32 s71, s23, 40960
    buffer_load_dwordx4 v[44:47], v10, s[60:63], s71 offen sc1
mega_kernel_yl61:
    s_bitcmp1_b32 s44, 2
    s_cbranch_scc0 mega_kernel_yl62
    buffer_load_dwordx4 v[80:83], v6, s[60:63], s22 offen offset:0 sc1
mega_kernel_yl62:
    s_bitcmp1_b32 s44, 3
    s_cbranch_scc0 mega_kernel_yl63
    buffer_load_dwordx4 v[84:87], v6, s[60:63], s22 offen offset:2560 sc1
mega_kernel_yl63:
    s_bitcmp1_b32 s44, 4
    s_cbranch_scc0 mega_kernel_yl64
    s_add_u32 s71, s22, 0
    buffer_load_dwordx4 v[88:91], v7, s[60:63], s71 offen sc1
mega_kernel_yl64:
    s_bitcmp1_b32 s44, 5
    s_cbranch_scc0 mega_kernel_yl65
    s_add_u32 s71, s22, 640
    buffer_load_dwordx4 v[92:95], v7, s[60:63], s71 offen sc1
mega_kernel_yl65:
    s_bitcmp1_b32 s44, 6
    s_cbranch_scc0 mega_kernel_yl66
    s_add_u32 s71, s22, 1280
    buffer_load_dwordx4 v[96:99], v7, s[60:63], s71 offen sc1
mega_kernel_yl66:
    s_bitcmp1_b32 s44, 7
    s_cbranch_scc0 mega_kernel_yl67
    s_add_u32 s71, s22, 1920
    buffer_load_dwordx4 v[100:103], v7, s[60:63], s71 offen sc1
mega_kernel_yl67:
    s_bitcmp1_b32 s44, 8
    s_cbranch_scc0 mega_kernel_yl68
    s_add_u32 s71, s22, 2560
    buffer_load_dwordx4 v[104:107], v7, s[60:63], s71 offen sc1
mega_kernel_yl68:
    s_bitcmp1_b32 s44, 9
    s_cbranch_scc0 mega_kernel_yl69
    s_add_u32 s71, s22, 3200
    buffer_load_dwordx4 v[108:111], v7, s[60:63], s71 offen sc1
mega_kernel_yl69:
    s_bitcmp1_b32 s44, 10
    s_cbranch_scc0 mega_kernel_yl70
    s_add_u32 s71, s22, 3840
    buffer_load_dwordx4 v[112:115], v7, s[60:63], s71 offen sc1
mega_kernel_yl70:
    s_bitcmp1_b32 s44, 11
    s_cbranch_scc0 mega_kernel_yl71
    s_add_u32 s71, s22, 4480
    buffer_load_dwordx4 v[116:119], v7, s[60:63], s71 offen sc1
mega_kernel_yl71:
    s_waitcnt vmcnt(0)
    s_bitcmp1_b32 s44, 0
    s_cbranch_scc0 mega_kernel_yc72
    v_max3_u32 v120, v40, v41, v42
    v_max_u32 v120, v120, v43
    v_cmp_eq_u32 vcc, -1, v120
    s_cbranch_vccnz mega_kernel_yc72
    s_bitset0_b32 s44, 0
mega_kernel_yc72:
    s_bitcmp1_b32 s44, 1
    s_cbranch_scc0 mega_kernel_yc73
    v_max3_u32 v120, v44, v45, v46
    v_max_u32 v120, v120, v47
    v_cmp_eq_u32 vcc, -1, v120
    s_cbranch_vccnz mega_kernel_yc73
    s_bitset0_b32 s44, 1
mega_kernel_yc73:
    s_bitcmp1_b32 s44, 2
    s_cbranch_scc0 mega_kernel_yc74
    v_max3_u32 v120, v80, v81, v82
    v_max_u32 v120, v120, v83
    v_cmp_eq_u32 vcc, -1, v120
    s_cbranch_vccnz mega_kernel_yc74
    s_bitset0_b32 s44, 2
mega_kernel_yc74:
    s_bitcmp1_b32 s44, 3
    s_cbranch_scc0 mega_kernel_yc75
    v_max3_u32 v120, v84, v85, v86
    v_max_u32 v120, v120, v87
    v_cmp_eq_u32 vcc, -1, v120
    s_cbranch_vccnz mega_kernel_yc75
    s_bitset0_b32 s44, 3
mega_kernel_yc75:
    s_bitcmp1_b32 s44, 4
    s_cbranch_scc0 mega_kernel_yc76
    v_max3_u32 v120, v88, v89, v90
    v_max_u32 v120, v120, v91
    v_cmp_eq_u32 vcc, -1, v120
    s_cbranch_vccnz mega_kernel_yc76
    s_bitset0_b32 s44, 4
mega_kernel_yc76:
    s_bitcmp1_b32 s44, 5
    s_cbranch_scc0 mega_kernel_yc77
    v_max3_u32 v120, v92, v93, v94
    v_max_u32 v120, v120, v95
    v_cmp_eq_u32 vcc, -1, v120
    s_cbranch_vccnz mega_kernel_yc77
    s_bitset0_b32 s44, 5
mega_kernel_yc77:
    s_bitcmp1_b32 s44, 6
    s_cbranch_scc0 mega_kernel_yc78
    v_max3_u32 v120, v96, v97, v98
    v_max_u32 v120, v120, v99
    v_cmp_eq_u32 vcc, -1, v120
    s_cbranch_vccnz mega_kernel_yc78
    s_bitset0_b32 s44, 6
mega_kernel_yc78:
    s_bitcmp1_b32 s44, 7
    s_cbranch_scc0 mega_kernel_yc79
    v_max3_u32 v120, v100, v101, v102
    v_max_u32 v120, v120, v103
    v_cmp_eq_u32 vcc, -1, v120
    s_cbranch_vccnz mega_kernel_yc79
    s_bitset0_b32 s44, 7
mega_kernel_yc79:
    s_bitcmp1_b32 s44, 8
    s_cbranch_scc0 mega_kernel_yc80
    v_max3_u32 v120, v104, v105, v106
    v_max_u32 v120, v120, v107
    v_cmp_eq_u32 vcc, -1, v120
    s_cbranch_vccnz mega_kernel_yc80
    s_bitset0_b32 s44, 8
mega_kernel_yc80:
    s_bitcmp1_b32 s44, 9
    s_cbranch_scc0 mega_kernel_yc81
    v_max3_u32 v120, v108, v109, v110
    v_max_u32 v120, v120, v111
    v_cmp_eq_u32 vcc, -1, v120
    s_cbranch_vccnz mega_kernel_yc81
    s_bitset0_b32 s44, 9
mega_kernel_yc81:
    s_bitcmp1_b32 s44, 10
    s_cbranch_scc0 mega_kernel_yc82
    v_max3_u32 v120, v112, v113, v114
    v_max_u32 v120, v120, v115
    v_cmp_eq_u32 vcc, -1, v120
    s_cbranch_vccnz mega_kernel_yc82
    s_bitset0_b32 s44, 10
mega_kernel_yc82:
    s_bitcmp1_b32 s44, 11
    s_cbranch_scc0 mega_kernel_yc83
    v_max3_u32 v120, v116, v117, v118
    v_max_u32 v120, v120, v119
    v_cmp_eq_u32 vcc, -1, v120
    s_cbranch_vccnz mega_kernel_yc83
    s_bitset0_b32 s44, 11
mega_kernel_yc83:
    s_cmp_eq_u32 s44, 0
    s_cbranch_scc1 mega_kernel_Yok53
    s_add_u32 s31, s31, 1
    s_cmp_lt_u32 s31, 65536
    s_cbranch_scc1 mega_kernel_Ypoll52
mega_kernel_Yok53:
    v_mfma_f32_16x16x32_bf16 v[124:127], v[40:43], v[80:83], 0
    v_mfma_f32_16x16x32_bf16 v[124:127], v[44:47], v[84:87], v[124:127]
    v_mfma_f32_16x16x32_bf16 v[124:127], v[48:51], v[88:91], v[124:127]
    v_mfma_f32_16x16x32_bf16 v[124:127], v[52:55], v[92:95], v[124:127]
    v_mfma_f32_16x16x32_bf16 v[124:127], v[56:59], v[96:99], v[124:127]
    v_mfma_f32_16x16x32_bf16 v[124:127], v[60:63], v[100:103], v[124:127]
    v_mfma_f32_16x16x32_bf16 v[124:127], v[64:67], v[104:107], v[124:127]
    v_mfma_f32_16x16x32_bf16 v[124:127], v[68:71], v[108:111], v[124:127]
    v_mfma_f32_16x16x32_bf16 v[124:127], v[72:75], v[112:115], v[124:127]
    v_mfma_f32_16x16x32_bf16 v[124:127], v[76:79], v[116:119], v[124:127]
    s_nop 7
    ds_write_b128 v11, v[124:127]
    s_waitcnt lgkmcnt(0)
    s_barrier
    s_cmp_lg_u32 s74, 0
    s_cbranch_scc1 mega_kernel_Ynext54
    ds_read_b128 v[128:131], v12 offset:1024
    ds_read_b128 v[132:135], v12 offset:2048
    ds_read_b128 v[136:139], v12 offset:3072
    s_waitcnt lgkmcnt(0)
    v_add_f32 v124, v124, v128
    v_add_f32 v132, v132, v136
    v_add_f32 v125, v125, v129
    v_add_f32 v133, v133, v137
    v_add_f32 v126, v126, v130
    v_add_f32 v134, v134, v138
    v_add_f32 v127, v127, v131
    v_add_f32 v135, v135, v139
    v_add_f32 v124, v124, v132
    v_add_f32 v125, v125, v133
    v_add_f32 v126, v126, v134
    v_add_f32 v127, v127, v135
    v_cvt_pk_bf16_f32 v140, v124, v125
    v_cvt_pk_bf16_f32 v141, v126, v127
    v_min_u32 v140, 0xfffffffe, v140
    v_min_u32 v141, 0xfffffffe, v141
    s_mov_b64 exec, s[80:81]
    buffer_store_dwordx2 v[140:141], v13, s[60:63], s25 offen sc1
    s_cmp_lg_u32 s20, 0
    s_cbranch_scc1 mega_kernel_npf84
    s_add_u32 s3, s29, 1
    v_mov_b32 v142, s3
    v_mov_b32 v143, 0
    s_mov_b64 exec, 1
    s_mov_b32 s71, 204502272
    buffer_store_dword v142, v143, s[60:63], s71 offen sc1
mega_kernel_npf84:
    s_mov_b64 exec, -1
mega_kernel_Ynext54:
    s_add_u32 s29, s29, 1
    s_add_u32 s22, s22, 20480
    s_add_u32 s23, s23, 327680
    s_add_u32 s24, s24, 1310720
    s_add_u32 s25, s25, 10240
    s_cmp_lt_u32 s29, 64
    s_cbranch_scc1 mega_kernel_Yloop51
    s_branch mega_T2_LA
    s_branch mega_kernel_tsk85
mega_T2_LQ:
    s_branch mega_T3_LQ
mega_T2_LV:
    s_branch mega_T3_LV
mega_T2_LA:
    s_branch mega_T3_LA
mega_T2_LU:
    s_branch mega_T3_LU
mega_T2_LD:
    s_branch mega_T3_LD
mega_T2_done:
    s_branch mega_T3_done
mega_kernel_tsk85:
mega_kernel_qkv2:
    s_load_dwordx2 s[10:11], s[0:1], 16
    s_load_dwordx2 s[12:13], s[0:1], 24
    s_load_dwordx2 s[14:15], s[0:1], 32
    s_sub_u32 s16, s2, 104
    s_mov_b32 s18, 0
    s_cmp_ge_u32 s16, 24
    s_addc_u32 s18, s18, 0
    s_cmp_ge_u32 s16, 48
    s_addc_u32 s18, s18, 0
    s_mul_i32 s19, s18, 24
    s_sub_u32 s19, s16, s19
    s_lshl_b32 s19, s19, 8
    s_lshl_b32 s3, s74, 6
    s_add_u32 s19, s19, s3
    s_waitcnt lgkmcnt(0)
    s_cmp_eq_u32 s18, 1
    s_cselect_b32 s10, s12, s10
    s_cselect_b32 s11, s13, s11
    s_cmp_eq_u32 s18, 2
    s_cselect_b32 s10, s14, s10
    s_cselect_b32 s11, s15, s11
    s_mov_b32 s64, s10
    s_and_b32 s65, s11, 0xffff
    s_mov_b32 s66, 7864320
    s_mov_b32 s67, 0x00020000
    s_mov_b32 s3, 98304
    v_mul_lo_u32 v5, v4, s3
    v_lshl_add_u32 v5, v3, 3, v5
    s_lshl_b32 s70, s19, 1
    s_cmp_lg_u32 s18, 0
    s_cbranch_scc1 mega_kernel_nq86
    v_mov_b32 v27, 160
    s_mov_b32 s69, 0
mega_kernel_cw87:
    buffer_load_dword v26, v27, s[88:91], 0 offen sc1
    s_add_u32 s69, s69, 1
    s_cmp_ge_u32 s69, 1048576
    s_cbranch_scc1 mega_kernel_cwo88
    s_waitcnt vmcnt(0)
    v_cmp_gt_u32 vcc, 128, v26
    s_cbranch_vccz mega_kernel_cwo88
    s_sleep 8
    s_branch mega_kernel_cw87
mega_kernel_cwo88:
mega_kernel_nq86:
    s_add_u32 s71, s70, 0
    buffer_load_dwordx2 v[32:33], v5, s[64:67], s71 offen
    s_add_u32 s71, s70, 12288
    buffer_load_dwordx2 v[34:35], v5, s[64:67], s71 offen
    s_add_u32 s71, s70, 24576
    buffer_load_dwordx2 v[36:37], v5, s[64:67], s71 offen
    s_add_u32 s71, s70, 36864
    buffer_load_dwordx2 v[38:39], v5, s[64:67], s71 offen
    s_add_u32 s71, s70, 49152
    buffer_load_dwordx2 v[40:41], v5, s[64:67], s71 offen
    s_add_u32 s71, s70, 61440
    buffer_load_dwordx2 v[42:43], v5, s[64:67], s71 offen
    s_add_u32 s71, s70, 73728
    buffer_load_dwordx2 v[44:45], v5, s[64:67], s71 offen
    s_add_u32 s71, s70, 86016
    buffer_load_dwordx2 v[46:47], v5, s[64:67], s71 offen
    s_add_u32 s71, s70, 393216
    buffer_load_dwordx2 v[48:49], v5, s[64:67], s71 offen
    s_add_u32 s71, s70, 405504
    buffer_load_dwordx2 v[50:51], v5, s[64:67], s71 offen
    s_add_u32 s71, s70, 417792
    buffer_load_dwordx2 v[52:53], v5, s[64:67], s71 offen
    s_add_u32 s71, s70, 430080
    buffer_load_dwordx2 v[54:55], v5, s[64:67], s71 offen
    s_add_u32 s71, s70, 442368
    buffer_load_dwordx2 v[56:57], v5, s[64:67], s71 offen
    s_add_u32 s71, s70, 454656
    buffer_load_dwordx2 v[58:59], v5, s[64:67], s71 offen
    s_add_u32 s71, s70, 466944
    buffer_load_dwordx2 v[60:61], v5, s[64:67], s71 offen
    s_add_u32 s71, s70, 479232
    buffer_load_dwordx2 v[62:63], v5, s[64:67], s71 offen
    s_add_u32 s71, s70, 786432
    buffer_load_dwordx2 v[64:65], v5, s[64:67], s71 offen
    s_add_u32 s71, s70, 798720
    buffer_load_dwordx2 v[66:67], v5, s[64:67], s71 offen
    s_add_u32 s71, s70, 811008
    buffer_load_dwordx2 v[68:69], v5, s[64:67], s71 offen
    s_add_u32 s71, s70, 823296
    buffer_load_dwordx2 v[70:71], v5, s[64:67], s71 offen
    s_add_u32 s71, s70, 835584
    buffer_load_dwordx2 v[72:73], v5, s[64:67], s71 offen
    s_add_u32 s71, s70, 847872
    buffer_load_dwordx2 v[74:75], v5, s[64:67], s71 offen
    s_add_u32 s71, s70, 860160
    buffer_load_dwordx2 v[76:77], v5, s[64:67], s71 offen
    s_add_u32 s71, s70, 872448
    buffer_load_dwordx2 v[78:79], v5, s[64:67], s71 offen
    s_add_u32 s71, s70, 1179648
    buffer_load_dwordx2 v[80:81], v5, s[64:67], s71 offen
    s_add_u32 s71, s70, 1191936
    buffer_load_dwordx2 v[82:83], v5, s[64:67], s71 offen
    s_add_u32 s71, s70, 1204224
    buffer_load_dwordx2 v[84:85], v5, s[64:67], s71 offen
    s_add_u32 s71, s70, 1216512
    buffer_load_dwordx2 v[86:87], v5, s[64:67], s71 offen
    s_add_u32 s71, s70, 1228800
    buffer_load_dwordx2 v[88:89], v5, s[64:67], s71 offen
    s_add_u32 s71, s70, 1241088
    buffer_load_dwordx2 v[90:91], v5, s[64:67], s71 offen
    s_add_u32 s71, s70, 1253376
    buffer_load_dwordx2 v[92:93], v5, s[64:67], s71 offen
    s_add_u32 s71, s70, 1265664
    buffer_load_dwordx2 v[94:95], v5, s[64:67], s71 offen
    s_add_u32 s71, s70, 1572864
    buffer_load_dwordx2 v[96:97], v5, s[64:67], s71 offen
    s_add_u32 s71, s70, 1585152
    buffer_load_dwordx2 v[98:99], v5, s[64:67], s71 offen
    s_add_u32 s71, s70, 1597440
    buffer_load_dwordx2 v[100:101], v5, s[64:67], s71 offen
    s_add_u32 s71, s70, 1609728
    buffer_load_dwordx2 v[102:103], v5, s[64:67], s71 offen
    s_add_u32 s71, s70, 1622016
    buffer_load_dwordx2 v[104:105], v5, s[64:67], s71 offen
    s_add_u32 s71, s70, 1634304
    buffer_load_dwordx2 v[106:107], v5, s[64:67], s71 offen
    s_add_u32 s71, s70, 1646592
    buffer_load_dwordx2 v[108:109], v5, s[64:67], s71 offen
    s_add_u32 s71, s70, 1658880
    buffer_load_dwordx2 v[110:111], v5, s[64:67], s71 offen
    s_add_u32 s71, s70, 1966080
    buffer_load_dwordx2 v[112:113], v5, s[64:67], s71 offen
    s_add_u32 s71, s70, 1978368
    buffer_load_dwordx2 v[114:115], v5, s[64:67], s71 offen
    s_add_u32 s71, s70, 1990656
    buffer_load_dwordx2 v[116:117], v5, s[64:67], s71 offen
    s_add_u32 s71, s70, 2002944
    buffer_load_dwordx2 v[118:119], v5, s[64:67], s71 offen
    s_add_u32 s71, s70, 2015232
    buffer_load_dwordx2 v[120:121], v5, s[64:67], s71 offen
    s_add_u32 s71, s70, 2027520
    buffer_load_dwordx2 v[122:123], v5, s[64:67], s71 offen
    s_add_u32 s71, s70, 2039808
    buffer_load_dwordx2 v[124:125], v5, s[64:67], s71 offen
    s_add_u32 s71, s70, 2052096
    buffer_load_dwordx2 v[126:127], v5, s[64:67], s71 offen
    s_waitcnt vmcnt(32)
    v_perm_b32 v28, v34, v32, s72
    v_perm_b32 v29, v38, v36, s72
    v_perm_b32 v30, v42, v40, s72
    v_perm_b32 v31, v46, v44, s72
    v_accvgpr_write_b32 a0, v28
    v_accvgpr_write_b32 a1, v29
    v_accvgpr_write_b32 a2, v30
    v_accvgpr_write_b32 a3, v31
    v_perm_b32 v28, v34, v32, s73
    v_perm_b32 v29, v38, v36, s73
    v_perm_b32 v30, v42, v40, s73
    v_perm_b32 v31, v46, v44, s73
    v_accvgpr_write_b32 a80, v28
    v_accvgpr_write_b32 a81, v29
    v_accvgpr_write_b32 a82, v30
    v_accvgpr_write_b32 a83, v31
    v_perm_b32 v28, v35, v33, s72
    v_perm_b32 v29, v39, v37, s72
    v_perm_b32 v30, v43, v41, s72
    v_perm_b32 v31, v47, v45, s72
    v_accvgpr_write_b32 a160, v28
    v_accvgpr_write_b32 a161, v29
    v_accvgpr_write_b32 a162, v30
    v_accvgpr_write_b32 a163, v31
    v_perm_b32 v28, v35, v33, s73
    v_perm_b32 v29, v39, v37, s73
    v_perm_b32 v30, v43, v41, s73
    v_perm_b32 v31, v47, v45, s73
    v_accvgpr_write_b32 a240, v28
    v_accvgpr_write_b32 a241, v29
    v_accvgpr_write_b32 a242, v30
    v_accvgpr_write_b32 a243, v31
    v_perm_b32 v28, v50, v48, s72
    v_perm_b32 v29, v54, v52, s72
    v_perm_b32 v30, v58, v56, s72
    v_perm_b32 v31, v62, v60, s72
    v_accvgpr_write_b32 a4, v28
    v_accvgpr_write_b32 a5, v29
    v_accvgpr_write_b32 a6, v30
    v_accvgpr_write_b32 a7, v31
    v_perm_b32 v28, v50, v48, s73
    v_perm_b32 v29, v54, v52, s73
    v_perm_b32 v30, v58, v56, s73
    v_perm_b32 v31, v62, v60, s73
    v_accvgpr_write_b32 a84, v28
    v_accvgpr_write_b32 a85, v29
    v_accvgpr_write_b32 a86, v30
    v_accvgpr_write_b32 a87, v31
    v_perm_b32 v28, v51, v49, s72
    v_perm_b32 v29, v55, v53, s72
    v_perm_b32 v30, v59, v57, s72
    v_perm_b32 v31, v63, v61, s72
    v_accvgpr_write_b32 a164, v28
    v_accvgpr_write_b32 a165, v29
    v_accvgpr_write_b32 a166, v30
    v_accvgpr_write_b32 a167, v31
    v_perm_b32 v28, v51, v49, s73
    v_perm_b32 v29, v55, v53, s73
    v_perm_b32 v30, v59, v57, s73
    v_perm_b32 v31, v63, v61, s73
    v_accvgpr_write_b32 a244, v28
    v_accvgpr_write_b32 a245, v29
    v_accvgpr_write_b32 a246, v30
    v_accvgpr_write_b32 a247, v31
    s_add_u32 s71, s70, 2359296
    buffer_load_dwordx2 v[32:33], v5, s[64:67], s71 offen
    s_add_u32 s71, s70, 2371584
    buffer_load_dwordx2 v[34:35], v5, s[64:67], s71 offen
    s_add_u32 s71, s70, 2383872
    buffer_load_dwordx2 v[36:37], v5, s[64:67], s71 offen
    s_add_u32 s71, s70, 2396160
    buffer_load_dwordx2 v[38:39], v5, s[64:67], s71 offen
    s_add_u32 s71, s70, 2408448
    buffer_load_dwordx2 v[40:41], v5, s[64:67], s71 offen
    s_add_u32 s71, s70, 2420736
    buffer_load_dwordx2 v[42:43], v5, s[64:67], s71 offen
    s_add_u32 s71, s70, 2433024
    buffer_load_dwordx2 v[44:45], v5, s[64:67], s71 offen
    s_add_u32 s71, s70, 2445312
    buffer_load_dwordx2 v[46:47], v5, s[64:67], s71 offen
    s_add_u32 s71, s70, 2752512
    buffer_load_dwordx2 v[48:49], v5, s[64:67], s71 offen
    s_add_u32 s71, s70, 2764800
    buffer_load_dwordx2 v[50:51], v5, s[64:67], s71 offen
    s_add_u32 s71, s70, 2777088
    buffer_load_dwordx2 v[52:53], v5, s[64:67], s71 offen
    s_add_u32 s71, s70, 2789376
    buffer_load_dwordx2 v[54:55], v5, s[64:67], s71 offen
    s_add_u32 s71, s70, 2801664
    buffer_load_dwordx2 v[56:57], v5, s[64:67], s71 offen
    s_add_u32 s71, s70, 2813952
    buffer_load_dwordx2 v[58:59], v5, s[64:67], s71 offen
    s_add_u32 s71, s70, 2826240
    buffer_load_dwordx2 v[60:61], v5, s[64:67], s71 offen
    s_add_u32 s71, s70, 2838528
    buffer_load_dwordx2 v[62:63], v5, s[64:67], s71 offen
    s_waitcnt vmcnt(32)
    v_perm_b32 v28, v66, v64, s72
    v_perm_b32 v29, v70, v68, s72
    v_perm_b32 v30, v74, v72, s72
    v_perm_b32 v31, v78, v76, s72
    v_accvgpr_write_b32 a8, v28
    v_accvgpr_write_b32 a9, v29
    v_accvgpr_write_b32 a10, v30
    v_accvgpr_write_b32 a11, v31
    v_perm_b32 v28, v66, v64, s73
    v_perm_b32 v29, v70, v68, s73
    v_perm_b32 v30, v74, v72, s73
    v_perm_b32 v31, v78, v76, s73
    v_accvgpr_write_b32 a88, v28
    v_accvgpr_write_b32 a89, v29
    v_accvgpr_write_b32 a90, v30
    v_accvgpr_write_b32 a91, v31
    v_perm_b32 v28, v67, v65, s72
    v_perm_b32 v29, v71, v69, s72
    v_perm_b32 v30, v75, v73, s72
    v_perm_b32 v31, v79, v77, s72
    v_accvgpr_write_b32 a168, v28
    v_accvgpr_write_b32 a169, v29
    v_accvgpr_write_b32 a170, v30
    v_accvgpr_write_b32 a171, v31
    v_perm_b32 v28, v67, v65, s73
    v_perm_b32 v29, v71, v69, s73
    v_perm_b32 v30, v75, v73, s73
    v_perm_b32 v31, v79, v77, s73
    v_accvgpr_write_b32 a248, v28
    v_accvgpr_write_b32 a249, v29
    v_accvgpr_write_b32 a250, v30
    v_accvgpr_write_b32 a251, v31
    v_perm_b32 v28, v82, v80, s72
    v_perm_b32 v29, v86, v84, s72
    v_perm_b32 v30, v90, v88, s72
    v_perm_b32 v31, v94, v92, s72
    v_accvgpr_write_b32 a12, v28
    v_accvgpr_write_b32 a13, v29
    v_accvgpr_write_b32 a14, v30
    v_accvgpr_write_b32 a15, v31
    v_perm_b32 v28, v82, v80, s73
    v_perm_b32 v29, v86, v84, s73
    v_perm_b32 v30, v90, v88, s73
    v_perm_b32 v31, v94, v92, s73
    v_accvgpr_write_b32 a92, v28
    v_accvgpr_write_b32 a93, v29
    v_accvgpr_write_b32 a94, v30
    v_accvgpr_write_b32 a95, v31
    v_perm_b32 v28, v83, v81, s72
    v_perm_b32 v29, v87, v85, s72
    v_perm_b32 v30, v91, v89, s72
    v_perm_b32 v31, v95, v93, s72
    v_accvgpr_write_b32 a172, v28
    v_accvgpr_write_b32 a173, v29
    v_accvgpr_write_b32 a174, v30
    v_accvgpr_write_b32 a175, v31
    v_perm_b32 v28, v83, v81, s73
    v_perm_b32 v29, v87, v85, s73
    v_perm_b32 v30, v91, v89, s73
    v_perm_b32 v31, v95, v93, s73
    v_accvgpr_write_b32 a252, v28
    v_accvgpr_write_b32 a253, v29
    v_accvgpr_write_b32 a254, v30
    v_accvgpr_write_b32 a255, v31
    s_add_u32 s71, s70, 3145728
    buffer_load_dwordx2 v[64:65], v5, s[64:67], s71 offen
    s_add_u32 s71, s70, 3158016
    buffer_load_dwordx2 v[66:67], v5, s[64:67], s71 offen
    s_add_u32 s71, s70, 3170304
    buffer_load_dwordx2 v[68:69], v5, s[64:67], s71 offen
    s_add_u32 s71, s70, 3182592
    buffer_load_dwordx2 v[70:71], v5, s[64:67], s71 offen
    s_add_u32 s71, s70, 3194880
    buffer_load_dwordx2 v[72:73], v5, s[64:67], s71 offen
    s_add_u32 s71, s70, 3207168
    buffer_load_dwordx2 v[74:75], v5, s[64:67], s71 offen
    s_add_u32 s71, s70, 3219456
    buffer_load_dwordx2 v[76:77], v5, s[64:67], s71 offen
    s_add_u32 s71, s70, 3231744
    buffer_load_dwordx2 v[78:79], v5, s[64:67], s71 offen
    s_add_u32 s71, s70, 3538944
    buffer_load_dwordx2 v[80:81], v5, s[64:67], s71 offen
    s_add_u32 s71, s70, 3551232
    buffer_load_dwordx2 v[82:83], v5, s[64:67], s71 offen
    s_add_u32 s71, s70, 3563520
    buffer_load_dwordx2 v[84:85], v5, s[64:67], s71 offen
    s_add_u32 s71, s70, 3575808
    buffer_load_dwordx2 v[86:87], v5, s[64:67], s71 offen
    s_add_u32 s71, s70, 3588096
    buffer_load_dwordx2 v[88:89], v5, s[64:67], s71 offen
    s_add_u32 s71, s70, 3600384
    buffer_load_dwordx2 v[90:91], v5, s[64:67], s71 offen
    s_add_u32 s71, s70, 3612672
    buffer_load_dwordx2 v[92:93], v5, s[64:67], s71 offen
    s_add_u32 s71, s70, 3624960
    buffer_load_dwordx2 v[94:95], v5, s[64:67], s71 offen
    s_waitcnt vmcnt(32)
    v_perm_b32 v28, v98, v96, s72
    v_perm_b32 v29, v102, v100, s72
    v_perm_b32 v30, v106, v104, s72
    v_perm_b32 v31, v110, v108, s72
    v_accvgpr_write_b32 a16, v28
    v_accvgpr_write_b32 a17, v29
    v_accvgpr_write_b32 a18, v30
    v_accvgpr_write_b32 a19, v31
    v_perm_b32 v28, v98, v96, s73
    v_perm_b32 v29, v102, v100, s73
    v_perm_b32 v30, v106, v104, s73
    v_perm_b32 v31, v110, v108, s73
    v_accvgpr_write_b32 a96, v28
    v_accvgpr_write_b32 a97, v29
    v_accvgpr_write_b32 a98, v30
    v_accvgpr_write_b32 a99, v31
    v_perm_b32 v28, v99, v97, s72
    v_perm_b32 v29, v103, v101, s72
    v_perm_b32 v30, v107, v105, s72
    v_perm_b32 v31, v111, v109, s72
    v_accvgpr_write_b32 a176, v28
    v_accvgpr_write_b32 a177, v29
    v_accvgpr_write_b32 a178, v30
    v_accvgpr_write_b32 a179, v31
    v_perm_b32 v192, v99, v97, s73
    v_perm_b32 v193, v103, v101, s73
    v_perm_b32 v194, v107, v105, s73
    v_perm_b32 v195, v111, v109, s73
    v_perm_b32 v28, v114, v112, s72
    v_perm_b32 v29, v118, v116, s72
    v_perm_b32 v30, v122, v120, s72
    v_perm_b32 v31, v126, v124, s72
    v_accvgpr_write_b32 a20, v28
    v_accvgpr_write_b32 a21, v29
    v_accvgpr_write_b32 a22, v30
    v_accvgpr_write_b32 a23, v31
    v_perm_b32 v28, v114, v112, s73
    v_perm_b32 v29, v118, v116, s73
    v_perm_b32 v30, v122, v120, s73
    v_perm_b32 v31, v126, v124, s73
    v_accvgpr_write_b32 a100, v28
    v_accvgpr_write_b32 a101, v29
    v_accvgpr_write_b32 a102, v30
    v_accvgpr_write_b32 a103, v31
    v_perm_b32 v28, v115, v113, s72
    v_perm_b32 v29, v119, v117, s72
    v_perm_b32 v30, v123, v121, s72
    v_perm_b32 v31, v127, v125, s72
    v_accvgpr_write_b32 a180, v28
    v_accvgpr_write_b32 a181, v29
    v_accvgpr_write_b32 a182, v30
    v_accvgpr_write_b32 a183, v31
    v_perm_b32 v196, v115, v113, s73
    v_perm_b32 v197, v119, v117, s73
    v_perm_b32 v198, v123, v121, s73
    v_perm_b32 v199, v127, v125, s73
    s_add_u32 s71, s70, 3932160
    buffer_load_dwordx2 v[96:97], v5, s[64:67], s71 offen
    s_add_u32 s71, s70, 3944448
    buffer_load_dwordx2 v[98:99], v5, s[64:67], s71 offen
    s_add_u32 s71, s70, 3956736
    buffer_load_dwordx2 v[100:101], v5, s[64:67], s71 offen
    s_add_u32 s71, s70, 3969024
    buffer_load_dwordx2 v[102:103], v5, s[64:67], s71 offen
    s_add_u32 s71, s70, 3981312
    buffer_load_dwordx2 v[104:105], v5, s[64:67], s71 offen
    s_add_u32 s71, s70, 3993600
    buffer_load_dwordx2 v[106:107], v5, s[64:67], s71 offen
    s_add_u32 s71, s70, 4005888
    buffer_load_dwordx2 v[108:109], v5, s[64:67], s71 offen
    s_add_u32 s71, s70, 4018176
    buffer_load_dwordx2 v[110:111], v5, s[64:67], s71 offen
    s_add_u32 s71, s70, 4325376
    buffer_load_dwordx2 v[112:113], v5, s[64:67], s71 offen
    s_add_u32 s71, s70, 4337664
    buffer_load_dwordx2 v[114:115], v5, s[64:67], s71 offen
    s_add_u32 s71, s70, 4349952
    buffer_load_dwordx2 v[116:117], v5, s[64:67], s71 offen
    s_add_u32 s71, s70, 4362240
    buffer_load_dwordx2 v[118:119], v5, s[64:67], s71 offen
    s_add_u32 s71, s70, 4374528
    buffer_load_dwordx2 v[120:121], v5, s[64:67], s71 offen
    s_add_u32 s71, s70, 4386816
    buffer_load_dwordx2 v[122:123], v5, s[64:67], s71 offen
    s_add_u32 s71, s70, 4399104
    buffer_load_dwordx2 v[124:125], v5, s[64:67], s71 offen
    s_add_u32 s71, s70, 4411392
    buffer_load_dwordx2 v[126:127], v5, s[64:67], s71 offen
    s_waitcnt vmcnt(32)
    v_perm_b32 v28, v34, v32, s72
    v_perm_b32 v29, v38, v36, s72
    v_perm_b32 v30, v42, v40, s72
    v_perm_b32 v31, v46, v44, s72
    v_accvgpr_write_b32 a24, v28
    v_accvgpr_write_b32 a25, v29
    v_accvgpr_write_b32 a26, v30
    v_accvgpr_write_b32 a27, v31
    v_perm_b32 v28, v34, v32, s73
    v_perm_b32 v29, v38, v36, s73
    v_perm_b32 v30, v42, v40, s73
    v_perm_b32 v31, v46, v44, s73
    v_accvgpr_write_b32 a104, v28
    v_accvgpr_write_b32 a105, v29
    v_accvgpr_write_b32 a106, v30
    v_accvgpr_write_b32 a107, v31
    v_perm_b32 v28, v35, v33, s72
    v_perm_b32 v29, v39, v37, s72
    v_perm_b32 v30, v43, v41, s72
    v_perm_b32 v31, v47, v45, s72
    v_accvgpr_write_b32 a184, v28
    v_accvgpr_write_b32 a185, v29
    v_accvgpr_write_b32 a186, v30
    v_accvgpr_write_b32 a187, v31
    v_perm_b32 v200, v35, v33, s73
    v_perm_b32 v201, v39, v37, s73
    v_perm_b32 v202, v43, v41, s73
    v_perm_b32 v203, v47, v45, s73
    v_perm_b32 v28, v50, v48, s72
    v_perm_b32 v29, v54, v52, s72
    v_perm_b32 v30, v58, v56, s72
    v_perm_b32 v31, v62, v60, s72
    v_accvgpr_write_b32 a28, v28
    v_accvgpr_write_b32 a29, v29
    v_accvgpr_write_b32 a30, v30
    v_accvgpr_write_b32 a31, v31
    v_perm_b32 v28, v50, v48, s73
    v_perm_b32 v29, v54, v52, s73
    v_perm_b32 v30, v58, v56, s73
    v_perm_b32 v31, v62, v60, s73
    v_accvgpr_write_b32 a108, v28
    v_accvgpr_write_b32 a109, v29
    v_accvgpr_write_b32 a110, v30
    v_accvgpr_write_b32 a111, v31
    v_perm_b32 v28, v51, v49, s72
    v_perm_b32 v29, v55, v53, s72
    v_perm_b32 v30, v59, v57, s72
    v_perm_b32 v31, v63, v61, s72
    v_accvgpr_write_b32 a188, v28
    v_accvgpr_write_b32 a189, v29
    v_accvgpr_write_b32 a190, v30
    v_accvgpr_write_b32 a191, v31
    v_perm_b32 v204, v51, v49, s73
    v_perm_b32 v205, v55, v53, s73
    v_perm_b32 v206, v59, v57, s73
    v_perm_b32 v207, v63, v61, s73
    s_add_u32 s71, s70, 4718592
    buffer_load_dwordx2 v[32:33], v5, s[64:67], s71 offen
    s_add_u32 s71, s70, 4730880
    buffer_load_dwordx2 v[34:35], v5, s[64:67], s71 offen
    s_add_u32 s71, s70, 4743168
    buffer_load_dwordx2 v[36:37], v5, s[64:67], s71 offen
    s_add_u32 s71, s70, 4755456
    buffer_load_dwordx2 v[38:39], v5, s[64:67], s71 offen
    s_add_u32 s71, s70, 4767744
    buffer_load_dwordx2 v[40:41], v5, s[64:67], s71 offen
    s_add_u32 s71, s70, 4780032
    buffer_load_dwordx2 v[42:43], v5, s[64:67], s71 offen
    s_add_u32 s71, s70, 4792320
    buffer_load_dwordx2 v[44:45], v5, s[64:67], s71 offen
    s_add_u32 s71, s70, 4804608
    buffer_load_dwordx2 v[46:47], v5, s[64:67], s71 offen
    s_add_u32 s71, s70, 5111808
    buffer_load_dwordx2 v[48:49], v5, s[64:67], s71 offen
    s_add_u32 s71, s70, 5124096
    buffer_load_dwordx2 v[50:51], v5, s[64:67], s71 offen
    s_add_u32 s71, s70, 5136384
    buffer_load_dwordx2 v[52:53], v5, s[64:67], s71 offen
    s_add_u32 s71, s70, 5148672
    buffer_load_dwordx2 v[54:55], v5, s[64:67], s71 offen
    s_add_u32 s71, s70, 5160960
    buffer_load_dwordx2 v[56:57], v5, s[64:67], s71 offen
    s_add_u32 s71, s70, 5173248
    buffer_load_dwordx2 v[58:59], v5, s[64:67], s71 offen
    s_add_u32 s71, s70, 5185536
    buffer_load_dwordx2 v[60:61], v5, s[64:67], s71 offen
    s_add_u32 s71, s70, 5197824
    buffer_load_dwordx2 v[62:63], v5, s[64:67], s71 offen
    s_waitcnt vmcnt(32)
    v_perm_b32 v28, v66, v64, s72
    v_perm_b32 v29, v70, v68, s72
    v_perm_b32 v30, v74, v72, s72
    v_perm_b32 v31, v78, v76, s72
    v_accvgpr_write_b32 a32, v28
    v_accvgpr_write_b32 a33, v29
    v_accvgpr_write_b32 a34, v30
    v_accvgpr_write_b32 a35, v31
    v_perm_b32 v28, v66, v64, s73
    v_perm_b32 v29, v70, v68, s73
    v_perm_b32 v30, v74, v72, s73
    v_perm_b32 v31, v78, v76, s73
    v_accvgpr_write_b32 a112, v28
    v_accvgpr_write_b32 a113, v29
    v_accvgpr_write_b32 a114, v30
    v_accvgpr_write_b32 a115, v31
    v_perm_b32 v28, v67, v65, s72
    v_perm_b32 v29, v71, v69, s72
    v_perm_b32 v30, v75, v73, s72
    v_perm_b32 v31, v79, v77, s72
    v_accvgpr_write_b32 a192, v28
    v_accvgpr_write_b32 a193, v29
    v_accvgpr_write_b32 a194, v30
    v_accvgpr_write_b32 a195, v31
    v_perm_b32 v208, v67, v65, s73
    v_perm_b32 v209, v71, v69, s73
    v_perm_b32 v210, v75, v73, s73
    v_perm_b32 v211, v79, v77, s73
    v_perm_b32 v28, v82, v80, s72
    v_perm_b32 v29, v86, v84, s72
    v_perm_b32 v30, v90, v88, s72
    v_perm_b32 v31, v94, v92, s72
    v_accvgpr_write_b32 a36, v28
    v_accvgpr_write_b32 a37, v29
    v_accvgpr_write_b32 a38, v30
    v_accvgpr_write_b32 a39, v31
    v_perm_b32 v28, v82, v80, s73
    v_perm_b32 v29, v86, v84, s73
    v_perm_b32 v30, v90, v88, s73
    v_perm_b32 v31, v94, v92, s73
    v_accvgpr_write_b32 a116, v28
    v_accvgpr_write_b32 a117, v29
    v_accvgpr_write_b32 a118, v30
    v_accvgpr_write_b32 a119, v31
    v_perm_b32 v28, v83, v81, s72
    v_perm_b32 v29, v87, v85, s72
    v_perm_b32 v30, v91, v89, s72
    v_perm_b32 v31, v95, v93, s72
    v_accvgpr_write_b32 a196, v28
    v_accvgpr_write_b32 a197, v29
    v_accvgpr_write_b32 a198, v30
    v_accvgpr_write_b32 a199, v31
    v_perm_b32 v212, v83, v81, s73
    v_perm_b32 v213, v87, v85, s73
    v_perm_b32 v214, v91, v89, s73
    v_perm_b32 v215, v95, v93, s73
    s_add_u32 s71, s70, 5505024
    buffer_load_dwordx2 v[64:65], v5, s[64:67], s71 offen
    s_add_u32 s71, s70, 5517312
    buffer_load_dwordx2 v[66:67], v5, s[64:67], s71 offen
    s_add_u32 s71, s70, 5529600
    buffer_load_dwordx2 v[68:69], v5, s[64:67], s71 offen
    s_add_u32 s71, s70, 5541888
    buffer_load_dwordx2 v[70:71], v5, s[64:67], s71 offen
    s_add_u32 s71, s70, 5554176
    buffer_load_dwordx2 v[72:73], v5, s[64:67], s71 offen
    s_add_u32 s71, s70, 5566464
    buffer_load_dwordx2 v[74:75], v5, s[64:67], s71 offen
    s_add_u32 s71, s70, 5578752
    buffer_load_dwordx2 v[76:77], v5, s[64:67], s71 offen
    s_add_u32 s71, s70, 5591040
    buffer_load_dwordx2 v[78:79], v5, s[64:67], s71 offen
    s_add_u32 s71, s70, 5898240
    buffer_load_dwordx2 v[80:81], v5, s[64:67], s71 offen
    s_add_u32 s71, s70, 5910528
    buffer_load_dwordx2 v[82:83], v5, s[64:67], s71 offen
    s_add_u32 s71, s70, 5922816
    buffer_load_dwordx2 v[84:85], v5, s[64:67], s71 offen
    s_add_u32 s71, s70, 5935104
    buffer_load_dwordx2 v[86:87], v5, s[64:67], s71 offen
    s_add_u32 s71, s70, 5947392
    buffer_load_dwordx2 v[88:89], v5, s[64:67], s71 offen
    s_add_u32 s71, s70, 5959680
    buffer_load_dwordx2 v[90:91], v5, s[64:67], s71 offen
    s_add_u32 s71, s70, 5971968
    buffer_load_dwordx2 v[92:93], v5, s[64:67], s71 offen
    s_add_u32 s71, s70, 5984256
    buffer_load_dwordx2 v[94:95], v5, s[64:67], s71 offen
    s_waitcnt vmcnt(32)
    v_perm_b32 v28, v98, v96, s72
    v_perm_b32 v29, v102, v100, s72
    v_perm_b32 v30, v106, v104, s72
    v_perm_b32 v31, v110, v108, s72
    v_accvgpr_write_b32 a40, v28
    v_accvgpr_write_b32 a41, v29
    v_accvgpr_write_b32 a42, v30
    v_accvgpr_write_b32 a43, v31
    v_perm_b32 v28, v98, v96, s73
    v_perm_b32 v29, v102, v100, s73
    v_perm_b32 v30, v106, v104, s73
    v_perm_b32 v31, v110, v108, s73
    v_accvgpr_write_b32 a120, v28
    v_accvgpr_write_b32 a121, v29
    v_accvgpr_write_b32 a122, v30
    v_accvgpr_write_b32 a123, v31
    v_perm_b32 v28, v99, v97, s72
    v_perm_b32 v29, v103, v101, s72
    v_perm_b32 v30, v107, v105, s72
    v_perm_b32 v31, v111, v109, s72
    v_accvgpr_write_b32 a200, v28
    v_accvgpr_write_b32 a201, v29
    v_accvgpr_write_b32 a202, v30
    v_accvgpr_write_b32 a203, v31
    v_perm_b32 v216, v99, v97, s73
    v_perm_b32 v217, v103, v101, s73
    v_perm_b32 v218, v107, v105, s73
    v_perm_b32 v219, v111, v109, s73
    v_perm_b32 v28, v114, v112, s72
    v_perm_b32 v29, v118, v116, s72
    v_perm_b32 v30, v122, v120, s72
    v_perm_b32 v31, v126, v124, s72
    v_accvgpr_write_b32 a44, v28
    v_accvgpr_write_b32 a45, v29
    v_accvgpr_write_b32 a46, v30
    v_accvgpr_write_b32 a47, v31
    v_perm_b32 v28, v114, v112, s73
    v_perm_b32 v29, v118, v116, s73
    v_perm_b32 v30, v122, v120, s73
    v_perm_b32 v31, v126, v124, s73
    v_accvgpr_write_b32 a124, v28
    v_accvgpr_write_b32 a125, v29
    v_accvgpr_write_b32 a126, v30
    v_accvgpr_write_b32 a127, v31
    v_perm_b32 v28, v115, v113, s72
    v_perm_b32 v29, v119, v117, s72
    v_perm_b32 v30, v123, v121, s72
    v_perm_b32 v31, v127, v125, s72
    v_accvgpr_write_b32 a204, v28
    v_accvgpr_write_b32 a205, v29
    v_accvgpr_write_b32 a206, v30
    v_accvgpr_write_b32 a207, v31
    v_perm_b32 v220, v115, v113, s73
    v_perm_b32 v221, v119, v117, s73
    v_perm_b32 v222, v123, v121, s73
    v_perm_b32 v223, v127, v125, s73
    s_add_u32 s71, s70, 6291456
    buffer_load_dwordx2 v[96:97], v5, s[64:67], s71 offen
    s_add_u32 s71, s70, 6303744
    buffer_load_dwordx2 v[98:99], v5, s[64:67], s71 offen
    s_add_u32 s71, s70, 6316032
    buffer_load_dwordx2 v[100:101], v5, s[64:67], s71 offen
    s_add_u32 s71, s70, 6328320
    buffer_load_dwordx2 v[102:103], v5, s[64:67], s71 offen
    s_add_u32 s71, s70, 6340608
    buffer_load_dwordx2 v[104:105], v5, s[64:67], s71 offen
    s_add_u32 s71, s70, 6352896
    buffer_load_dwordx2 v[106:107], v5, s[64:67], s71 offen
    s_add_u32 s71, s70, 6365184
    buffer_load_dwordx2 v[108:109], v5, s[64:67], s71 offen
    s_add_u32 s71, s70, 6377472
    buffer_load_dwordx2 v[110:111], v5, s[64:67], s71 offen
    s_add_u32 s71, s70, 6684672
    buffer_load_dwordx2 v[112:113], v5, s[64:67], s71 offen
    s_add_u32 s71, s70, 6696960
    buffer_load_dwordx2 v[114:115], v5, s[64:67], s71 offen
    s_add_u32 s71, s70, 6709248
    buffer_load_dwordx2 v[116:117], v5, s[64:67], s71 offen
    s_add_u32 s71, s70, 6721536
    buffer_load_dwordx2 v[118:119], v5, s[64:67], s71 offen
    s_add_u32 s71, s70, 6733824
    buffer_load_dwordx2 v[120:121], v5, s[64:67], s71 offen
    s_add_u32 s71, s70, 6746112
    buffer_load_dwordx2 v[122:123], v5, s[64:67], s71 offen
    s_add_u32 s71, s70, 6758400
    buffer_load_dwordx2 v[124:125], v5, s[64:67], s71 offen
    s_add_u32 s71, s70, 6770688
    buffer_load_dwordx2 v[126:127], v5, s[64:67], s71 offen
    s_waitcnt vmcnt(32)
    v_perm_b32 v28, v34, v32, s72
    v_perm_b32 v29, v38, v36, s72
    v_perm_b32 v30, v42, v40, s72
    v_perm_b32 v31, v46, v44, s72
    v_accvgpr_write_b32 a48, v28
    v_accvgpr_write_b32 a49, v29
    v_accvgpr_write_b32 a50, v30
    v_accvgpr_write_b32 a51, v31
    v_perm_b32 v28, v34, v32, s73
    v_perm_b32 v29, v38, v36, s73
    v_perm_b32 v30, v42, v40, s73
    v_perm_b32 v31, v46, v44, s73
    v_accvgpr_write_b32 a128, v28
    v_accvgpr_write_b32 a129, v29
    v_accvgpr_write_b32 a130, v30
    v_accvgpr_write_b32 a131, v31
    v_perm_b32 v28, v35, v33, s72
    v_perm_b32 v29, v39, v37, s72
    v_perm_b32 v30, v43, v41, s72
    v_perm_b32 v31, v47, v45, s72
    v_accvgpr_write_b32 a208, v28
    v_accvgpr_write_b32 a209, v29
    v_accvgpr_write_b32 a210, v30
    v_accvgpr_write_b32 a211, v31
    v_perm_b32 v224, v35, v33, s73
    v_perm_b32 v225, v39, v37, s73
    v_perm_b32 v226, v43, v41, s73
    v_perm_b32 v227, v47, v45, s73
    v_perm_b32 v28, v50, v48, s72
    v_perm_b32 v29, v54, v52, s72
    v_perm_b32 v30, v58, v56, s72
    v_perm_b32 v31, v62, v60, s72
    v_accvgpr_write_b32 a52, v28
    v_accvgpr_write_b32 a53, v29
    v_accvgpr_write_b32 a54, v30
    v_accvgpr_write_b32 a55, v31
    v_perm_b32 v28, v50, v48, s73
    v_perm_b32 v29, v54, v52, s73
    v_perm_b32 v30, v58, v56, s73
    v_perm_b32 v31, v62, v60, s73
    v_accvgpr_write_b32 a132, v28
    v_accvgpr_write_b32 a133, v29
    v_accvgpr_write_b32 a134, v30
    v_accvgpr_write_b32 a135, v31
    v_perm_b32 v28, v51, v49, s72
    v_perm_b32 v29, v55, v53, s72
    v_perm_b32 v30, v59, v57, s72
    v_perm_b32 v31, v63, v61, s72
    v_accvgpr_write_b32 a212, v28
    v_accvgpr_write_b32 a213, v29
    v_accvgpr_write_b32 a214, v30
    v_accvgpr_write_b32 a215, v31
    v_perm_b32 v228, v51, v49, s73
    v_perm_b32 v229, v55, v53, s73
    v_perm_b32 v230, v59, v57, s73
    v_perm_b32 v231, v63, v61, s73
    s_add_u32 s71, s70, 7077888
    buffer_load_dwordx2 v[32:33], v5, s[64:67], s71 offen
    s_add_u32 s71, s70, 7090176
    buffer_load_dwordx2 v[34:35], v5, s[64:67], s71 offen
    s_add_u32 s71, s70, 7102464
    buffer_load_dwordx2 v[36:37], v5, s[64:67], s71 offen
    s_add_u32 s71, s70, 7114752
    buffer_load_dwordx2 v[38:39], v5, s[64:67], s71 offen
    s_add_u32 s71, s70, 7127040
    buffer_load_dwordx2 v[40:41], v5, s[64:67], s71 offen
    s_add_u32 s71, s70, 7139328
    buffer_load_dwordx2 v[42:43], v5, s[64:67], s71 offen
    s_add_u32 s71, s70, 7151616
    buffer_load_dwordx2 v[44:45], v5, s[64:67], s71 offen
    s_add_u32 s71, s70, 7163904
    buffer_load_dwordx2 v[46:47], v5, s[64:67], s71 offen
    s_add_u32 s71, s70, 7471104
    buffer_load_dwordx2 v[48:49], v5, s[64:67], s71 offen
    s_add_u32 s71, s70, 7483392
    buffer_load_dwordx2 v[50:51], v5, s[64:67], s71 offen
    s_add_u32 s71, s70, 7495680
    buffer_load_dwordx2 v[52:53], v5, s[64:67], s71 offen
    s_add_u32 s71, s70, 7507968
    buffer_load_dwordx2 v[54:55], v5, s[64:67], s71 offen
    s_add_u32 s71, s70, 7520256
    buffer_load_dwordx2 v[56:57], v5, s[64:67], s71 offen
    s_add_u32 s71, s70, 7532544
    buffer_load_dwordx2 v[58:59], v5, s[64:67], s71 offen
    s_add_u32 s71, s70, 7544832
    buffer_load_dwordx2 v[60:61], v5, s[64:67], s71 offen
    s_add_u32 s71, s70, 7557120
    buffer_load_dwordx2 v[62:63], v5, s[64:67], s71 offen
    s_waitcnt vmcnt(32)
    v_perm_b32 v28, v66, v64, s72
    v_perm_b32 v29, v70, v68, s72
    v_perm_b32 v30, v74, v72, s72
    v_perm_b32 v31, v78, v76, s72
    v_accvgpr_write_b32 a56, v28
    v_accvgpr_write_b32 a57, v29
    v_accvgpr_write_b32 a58, v30
    v_accvgpr_write_b32 a59, v31
    v_perm_b32 v28, v66, v64, s73
    v_perm_b32 v29, v70, v68, s73
    v_perm_b32 v30, v74, v72, s73
    v_perm_b32 v31, v78, v76, s73
    v_accvgpr_write_b32 a136, v28
    v_accvgpr_write_b32 a137, v29
    v_accvgpr_write_b32 a138, v30
    v_accvgpr_write_b32 a139, v31
    v_perm_b32 v28, v67, v65, s72
    v_perm_b32 v29, v71, v69, s72
    v_perm_b32 v30, v75, v73, s72
    v_perm_b32 v31, v79, v77, s72
    v_accvgpr_write_b32 a216, v28
    v_accvgpr_write_b32 a217, v29
    v_accvgpr_write_b32 a218, v30
    v_accvgpr_write_b32 a219, v31
    v_perm_b32 v232, v67, v65, s73
    v_perm_b32 v233, v71, v69, s73
    v_perm_b32 v234, v75, v73, s73
    v_perm_b32 v235, v79, v77, s73
    v_perm_b32 v28, v82, v80, s72
    v_perm_b32 v29, v86, v84, s72
    v_perm_b32 v30, v90, v88, s72
    v_perm_b32 v31, v94, v92, s72
    v_accvgpr_write_b32 a60, v28
    v_accvgpr_write_b32 a61, v29
    v_accvgpr_write_b32 a62, v30
    v_accvgpr_write_b32 a63, v31
    v_perm_b32 v28, v82, v80, s73
    v_perm_b32 v29, v86, v84, s73
    v_perm_b32 v30, v90, v88, s73
    v_perm_b32 v31, v94, v92, s73
    v_accvgpr_write_b32 a140, v28
    v_accvgpr_write_b32 a141, v29
    v_accvgpr_write_b32 a142, v30
    v_accvgpr_write_b32 a143, v31
    v_perm_b32 v28, v83, v81, s72
    v_perm_b32 v29, v87, v85, s72
    v_perm_b32 v30, v91, v89, s72
    v_perm_b32 v31, v95, v93, s72
    v_accvgpr_write_b32 a220, v28
    v_accvgpr_write_b32 a221, v29
    v_accvgpr_write_b32 a222, v30
    v_accvgpr_write_b32 a223, v31
    v_perm_b32 v236, v83, v81, s73
    v_perm_b32 v237, v87, v85, s73
    v_perm_b32 v238, v91, v89, s73
    v_perm_b32 v239, v95, v93, s73
    s_waitcnt vmcnt(16)
    v_perm_b32 v28, v98, v96, s72
    v_perm_b32 v29, v102, v100, s72
    v_perm_b32 v30, v106, v104, s72
    v_perm_b32 v31, v110, v108, s72
    v_accvgpr_write_b32 a64, v28
    v_accvgpr_write_b32 a65, v29
    v_accvgpr_write_b32 a66, v30
    v_accvgpr_write_b32 a67, v31
    v_perm_b32 v28, v98, v96, s73
    v_perm_b32 v29, v102, v100, s73
    v_perm_b32 v30, v106, v104, s73
    v_perm_b32 v31, v110, v108, s73
    v_accvgpr_write_b32 a144, v28
    v_accvgpr_write_b32 a145, v29
    v_accvgpr_write_b32 a146, v30
    v_accvgpr_write_b32 a147, v31
    v_perm_b32 v28, v99, v97, s72
    v_perm_b32 v29, v103, v101, s72
    v_perm_b32 v30, v107, v105, s72
    v_perm_b32 v31, v111, v109, s72
    v_accvgpr_write_b32 a224, v28
    v_accvgpr_write_b32 a225, v29
    v_accvgpr_write_b32 a226, v30
    v_accvgpr_write_b32 a227, v31
    v_perm_b32 v240, v99, v97, s73
    v_perm_b32 v241, v103, v101, s73
    v_perm_b32 v242, v107, v105, s73
    v_perm_b32 v243, v111, v109, s73
    v_perm_b32 v28, v114, v112, s72
    v_perm_b32 v29, v118, v116, s72
    v_perm_b32 v30, v122, v120, s72
    v_perm_b32 v31, v126, v124, s72
    v_accvgpr_write_b32 a68, v28
    v_accvgpr_write_b32 a69, v29
    v_accvgpr_write_b32 a70, v30
    v_accvgpr_write_b32 a71, v31
    v_perm_b32 v28, v114, v112, s73
    v_perm_b32 v29, v118, v116, s73
    v_perm_b32 v30, v122, v120, s73
    v_perm_b32 v31, v126, v124, s73
    v_accvgpr_write_b32 a148, v28
    v_accvgpr_write_b32 a149, v29
    v_accvgpr_write_b32 a150, v30
    v_accvgpr_write_b32 a151, v31
    v_perm_b32 v28, v115, v113, s72
    v_perm_b32 v29, v119, v117, s72
    v_perm_b32 v30, v123, v121, s72
    v_perm_b32 v31, v127, v125, s72
    v_accvgpr_write_b32 a228, v28
    v_accvgpr_write_b32 a229, v29
    v_accvgpr_write_b32 a230, v30
    v_accvgpr_write_b32 a231, v31
    v_perm_b32 v244, v115, v113, s73
    v_perm_b32 v245, v119, v117, s73
    v_perm_b32 v246, v123, v121, s73
    v_perm_b32 v247, v127, v125, s73
    s_waitcnt vmcnt(0)
    v_perm_b32 v28, v34, v32, s72
    v_perm_b32 v29, v38, v36, s72
    v_perm_b32 v30, v42, v40, s72
    v_perm_b32 v31, v46, v44, s72
    v_accvgpr_write_b32 a72, v28
    v_accvgpr_write_b32 a73, v29
    v_accvgpr_write_b32 a74, v30
    v_accvgpr_write_b32 a75, v31
    v_perm_b32 v28, v34, v32, s73
    v_perm_b32 v29, v38, v36, s73
    v_perm_b32 v30, v42, v40, s73
    v_perm_b32 v31, v46, v44, s73
    v_accvgpr_write_b32 a152, v28
    v_accvgpr_write_b32 a153, v29
    v_accvgpr_write_b32 a154, v30
    v_accvgpr_write_b32 a155, v31
    v_perm_b32 v28, v35, v33, s72
    v_perm_b32 v29, v39, v37, s72
    v_perm_b32 v30, v43, v41, s72
    v_perm_b32 v31, v47, v45, s72
    v_accvgpr_write_b32 a232, v28
    v_accvgpr_write_b32 a233, v29
    v_accvgpr_write_b32 a234, v30
    v_accvgpr_write_b32 a235, v31
    v_perm_b32 v248, v35, v33, s73
    v_perm_b32 v249, v39, v37, s73
    v_perm_b32 v250, v43, v41, s73
    v_perm_b32 v251, v47, v45, s73
    v_perm_b32 v28, v50, v48, s72
    v_perm_b32 v29, v54, v52, s72
    v_perm_b32 v30, v58, v56, s72
    v_perm_b32 v31, v62, v60, s72
    v_accvgpr_write_b32 a76, v28
    v_accvgpr_write_b32 a77, v29
    v_accvgpr_write_b32 a78, v30
    v_accvgpr_write_b32 a79, v31
    v_perm_b32 v28, v50, v48, s73
    v_perm_b32 v29, v54, v52, s73
    v_perm_b32 v30, v58, v56, s73
    v_perm_b32 v31, v62, v60, s73
    v_accvgpr_write_b32 a156, v28
    v_accvgpr_write_b32 a157, v29
    v_accvgpr_write_b32 a158, v30
    v_accvgpr_write_b32 a159, v31
    v_perm_b32 v28, v51, v49, s72
    v_perm_b32 v29, v55, v53, s72
    v_perm_b32 v30, v59, v57, s72
    v_perm_b32 v31, v63, v61, s72
    v_accvgpr_write_b32 a236, v28
    v_accvgpr_write_b32 a237, v29
    v_accvgpr_write_b32 a238, v30
    v_accvgpr_write_b32 a239, v31
    v_perm_b32 v252, v51, v49, s73
    v_perm_b32 v253, v55, v53, s73
    v_perm_b32 v254, v59, v57, s73
    v_perm_b32 v255, v63, v61, s73
    v_mov_b32 v21, v20
    v_add_u32 v22, 40960, v20
    s_mov_b32 s20, 16384
    s_mov_b32 s3, 49152
    v_mul_lo_u32 v23, v4, s3
    v_lshl_add_u32 v23, v3, 3, v23
    v_add_u32 v23, s70, v23
    s_mul_hi_u32 s22, s19, 0x1555556
    s_mul_i32 s23, s22, 192
    s_sub_u32 s23, s19, s23
    v_lshrrev_b32 v24, 3, v3
    s_lshr_b32 s3, s23, 5
    v_add_u32 v24, s3, v24
    v_lshlrev_b32 v24, 10, v24
    v_bfe_u32 v25, v3, 1, 2
    v_lshl_add_u32 v24, v25, 8, v24
    v_lshl_add_u32 v24, v4, 6, v24
    v_and_b32 v25, 1, v3
    v_lshl_add_u32 v24, v25, 3, v24
    s_mul_i32 s24, s22, 786432
    s_mov_b32 s25, 7880704
    s_cmp_eq_u32 s18, 1
    s_cselect_b32 s25, 33046528, s25
    s_cmp_eq_u32 s18, 2
    s_cselect_b32 s25, 58212352, s25
    s_add_u32 s24, s24, s25
    s_lshl_b32 s3, s74, 12
    s_add_u32 s3, s3, 81920
    v_lshlrev_b32 v26, 9, v4
    v_lshl_add_u32 v26, v3, 3, v26
    v_add_u32 v26, s3, v26
    v_lshrrev_b32 v27, 3, v3
    v_lshlrev_b32 v27, 10, v27
    v_bfe_u32 v25, v3, 1, 2
    v_lshl_add_u32 v27, v25, 8, v27
    v_lshl_add_u32 v27, v4, 6, v27
    v_and_b32 v25, 1, v3
    v_lshl_add_u32 v27, v25, 3, v27
    v_add_u32 v27, s3, v27
    v_add_u32 v28, s3, v20
    v_lshrrev_b32 v29, 3, v2
    s_movk_i32 s3, 12288
    v_mul_lo_u32 v29, v29, s3
    v_and_b32 v25, 7, v2
    v_lshl_add_u32 v29, v25, 4, v29
    v_add_u32 v29, s70, v29
    s_lshr_b32 s3, s23, 5
    s_lshl_b32 s3, s3, 10
    v_add_u32 v30, s3, v20
    s_cmp_eq_u32 s18, 0
    s_cbranch_scc1 mega_kernel_nq289
mega_kernel_nq289:
    v_mov_b32 v101, 160
    s_mov_b32 s69, 0
mega_kernel_cw90:
    buffer_load_dword v100, v101, s[88:91], 0 offen sc1
    s_add_u32 s69, s69, 1
    s_cmp_ge_u32 s69, 1048576
    s_cbranch_scc1 mega_kernel_cwo91
    s_waitcnt vmcnt(0)
    v_cmp_gt_u32 vcc, 128, v100
    s_cbranch_vccz mega_kernel_cwo91
    s_sleep 8
    s_branch mega_kernel_cw90
mega_kernel_cwo91:
    v_mov_b32 v101, 192
    s_mov_b32 s69, 0
mega_kernel_cw92:
    buffer_load_dword v100, v101, s[88:91], 0 offen sc1
    s_add_u32 s69, s69, 1
    s_cmp_ge_u32 s69, 1048576
    s_cbranch_scc1 mega_kernel_cwo93
    s_waitcnt vmcnt(0)
    v_cmp_gt_u32 vcc, 256, v100
    s_cbranch_vccz mega_kernel_cwo93
    s_sleep 8
    s_branch mega_kernel_cw92
mega_kernel_cwo93:
    s_mul_i32 s79, s74, 10240
    s_add_u32 s76, s20, s79
    s_mov_b32 s77, s79
    s_add_u32 s78, s79, 40960
    s_mov_b32 s75, 0
    s_add_u32 m0, s77, 0
    s_add_u32 s71, s76, 0
    buffer_load_dwordx4 v20, s[60:63], s71 offen lds
    s_add_u32 m0, s77, 1024
    s_add_u32 s71, s76, 1024
    buffer_load_dwordx4 v20, s[60:63], s71 offen lds
    s_add_u32 m0, s77, 2048
    s_add_u32 s71, s76, 2048
    buffer_load_dwordx4 v20, s[60:63], s71 offen lds
    s_add_u32 m0, s77, 3072
    s_add_u32 s71, s76, 3072
    buffer_load_dwordx4 v20, s[60:63], s71 offen lds
    s_add_u32 m0, s77, 4096
    s_add_u32 s71, s76, 4096
    buffer_load_dwordx4 v20, s[60:63], s71 offen lds
    s_add_u32 m0, s77, 5120
    s_add_u32 s71, s76, 5120
    buffer_load_dwordx4 v20, s[60:63], s71 offen lds
    s_add_u32 m0, s77, 6144
    s_add_u32 s71, s76, 6144
    buffer_load_dwordx4 v20, s[60:63], s71 offen lds
    s_add_u32 m0, s77, 7168
    s_add_u32 s71, s76, 7168
    buffer_load_dwordx4 v20, s[60:63], s71 offen lds
    s_add_u32 m0, s77, 8192
    s_add_u32 s71, s76, 8192
    buffer_load_dwordx4 v20, s[60:63], s71 offen lds
    s_add_u32 m0, s77, 9216
    s_add_u32 s71, s76, 9216
    buffer_load_dwordx4 v20, s[60:63], s71 offen lds
    s_add_u32 s76, s76, 40960
    s_waitcnt vmcnt(0)
mega_kernel_loop94:
    s_waitcnt vmcnt(4)
    s_barrier
    s_cmp_lt_u32 s75, 4
    s_cbranch_scc1 mega_kernel_nof96
    s_sub_u32 s68, s75, 1
    s_cmp_lg_u32 s74, 0
    s_cbranch_scc1 mega_kernel_pf97
    v_mov_b32 v150, s68
    v_mov_b32 v151, 0
    s_lshl_b32 s71, s16, 2
    s_add_u32 s71, s71, 204500992
    s_mov_b64 exec, 1
    buffer_store_dword v150, v151, s[60:63], s71 offen sc1
    s_mov_b64 exec, -1
mega_kernel_pf97:
mega_kernel_nof96:
    s_cmp_ge_u32 s75, 63
    s_cbranch_scc1 mega_kernel_skip95
    s_add_u32 m0, s78, 0
    s_add_u32 s71, s76, 0
    buffer_load_dwordx4 v20, s[60:63], s71 offen lds
    s_add_u32 m0, s78, 1024
    s_add_u32 s71, s76, 1024
    buffer_load_dwordx4 v20, s[60:63], s71 offen lds
    s_add_u32 m0, s78, 2048
    s_add_u32 s71, s76, 2048
    buffer_load_dwordx4 v20, s[60:63], s71 offen lds
    s_add_u32 m0, s78, 3072
    s_add_u32 s71, s76, 3072
    buffer_load_dwordx4 v20, s[60:63], s71 offen lds
    s_add_u32 m0, s78, 4096
    s_add_u32 s71, s76, 4096
    buffer_load_dwordx4 v20, s[60:63], s71 offen lds
    s_add_u32 m0, s78, 5120
    s_add_u32 s71, s76, 5120
    buffer_load_dwordx4 v20, s[60:63], s71 offen lds
    s_add_u32 m0, s78, 6144
    s_add_u32 s71, s76, 6144
    buffer_load_dwordx4 v20, s[60:63], s71 offen lds
    s_add_u32 m0, s78, 7168
    s_add_u32 s71, s76, 7168
    buffer_load_dwordx4 v20, s[60:63], s71 offen lds
    s_add_u32 m0, s78, 8192
    s_add_u32 s71, s76, 8192
    buffer_load_dwordx4 v20, s[60:63], s71 offen lds
    s_add_u32 m0, s78, 9216
    s_add_u32 s71, s76, 9216
    buffer_load_dwordx4 v20, s[60:63], s71 offen lds
    s_add_u32 s76, s76, 40960
mega_kernel_skip95:
    ds_read_b128 v[64:67], v21 offset:0
    ds_read_b128 v[68:71], v21 offset:20480
    ds_read_b128 v[72:75], v21 offset:1024
    ds_read_b128 v[76:79], v21 offset:21504
    s_waitcnt lgkmcnt(3)
    v_mfma_f32_16x16x32_bf16 v[32:35], v[64:67], a[0:3], 0
    v_mfma_f32_16x16x32_bf16 v[36:39], v[64:67], a[80:83], 0
    v_mfma_f32_16x16x32_bf16 v[40:43], v[64:67], a[160:163], 0
    v_mfma_f32_16x16x32_bf16 v[44:47], v[64:67], a[240:243], 0
    ds_read_b128 v[64:67], v21 offset:2048
    s_waitcnt lgkmcnt(3)
    v_mfma_f32_16x16x32_bf16 v[48:51], v[68:71], a[0:3], 0
    v_mfma_f32_16x16x32_bf16 v[52:55], v[68:71], a[80:83], 0
    v_mfma_f32_16x16x32_bf16 v[56:59], v[68:71], a[160:163], 0
    v_mfma_f32_16x16x32_bf16 v[60:63], v[68:71], a[240:243], 0
    ds_read_b128 v[68:71], v21 offset:22528
    s_waitcnt lgkmcnt(3)
    v_mfma_f32_16x16x32_bf16 v[32:35], v[72:75], a[4:7], v[32:35]
    v_mfma_f32_16x16x32_bf16 v[36:39], v[72:75], a[84:87], v[36:39]
    v_mfma_f32_16x16x32_bf16 v[40:43], v[72:75], a[164:167], v[40:43]
    v_mfma_f32_16x16x32_bf16 v[44:47], v[72:75], a[244:247], v[44:47]
    ds_read_b128 v[72:75], v21 offset:3072
    s_waitcnt lgkmcnt(3)
    v_mfma_f32_16x16x32_bf16 v[48:51], v[76:79], a[4:7], v[48:51]
    v_mfma_f32_16x16x32_bf16 v[52:55], v[76:79], a[84:87], v[52:55]
    v_mfma_f32_16x16x32_bf16 v[56:59], v[76:79], a[164:167], v[56:59]
    v_mfma_f32_16x16x32_bf16 v[60:63], v[76:79], a[244:247], v[60:63]
    ds_read_b128 v[76:79], v21 offset:23552
    s_waitcnt lgkmcnt(3)
    v_mfma_f32_16x16x32_bf16 v[32:35], v[64:67], a[8:11], v[32:35]
    v_mfma_f32_16x16x32_bf16 v[36:39], v[64:67], a[88:91], v[36:39]
    v_mfma_f32_16x16x32_bf16 v[40:43], v[64:67], a[168:171], v[40:43]
    v_mfma_f32_16x16x32_bf16 v[44:47], v[64:67], a[248:251], v[44:47]
    ds_read_b128 v[64:67], v21 offset:4096
    s_waitcnt lgkmcnt(3)
    v_mfma_f32_16x16x32_bf16 v[48:51], v[68:71], a[8:11], v[48:51]
    v_mfma_f32_16x16x32_bf16 v[52:55], v[68:71], a[88:91], v[52:55]
    v_mfma_f32_16x16x32_bf16 v[56:59], v[68:71], a[168:171], v[56:59]
    v_mfma_f32_16x16x32_bf16 v[60:63], v[68:71], a[248:251], v[60:63]
    ds_read_b128 v[68:71], v21 offset:24576
    s_waitcnt lgkmcnt(3)
    v_mfma_f32_16x16x32_bf16 v[32:35], v[72:75], a[12:15], v[32:35]
    v_mfma_f32_16x16x32_bf16 v[36:39], v[72:75], a[92:95], v[36:39]
    v_mfma_f32_16x16x32_bf16 v[40:43], v[72:75], a[172:175], v[40:43]
    v_mfma_f32_16x16x32_bf16 v[44:47], v[72:75], a[252:255], v[44:47]
    ds_read_b128 v[72:75], v21 offset:5120
    s_waitcnt lgkmcnt(3)
    v_mfma_f32_16x16x32_bf16 v[48:51], v[76:79], a[12:15], v[48:51]
    v_mfma_f32_16x16x32_bf16 v[52:55], v[76:79], a[92:95], v[52:55]
    v_mfma_f32_16x16x32_bf16 v[56:59], v[76:79], a[172:175], v[56:59]
    v_mfma_f32_16x16x32_bf16 v[60:63], v[76:79], a[252:255], v[60:63]
    ds_read_b128 v[76:79], v21 offset:25600
    s_waitcnt lgkmcnt(3)
    v_mfma_f32_16x16x32_bf16 v[32:35], v[64:67], a[16:19], v[32:35]
    v_mfma_f32_16x16x32_bf16 v[36:39], v[64:67], a[96:99], v[36:39]
    v_mfma_f32_16x16x32_bf16 v[40:43], v[64:67], a[176:179], v[40:43]
    v_mfma_f32_16x16x32_bf16 v[44:47], v[64:67], v[192:195], v[44:47]
    ds_read_b128 v[64:67], v21 offset:6144
    s_waitcnt lgkmcnt(3)
    v_mfma_f32_16x16x32_bf16 v[48:51], v[68:71], a[16:19], v[48:51]
    v_mfma_f32_16x16x32_bf16 v[52:55], v[68:71], a[96:99], v[52:55]
    v_mfma_f32_16x16x32_bf16 v[56:59], v[68:71], a[176:179], v[56:59]
    v_mfma_f32_16x16x32_bf16 v[60:63], v[68:71], v[192:195], v[60:63]
    ds_read_b128 v[68:71], v21 offset:26624
    s_waitcnt lgkmcnt(3)
    v_mfma_f32_16x16x32_bf16 v[32:35], v[72:75], a[20:23], v[32:35]
    v_mfma_f32_16x16x32_bf16 v[36:39], v[72:75], a[100:103], v[36:39]
    v_mfma_f32_16x16x32_bf16 v[40:43], v[72:75], a[180:183], v[40:43]
    v_mfma_f32_16x16x32_bf16 v[44:47], v[72:75], v[196:199], v[44:47]
    ds_read_b128 v[72:75], v21 offset:7168
    s_waitcnt lgkmcnt(3)
    v_mfma_f32_16x16x32_bf16 v[48:51], v[76:79], a[20:23], v[48:51]
    v_mfma_f32_16x16x32_bf16 v[52:55], v[76:79], a[100:103], v[52:55]
    v_mfma_f32_16x16x32_bf16 v[56:59], v[76:79], a[180:183], v[56:59]
    v_mfma_f32_16x16x32_bf16 v[60:63], v[76:79], v[196:199], v[60:63]
    ds_read_b128 v[76:79], v21 offset:27648
    s_waitcnt lgkmcnt(3)
    v_mfma_f32_16x16x32_bf16 v[32:35], v[64:67], a[24:27], v[32:35]
    v_mfma_f32_16x16x32_bf16 v[36:39], v[64:67], a[104:107], v[36:39]
    v_mfma_f32_16x16x32_bf16 v[40:43], v[64:67], a[184:187], v[40:43]
    v_mfma_f32_16x16x32_bf16 v[44:47], v[64:67], v[200:203], v[44:47]
    ds_read_b128 v[64:67], v21 offset:8192
    s_waitcnt lgkmcnt(3)
    v_mfma_f32_16x16x32_bf16 v[48:51], v[68:71], a[24:27], v[48:51]
    v_mfma_f32_16x16x32_bf16 v[52:55], v[68:71], a[104:107], v[52:55]
    v_mfma_f32_16x16x32_bf16 v[56:59], v[68:71], a[184:187], v[56:59]
    v_mfma_f32_16x16x32_bf16 v[60:63], v[68:71], v[200:203], v[60:63]
    ds_read_b128 v[68:71], v21 offset:28672
    s_waitcnt lgkmcnt(3)
    v_mfma_f32_16x16x32_bf16 v[32:35], v[72:75], a[28:31], v[32:35]
    v_mfma_f32_16x16x32_bf16 v[36:39], v[72:75], a[108:111], v[36:39]
    v_mfma_f32_16x16x32_bf16 v[40:43], v[72:75], a[188:191], v[40:43]
    v_mfma_f32_16x16x32_bf16 v[44:47], v[72:75], v[204:207], v[44:47]
    ds_read_b128 v[72:75], v21 offset:9216
    s_waitcnt lgkmcnt(3)
    v_mfma_f32_16x16x32_bf16 v[48:51], v[76:79], a[28:31], v[48:51]
    v_mfma_f32_16x16x32_bf16 v[52:55], v[76:79], a[108:111], v[52:55]
    v_mfma_f32_16x16x32_bf16 v[56:59], v[76:79], a[188:191], v[56:59]
    v_mfma_f32_16x16x32_bf16 v[60:63], v[76:79], v[204:207], v[60:63]
    ds_read_b128 v[76:79], v21 offset:29696
    s_waitcnt lgkmcnt(3)
    v_mfma_f32_16x16x32_bf16 v[32:35], v[64:67], a[32:35], v[32:35]
    v_mfma_f32_16x16x32_bf16 v[36:39], v[64:67], a[112:115], v[36:39]
    v_mfma_f32_16x16x32_bf16 v[40:43], v[64:67], a[192:195], v[40:43]
    v_mfma_f32_16x16x32_bf16 v[44:47], v[64:67], v[208:211], v[44:47]
    ds_read_b128 v[64:67], v21 offset:10240
    s_waitcnt lgkmcnt(3)
    v_mfma_f32_16x16x32_bf16 v[48:51], v[68:71], a[32:35], v[48:51]
    v_mfma_f32_16x16x32_bf16 v[52:55], v[68:71], a[112:115], v[52:55]
    v_mfma_f32_16x16x32_bf16 v[56:59], v[68:71], a[192:195], v[56:59]
    v_mfma_f32_16x16x32_bf16 v[60:63], v[68:71], v[208:211], v[60:63]
    ds_read_b128 v[68:71], v21 offset:30720
    s_waitcnt lgkmcnt(3)
    v_mfma_f32_16x16x32_bf16 v[32:35], v[72:75], a[36:39], v[32:35]
    v_mfma_f32_16x16x32_bf16 v[36:39], v[72:75], a[116:119], v[36:39]
    v_mfma_f32_16x16x32_bf16 v[40:43], v[72:75], a[196:199], v[40:43]
    v_mfma_f32_16x16x32_bf16 v[44:47], v[72:75], v[212:215], v[44:47]
    ds_read_b128 v[72:75], v21 offset:11264
    s_waitcnt lgkmcnt(3)
    v_mfma_f32_16x16x32_bf16 v[48:51], v[76:79], a[36:39], v[48:51]
    v_mfma_f32_16x16x32_bf16 v[52:55], v[76:79], a[116:119], v[52:55]
    v_mfma_f32_16x16x32_bf16 v[56:59], v[76:79], a[196:199], v[56:59]
    v_mfma_f32_16x16x32_bf16 v[60:63], v[76:79], v[212:215], v[60:63]
    ds_read_b128 v[76:79], v21 offset:31744
    s_waitcnt lgkmcnt(3)
    v_mfma_f32_16x16x32_bf16 v[32:35], v[64:67], a[40:43], v[32:35]
    v_mfma_f32_16x16x32_bf16 v[36:39], v[64:67], a[120:123], v[36:39]
    v_mfma_f32_16x16x32_bf16 v[40:43], v[64:67], a[200:203], v[40:43]
    v_mfma_f32_16x16x32_bf16 v[44:47], v[64:67], v[216:219], v[44:47]
    ds_read_b128 v[64:67], v21 offset:12288
    s_waitcnt lgkmcnt(3)
    v_mfma_f32_16x16x32_bf16 v[48:51], v[68:71], a[40:43], v[48:51]
    v_mfma_f32_16x16x32_bf16 v[52:55], v[68:71], a[120:123], v[52:55]
    v_mfma_f32_16x16x32_bf16 v[56:59], v[68:71], a[200:203], v[56:59]
    v_mfma_f32_16x16x32_bf16 v[60:63], v[68:71], v[216:219], v[60:63]
    ds_read_b128 v[68:71], v21 offset:32768
    s_waitcnt lgkmcnt(3)
    v_mfma_f32_16x16x32_bf16 v[32:35], v[72:75], a[44:47], v[32:35]
    v_mfma_f32_16x16x32_bf16 v[36:39], v[72:75], a[124:127], v[36:39]
    v_mfma_f32_16x16x32_bf16 v[40:43], v[72:75], a[204:207], v[40:43]
    v_mfma_f32_16x16x32_bf16 v[44:47], v[72:75], v[220:223], v[44:47]
    ds_read_b128 v[72:75], v21 offset:13312
    s_waitcnt lgkmcnt(3)
    v_mfma_f32_16x16x32_bf16 v[48:51], v[76:79], a[44:47], v[48:51]
    v_mfma_f32_16x16x32_bf16 v[52:55], v[76:79], a[124:127], v[52:55]
    v_mfma_f32_16x16x32_bf16 v[56:59], v[76:79], a[204:207], v[56:59]
    v_mfma_f32_16x16x32_bf16 v[60:63], v[76:79], v[220:223], v[60:63]
    ds_read_b128 v[76:79], v21 offset:33792
    s_waitcnt lgkmcnt(3)
    v_mfma_f32_16x16x32_bf16 v[32:35], v[64:67], a[48:51], v[32:35]
    v_mfma_f32_16x16x32_bf16 v[36:39], v[64:67], a[128:131], v[36:39]
    v_mfma_f32_16x16x32_bf16 v[40:43], v[64:67], a[208:211], v[40:43]
    v_mfma_f32_16x16x32_bf16 v[44:47], v[64:67], v[224:227], v[44:47]
    ds_read_b128 v[64:67], v21 offset:14336
    s_waitcnt lgkmcnt(3)
    v_mfma_f32_16x16x32_bf16 v[48:51], v[68:71], a[48:51], v[48:51]
    v_mfma_f32_16x16x32_bf16 v[52:55], v[68:71], a[128:131], v[52:55]
    v_mfma_f32_16x16x32_bf16 v[56:59], v[68:71], a[208:211], v[56:59]
    v_mfma_f32_16x16x32_bf16 v[60:63], v[68:71], v[224:227], v[60:63]
    ds_read_b128 v[68:71], v21 offset:34816
    s_waitcnt lgkmcnt(3)
    v_mfma_f32_16x16x32_bf16 v[32:35], v[72:75], a[52:55], v[32:35]
    v_mfma_f32_16x16x32_bf16 v[36:39], v[72:75], a[132:135], v[36:39]
    v_mfma_f32_16x16x32_bf16 v[40:43], v[72:75], a[212:215], v[40:43]
    v_mfma_f32_16x16x32_bf16 v[44:47], v[72:75], v[228:231], v[44:47]
    ds_read_b128 v[72:75], v21 offset:15360
    s_waitcnt lgkmcnt(3)
    v_mfma_f32_16x16x32_bf16 v[48:51], v[76:79], a[52:55], v[48:51]
    v_mfma_f32_16x16x32_bf16 v[52:55], v[76:79], a[132:135], v[52:55]
    v_mfma_f32_16x16x32_bf16 v[56:59], v[76:79], a[212:215], v[56:59]
    v_mfma_f32_16x16x32_bf16 v[60:63], v[76:79], v[228:231], v[60:63]
    ds_read_b128 v[76:79], v21 offset:35840
    s_waitcnt lgkmcnt(3)
    v_mfma_f32_16x16x32_bf16 v[32:35], v[64:67], a[56:59], v[32:35]
    v_mfma_f32_16x16x32_bf16 v[36:39], v[64:67], a[136:139], v[36:39]
    v_mfma_f32_16x16x32_bf16 v[40:43], v[64:67], a[216:219], v[40:43]
    v_mfma_f32_16x16x32_bf16 v[44:47], v[64:67], v[232:235], v[44:47]
    ds_read_b128 v[64:67], v21 offset:16384
    s_waitcnt lgkmcnt(3)
    v_mfma_f32_16x16x32_bf16 v[48:51], v[68:71], a[56:59], v[48:51]
    v_mfma_f32_16x16x32_bf16 v[52:55], v[68:71], a[136:139], v[52:55]
    v_mfma_f32_16x16x32_bf16 v[56:59], v[68:71], a[216:219], v[56:59]
    v_mfma_f32_16x16x32_bf16 v[60:63], v[68:71], v[232:235], v[60:63]
    ds_read_b128 v[68:71], v21 offset:36864
    s_waitcnt lgkmcnt(3)
    v_mfma_f32_16x16x32_bf16 v[32:35], v[72:75], a[60:63], v[32:35]
    v_mfma_f32_16x16x32_bf16 v[36:39], v[72:75], a[140:143], v[36:39]
    v_mfma_f32_16x16x32_bf16 v[40:43], v[72:75], a[220:223], v[40:43]
    v_mfma_f32_16x16x32_bf16 v[44:47], v[72:75], v[236:239], v[44:47]
    ds_read_b128 v[72:75], v21 offset:17408
    s_waitcnt lgkmcnt(3)
    v_mfma_f32_16x16x32_bf16 v[48:51], v[76:79], a[60:63], v[48:51]
    v_mfma_f32_16x16x32_bf16 v[52:55], v[76:79], a[140:143], v[52:55]
    v_mfma_f32_16x16x32_bf16 v[56:59], v[76:79], a[220:223], v[56:59]
    v_mfma_f32_16x16x32_bf16 v[60:63], v[76:79], v[236:239], v[60:63]
    ds_read_b128 v[76:79], v21 offset:37888
    s_waitcnt lgkmcnt(3)
    v_mfma_f32_16x16x32_bf16 v[32:35], v[64:67], a[64:67], v[32:35]
    v_mfma_f32_16x16x32_bf16 v[36:39], v[64:67], a[144:147], v[36:39]
    v_mfma_f32_16x16x32_bf16 v[40:43], v[64:67], a[224:227], v[40:43]
    v_mfma_f32_16x16x32_bf16 v[44:47], v[64:67], v[240:243], v[44:47]
    ds_read_b128 v[64:67], v21 offset:18432
    s_waitcnt lgkmcnt(3)
    v_mfma_f32_16x16x32_bf16 v[48:51], v[68:71], a[64:67], v[48:51]
    v_mfma_f32_16x16x32_bf16 v[52:55], v[68:71], a[144:147], v[52:55]
    v_mfma_f32_16x16x32_bf16 v[56:59], v[68:71], a[224:227], v[56:59]
    v_mfma_f32_16x16x32_bf16 v[60:63], v[68:71], v[240:243], v[60:63]
    ds_read_b128 v[68:71], v21 offset:38912
    s_waitcnt lgkmcnt(3)
    v_mfma_f32_16x16x32_bf16 v[32:35], v[72:75], a[68:71], v[32:35]
    v_mfma_f32_16x16x32_bf16 v[36:39], v[72:75], a[148:151], v[36:39]
    v_mfma_f32_16x16x32_bf16 v[40:43], v[72:75], a[228:231], v[40:43]
    v_mfma_f32_16x16x32_bf16 v[44:47], v[72:75], v[244:247], v[44:47]
    ds_read_b128 v[72:75], v21 offset:19456
    s_waitcnt lgkmcnt(3)
    v_mfma_f32_16x16x32_bf16 v[48:51], v[76:79], a[68:71], v[48:51]
    v_mfma_f32_16x16x32_bf16 v[52:55], v[76:79], a[148:151], v[52:55]
    v_mfma_f32_16x16x32_bf16 v[56:59], v[76:79], a[228:231], v[56:59]
    v_mfma_f32_16x16x32_bf16 v[60:63], v[76:79], v[244:247], v[60:63]
    ds_read_b128 v[76:79], v21 offset:39936
    s_waitcnt lgkmcnt(3)
    v_mfma_f32_16x16x32_bf16 v[32:35], v[64:67], a[72:75], v[32:35]
    v_mfma_f32_16x16x32_bf16 v[36:39], v[64:67], a[152:155], v[36:39]
    v_mfma_f32_16x16x32_bf16 v[40:43], v[64:67], a[232:235], v[40:43]
    v_mfma_f32_16x16x32_bf16 v[44:47], v[64:67], v[248:251], v[44:47]
    s_waitcnt lgkmcnt(2)
    v_mfma_f32_16x16x32_bf16 v[48:51], v[68:71], a[72:75], v[48:51]
    v_mfma_f32_16x16x32_bf16 v[52:55], v[68:71], a[152:155], v[52:55]
    v_mfma_f32_16x16x32_bf16 v[56:59], v[68:71], a[232:235], v[56:59]
    v_mfma_f32_16x16x32_bf16 v[60:63], v[68:71], v[248:251], v[60:63]
    s_waitcnt lgkmcnt(1)
    v_mfma_f32_16x16x32_bf16 v[32:35], v[72:75], a[76:79], v[32:35]
    v_mfma_f32_16x16x32_bf16 v[36:39], v[72:75], a[156:159], v[36:39]
    v_mfma_f32_16x16x32_bf16 v[40:43], v[72:75], a[236:239], v[40:43]
    v_mfma_f32_16x16x32_bf16 v[44:47], v[72:75], v[252:255], v[44:47]
    s_waitcnt lgkmcnt(0)
    v_mfma_f32_16x16x32_bf16 v[48:51], v[76:79], a[76:79], v[48:51]
    v_mfma_f32_16x16x32_bf16 v[52:55], v[76:79], a[156:159], v[52:55]
    v_mfma_f32_16x16x32_bf16 v[56:59], v[76:79], a[236:239], v[56:59]
    v_mfma_f32_16x16x32_bf16 v[60:63], v[76:79], v[252:255], v[60:63]
    s_nop 7
    v_cvt_pk_bf16_f32 v80, v32, v36
    v_cvt_pk_bf16_f32 v81, v40, v44
    v_cvt_pk_bf16_f32 v82, v33, v37
    v_cvt_pk_bf16_f32 v83, v41, v45
    v_cvt_pk_bf16_f32 v84, v34, v38
    v_cvt_pk_bf16_f32 v85, v42, v46
    v_cvt_pk_bf16_f32 v86, v35, v39
    v_cvt_pk_bf16_f32 v87, v43, v47
    v_cvt_pk_bf16_f32 v88, v48, v52
    v_cvt_pk_bf16_f32 v89, v56, v60
    v_cvt_pk_bf16_f32 v90, v49, v53
    v_cvt_pk_bf16_f32 v91, v57, v61
    v_cvt_pk_bf16_f32 v92, v50, v54
    v_cvt_pk_bf16_f32 v93, v58, v62
    v_cvt_pk_bf16_f32 v94, v51, v55
    v_cvt_pk_bf16_f32 v95, v59, v63
mega_kernel_isv98:
    ds_write_b64 v27, v[80:81] offset:0
    ds_write_b64 v27, v[82:83] offset:16
    ds_write_b64 v27, v[84:85] offset:32
    ds_write_b64 v27, v[86:87] offset:48
    ds_write_b64 v27, v[88:89] offset:2048
    ds_write_b64 v27, v[90:91] offset:2064
    ds_write_b64 v27, v[92:93] offset:2080
    ds_write_b64 v27, v[94:95] offset:2096
    s_waitcnt lgkmcnt(0)
    ds_read_b128 v[96:99], v28 offset:0
    ds_read_b128 v[100:103], v28 offset:1024
    ds_read_b128 v[104:107], v28 offset:2048
    ds_read_b128 v[108:111], v28 offset:3072
    s_mul_i32 s3, s75, 12288
    s_add_u32 s3, s3, s24
    s_waitcnt lgkmcnt(0)
    s_add_u32 s71, s3, 0
    buffer_store_dwordx4 v[96:99], v30, s[60:63], s71 offen sc1
    s_add_u32 s71, s3, 1024
    buffer_store_dwordx4 v[100:103], v30, s[60:63], s71 offen sc1
    s_add_u32 s71, s3, 6144
    buffer_store_dwordx4 v[104:107], v30, s[60:63], s71 offen sc1
    s_add_u32 s71, s3, 7168
    buffer_store_dwordx4 v[108:111], v30, s[60:63], s71 offen sc1
mega_kernel_epiend99:
    s_add_u32 s75, s75, 1
    s_cmp_gt_u32 s75, 2
    s_cbranch_scc1 mega_kernel_ef101
    s_waitcnt vmcnt(0)
    s_barrier
    s_cmp_lg_u32 s74, 0
    s_cbranch_scc1 mega_kernel_pf102
    v_mov_b32 v150, s75
    v_mov_b32 v151, 0
    s_lshl_b32 s71, s16, 2
    s_add_u32 s71, s71, 204500992
    s_mov_b64 exec, 1
    buffer_store_dword v150, v151, s[60:63], s71 offen sc1
    s_mov_b64 exec, -1
mega_kernel_pf102:
mega_kernel_ef101:
    s_waitcnt vmcnt(4)
    s_barrier
    s_cmp_lt_u32 s75, 4
    s_cbranch_scc1 mega_kernel_nof104
    s_sub_u32 s68, s75, 1
    s_cmp_lg_u32 s74, 0
    s_cbranch_scc1 mega_kernel_pf105
    v_mov_b32 v150, s68
    v_mov_b32 v151, 0
    s_lshl_b32 s71, s16, 2
    s_add_u32 s71, s71, 204500992
    s_mov_b64 exec, 1
    buffer_store_dword v150, v151, s[60:63], s71 offen sc1
    s_mov_b64 exec, -1
mega_kernel_pf105:
mega_kernel_nof104:
    s_cmp_ge_u32 s75, 63
    s_cbranch_scc1 mega_kernel_skip103
    s_add_u32 m0, s77, 0
    s_add_u32 s71, s76, 0
    buffer_load_dwordx4 v20, s[60:63], s71 offen lds
    s_add_u32 m0, s77, 1024
    s_add_u32 s71, s76, 1024
    buffer_load_dwordx4 v20, s[60:63], s71 offen lds
    s_add_u32 m0, s77, 2048
    s_add_u32 s71, s76, 2048
    buffer_load_dwordx4 v20, s[60:63], s71 offen lds
    s_add_u32 m0, s77, 3072
    s_add_u32 s71, s76, 3072
    buffer_load_dwordx4 v20, s[60:63], s71 offen lds
    s_add_u32 m0, s77, 4096
    s_add_u32 s71, s76, 4096
    buffer_load_dwordx4 v20, s[60:63], s71 offen lds
    s_add_u32 m0, s77, 5120
    s_add_u32 s71, s76, 5120
    buffer_load_dwordx4 v20, s[60:63], s71 offen lds
    s_add_u32 m0, s77, 6144
    s_add_u32 s71, s76, 6144
    buffer_load_dwordx4 v20, s[60:63], s71 offen lds
    s_add_u32 m0, s77, 7168
    s_add_u32 s71, s76, 7168
    buffer_load_dwordx4 v20, s[60:63], s71 offen lds
    s_add_u32 m0, s77, 8192
    s_add_u32 s71, s76, 8192
    buffer_load_dwordx4 v20, s[60:63], s71 offen lds
    s_add_u32 m0, s77, 9216
    s_add_u32 s71, s76, 9216
    buffer_load_dwordx4 v20, s[60:63], s71 offen lds
    s_add_u32 s76, s76, 40960
mega_kernel_skip103:
    ds_read_b128 v[64:67], v22 offset:0
    ds_read_b128 v[68:71], v22 offset:20480
    ds_read_b128 v[72:75], v22 offset:1024
    ds_read_b128 v[76:79], v22 offset:21504
    s_waitcnt lgkmcnt(3)
    v_mfma_f32_16x16x32_bf16 v[32:35], v[64:67], a[0:3], 0
    v_mfma_f32_16x16x32_bf16 v[36:39], v[64:67], a[80:83], 0
    v_mfma_f32_16x16x32_bf16 v[40:43], v[64:67], a[160:163], 0
    v_mfma_f32_16x16x32_bf16 v[44:47], v[64:67], a[240:243], 0
    ds_read_b128 v[64:67], v22 offset:2048
    s_waitcnt lgkmcnt(3)
    v_mfma_f32_16x16x32_bf16 v[48:51], v[68:71], a[0:3], 0
    v_mfma_f32_16x16x32_bf16 v[52:55], v[68:71], a[80:83], 0
    v_mfma_f32_16x16x32_bf16 v[56:59], v[68:71], a[160:163], 0
    v_mfma_f32_16x16x32_bf16 v[60:63], v[68:71], a[240:243], 0
    ds_read_b128 v[68:71], v22 offset:22528
    s_waitcnt lgkmcnt(3)
    v_mfma_f32_16x16x32_bf16 v[32:35], v[72:75], a[4:7], v[32:35]
    v_mfma_f32_16x16x32_bf16 v[36:39], v[72:75], a[84:87], v[36:39]
    v_mfma_f32_16x16x32_bf16 v[40:43], v[72:75], a[164:167], v[40:43]
    v_mfma_f32_16x16x32_bf16 v[44:47], v[72:75], a[244:247], v[44:47]
    ds_read_b128 v[72:75], v22 offset:3072
    s_waitcnt lgkmcnt(3)
    v_mfma_f32_16x16x32_bf16 v[48:51], v[76:79], a[4:7], v[48:51]
    v_mfma_f32_16x16x32_bf16 v[52:55], v[76:79], a[84:87], v[52:55]
    v_mfma_f32_16x16x32_bf16 v[56:59], v[76:79], a[164:167], v[56:59]
    v_mfma_f32_16x16x32_bf16 v[60:63], v[76:79], a[244:247], v[60:63]
    ds_read_b128 v[76:79], v22 offset:23552
    s_waitcnt lgkmcnt(3)
    v_mfma_f32_16x16x32_bf16 v[32:35], v[64:67], a[8:11], v[32:35]
    v_mfma_f32_16x16x32_bf16 v[36:39], v[64:67], a[88:91], v[36:39]
    v_mfma_f32_16x16x32_bf16 v[40:43], v[64:67], a[168:171], v[40:43]
    v_mfma_f32_16x16x32_bf16 v[44:47], v[64:67], a[248:251], v[44:47]
    ds_read_b128 v[64:67], v22 offset:4096
    s_waitcnt lgkmcnt(3)
    v_mfma_f32_16x16x32_bf16 v[48:51], v[68:71], a[8:11], v[48:51]
    v_mfma_f32_16x16x32_bf16 v[52:55], v[68:71], a[88:91], v[52:55]
    v_mfma_f32_16x16x32_bf16 v[56:59], v[68:71], a[168:171], v[56:59]
    v_mfma_f32_16x16x32_bf16 v[60:63], v[68:71], a[248:251], v[60:63]
    ds_read_b128 v[68:71], v22 offset:24576
    s_waitcnt lgkmcnt(3)
    v_mfma_f32_16x16x32_bf16 v[32:35], v[72:75], a[12:15], v[32:35]
    v_mfma_f32_16x16x32_bf16 v[36:39], v[72:75], a[92:95], v[36:39]
    v_mfma_f32_16x16x32_bf16 v[40:43], v[72:75], a[172:175], v[40:43]
    v_mfma_f32_16x16x32_bf16 v[44:47], v[72:75], a[252:255], v[44:47]
    ds_read_b128 v[72:75], v22 offset:5120
    s_waitcnt lgkmcnt(3)
    v_mfma_f32_16x16x32_bf16 v[48:51], v[76:79], a[12:15], v[48:51]
    v_mfma_f32_16x16x32_bf16 v[52:55], v[76:79], a[92:95], v[52:55]
    v_mfma_f32_16x16x32_bf16 v[56:59], v[76:79], a[172:175], v[56:59]
    v_mfma_f32_16x16x32_bf16 v[60:63], v[76:79], a[252:255], v[60:63]
    ds_read_b128 v[76:79], v22 offset:25600
    s_waitcnt lgkmcnt(3)
    v_mfma_f32_16x16x32_bf16 v[32:35], v[64:67], a[16:19], v[32:35]
    v_mfma_f32_16x16x32_bf16 v[36:39], v[64:67], a[96:99], v[36:39]
    v_mfma_f32_16x16x32_bf16 v[40:43], v[64:67], a[176:179], v[40:43]
    v_mfma_f32_16x16x32_bf16 v[44:47], v[64:67], v[192:195], v[44:47]
    ds_read_b128 v[64:67], v22 offset:6144
    s_waitcnt lgkmcnt(3)
    v_mfma_f32_16x16x32_bf16 v[48:51], v[68:71], a[16:19], v[48:51]
    v_mfma_f32_16x16x32_bf16 v[52:55], v[68:71], a[96:99], v[52:55]
    v_mfma_f32_16x16x32_bf16 v[56:59], v[68:71], a[176:179], v[56:59]
    v_mfma_f32_16x16x32_bf16 v[60:63], v[68:71], v[192:195], v[60:63]
    ds_read_b128 v[68:71], v22 offset:26624
    s_waitcnt lgkmcnt(3)
    v_mfma_f32_16x16x32_bf16 v[32:35], v[72:75], a[20:23], v[32:35]
    v_mfma_f32_16x16x32_bf16 v[36:39], v[72:75], a[100:103], v[36:39]
    v_mfma_f32_16x16x32_bf16 v[40:43], v[72:75], a[180:183], v[40:43]
    v_mfma_f32_16x16x32_bf16 v[44:47], v[72:75], v[196:199], v[44:47]
    ds_read_b128 v[72:75], v22 offset:7168
    s_waitcnt lgkmcnt(3)
    v_mfma_f32_16x16x32_bf16 v[48:51], v[76:79], a[20:23], v[48:51]
    v_mfma_f32_16x16x32_bf16 v[52:55], v[76:79], a[100:103], v[52:55]
    v_mfma_f32_16x16x32_bf16 v[56:59], v[76:79], a[180:183], v[56:59]
    v_mfma_f32_16x16x32_bf16 v[60:63], v[76:79], v[196:199], v[60:63]
    ds_read_b128 v[76:79], v22 offset:27648
    s_waitcnt lgkmcnt(3)
    v_mfma_f32_16x16x32_bf16 v[32:35], v[64:67], a[24:27], v[32:35]
    v_mfma_f32_16x16x32_bf16 v[36:39], v[64:67], a[104:107], v[36:39]
    v_mfma_f32_16x16x32_bf16 v[40:43], v[64:67], a[184:187], v[40:43]
    v_mfma_f32_16x16x32_bf16 v[44:47], v[64:67], v[200:203], v[44:47]
    ds_read_b128 v[64:67], v22 offset:8192
    s_waitcnt lgkmcnt(3)
    v_mfma_f32_16x16x32_bf16 v[48:51], v[68:71], a[24:27], v[48:51]
    v_mfma_f32_16x16x32_bf16 v[52:55], v[68:71], a[104:107], v[52:55]
    v_mfma_f32_16x16x32_bf16 v[56:59], v[68:71], a[184:187], v[56:59]
    v_mfma_f32_16x16x32_bf16 v[60:63], v[68:71], v[200:203], v[60:63]
    ds_read_b128 v[68:71], v22 offset:28672
    s_waitcnt lgkmcnt(3)
    v_mfma_f32_16x16x32_bf16 v[32:35], v[72:75], a[28:31], v[32:35]
    v_mfma_f32_16x16x32_bf16 v[36:39], v[72:75], a[108:111], v[36:39]
    v_mfma_f32_16x16x32_bf16 v[40:43], v[72:75], a[188:191], v[40:43]
    v_mfma_f32_16x16x32_bf16 v[44:47], v[72:75], v[204:207], v[44:47]
    ds_read_b128 v[72:75], v22 offset:9216
    s_waitcnt lgkmcnt(3)
    v_mfma_f32_16x16x32_bf16 v[48:51], v[76:79], a[28:31], v[48:51]
    v_mfma_f32_16x16x32_bf16 v[52:55], v[76:79], a[108:111], v[52:55]
    v_mfma_f32_16x16x32_bf16 v[56:59], v[76:79], a[188:191], v[56:59]
    v_mfma_f32_16x16x32_bf16 v[60:63], v[76:79], v[204:207], v[60:63]
    ds_read_b128 v[76:79], v22 offset:29696
    s_waitcnt lgkmcnt(3)
    v_mfma_f32_16x16x32_bf16 v[32:35], v[64:67], a[32:35], v[32:35]
    v_mfma_f32_16x16x32_bf16 v[36:39], v[64:67], a[112:115], v[36:39]
    v_mfma_f32_16x16x32_bf16 v[40:43], v[64:67], a[192:195], v[40:43]
    v_mfma_f32_16x16x32_bf16 v[44:47], v[64:67], v[208:211], v[44:47]
    ds_read_b128 v[64:67], v22 offset:10240
    s_waitcnt lgkmcnt(3)
    v_mfma_f32_16x16x32_bf16 v[48:51], v[68:71], a[32:35], v[48:51]
    v_mfma_f32_16x16x32_bf16 v[52:55], v[68:71], a[112:115], v[52:55]
    v_mfma_f32_16x16x32_bf16 v[56:59], v[68:71], a[192:195], v[56:59]
    v_mfma_f32_16x16x32_bf16 v[60:63], v[68:71], v[208:211], v[60:63]
    ds_read_b128 v[68:71], v22 offset:30720
    s_waitcnt lgkmcnt(3)
    v_mfma_f32_16x16x32_bf16 v[32:35], v[72:75], a[36:39], v[32:35]
    v_mfma_f32_16x16x32_bf16 v[36:39], v[72:75], a[116:119], v[36:39]
    v_mfma_f32_16x16x32_bf16 v[40:43], v[72:75], a[196:199], v[40:43]
    v_mfma_f32_16x16x32_bf16 v[44:47], v[72:75], v[212:215], v[44:47]
    ds_read_b128 v[72:75], v22 offset:11264
    s_waitcnt lgkmcnt(3)
    v_mfma_f32_16x16x32_bf16 v[48:51], v[76:79], a[36:39], v[48:51]
    v_mfma_f32_16x16x32_bf16 v[52:55], v[76:79], a[116:119], v[52:55]
    v_mfma_f32_16x16x32_bf16 v[56:59], v[76:79], a[196:199], v[56:59]
    v_mfma_f32_16x16x32_bf16 v[60:63], v[76:79], v[212:215], v[60:63]
    ds_read_b128 v[76:79], v22 offset:31744
    s_waitcnt lgkmcnt(3)
    v_mfma_f32_16x16x32_bf16 v[32:35], v[64:67], a[40:43], v[32:35]
    v_mfma_f32_16x16x32_bf16 v[36:39], v[64:67], a[120:123], v[36:39]
    v_mfma_f32_16x16x32_bf16 v[40:43], v[64:67], a[200:203], v[40:43]
    v_mfma_f32_16x16x32_bf16 v[44:47], v[64:67], v[216:219], v[44:47]
    ds_read_b128 v[64:67], v22 offset:12288
    s_waitcnt lgkmcnt(3)
    v_mfma_f32_16x16x32_bf16 v[48:51], v[68:71], a[40:43], v[48:51]
    v_mfma_f32_16x16x32_bf16 v[52:55], v[68:71], a[120:123], v[52:55]
    v_mfma_f32_16x16x32_bf16 v[56:59], v[68:71], a[200:203], v[56:59]
    v_mfma_f32_16x16x32_bf16 v[60:63], v[68:71], v[216:219], v[60:63]
    ds_read_b128 v[68:71], v22 offset:32768
    s_waitcnt lgkmcnt(3)
    v_mfma_f32_16x16x32_bf16 v[32:35], v[72:75], a[44:47], v[32:35]
    v_mfma_f32_16x16x32_bf16 v[36:39], v[72:75], a[124:127], v[36:39]
    v_mfma_f32_16x16x32_bf16 v[40:43], v[72:75], a[204:207], v[40:43]
    v_mfma_f32_16x16x32_bf16 v[44:47], v[72:75], v[220:223], v[44:47]
    ds_read_b128 v[72:75], v22 offset:13312
    s_waitcnt lgkmcnt(3)
    v_mfma_f32_16x16x32_bf16 v[48:51], v[76:79], a[44:47], v[48:51]
    v_mfma_f32_16x16x32_bf16 v[52:55], v[76:79], a[124:127], v[52:55]
    v_mfma_f32_16x16x32_bf16 v[56:59], v[76:79], a[204:207], v[56:59]
    v_mfma_f32_16x16x32_bf16 v[60:63], v[76:79], v[220:223], v[60:63]
    ds_read_b128 v[76:79], v22 offset:33792
    s_waitcnt lgkmcnt(3)
    v_mfma_f32_16x16x32_bf16 v[32:35], v[64:67], a[48:51], v[32:35]
    v_mfma_f32_16x16x32_bf16 v[36:39], v[64:67], a[128:131], v[36:39]
    v_mfma_f32_16x16x32_bf16 v[40:43], v[64:67], a[208:211], v[40:43]
    v_mfma_f32_16x16x32_bf16 v[44:47], v[64:67], v[224:227], v[44:47]
    ds_read_b128 v[64:67], v22 offset:14336
    s_waitcnt lgkmcnt(3)
    v_mfma_f32_16x16x32_bf16 v[48:51], v[68:71], a[48:51], v[48:51]
    v_mfma_f32_16x16x32_bf16 v[52:55], v[68:71], a[128:131], v[52:55]
    v_mfma_f32_16x16x32_bf16 v[56:59], v[68:71], a[208:211], v[56:59]
    v_mfma_f32_16x16x32_bf16 v[60:63], v[68:71], v[224:227], v[60:63]
    ds_read_b128 v[68:71], v22 offset:34816
    s_waitcnt lgkmcnt(3)
    v_mfma_f32_16x16x32_bf16 v[32:35], v[72:75], a[52:55], v[32:35]
    v_mfma_f32_16x16x32_bf16 v[36:39], v[72:75], a[132:135], v[36:39]
    v_mfma_f32_16x16x32_bf16 v[40:43], v[72:75], a[212:215], v[40:43]
    v_mfma_f32_16x16x32_bf16 v[44:47], v[72:75], v[228:231], v[44:47]
    ds_read_b128 v[72:75], v22 offset:15360
    s_waitcnt lgkmcnt(3)
    v_mfma_f32_16x16x32_bf16 v[48:51], v[76:79], a[52:55], v[48:51]
    v_mfma_f32_16x16x32_bf16 v[52:55], v[76:79], a[132:135], v[52:55]
    v_mfma_f32_16x16x32_bf16 v[56:59], v[76:79], a[212:215], v[56:59]
    v_mfma_f32_16x16x32_bf16 v[60:63], v[76:79], v[228:231], v[60:63]
    ds_read_b128 v[76:79], v22 offset:35840
    s_waitcnt lgkmcnt(3)
    v_mfma_f32_16x16x32_bf16 v[32:35], v[64:67], a[56:59], v[32:35]
    v_mfma_f32_16x16x32_bf16 v[36:39], v[64:67], a[136:139], v[36:39]
    v_mfma_f32_16x16x32_bf16 v[40:43], v[64:67], a[216:219], v[40:43]
    v_mfma_f32_16x16x32_bf16 v[44:47], v[64:67], v[232:235], v[44:47]
    ds_read_b128 v[64:67], v22 offset:16384
    s_waitcnt lgkmcnt(3)
    v_mfma_f32_16x16x32_bf16 v[48:51], v[68:71], a[56:59], v[48:51]
    v_mfma_f32_16x16x32_bf16 v[52:55], v[68:71], a[136:139], v[52:55]
    v_mfma_f32_16x16x32_bf16 v[56:59], v[68:71], a[216:219], v[56:59]
    v_mfma_f32_16x16x32_bf16 v[60:63], v[68:71], v[232:235], v[60:63]
    ds_read_b128 v[68:71], v22 offset:36864
    s_waitcnt lgkmcnt(3)
    v_mfma_f32_16x16x32_bf16 v[32:35], v[72:75], a[60:63], v[32:35]
    v_mfma_f32_16x16x32_bf16 v[36:39], v[72:75], a[140:143], v[36:39]
    v_mfma_f32_16x16x32_bf16 v[40:43], v[72:75], a[220:223], v[40:43]
    v_mfma_f32_16x16x32_bf16 v[44:47], v[72:75], v[236:239], v[44:47]
    ds_read_b128 v[72:75], v22 offset:17408
    s_waitcnt lgkmcnt(3)
    v_mfma_f32_16x16x32_bf16 v[48:51], v[76:79], a[60:63], v[48:51]
    v_mfma_f32_16x16x32_bf16 v[52:55], v[76:79], a[140:143], v[52:55]
    v_mfma_f32_16x16x32_bf16 v[56:59], v[76:79], a[220:223], v[56:59]
    v_mfma_f32_16x16x32_bf16 v[60:63], v[76:79], v[236:239], v[60:63]
    ds_read_b128 v[76:79], v22 offset:37888
    s_waitcnt lgkmcnt(3)
    v_mfma_f32_16x16x32_bf16 v[32:35], v[64:67], a[64:67], v[32:35]
    v_mfma_f32_16x16x32_bf16 v[36:39], v[64:67], a[144:147], v[36:39]
    v_mfma_f32_16x16x32_bf16 v[40:43], v[64:67], a[224:227], v[40:43]
    v_mfma_f32_16x16x32_bf16 v[44:47], v[64:67], v[240:243], v[44:47]
    ds_read_b128 v[64:67], v22 offset:18432
    s_waitcnt lgkmcnt(3)
    v_mfma_f32_16x16x32_bf16 v[48:51], v[68:71], a[64:67], v[48:51]
    v_mfma_f32_16x16x32_bf16 v[52:55], v[68:71], a[144:147], v[52:55]
    v_mfma_f32_16x16x32_bf16 v[56:59], v[68:71], a[224:227], v[56:59]
    v_mfma_f32_16x16x32_bf16 v[60:63], v[68:71], v[240:243], v[60:63]
    ds_read_b128 v[68:71], v22 offset:38912
    s_waitcnt lgkmcnt(3)
    v_mfma_f32_16x16x32_bf16 v[32:35], v[72:75], a[68:71], v[32:35]
    v_mfma_f32_16x16x32_bf16 v[36:39], v[72:75], a[148:151], v[36:39]
    v_mfma_f32_16x16x32_bf16 v[40:43], v[72:75], a[228:231], v[40:43]
    v_mfma_f32_16x16x32_bf16 v[44:47], v[72:75], v[244:247], v[44:47]
    ds_read_b128 v[72:75], v22 offset:19456
    s_waitcnt lgkmcnt(3)
    v_mfma_f32_16x16x32_bf16 v[48:51], v[76:79], a[68:71], v[48:51]
    v_mfma_f32_16x16x32_bf16 v[52:55], v[76:79], a[148:151], v[52:55]
    v_mfma_f32_16x16x32_bf16 v[56:59], v[76:79], a[228:231], v[56:59]
    v_mfma_f32_16x16x32_bf16 v[60:63], v[76:79], v[244:247], v[60:63]
    ds_read_b128 v[76:79], v22 offset:39936
    s_waitcnt lgkmcnt(3)
    v_mfma_f32_16x16x32_bf16 v[32:35], v[64:67], a[72:75], v[32:35]
    v_mfma_f32_16x16x32_bf16 v[36:39], v[64:67], a[152:155], v[36:39]
    v_mfma_f32_16x16x32_bf16 v[40:43], v[64:67], a[232:235], v[40:43]
    v_mfma_f32_16x16x32_bf16 v[44:47], v[64:67], v[248:251], v[44:47]
    s_waitcnt lgkmcnt(2)
    v_mfma_f32_16x16x32_bf16 v[48:51], v[68:71], a[72:75], v[48:51]
    v_mfma_f32_16x16x32_bf16 v[52:55], v[68:71], a[152:155], v[52:55]
    v_mfma_f32_16x16x32_bf16 v[56:59], v[68:71], a[232:235], v[56:59]
    v_mfma_f32_16x16x32_bf16 v[60:63], v[68:71], v[248:251], v[60:63]
    s_waitcnt lgkmcnt(1)
    v_mfma_f32_16x16x32_bf16 v[32:35], v[72:75], a[76:79], v[32:35]
    v_mfma_f32_16x16x32_bf16 v[36:39], v[72:75], a[156:159], v[36:39]
    v_mfma_f32_16x16x32_bf16 v[40:43], v[72:75], a[236:239], v[40:43]
    v_mfma_f32_16x16x32_bf16 v[44:47], v[72:75], v[252:255], v[44:47]
    s_waitcnt lgkmcnt(0)
    v_mfma_f32_16x16x32_bf16 v[48:51], v[76:79], a[76:79], v[48:51]
    v_mfma_f32_16x16x32_bf16 v[52:55], v[76:79], a[156:159], v[52:55]
    v_mfma_f32_16x16x32_bf16 v[56:59], v[76:79], a[236:239], v[56:59]
    v_mfma_f32_16x16x32_bf16 v[60:63], v[76:79], v[252:255], v[60:63]
    s_nop 7
    v_cvt_pk_bf16_f32 v80, v32, v36
    v_cvt_pk_bf16_f32 v81, v40, v44
    v_cvt_pk_bf16_f32 v82, v33, v37
    v_cvt_pk_bf16_f32 v83, v41, v45
    v_cvt_pk_bf16_f32 v84, v34, v38
    v_cvt_pk_bf16_f32 v85, v42, v46
    v_cvt_pk_bf16_f32 v86, v35, v39
    v_cvt_pk_bf16_f32 v87, v43, v47
    v_cvt_pk_bf16_f32 v88, v48, v52
    v_cvt_pk_bf16_f32 v89, v56, v60
    v_cvt_pk_bf16_f32 v90, v49, v53
    v_cvt_pk_bf16_f32 v91, v57, v61
    v_cvt_pk_bf16_f32 v92, v50, v54
    v_cvt_pk_bf16_f32 v93, v58, v62
    v_cvt_pk_bf16_f32 v94, v51, v55
    v_cvt_pk_bf16_f32 v95, v59, v63
mega_kernel_isv106:
    ds_write_b64 v27, v[80:81] offset:0
    ds_write_b64 v27, v[82:83] offset:16
    ds_write_b64 v27, v[84:85] offset:32
    ds_write_b64 v27, v[86:87] offset:48
    ds_write_b64 v27, v[88:89] offset:2048
    ds_write_b64 v27, v[90:91] offset:2064
    ds_write_b64 v27, v[92:93] offset:2080
    ds_write_b64 v27, v[94:95] offset:2096
    s_waitcnt lgkmcnt(0)
    ds_read_b128 v[96:99], v28 offset:0
    ds_read_b128 v[100:103], v28 offset:1024
    ds_read_b128 v[104:107], v28 offset:2048
    ds_read_b128 v[108:111], v28 offset:3072
    s_mul_i32 s3, s75, 12288
    s_add_u32 s3, s3, s24
    s_waitcnt lgkmcnt(0)
    s_add_u32 s71, s3, 0
    buffer_store_dwordx4 v[96:99], v30, s[60:63], s71 offen sc1
    s_add_u32 s71, s3, 1024
    buffer_store_dwordx4 v[100:103], v30, s[60:63], s71 offen sc1
    s_add_u32 s71, s3, 6144
    buffer_store_dwordx4 v[104:107], v30, s[60:63], s71 offen sc1
    s_add_u32 s71, s3, 7168
    buffer_store_dwordx4 v[108:111], v30, s[60:63], s71 offen sc1
mega_kernel_epiend107:
    s_add_u32 s75, s75, 1
    s_cmp_gt_u32 s75, 2
    s_cbranch_scc1 mega_kernel_ef109
    s_waitcnt vmcnt(0)
    s_barrier
    s_cmp_lg_u32 s74, 0
    s_cbranch_scc1 mega_kernel_pf110
    v_mov_b32 v150, s75
    v_mov_b32 v151, 0
    s_lshl_b32 s71, s16, 2
    s_add_u32 s71, s71, 204500992
    s_mov_b64 exec, 1
    buffer_store_dword v150, v151, s[60:63], s71 offen sc1
    s_mov_b64 exec, -1
mega_kernel_pf110:
mega_kernel_ef109:
    s_cmp_lt_u32 s75, 64
    s_cbranch_scc1 mega_kernel_loop94
    s_waitcnt vmcnt(0)
    s_barrier
    s_cmp_lg_u32 s74, 0
    s_cbranch_scc1 mega_kernel_pf111
    v_mov_b32 v150, s75
    v_mov_b32 v151, 0
    s_lshl_b32 s71, s16, 2
    s_add_u32 s71, s71, 204500992
    s_mov_b64 exec, 1
    buffer_store_dword v150, v151, s[60:63], s71 offen sc1
    s_mov_b64 exec, -1
mega_kernel_pf111:
    s_branch mega_T3_LA
mega_kernel_vo3:
    s_load_dwordx2 s[10:11], s[0:1], 40
    s_sub_u32 s16, s2, 176
    s_waitcnt lgkmcnt(0)
    s_mov_b32 s64, s10
    s_and_b32 s65, s11, 0xffff
    s_mov_b32 s66, 7864320
    s_mov_b32 s67, 0x00020000
    s_movk_i32 s3, 10240
    v_mul_lo_u32 v5, v4, s3
    v_lshl_add_u32 v6, v3, 2, v5
    v_lshl_add_u32 v5, v3, 3, v5
    s_mul_i32 s19, s74, 160
    s_mul_i32 s3, s16, 245760
    s_lshl_b32 s26, s19, 1
    s_add_u32 s26, s26, s3
    s_add_u32 s27, s26, 128
    s_add_u32 s28, s26, 256
    s_add_u32 s71, s26, 0
    buffer_load_dwordx2 v[32:33], v5, s[64:67], s71 offen
    s_add_u32 s71, s26, 1280
    buffer_load_dwordx2 v[34:35], v5, s[64:67], s71 offen
    s_add_u32 s71, s26, 2560
    buffer_load_dwordx2 v[36:37], v5, s[64:67], s71 offen
    s_add_u32 s71, s26, 3840
    buffer_load_dwordx2 v[38:39], v5, s[64:67], s71 offen
    s_add_u32 s71, s26, 5120
    buffer_load_dwordx2 v[40:41], v5, s[64:67], s71 offen
    s_add_u32 s71, s26, 6400
    buffer_load_dwordx2 v[42:43], v5, s[64:67], s71 offen
    s_add_u32 s71, s26, 7680
    buffer_load_dwordx2 v[44:45], v5, s[64:67], s71 offen
    s_add_u32 s71, s26, 8960
    buffer_load_dwordx2 v[46:47], v5, s[64:67], s71 offen
    s_add_u32 s71, s26, 40960
    buffer_load_dwordx2 v[48:49], v5, s[64:67], s71 offen
    s_add_u32 s71, s26, 42240
    buffer_load_dwordx2 v[50:51], v5, s[64:67], s71 offen
    s_add_u32 s71, s26, 43520
    buffer_load_dwordx2 v[52:53], v5, s[64:67], s71 offen
    s_add_u32 s71, s26, 44800
    buffer_load_dwordx2 v[54:55], v5, s[64:67], s71 offen
    s_add_u32 s71, s26, 46080
    buffer_load_dwordx2 v[56:57], v5, s[64:67], s71 offen
    s_add_u32 s71, s26, 47360
    buffer_load_dwordx2 v[58:59], v5, s[64:67], s71 offen
    s_add_u32 s71, s26, 48640
    buffer_load_dwordx2 v[60:61], v5, s[64:67], s71 offen
    s_add_u32 s71, s26, 49920
    buffer_load_dwordx2 v[62:63], v5, s[64:67], s71 offen
    s_add_u32 s71, s26, 81920
    buffer_load_dwordx2 v[64:65], v5, s[64:67], s71 offen
    s_add_u32 s71, s26, 83200
    buffer_load_dwordx2 v[66:67], v5, s[64:67], s71 offen
    s_add_u32 s71, s26, 84480
    buffer_load_dwordx2 v[68:69], v5, s[64:67], s71 offen
    s_add_u32 s71, s26, 85760
    buffer_load_dwordx2 v[70:71], v5, s[64:67], s71 offen
    s_add_u32 s71, s26, 87040
    buffer_load_dwordx2 v[72:73], v5, s[64:67], s71 offen
    s_add_u32 s71, s26, 88320
    buffer_load_dwordx2 v[74:75], v5, s[64:67], s71 offen
    s_add_u32 s71, s26, 89600
    buffer_load_dwordx2 v[76:77], v5, s[64:67], s71 offen
    s_add_u32 s71, s26, 90880
    buffer_load_dwordx2 v[78:79], v5, s[64:67], s71 offen
    s_add_u32 s71, s26, 122880
    buffer_load_dwordx2 v[80:81], v5, s[64:67], s71 offen
    s_add_u32 s71, s26, 124160
    buffer_load_dwordx2 v[82:83], v5, s[64:67], s71 offen
    s_add_u32 s71, s26, 125440
    buffer_load_dwordx2 v[84:85], v5, s[64:67], s71 offen
    s_add_u32 s71, s26, 126720
    buffer_load_dwordx2 v[86:87], v5, s[64:67], s71 offen
    s_add_u32 s71, s26, 128000
    buffer_load_dwordx2 v[88:89], v5, s[64:67], s71 offen
    s_add_u32 s71, s26, 129280
    buffer_load_dwordx2 v[90:91], v5, s[64:67], s71 offen
    s_add_u32 s71, s26, 130560
    buffer_load_dwordx2 v[92:93], v5, s[64:67], s71 offen
    s_add_u32 s71, s26, 131840
    buffer_load_dwordx2 v[94:95], v5, s[64:67], s71 offen
    s_add_u32 s71, s26, 163840
    buffer_load_dwordx2 v[96:97], v5, s[64:67], s71 offen
    s_add_u32 s71, s26, 165120
    buffer_load_dwordx2 v[98:99], v5, s[64:67], s71 offen
    s_add_u32 s71, s26, 166400
    buffer_load_dwordx2 v[100:101], v5, s[64:67], s71 offen
    s_add_u32 s71, s26, 167680
    buffer_load_dwordx2 v[102:103], v5, s[64:67], s71 offen
    s_add_u32 s71, s26, 168960
    buffer_load_dwordx2 v[104:105], v5, s[64:67], s71 offen
    s_add_u32 s71, s26, 170240
    buffer_load_dwordx2 v[106:107], v5, s[64:67], s71 offen
    s_add_u32 s71, s26, 171520
    buffer_load_dwordx2 v[108:109], v5, s[64:67], s71 offen
    s_add_u32 s71, s26, 172800
    buffer_load_dwordx2 v[110:111], v5, s[64:67], s71 offen
    s_add_u32 s71, s26, 204800
    buffer_load_dwordx2 v[112:113], v5, s[64:67], s71 offen
    s_add_u32 s71, s26, 206080
    buffer_load_dwordx2 v[114:115], v5, s[64:67], s71 offen
    s_add_u32 s71, s26, 207360
    buffer_load_dwordx2 v[116:117], v5, s[64:67], s71 offen
    s_add_u32 s71, s26, 208640
    buffer_load_dwordx2 v[118:119], v5, s[64:67], s71 offen
    s_add_u32 s71, s26, 209920
    buffer_load_dwordx2 v[120:121], v5, s[64:67], s71 offen
    s_add_u32 s71, s26, 211200
    buffer_load_dwordx2 v[122:123], v5, s[64:67], s71 offen
    s_add_u32 s71, s26, 212480
    buffer_load_dwordx2 v[124:125], v5, s[64:67], s71 offen
    s_add_u32 s71, s26, 213760
    buffer_load_dwordx2 v[126:127], v5, s[64:67], s71 offen
    s_waitcnt vmcnt(32)
    v_perm_b32 v28, v34, v32, s72
    v_perm_b32 v29, v38, v36, s72
    v_perm_b32 v30, v42, v40, s72
    v_perm_b32 v31, v46, v44, s72
    v_accvgpr_write_b32 a0, v28
    v_accvgpr_write_b32 a1, v29
    v_accvgpr_write_b32 a2, v30
    v_accvgpr_write_b32 a3, v31
    v_perm_b32 v28, v34, v32, s73
    v_perm_b32 v29, v38, v36, s73
    v_perm_b32 v30, v42, v40, s73
    v_perm_b32 v31, v46, v44, s73
    v_accvgpr_write_b32 a24, v28
    v_accvgpr_write_b32 a25, v29
    v_accvgpr_write_b32 a26, v30
    v_accvgpr_write_b32 a27, v31
    v_perm_b32 v28, v35, v33, s72
    v_perm_b32 v29, v39, v37, s72
    v_perm_b32 v30, v43, v41, s72
    v_perm_b32 v31, v47, v45, s72
    v_accvgpr_write_b32 a48, v28
    v_accvgpr_write_b32 a49, v29
    v_accvgpr_write_b32 a50, v30
    v_accvgpr_write_b32 a51, v31
    v_perm_b32 v28, v35, v33, s73
    v_perm_b32 v29, v39, v37, s73
    v_perm_b32 v30, v43, v41, s73
    v_perm_b32 v31, v47, v45, s73
    v_accvgpr_write_b32 a72, v28
    v_accvgpr_write_b32 a73, v29
    v_accvgpr_write_b32 a74, v30
    v_accvgpr_write_b32 a75, v31
    v_perm_b32 v28, v50, v48, s72
    v_perm_b32 v29, v54, v52, s72
    v_perm_b32 v30, v58, v56, s72
    v_perm_b32 v31, v62, v60, s72
    v_accvgpr_write_b32 a4, v28
    v_accvgpr_write_b32 a5, v29
    v_accvgpr_write_b32 a6, v30
    v_accvgpr_write_b32 a7, v31
    v_perm_b32 v28, v50, v48, s73
    v_perm_b32 v29, v54, v52, s73
    v_perm_b32 v30, v58, v56, s73
    v_perm_b32 v31, v62, v60, s73
    v_accvgpr_write_b32 a28, v28
    v_accvgpr_write_b32 a29, v29
    v_accvgpr_write_b32 a30, v30
    v_accvgpr_write_b32 a31, v31
    v_perm_b32 v28, v51, v49, s72
    v_perm_b32 v29, v55, v53, s72
    v_perm_b32 v30, v59, v57, s72
    v_perm_b32 v31, v63, v61, s72
    v_accvgpr_write_b32 a52, v28
    v_accvgpr_write_b32 a53, v29
    v_accvgpr_write_b32 a54, v30
    v_accvgpr_write_b32 a55, v31
    v_perm_b32 v28, v51, v49, s73
    v_perm_b32 v29, v55, v53, s73
    v_perm_b32 v30, v59, v57, s73
    v_perm_b32 v31, v63, v61, s73
    v_accvgpr_write_b32 a76, v28
    v_accvgpr_write_b32 a77, v29
    v_accvgpr_write_b32 a78, v30
    v_accvgpr_write_b32 a79, v31
    s_waitcnt vmcnt(16)
    v_perm_b32 v28, v66, v64, s72
    v_perm_b32 v29, v70, v68, s72
    v_perm_b32 v30, v74, v72, s72
    v_perm_b32 v31, v78, v76, s72
    v_accvgpr_write_b32 a8, v28
    v_accvgpr_write_b32 a9, v29
    v_accvgpr_write_b32 a10, v30
    v_accvgpr_write_b32 a11, v31
    v_perm_b32 v28, v66, v64, s73
    v_perm_b32 v29, v70, v68, s73
    v_perm_b32 v30, v74, v72, s73
    v_perm_b32 v31, v78, v76, s73
    v_accvgpr_write_b32 a32, v28
    v_accvgpr_write_b32 a33, v29
    v_accvgpr_write_b32 a34, v30
    v_accvgpr_write_b32 a35, v31
    v_perm_b32 v28, v67, v65, s72
    v_perm_b32 v29, v71, v69, s72
    v_perm_b32 v30, v75, v73, s72
    v_perm_b32 v31, v79, v77, s72
    v_accvgpr_write_b32 a56, v28
    v_accvgpr_write_b32 a57, v29
    v_accvgpr_write_b32 a58, v30
    v_accvgpr_write_b32 a59, v31
    v_perm_b32 v28, v67, v65, s73
    v_perm_b32 v29, v71, v69, s73
    v_perm_b32 v30, v75, v73, s73
    v_perm_b32 v31, v79, v77, s73
    v_accvgpr_write_b32 a80, v28
    v_accvgpr_write_b32 a81, v29
    v_accvgpr_write_b32 a82, v30
    v_accvgpr_write_b32 a83, v31
    v_perm_b32 v28, v82, v80, s72
    v_perm_b32 v29, v86, v84, s72
    v_perm_b32 v30, v90, v88, s72
    v_perm_b32 v31, v94, v92, s72
    v_accvgpr_write_b32 a12, v28
    v_accvgpr_write_b32 a13, v29
    v_accvgpr_write_b32 a14, v30
    v_accvgpr_write_b32 a15, v31
    v_perm_b32 v28, v82, v80, s73
    v_perm_b32 v29, v86, v84, s73
    v_perm_b32 v30, v90, v88, s73
    v_perm_b32 v31, v94, v92, s73
    v_accvgpr_write_b32 a36, v28
    v_accvgpr_write_b32 a37, v29
    v_accvgpr_write_b32 a38, v30
    v_accvgpr_write_b32 a39, v31
    v_perm_b32 v28, v83, v81, s72
    v_perm_b32 v29, v87, v85, s72
    v_perm_b32 v30, v91, v89, s72
    v_perm_b32 v31, v95, v93, s72
    v_accvgpr_write_b32 a60, v28
    v_accvgpr_write_b32 a61, v29
    v_accvgpr_write_b32 a62, v30
    v_accvgpr_write_b32 a63, v31
    v_perm_b32 v28, v83, v81, s73
    v_perm_b32 v29, v87, v85, s73
    v_perm_b32 v30, v91, v89, s73
    v_perm_b32 v31, v95, v93, s73
    v_accvgpr_write_b32 a84, v28
    v_accvgpr_write_b32 a85, v29
    v_accvgpr_write_b32 a86, v30
    v_accvgpr_write_b32 a87, v31
    s_waitcnt vmcnt(0)
    v_perm_b32 v28, v98, v96, s72
    v_perm_b32 v29, v102, v100, s72
    v_perm_b32 v30, v106, v104, s72
    v_perm_b32 v31, v110, v108, s72
    v_accvgpr_write_b32 a16, v28
    v_accvgpr_write_b32 a17, v29
    v_accvgpr_write_b32 a18, v30
    v_accvgpr_write_b32 a19, v31
    v_perm_b32 v28, v98, v96, s73
    v_perm_b32 v29, v102, v100, s73
    v_perm_b32 v30, v106, v104, s73
    v_perm_b32 v31, v110, v108, s73
    v_accvgpr_write_b32 a40, v28
    v_accvgpr_write_b32 a41, v29
    v_accvgpr_write_b32 a42, v30
    v_accvgpr_write_b32 a43, v31
    v_perm_b32 v28, v99, v97, s72
    v_perm_b32 v29, v103, v101, s72
    v_perm_b32 v30, v107, v105, s72
    v_perm_b32 v31, v111, v109, s72
    v_accvgpr_write_b32 a64, v28
    v_accvgpr_write_b32 a65, v29
    v_accvgpr_write_b32 a66, v30
    v_accvgpr_write_b32 a67, v31
    v_perm_b32 v28, v99, v97, s73
    v_perm_b32 v29, v103, v101, s73
    v_perm_b32 v30, v107, v105, s73
    v_perm_b32 v31, v111, v109, s73
    v_accvgpr_write_b32 a88, v28
    v_accvgpr_write_b32 a89, v29
    v_accvgpr_write_b32 a90, v30
    v_accvgpr_write_b32 a91, v31
    v_perm_b32 v28, v114, v112, s72
    v_perm_b32 v29, v118, v116, s72
    v_perm_b32 v30, v122, v120, s72
    v_perm_b32 v31, v126, v124, s72
    v_accvgpr_write_b32 a20, v28
    v_accvgpr_write_b32 a21, v29
    v_accvgpr_write_b32 a22, v30
    v_accvgpr_write_b32 a23, v31
    v_perm_b32 v28, v114, v112, s73
    v_perm_b32 v29, v118, v116, s73
    v_perm_b32 v30, v122, v120, s73
    v_perm_b32 v31, v126, v124, s73
    v_accvgpr_write_b32 a44, v28
    v_accvgpr_write_b32 a45, v29
    v_accvgpr_write_b32 a46, v30
    v_accvgpr_write_b32 a47, v31
    v_perm_b32 v28, v115, v113, s72
    v_perm_b32 v29, v119, v117, s72
    v_perm_b32 v30, v123, v121, s72
    v_perm_b32 v31, v127, v125, s72
    v_accvgpr_write_b32 a68, v28
    v_accvgpr_write_b32 a69, v29
    v_accvgpr_write_b32 a70, v30
    v_accvgpr_write_b32 a71, v31
    v_perm_b32 v28, v115, v113, s73
    v_perm_b32 v29, v119, v117, s73
    v_perm_b32 v30, v123, v121, s73
    v_perm_b32 v31, v127, v125, s73
    v_accvgpr_write_b32 a92, v28
    v_accvgpr_write_b32 a93, v29
    v_accvgpr_write_b32 a94, v30
    v_accvgpr_write_b32 a95, v31
    s_add_u32 s71, s27, 0
    buffer_load_dwordx2 v[32:33], v5, s[64:67], s71 offen
    s_add_u32 s71, s27, 1280
    buffer_load_dwordx2 v[34:35], v5, s[64:67], s71 offen
    s_add_u32 s71, s27, 2560
    buffer_load_dwordx2 v[36:37], v5, s[64:67], s71 offen
    s_add_u32 s71, s27, 3840
    buffer_load_dwordx2 v[38:39], v5, s[64:67], s71 offen
    s_add_u32 s71, s27, 5120
    buffer_load_dwordx2 v[40:41], v5, s[64:67], s71 offen
    s_add_u32 s71, s27, 6400
    buffer_load_dwordx2 v[42:43], v5, s[64:67], s71 offen
    s_add_u32 s71, s27, 7680
    buffer_load_dwordx2 v[44:45], v5, s[64:67], s71 offen
    s_add_u32 s71, s27, 8960
    buffer_load_dwordx2 v[46:47], v5, s[64:67], s71 offen
    s_add_u32 s71, s27, 40960
    buffer_load_dwordx2 v[48:49], v5, s[64:67], s71 offen
    s_add_u32 s71, s27, 42240
    buffer_load_dwordx2 v[50:51], v5, s[64:67], s71 offen
    s_add_u32 s71, s27, 43520
    buffer_load_dwordx2 v[52:53], v5, s[64:67], s71 offen
    s_add_u32 s71, s27, 44800
    buffer_load_dwordx2 v[54:55], v5, s[64:67], s71 offen
    s_add_u32 s71, s27, 46080
    buffer_load_dwordx2 v[56:57], v5, s[64:67], s71 offen
    s_add_u32 s71, s27, 47360
    buffer_load_dwordx2 v[58:59], v5, s[64:67], s71 offen
    s_add_u32 s71, s27, 48640
    buffer_load_dwordx2 v[60:61], v5, s[64:67], s71 offen
    s_add_u32 s71, s27, 49920
    buffer_load_dwordx2 v[62:63], v5, s[64:67], s71 offen
    s_add_u32 s71, s27, 81920
    buffer_load_dwordx2 v[64:65], v5, s[64:67], s71 offen
    s_add_u32 s71, s27, 83200
    buffer_load_dwordx2 v[66:67], v5, s[64:67], s71 offen
    s_add_u32 s71, s27, 84480
    buffer_load_dwordx2 v[68:69], v5, s[64:67], s71 offen
    s_add_u32 s71, s27, 85760
    buffer_load_dwordx2 v[70:71], v5, s[64:67], s71 offen
    s_add_u32 s71, s27, 87040
    buffer_load_dwordx2 v[72:73], v5, s[64:67], s71 offen
    s_add_u32 s71, s27, 88320
    buffer_load_dwordx2 v[74:75], v5, s[64:67], s71 offen
    s_add_u32 s71, s27, 89600
    buffer_load_dwordx2 v[76:77], v5, s[64:67], s71 offen
    s_add_u32 s71, s27, 90880
    buffer_load_dwordx2 v[78:79], v5, s[64:67], s71 offen
    s_add_u32 s71, s27, 122880
    buffer_load_dwordx2 v[80:81], v5, s[64:67], s71 offen
    s_add_u32 s71, s27, 124160
    buffer_load_dwordx2 v[82:83], v5, s[64:67], s71 offen
    s_add_u32 s71, s27, 125440
    buffer_load_dwordx2 v[84:85], v5, s[64:67], s71 offen
    s_add_u32 s71, s27, 126720
    buffer_load_dwordx2 v[86:87], v5, s[64:67], s71 offen
    s_add_u32 s71, s27, 128000
    buffer_load_dwordx2 v[88:89], v5, s[64:67], s71 offen
    s_add_u32 s71, s27, 129280
    buffer_load_dwordx2 v[90:91], v5, s[64:67], s71 offen
    s_add_u32 s71, s27, 130560
    buffer_load_dwordx2 v[92:93], v5, s[64:67], s71 offen
    s_add_u32 s71, s27, 131840
    buffer_load_dwordx2 v[94:95], v5, s[64:67], s71 offen
    s_add_u32 s71, s27, 163840
    buffer_load_dwordx2 v[96:97], v5, s[64:67], s71 offen
    s_add_u32 s71, s27, 165120
    buffer_load_dwordx2 v[98:99], v5, s[64:67], s71 offen
    s_add_u32 s71, s27, 166400
    buffer_load_dwordx2 v[100:101], v5, s[64:67], s71 offen
    s_add_u32 s71, s27, 167680
    buffer_load_dwordx2 v[102:103], v5, s[64:67], s71 offen
    s_add_u32 s71, s27, 168960
    buffer_load_dwordx2 v[104:105], v5, s[64:67], s71 offen
    s_add_u32 s71, s27, 170240
    buffer_load_dwordx2 v[106:107], v5, s[64:67], s71 offen
    s_add_u32 s71, s27, 171520
    buffer_load_dwordx2 v[108:109], v5, s[64:67], s71 offen
    s_add_u32 s71, s27, 172800
    buffer_load_dwordx2 v[110:111], v5, s[64:67], s71 offen
    s_add_u32 s71, s27, 204800
    buffer_load_dwordx2 v[112:113], v5, s[64:67], s71 offen
    s_add_u32 s71, s27, 206080
    buffer_load_dwordx2 v[114:115], v5, s[64:67], s71 offen
    s_add_u32 s71, s27, 207360
    buffer_load_dwordx2 v[116:117], v5, s[64:67], s71 offen
    s_add_u32 s71, s27, 208640
    buffer_load_dwordx2 v[118:119], v5, s[64:67], s71 offen
    s_add_u32 s71, s27, 209920
    buffer_load_dwordx2 v[120:121], v5, s[64:67], s71 offen
    s_add_u32 s71, s27, 211200
    buffer_load_dwordx2 v[122:123], v5, s[64:67], s71 offen
    s_add_u32 s71, s27, 212480
    buffer_load_dwordx2 v[124:125], v5, s[64:67], s71 offen
    s_add_u32 s71, s27, 213760
    buffer_load_dwordx2 v[126:127], v5, s[64:67], s71 offen
    s_waitcnt vmcnt(32)
    v_perm_b32 v28, v34, v32, s72
    v_perm_b32 v29, v38, v36, s72
    v_perm_b32 v30, v42, v40, s72
    v_perm_b32 v31, v46, v44, s72
    v_accvgpr_write_b32 a96, v28
    v_accvgpr_write_b32 a97, v29
    v_accvgpr_write_b32 a98, v30
    v_accvgpr_write_b32 a99, v31
    v_perm_b32 v28, v34, v32, s73
    v_perm_b32 v29, v38, v36, s73
    v_perm_b32 v30, v42, v40, s73
    v_perm_b32 v31, v46, v44, s73
    v_accvgpr_write_b32 a120, v28
    v_accvgpr_write_b32 a121, v29
    v_accvgpr_write_b32 a122, v30
    v_accvgpr_write_b32 a123, v31
    v_perm_b32 v28, v35, v33, s72
    v_perm_b32 v29, v39, v37, s72
    v_perm_b32 v30, v43, v41, s72
    v_perm_b32 v31, v47, v45, s72
    v_accvgpr_write_b32 a144, v28
    v_accvgpr_write_b32 a145, v29
    v_accvgpr_write_b32 a146, v30
    v_accvgpr_write_b32 a147, v31
    v_perm_b32 v28, v35, v33, s73
    v_perm_b32 v29, v39, v37, s73
    v_perm_b32 v30, v43, v41, s73
    v_perm_b32 v31, v47, v45, s73
    v_accvgpr_write_b32 a168, v28
    v_accvgpr_write_b32 a169, v29
    v_accvgpr_write_b32 a170, v30
    v_accvgpr_write_b32 a171, v31
    v_perm_b32 v28, v50, v48, s72
    v_perm_b32 v29, v54, v52, s72
    v_perm_b32 v30, v58, v56, s72
    v_perm_b32 v31, v62, v60, s72
    v_accvgpr_write_b32 a100, v28
    v_accvgpr_write_b32 a101, v29
    v_accvgpr_write_b32 a102, v30
    v_accvgpr_write_b32 a103, v31
    v_perm_b32 v28, v50, v48, s73
    v_perm_b32 v29, v54, v52, s73
    v_perm_b32 v30, v58, v56, s73
    v_perm_b32 v31, v62, v60, s73
    v_accvgpr_write_b32 a124, v28
    v_accvgpr_write_b32 a125, v29
    v_accvgpr_write_b32 a126, v30
    v_accvgpr_write_b32 a127, v31
    v_perm_b32 v28, v51, v49, s72
    v_perm_b32 v29, v55, v53, s72
    v_perm_b32 v30, v59, v57, s72
    v_perm_b32 v31, v63, v61, s72
    v_accvgpr_write_b32 a148, v28
    v_accvgpr_write_b32 a149, v29
    v_accvgpr_write_b32 a150, v30
    v_accvgpr_write_b32 a151, v31
    v_perm_b32 v28, v51, v49, s73
    v_perm_b32 v29, v55, v53, s73
    v_perm_b32 v30, v59, v57, s73
    v_perm_b32 v31, v63, v61, s73
    v_accvgpr_write_b32 a172, v28
    v_accvgpr_write_b32 a173, v29
    v_accvgpr_write_b32 a174, v30
    v_accvgpr_write_b32 a175, v31
    s_waitcnt vmcnt(16)
    v_perm_b32 v28, v66, v64, s72
    v_perm_b32 v29, v70, v68, s72
    v_perm_b32 v30, v74, v72, s72
    v_perm_b32 v31, v78, v76, s72
    v_accvgpr_write_b32 a104, v28
    v_accvgpr_write_b32 a105, v29
    v_accvgpr_write_b32 a106, v30
    v_accvgpr_write_b32 a107, v31
    v_perm_b32 v28, v66, v64, s73
    v_perm_b32 v29, v70, v68, s73
    v_perm_b32 v30, v74, v72, s73
    v_perm_b32 v31, v78, v76, s73
    v_accvgpr_write_b32 a128, v28
    v_accvgpr_write_b32 a129, v29
    v_accvgpr_write_b32 a130, v30
    v_accvgpr_write_b32 a131, v31
    v_perm_b32 v28, v67, v65, s72
    v_perm_b32 v29, v71, v69, s72
    v_perm_b32 v30, v75, v73, s72
    v_perm_b32 v31, v79, v77, s72
    v_accvgpr_write_b32 a152, v28
    v_accvgpr_write_b32 a153, v29
    v_accvgpr_write_b32 a154, v30
    v_accvgpr_write_b32 a155, v31
    v_perm_b32 v28, v67, v65, s73
    v_perm_b32 v29, v71, v69, s73
    v_perm_b32 v30, v75, v73, s73
    v_perm_b32 v31, v79, v77, s73
    v_accvgpr_write_b32 a176, v28
    v_accvgpr_write_b32 a177, v29
    v_accvgpr_write_b32 a178, v30
    v_accvgpr_write_b32 a179, v31
    v_perm_b32 v28, v82, v80, s72
    v_perm_b32 v29, v86, v84, s72
    v_perm_b32 v30, v90, v88, s72
    v_perm_b32 v31, v94, v92, s72
    v_accvgpr_write_b32 a108, v28
    v_accvgpr_write_b32 a109, v29
    v_accvgpr_write_b32 a110, v30
    v_accvgpr_write_b32 a111, v31
    v_perm_b32 v28, v82, v80, s73
    v_perm_b32 v29, v86, v84, s73
    v_perm_b32 v30, v90, v88, s73
    v_perm_b32 v31, v94, v92, s73
    v_accvgpr_write_b32 a132, v28
    v_accvgpr_write_b32 a133, v29
    v_accvgpr_write_b32 a134, v30
    v_accvgpr_write_b32 a135, v31
    v_perm_b32 v28, v83, v81, s72
    v_perm_b32 v29, v87, v85, s72
    v_perm_b32 v30, v91, v89, s72
    v_perm_b32 v31, v95, v93, s72
    v_accvgpr_write_b32 a156, v28
    v_accvgpr_write_b32 a157, v29
    v_accvgpr_write_b32 a158, v30
    v_accvgpr_write_b32 a159, v31
    v_perm_b32 v28, v83, v81, s73
    v_perm_b32 v29, v87, v85, s73
    v_perm_b32 v30, v91, v89, s73
    v_perm_b32 v31, v95, v93, s73
    v_accvgpr_write_b32 a180, v28
    v_accvgpr_write_b32 a181, v29
    v_accvgpr_write_b32 a182, v30
    v_accvgpr_write_b32 a183, v31
    s_waitcnt vmcnt(0)
    v_perm_b32 v28, v98, v96, s72
    v_perm_b32 v29, v102, v100, s72
    v_perm_b32 v30, v106, v104, s72
    v_perm_b32 v31, v110, v108, s72
    v_accvgpr_write_b32 a112, v28
    v_accvgpr_write_b32 a113, v29
    v_accvgpr_write_b32 a114, v30
    v_accvgpr_write_b32 a115, v31
    v_perm_b32 v28, v98, v96, s73
    v_perm_b32 v29, v102, v100, s73
    v_perm_b32 v30, v106, v104, s73
    v_perm_b32 v31, v110, v108, s73
    v_accvgpr_write_b32 a136, v28
    v_accvgpr_write_b32 a137, v29
    v_accvgpr_write_b32 a138, v30
    v_accvgpr_write_b32 a139, v31
    v_perm_b32 v28, v99, v97, s72
    v_perm_b32 v29, v103, v101, s72
    v_perm_b32 v30, v107, v105, s72
    v_perm_b32 v31, v111, v109, s72
    v_accvgpr_write_b32 a160, v28
    v_accvgpr_write_b32 a161, v29
    v_accvgpr_write_b32 a162, v30
    v_accvgpr_write_b32 a163, v31
    v_perm_b32 v28, v99, v97, s73
    v_perm_b32 v29, v103, v101, s73
    v_perm_b32 v30, v107, v105, s73
    v_perm_b32 v31, v111, v109, s73
    v_accvgpr_write_b32 a184, v28
    v_accvgpr_write_b32 a185, v29
    v_accvgpr_write_b32 a186, v30
    v_accvgpr_write_b32 a187, v31
    v_perm_b32 v28, v114, v112, s72
    v_perm_b32 v29, v118, v116, s72
    v_perm_b32 v30, v122, v120, s72
    v_perm_b32 v31, v126, v124, s72
    v_accvgpr_write_b32 a116, v28
    v_accvgpr_write_b32 a117, v29
    v_accvgpr_write_b32 a118, v30
    v_accvgpr_write_b32 a119, v31
    v_perm_b32 v28, v114, v112, s73
    v_perm_b32 v29, v118, v116, s73
    v_perm_b32 v30, v122, v120, s73
    v_perm_b32 v31, v126, v124, s73
    v_accvgpr_write_b32 a140, v28
    v_accvgpr_write_b32 a141, v29
    v_accvgpr_write_b32 a142, v30
    v_accvgpr_write_b32 a143, v31
    v_perm_b32 v28, v115, v113, s72
    v_perm_b32 v29, v119, v117, s72
    v_perm_b32 v30, v123, v121, s72
    v_perm_b32 v31, v127, v125, s72
    v_accvgpr_write_b32 a164, v28
    v_accvgpr_write_b32 a165, v29
    v_accvgpr_write_b32 a166, v30
    v_accvgpr_write_b32 a167, v31
    v_perm_b32 v28, v115, v113, s73
    v_perm_b32 v29, v119, v117, s73
    v_perm_b32 v30, v123, v121, s73
    v_perm_b32 v31, v127, v125, s73
    v_accvgpr_write_b32 a188, v28
    v_accvgpr_write_b32 a189, v29
    v_accvgpr_write_b32 a190, v30
    v_accvgpr_write_b32 a191, v31
    s_add_u32 s71, s28, 0
    buffer_load_dword v32, v6, s[64:67], s71 offen
    s_add_u32 s71, s28, 1280
    buffer_load_dword v33, v6, s[64:67], s71 offen
    s_add_u32 s71, s28, 2560
    buffer_load_dword v34, v6, s[64:67], s71 offen
    s_add_u32 s71, s28, 3840
    buffer_load_dword v35, v6, s[64:67], s71 offen
    s_add_u32 s71, s28, 5120
    buffer_load_dword v36, v6, s[64:67], s71 offen
    s_add_u32 s71, s28, 6400
    buffer_load_dword v37, v6, s[64:67], s71 offen
    s_add_u32 s71, s28, 7680
    buffer_load_dword v38, v6, s[64:67], s71 offen
    s_add_u32 s71, s28, 8960
    buffer_load_dword v39, v6, s[64:67], s71 offen
    s_add_u32 s71, s28, 40960
    buffer_load_dword v40, v6, s[64:67], s71 offen
    s_add_u32 s71, s28, 42240
    buffer_load_dword v41, v6, s[64:67], s71 offen
    s_add_u32 s71, s28, 43520
    buffer_load_dword v42, v6, s[64:67], s71 offen
    s_add_u32 s71, s28, 44800
    buffer_load_dword v43, v6, s[64:67], s71 offen
    s_add_u32 s71, s28, 46080
    buffer_load_dword v44, v6, s[64:67], s71 offen
    s_add_u32 s71, s28, 47360
    buffer_load_dword v45, v6, s[64:67], s71 offen
    s_add_u32 s71, s28, 48640
    buffer_load_dword v46, v6, s[64:67], s71 offen
    s_add_u32 s71, s28, 49920
    buffer_load_dword v47, v6, s[64:67], s71 offen
    s_add_u32 s71, s28, 81920
    buffer_load_dword v48, v6, s[64:67], s71 offen
    s_add_u32 s71, s28, 83200
    buffer_load_dword v49, v6, s[64:67], s71 offen
    s_add_u32 s71, s28, 84480
    buffer_load_dword v50, v6, s[64:67], s71 offen
    s_add_u32 s71, s28, 85760
    buffer_load_dword v51, v6, s[64:67], s71 offen
    s_add_u32 s71, s28, 87040
    buffer_load_dword v52, v6, s[64:67], s71 offen
    s_add_u32 s71, s28, 88320
    buffer_load_dword v53, v6, s[64:67], s71 offen
    s_add_u32 s71, s28, 89600
    buffer_load_dword v54, v6, s[64:67], s71 offen
    s_add_u32 s71, s28, 90880
    buffer_load_dword v55, v6, s[64:67], s71 offen
    s_add_u32 s71, s28, 122880
    buffer_load_dword v56, v6, s[64:67], s71 offen
    s_add_u32 s71, s28, 124160
    buffer_load_dword v57, v6, s[64:67], s71 offen
    s_add_u32 s71, s28, 125440
    buffer_load_dword v58, v6, s[64:67], s71 offen
    s_add_u32 s71, s28, 126720
    buffer_load_dword v59, v6, s[64:67], s71 offen
    s_add_u32 s71, s28, 128000
    buffer_load_dword v60, v6, s[64:67], s71 offen
    s_add_u32 s71, s28, 129280
    buffer_load_dword v61, v6, s[64:67], s71 offen
    s_add_u32 s71, s28, 130560
    buffer_load_dword v62, v6, s[64:67], s71 offen
    s_add_u32 s71, s28, 131840
    buffer_load_dword v63, v6, s[64:67], s71 offen
    s_add_u32 s71, s28, 163840
    buffer_load_dword v64, v6, s[64:67], s71 offen
    s_add_u32 s71, s28, 165120
    buffer_load_dword v65, v6, s[64:67], s71 offen
    s_add_u32 s71, s28, 166400
    buffer_load_dword v66, v6, s[64:67], s71 offen
    s_add_u32 s71, s28, 167680
    buffer_load_dword v67, v6, s[64:67], s71 offen
    s_add_u32 s71, s28, 168960
    buffer_load_dword v68, v6, s[64:67], s71 offen
    s_add_u32 s71, s28, 170240
    buffer_load_dword v69, v6, s[64:67], s71 offen
    s_add_u32 s71, s28, 171520
    buffer_load_dword v70, v6, s[64:67], s71 offen
    s_add_u32 s71, s28, 172800
    buffer_load_dword v71, v6, s[64:67], s71 offen
    s_add_u32 s71, s28, 204800
    buffer_load_dword v72, v6, s[64:67], s71 offen
    s_add_u32 s71, s28, 206080
    buffer_load_dword v73, v6, s[64:67], s71 offen
    s_add_u32 s71, s28, 207360
    buffer_load_dword v74, v6, s[64:67], s71 offen
    s_add_u32 s71, s28, 208640
    buffer_load_dword v75, v6, s[64:67], s71 offen
    s_add_u32 s71, s28, 209920
    buffer_load_dword v76, v6, s[64:67], s71 offen
    s_add_u32 s71, s28, 211200
    buffer_load_dword v77, v6, s[64:67], s71 offen
    s_add_u32 s71, s28, 212480
    buffer_load_dword v78, v6, s[64:67], s71 offen
    s_add_u32 s71, s28, 213760
    buffer_load_dword v79, v6, s[64:67], s71 offen
    s_waitcnt vmcnt(16)
    v_perm_b32 v28, v33, v32, s72
    v_perm_b32 v29, v35, v34, s72
    v_perm_b32 v30, v37, v36, s72
    v_perm_b32 v31, v39, v38, s72
    v_accvgpr_write_b32 a192, v28
    v_accvgpr_write_b32 a193, v29
    v_accvgpr_write_b32 a194, v30
    v_accvgpr_write_b32 a195, v31
    v_perm_b32 v28, v33, v32, s73
    v_perm_b32 v29, v35, v34, s73
    v_perm_b32 v30, v37, v36, s73
    v_perm_b32 v31, v39, v38, s73
    v_accvgpr_write_b32 a216, v28
    v_accvgpr_write_b32 a217, v29
    v_accvgpr_write_b32 a218, v30
    v_accvgpr_write_b32 a219, v31
    v_perm_b32 v28, v41, v40, s72
    v_perm_b32 v29, v43, v42, s72
    v_perm_b32 v30, v45, v44, s72
    v_perm_b32 v31, v47, v46, s72
    v_accvgpr_write_b32 a196, v28
    v_accvgpr_write_b32 a197, v29
    v_accvgpr_write_b32 a198, v30
    v_accvgpr_write_b32 a199, v31
    v_perm_b32 v28, v41, v40, s73
    v_perm_b32 v29, v43, v42, s73
    v_perm_b32 v30, v45, v44, s73
    v_perm_b32 v31, v47, v46, s73
    v_accvgpr_write_b32 a220, v28
    v_accvgpr_write_b32 a221, v29
    v_accvgpr_write_b32 a222, v30
    v_accvgpr_write_b32 a223, v31
    v_perm_b32 v28, v49, v48, s72
    v_perm_b32 v29, v51, v50, s72
    v_perm_b32 v30, v53, v52, s72
    v_perm_b32 v31, v55, v54, s72
    v_accvgpr_write_b32 a200, v28
    v_accvgpr_write_b32 a201, v29
    v_accvgpr_write_b32 a202, v30
    v_accvgpr_write_b32 a203, v31
    v_perm_b32 v28, v49, v48, s73
    v_perm_b32 v29, v51, v50, s73
    v_perm_b32 v30, v53, v52, s73
    v_perm_b32 v31, v55, v54, s73
    v_accvgpr_write_b32 a224, v28
    v_accvgpr_write_b32 a225, v29
    v_accvgpr_write_b32 a226, v30
    v_accvgpr_write_b32 a227, v31
    v_perm_b32 v28, v57, v56, s72
    v_perm_b32 v29, v59, v58, s72
    v_perm_b32 v30, v61, v60, s72
    v_perm_b32 v31, v63, v62, s72
    v_accvgpr_write_b32 a204, v28
    v_accvgpr_write_b32 a205, v29
    v_accvgpr_write_b32 a206, v30
    v_accvgpr_write_b32 a207, v31
    v_perm_b32 v28, v57, v56, s73
    v_perm_b32 v29, v59, v58, s73
    v_perm_b32 v30, v61, v60, s73
    v_perm_b32 v31, v63, v62, s73
    v_accvgpr_write_b32 a228, v28
    v_accvgpr_write_b32 a229, v29
    v_accvgpr_write_b32 a230, v30
    v_accvgpr_write_b32 a231, v31
    s_waitcnt vmcnt(0)
    v_perm_b32 v28, v65, v64, s72
    v_perm_b32 v29, v67, v66, s72
    v_perm_b32 v30, v69, v68, s72
    v_perm_b32 v31, v71, v70, s72
    v_accvgpr_write_b32 a208, v28
    v_accvgpr_write_b32 a209, v29
    v_accvgpr_write_b32 a210, v30
    v_accvgpr_write_b32 a211, v31
    v_perm_b32 v28, v65, v64, s73
    v_perm_b32 v29, v67, v66, s73
    v_perm_b32 v30, v69, v68, s73
    v_perm_b32 v31, v71, v70, s73
    v_accvgpr_write_b32 a232, v28
    v_accvgpr_write_b32 a233, v29
    v_accvgpr_write_b32 a234, v30
    v_accvgpr_write_b32 a235, v31
    v_perm_b32 v28, v73, v72, s72
    v_perm_b32 v29, v75, v74, s72
    v_perm_b32 v30, v77, v76, s72
    v_perm_b32 v31, v79, v78, s72
    v_accvgpr_write_b32 a212, v28
    v_accvgpr_write_b32 a213, v29
    v_accvgpr_write_b32 a214, v30
    v_accvgpr_write_b32 a215, v31
    v_perm_b32 v28, v73, v72, s73
    v_perm_b32 v29, v75, v74, s73
    v_perm_b32 v30, v77, v76, s73
    v_perm_b32 v31, v79, v78, s73
    v_accvgpr_write_b32 a236, v28
    v_accvgpr_write_b32 a237, v29
    v_accvgpr_write_b32 a238, v30
    v_accvgpr_write_b32 a239, v31
    v_mov_b32 v21, v20
    v_add_u32 v22, 12288, v20
    s_mul_i32 s20, s16, 786432
    s_add_u32 s20, s20, 58212352
    v_lshlrev_b32 v23, 8, v3
    v_lshl_add_u32 v23, v4, 4, v23
    v_lshlrev_b32 v24, 7, v3
    v_lshl_add_u32 v24, v4, 4, v24
    s_mul_i32 s3, s16, 3
    s_lshr_b32 s3, s3, 2
    s_min_u32 s3, s3, 22
    s_add_u32 s3, s3, 48
    s_lshl_b32 s3, s3, 2
    v_mov_b32 v25, s3
    s_mul_i32 s3, s74, 10240
    s_add_u32 s3, s3, 32768
    v_add_u32 v27, s3, v23
    v_add_u32 v28, s3, v24
    v_add_u32 v29, s3, v20
    s_mov_b32 s29, 0
    s_add_u32 s17, s16, 72
    v_mov_b32 v151, 192
    s_mov_b32 s69, 0
mega_kernel_cw112:
    buffer_load_dword v150, v151, s[88:91], 0 offen sc1
    s_add_u32 s69, s69, 1
    s_cmp_ge_u32 s69, 1048576
    s_cbranch_scc1 mega_kernel_cwo113
    s_waitcnt vmcnt(0)
    v_cmp_gt_u32 vcc, 256, v150
    s_cbranch_vccz mega_kernel_cwo113
    s_sleep 8
    s_branch mega_kernel_cw112
mega_kernel_cwo113:
    s_mul_i32 s79, s74, 3072
    s_add_u32 s76, s20, s79
    s_mov_b32 s77, s79
    s_add_u32 s78, s79, 12288
    s_mov_b32 s75, 0
    s_mov_b32 s68, 1
    s_cmp_ge_u32 s29, s68
    s_cbranch_scc1 mega_kernel_wf114
    s_mov_b32 s69, 0
mega_kernel_wfl115:
    s_mov_b32 s71, 204500992
    buffer_load_dwordx2 v[150:151], v25, s[60:63], s71 offen sc1
    s_waitcnt vmcnt(0)
    v_min_u32 v150, v150, v151
    s_nop 0
    v_readfirstlane_b32 s29, v150
    s_add_u32 s69, s69, 1
    s_cmp_ge_u32 s69, 262144
    s_cbranch_scc1 mega_kernel_wf114
    s_cmp_lt_u32 s29, s68
    s_cbranch_scc1 mega_kernel_wfl115
mega_kernel_wf114:
    s_add_u32 m0, s77, 0
    s_add_u32 s71, s76, 0
    buffer_load_dwordx4 v20, s[60:63], s71 offen lds
    s_add_u32 m0, s77, 1024
    s_add_u32 s71, s76, 1024
    buffer_load_dwordx4 v20, s[60:63], s71 offen lds
    s_add_u32 m0, s77, 2048
    s_add_u32 s71, s76, 2048
    buffer_load_dwordx4 v20, s[60:63], s71 offen lds
    s_add_u32 s76, s76, 12288
    s_waitcnt vmcnt(0)
mega_kernel_loop116:
    s_waitcnt vmcnt(10)
    s_barrier
    s_cmp_lt_u32 s75, 4
    s_cbranch_scc1 mega_kernel_nof118
    s_sub_u32 s68, s75, 1
    s_cmp_lg_u32 s74, 0
    s_cbranch_scc1 mega_kernel_pf119
    v_mov_b32 v150, s68
    v_mov_b32 v151, 0
    s_lshl_b32 s71, s17, 2
    s_add_u32 s71, s71, 204500992
    s_mov_b64 exec, 1
    buffer_store_dword v150, v151, s[60:63], s71 offen sc1
    s_mov_b64 exec, -1
mega_kernel_pf119:
mega_kernel_nof118:
    s_cmp_ge_u32 s75, 63
    s_cbranch_scc1 mega_kernel_skip117
    s_cmp_lt_u32 s75, 2
    s_cbranch_scc1 mega_kernel_skip117
    s_add_u32 s68, s75, 2
    s_cmp_ge_u32 s29, s68
    s_cbranch_scc1 mega_kernel_wf120
    s_mov_b32 s69, 0
mega_kernel_wfl121:
    s_mov_b32 s71, 204500992
    buffer_load_dwordx2 v[150:151], v25, s[60:63], s71 offen sc1
    s_waitcnt vmcnt(0)
    v_min_u32 v150, v150, v151
    s_nop 0
    v_readfirstlane_b32 s29, v150
    s_add_u32 s69, s69, 1
    s_cmp_ge_u32 s69, 262144
    s_cbranch_scc1 mega_kernel_wf120
    s_cmp_lt_u32 s29, s68
    s_cbranch_scc1 mega_kernel_wfl121
mega_kernel_wf120:
    s_add_u32 m0, s78, 0
    s_add_u32 s71, s76, 0
    buffer_load_dwordx4 v20, s[60:63], s71 offen lds
    s_add_u32 m0, s78, 1024
    s_add_u32 s71, s76, 1024
    buffer_load_dwordx4 v20, s[60:63], s71 offen lds
    s_add_u32 m0, s78, 2048
    s_add_u32 s71, s76, 2048
    buffer_load_dwordx4 v20, s[60:63], s71 offen lds
    s_add_u32 s76, s76, 12288
mega_kernel_skip117:
    ds_read_b128 v[112:115], v21 offset:0
    ds_read_b128 v[116:119], v21 offset:6144
    ds_read_b128 v[120:123], v21 offset:1024
    ds_read_b128 v[124:127], v21 offset:7168
    s_waitcnt lgkmcnt(3)
    v_mfma_f32_16x16x32_bf16 v[32:35], v[112:115], a[0:3], 0
    v_mfma_f32_16x16x32_bf16 v[36:39], v[112:115], a[24:27], 0
    v_mfma_f32_16x16x32_bf16 v[40:43], v[112:115], a[48:51], 0
    v_mfma_f32_16x16x32_bf16 v[44:47], v[112:115], a[72:75], 0
    v_mfma_f32_16x16x32_bf16 v[48:51], v[112:115], a[96:99], 0
    v_mfma_f32_16x16x32_bf16 v[52:55], v[112:115], a[120:123], 0
    v_mfma_f32_16x16x32_bf16 v[56:59], v[112:115], a[144:147], 0
    v_mfma_f32_16x16x32_bf16 v[60:63], v[112:115], a[168:171], 0
    v_mfma_f32_16x16x32_bf16 v[64:67], v[112:115], a[192:195], 0
    v_mfma_f32_16x16x32_bf16 v[68:71], v[112:115], a[216:219], 0
    ds_read_b128 v[112:115], v21 offset:2048
    s_waitcnt lgkmcnt(3)
    v_mfma_f32_16x16x32_bf16 v[72:75], v[116:119], a[0:3], 0
    v_mfma_f32_16x16x32_bf16 v[76:79], v[116:119], a[24:27], 0
    v_mfma_f32_16x16x32_bf16 v[80:83], v[116:119], a[48:51], 0
    v_mfma_f32_16x16x32_bf16 v[84:87], v[116:119], a[72:75], 0
    v_mfma_f32_16x16x32_bf16 v[88:91], v[116:119], a[96:99], 0
    v_mfma_f32_16x16x32_bf16 v[92:95], v[116:119], a[120:123], 0
    v_mfma_f32_16x16x32_bf16 v[96:99], v[116:119], a[144:147], 0
    v_mfma_f32_16x16x32_bf16 v[100:103], v[116:119], a[168:171], 0
    v_mfma_f32_16x16x32_bf16 v[104:107], v[116:119], a[192:195], 0
    v_mfma_f32_16x16x32_bf16 v[108:111], v[116:119], a[216:219], 0
    ds_read_b128 v[116:119], v21 offset:8192
    s_waitcnt lgkmcnt(3)
    v_mfma_f32_16x16x32_bf16 v[32:35], v[120:123], a[4:7], v[32:35]
    v_mfma_f32_16x16x32_bf16 v[36:39], v[120:123], a[28:31], v[36:39]
    v_mfma_f32_16x16x32_bf16 v[40:43], v[120:123], a[52:55], v[40:43]
    v_mfma_f32_16x16x32_bf16 v[44:47], v[120:123], a[76:79], v[44:47]
    v_mfma_f32_16x16x32_bf16 v[48:51], v[120:123], a[100:103], v[48:51]
    v_mfma_f32_16x16x32_bf16 v[52:55], v[120:123], a[124:127], v[52:55]
    v_mfma_f32_16x16x32_bf16 v[56:59], v[120:123], a[148:151], v[56:59]
    v_mfma_f32_16x16x32_bf16 v[60:63], v[120:123], a[172:175], v[60:63]
    v_mfma_f32_16x16x32_bf16 v[64:67], v[120:123], a[196:199], v[64:67]
    v_mfma_f32_16x16x32_bf16 v[68:71], v[120:123], a[220:223], v[68:71]
    ds_read_b128 v[120:123], v21 offset:3072
    s_waitcnt lgkmcnt(3)
    v_mfma_f32_16x16x32_bf16 v[72:75], v[124:127], a[4:7], v[72:75]
    v_mfma_f32_16x16x32_bf16 v[76:79], v[124:127], a[28:31], v[76:79]
    v_mfma_f32_16x16x32_bf16 v[80:83], v[124:127], a[52:55], v[80:83]
    v_mfma_f32_16x16x32_bf16 v[84:87], v[124:127], a[76:79], v[84:87]
    v_mfma_f32_16x16x32_bf16 v[88:91], v[124:127], a[100:103], v[88:91]
    v_mfma_f32_16x16x32_bf16 v[92:95], v[124:127], a[124:127], v[92:95]
    v_mfma_f32_16x16x32_bf16 v[96:99], v[124:127], a[148:151], v[96:99]
    v_mfma_f32_16x16x32_bf16 v[100:103], v[124:127], a[172:175], v[100:103]
    v_mfma_f32_16x16x32_bf16 v[104:107], v[124:127], a[196:199], v[104:107]
    v_mfma_f32_16x16x32_bf16 v[108:111], v[124:127], a[220:223], v[108:111]
    ds_read_b128 v[124:127], v21 offset:9216
    s_waitcnt lgkmcnt(3)
    v_mfma_f32_16x16x32_bf16 v[32:35], v[112:115], a[8:11], v[32:35]
    v_mfma_f32_16x16x32_bf16 v[36:39], v[112:115], a[32:35], v[36:39]
    v_mfma_f32_16x16x32_bf16 v[40:43], v[112:115], a[56:59], v[40:43]
    v_mfma_f32_16x16x32_bf16 v[44:47], v[112:115], a[80:83], v[44:47]
    v_mfma_f32_16x16x32_bf16 v[48:51], v[112:115], a[104:107], v[48:51]
    v_mfma_f32_16x16x32_bf16 v[52:55], v[112:115], a[128:131], v[52:55]
    v_mfma_f32_16x16x32_bf16 v[56:59], v[112:115], a[152:155], v[56:59]
    v_mfma_f32_16x16x32_bf16 v[60:63], v[112:115], a[176:179], v[60:63]
    v_mfma_f32_16x16x32_bf16 v[64:67], v[112:115], a[200:203], v[64:67]
    v_mfma_f32_16x16x32_bf16 v[68:71], v[112:115], a[224:227], v[68:71]
    ds_read_b128 v[112:115], v21 offset:4096
    s_waitcnt lgkmcnt(3)
    v_mfma_f32_16x16x32_bf16 v[72:75], v[116:119], a[8:11], v[72:75]
    v_mfma_f32_16x16x32_bf16 v[76:79], v[116:119], a[32:35], v[76:79]
    v_mfma_f32_16x16x32_bf16 v[80:83], v[116:119], a[56:59], v[80:83]
    v_mfma_f32_16x16x32_bf16 v[84:87], v[116:119], a[80:83], v[84:87]
    v_mfma_f32_16x16x32_bf16 v[88:91], v[116:119], a[104:107], v[88:91]
    v_mfma_f32_16x16x32_bf16 v[92:95], v[116:119], a[128:131], v[92:95]
    v_mfma_f32_16x16x32_bf16 v[96:99], v[116:119], a[152:155], v[96:99]
    v_mfma_f32_16x16x32_bf16 v[100:103], v[116:119], a[176:179], v[100:103]
    v_mfma_f32_16x16x32_bf16 v[104:107], v[116:119], a[200:203], v[104:107]
    v_mfma_f32_16x16x32_bf16 v[108:111], v[116:119], a[224:227], v[108:111]
    ds_read_b128 v[116:119], v21 offset:10240
    s_waitcnt lgkmcnt(3)
    v_mfma_f32_16x16x32_bf16 v[32:35], v[120:123], a[12:15], v[32:35]
    v_mfma_f32_16x16x32_bf16 v[36:39], v[120:123], a[36:39], v[36:39]
    v_mfma_f32_16x16x32_bf16 v[40:43], v[120:123], a[60:63], v[40:43]
    v_mfma_f32_16x16x32_bf16 v[44:47], v[120:123], a[84:87], v[44:47]
    v_mfma_f32_16x16x32_bf16 v[48:51], v[120:123], a[108:111], v[48:51]
    v_mfma_f32_16x16x32_bf16 v[52:55], v[120:123], a[132:135], v[52:55]
    v_mfma_f32_16x16x32_bf16 v[56:59], v[120:123], a[156:159], v[56:59]
    v_mfma_f32_16x16x32_bf16 v[60:63], v[120:123], a[180:183], v[60:63]
    v_mfma_f32_16x16x32_bf16 v[64:67], v[120:123], a[204:207], v[64:67]
    v_mfma_f32_16x16x32_bf16 v[68:71], v[120:123], a[228:231], v[68:71]
    ds_read_b128 v[120:123], v21 offset:5120
    s_waitcnt lgkmcnt(3)
    v_mfma_f32_16x16x32_bf16 v[72:75], v[124:127], a[12:15], v[72:75]
    v_mfma_f32_16x16x32_bf16 v[76:79], v[124:127], a[36:39], v[76:79]
    v_mfma_f32_16x16x32_bf16 v[80:83], v[124:127], a[60:63], v[80:83]
    v_mfma_f32_16x16x32_bf16 v[84:87], v[124:127], a[84:87], v[84:87]
    v_mfma_f32_16x16x32_bf16 v[88:91], v[124:127], a[108:111], v[88:91]
    v_mfma_f32_16x16x32_bf16 v[92:95], v[124:127], a[132:135], v[92:95]
    v_mfma_f32_16x16x32_bf16 v[96:99], v[124:127], a[156:159], v[96:99]
    v_mfma_f32_16x16x32_bf16 v[100:103], v[124:127], a[180:183], v[100:103]
    v_mfma_f32_16x16x32_bf16 v[104:107], v[124:127], a[204:207], v[104:107]
    v_mfma_f32_16x16x32_bf16 v[108:111], v[124:127], a[228:231], v[108:111]
    ds_read_b128 v[124:127], v21 offset:11264
    s_waitcnt lgkmcnt(3)
    v_mfma_f32_16x16x32_bf16 v[32:35], v[112:115], a[16:19], v[32:35]
    v_mfma_f32_16x16x32_bf16 v[36:39], v[112:115], a[40:43], v[36:39]
    v_mfma_f32_16x16x32_bf16 v[40:43], v[112:115], a[64:67], v[40:43]
    v_mfma_f32_16x16x32_bf16 v[44:47], v[112:115], a[88:91], v[44:47]
    v_mfma_f32_16x16x32_bf16 v[48:51], v[112:115], a[112:115], v[48:51]
    v_mfma_f32_16x16x32_bf16 v[52:55], v[112:115], a[136:139], v[52:55]
    v_mfma_f32_16x16x32_bf16 v[56:59], v[112:115], a[160:163], v[56:59]
    v_mfma_f32_16x16x32_bf16 v[60:63], v[112:115], a[184:187], v[60:63]
    v_mfma_f32_16x16x32_bf16 v[64:67], v[112:115], a[208:211], v[64:67]
    v_mfma_f32_16x16x32_bf16 v[68:71], v[112:115], a[232:235], v[68:71]
    s_waitcnt lgkmcnt(2)
    v_mfma_f32_16x16x32_bf16 v[72:75], v[116:119], a[16:19], v[72:75]
    v_mfma_f32_16x16x32_bf16 v[76:79], v[116:119], a[40:43], v[76:79]
    v_mfma_f32_16x16x32_bf16 v[80:83], v[116:119], a[64:67], v[80:83]
    v_mfma_f32_16x16x32_bf16 v[84:87], v[116:119], a[88:91], v[84:87]
    v_mfma_f32_16x16x32_bf16 v[88:91], v[116:119], a[112:115], v[88:91]
    v_mfma_f32_16x16x32_bf16 v[92:95], v[116:119], a[136:139], v[92:95]
    v_mfma_f32_16x16x32_bf16 v[96:99], v[116:119], a[160:163], v[96:99]
    v_mfma_f32_16x16x32_bf16 v[100:103], v[116:119], a[184:187], v[100:103]
    v_mfma_f32_16x16x32_bf16 v[104:107], v[116:119], a[208:211], v[104:107]
    v_mfma_f32_16x16x32_bf16 v[108:111], v[116:119], a[232:235], v[108:111]
    s_waitcnt lgkmcnt(1)
    v_mfma_f32_16x16x32_bf16 v[32:35], v[120:123], a[20:23], v[32:35]
    v_mfma_f32_16x16x32_bf16 v[36:39], v[120:123], a[44:47], v[36:39]
    v_mfma_f32_16x16x32_bf16 v[40:43], v[120:123], a[68:71], v[40:43]
    v_mfma_f32_16x16x32_bf16 v[44:47], v[120:123], a[92:95], v[44:47]
    v_mfma_f32_16x16x32_bf16 v[48:51], v[120:123], a[116:119], v[48:51]
    v_mfma_f32_16x16x32_bf16 v[52:55], v[120:123], a[140:143], v[52:55]
    v_mfma_f32_16x16x32_bf16 v[56:59], v[120:123], a[164:167], v[56:59]
    v_mfma_f32_16x16x32_bf16 v[60:63], v[120:123], a[188:191], v[60:63]
    v_mfma_f32_16x16x32_bf16 v[64:67], v[120:123], a[212:215], v[64:67]
    v_mfma_f32_16x16x32_bf16 v[68:71], v[120:123], a[236:239], v[68:71]
    s_waitcnt lgkmcnt(0)
    v_mfma_f32_16x16x32_bf16 v[72:75], v[124:127], a[20:23], v[72:75]
    v_mfma_f32_16x16x32_bf16 v[76:79], v[124:127], a[44:47], v[76:79]
    v_mfma_f32_16x16x32_bf16 v[80:83], v[124:127], a[68:71], v[80:83]
    v_mfma_f32_16x16x32_bf16 v[84:87], v[124:127], a[92:95], v[84:87]
    v_mfma_f32_16x16x32_bf16 v[88:91], v[124:127], a[116:119], v[88:91]
    v_mfma_f32_16x16x32_bf16 v[92:95], v[124:127], a[140:143], v[92:95]
    v_mfma_f32_16x16x32_bf16 v[96:99], v[124:127], a[164:167], v[96:99]
    v_mfma_f32_16x16x32_bf16 v[100:103], v[124:127], a[188:191], v[100:103]
    v_mfma_f32_16x16x32_bf16 v[104:107], v[124:127], a[212:215], v[104:107]
    v_mfma_f32_16x16x32_bf16 v[108:111], v[124:127], a[236:239], v[108:111]
    s_nop 7
    s_lshl_b32 s3, s75, 5
    s_add_u32 s3, s3, s16
    s_mul_i32 s3, s3, 640
    s_add_u32 s3, s3, s19
    s_lshl_b32 s3, s3, 6
    s_add_u32 s3, s3, 83378176
    v_cvt_pk_bf16_f32 v128, v32, v33
    v_cvt_pk_bf16_f32 v129, v34, v35
    v_cvt_pk_bf16_f32 v130, v72, v73
    v_cvt_pk_bf16_f32 v131, v74, v75
    ds_write_b128 v27, v[128:131] offset:0
    v_cvt_pk_bf16_f32 v132, v36, v37
    v_cvt_pk_bf16_f32 v133, v38, v39
    v_cvt_pk_bf16_f32 v134, v76, v77
    v_cvt_pk_bf16_f32 v135, v78, v79
    ds_write_b128 v27, v[132:135] offset:64
    v_cvt_pk_bf16_f32 v136, v40, v41
    v_cvt_pk_bf16_f32 v137, v42, v43
    v_cvt_pk_bf16_f32 v138, v80, v81
    v_cvt_pk_bf16_f32 v139, v82, v83
    ds_write_b128 v27, v[136:139] offset:128
    v_cvt_pk_bf16_f32 v140, v44, v45
    v_cvt_pk_bf16_f32 v141, v46, v47
    v_cvt_pk_bf16_f32 v142, v84, v85
    v_cvt_pk_bf16_f32 v143, v86, v87
    ds_write_b128 v27, v[140:143] offset:192
    v_cvt_pk_bf16_f32 v128, v48, v49
    v_cvt_pk_bf16_f32 v129, v50, v51
    v_cvt_pk_bf16_f32 v130, v88, v89
    v_cvt_pk_bf16_f32 v131, v90, v91
    ds_write_b128 v27, v[128:131] offset:4096
    v_cvt_pk_bf16_f32 v132, v52, v53
    v_cvt_pk_bf16_f32 v133, v54, v55
    v_cvt_pk_bf16_f32 v134, v92, v93
    v_cvt_pk_bf16_f32 v135, v94, v95
    ds_write_b128 v27, v[132:135] offset:4160
    v_cvt_pk_bf16_f32 v136, v56, v57
    v_cvt_pk_bf16_f32 v137, v58, v59
    v_cvt_pk_bf16_f32 v138, v96, v97
    v_cvt_pk_bf16_f32 v139, v98, v99
    ds_write_b128 v27, v[136:139] offset:4224
    v_cvt_pk_bf16_f32 v140, v60, v61
    v_cvt_pk_bf16_f32 v141, v62, v63
    v_cvt_pk_bf16_f32 v142, v100, v101
    v_cvt_pk_bf16_f32 v143, v102, v103
    ds_write_b128 v27, v[140:143] offset:4288
    v_cvt_pk_bf16_f32 v128, v64, v65
    v_cvt_pk_bf16_f32 v129, v66, v67
    v_cvt_pk_bf16_f32 v130, v104, v105
    v_cvt_pk_bf16_f32 v131, v106, v107
    ds_write_b128 v28, v[128:131] offset:8192
    v_cvt_pk_bf16_f32 v132, v68, v69
    v_cvt_pk_bf16_f32 v133, v70, v71
    v_cvt_pk_bf16_f32 v134, v108, v109
    v_cvt_pk_bf16_f32 v135, v110, v111
    ds_write_b128 v28, v[132:135] offset:8256
    s_waitcnt lgkmcnt(0)
    ds_read_b128 v[152:155], v29 offset:0
    ds_read_b128 v[156:159], v29 offset:1024
    ds_read_b128 v[160:163], v29 offset:2048
    ds_read_b128 v[164:167], v29 offset:3072
    ds_read_b128 v[168:171], v29 offset:4096
    ds_read_b128 v[172:175], v29 offset:5120
    ds_read_b128 v[176:179], v29 offset:6144
    ds_read_b128 v[180:183], v29 offset:7168
    ds_read_b128 v[184:187], v29 offset:8192
    ds_read_b128 v[188:191], v29 offset:9216
    s_waitcnt lgkmcnt(9)
    s_add_u32 s71, s3, 0
    buffer_store_dwordx4 v[152:155], v20, s[60:63], s71 offen sc1
    s_waitcnt lgkmcnt(8)
    s_add_u32 s71, s3, 1024
    buffer_store_dwordx4 v[156:159], v20, s[60:63], s71 offen sc1
    s_waitcnt lgkmcnt(7)
    s_add_u32 s71, s3, 2048
    buffer_store_dwordx4 v[160:163], v20, s[60:63], s71 offen sc1
    s_waitcnt lgkmcnt(6)
    s_add_u32 s71, s3, 3072
    buffer_store_dwordx4 v[164:167], v20, s[60:63], s71 offen sc1
    s_waitcnt lgkmcnt(5)
    s_add_u32 s71, s3, 4096
    buffer_store_dwordx4 v[168:171], v20, s[60:63], s71 offen sc1
    s_waitcnt lgkmcnt(4)
    s_add_u32 s71, s3, 5120
    buffer_store_dwordx4 v[172:175], v20, s[60:63], s71 offen sc1
    s_waitcnt lgkmcnt(3)
    s_add_u32 s71, s3, 6144
    buffer_store_dwordx4 v[176:179], v20, s[60:63], s71 offen sc1
    s_waitcnt lgkmcnt(2)
    s_add_u32 s71, s3, 7168
    buffer_store_dwordx4 v[180:183], v20, s[60:63], s71 offen sc1
    s_waitcnt lgkmcnt(1)
    s_add_u32 s71, s3, 8192
    buffer_store_dwordx4 v[184:187], v20, s[60:63], s71 offen sc1
    s_waitcnt lgkmcnt(0)
    s_add_u32 s71, s3, 9216
    buffer_store_dwordx4 v[188:191], v20, s[60:63], s71 offen sc1
    s_nop 1
    s_add_u32 s75, s75, 1
    s_cmp_gt_u32 s75, 2
    s_cbranch_scc1 mega_kernel_ef122
    s_waitcnt vmcnt(0)
    s_barrier
    s_cmp_lg_u32 s74, 0
    s_cbranch_scc1 mega_kernel_pf123
    v_mov_b32 v150, s75
    v_mov_b32 v151, 0
    s_lshl_b32 s71, s17, 2
    s_add_u32 s71, s71, 204500992
    s_mov_b64 exec, 1
    buffer_store_dword v150, v151, s[60:63], s71 offen sc1
    s_mov_b64 exec, -1
mega_kernel_pf123:
    s_add_u32 s68, s75, 1
    s_cmp_ge_u32 s29, s68
    s_cbranch_scc1 mega_kernel_wf124
    s_mov_b32 s69, 0
mega_kernel_wfl125:
    s_mov_b32 s71, 204500992
    buffer_load_dwordx2 v[150:151], v25, s[60:63], s71 offen sc1
    s_waitcnt vmcnt(0)
    v_min_u32 v150, v150, v151
    s_nop 0
    v_readfirstlane_b32 s29, v150
    s_add_u32 s69, s69, 1
    s_cmp_ge_u32 s69, 262144
    s_cbranch_scc1 mega_kernel_wf124
    s_cmp_lt_u32 s29, s68
    s_cbranch_scc1 mega_kernel_wfl125
mega_kernel_wf124:
    s_add_u32 m0, s78, 0
    s_add_u32 s71, s76, 0
    buffer_load_dwordx4 v20, s[60:63], s71 offen lds
    s_add_u32 m0, s78, 1024
    s_add_u32 s71, s76, 1024
    buffer_load_dwordx4 v20, s[60:63], s71 offen lds
    s_add_u32 m0, s78, 2048
    s_add_u32 s71, s76, 2048
    buffer_load_dwordx4 v20, s[60:63], s71 offen lds
    s_add_u32 s76, s76, 12288
    s_waitcnt vmcnt(0)
mega_kernel_ef122:
    s_waitcnt vmcnt(10)
    s_barrier
    s_cmp_lt_u32 s75, 4
    s_cbranch_scc1 mega_kernel_nof127
    s_sub_u32 s68, s75, 1
    s_cmp_lg_u32 s74, 0
    s_cbranch_scc1 mega_kernel_pf128
    v_mov_b32 v150, s68
    v_mov_b32 v151, 0
    s_lshl_b32 s71, s17, 2
    s_add_u32 s71, s71, 204500992
    s_mov_b64 exec, 1
    buffer_store_dword v150, v151, s[60:63], s71 offen sc1
    s_mov_b64 exec, -1
mega_kernel_pf128:
mega_kernel_nof127:
    s_cmp_ge_u32 s75, 63
    s_cbranch_scc1 mega_kernel_skip126
    s_cmp_lt_u32 s75, 2
    s_cbranch_scc1 mega_kernel_skip126
    s_add_u32 s68, s75, 2
    s_cmp_ge_u32 s29, s68
    s_cbranch_scc1 mega_kernel_wf129
    s_mov_b32 s69, 0
mega_kernel_wfl130:
    s_mov_b32 s71, 204500992
    buffer_load_dwordx2 v[150:151], v25, s[60:63], s71 offen sc1
    s_waitcnt vmcnt(0)
    v_min_u32 v150, v150, v151
    s_nop 0
    v_readfirstlane_b32 s29, v150
    s_add_u32 s69, s69, 1
    s_cmp_ge_u32 s69, 262144
    s_cbranch_scc1 mega_kernel_wf129
    s_cmp_lt_u32 s29, s68
    s_cbranch_scc1 mega_kernel_wfl130
mega_kernel_wf129:
    s_add_u32 m0, s77, 0
    s_add_u32 s71, s76, 0
    buffer_load_dwordx4 v20, s[60:63], s71 offen lds
    s_add_u32 m0, s77, 1024
    s_add_u32 s71, s76, 1024
    buffer_load_dwordx4 v20, s[60:63], s71 offen lds
    s_add_u32 m0, s77, 2048
    s_add_u32 s71, s76, 2048
    buffer_load_dwordx4 v20, s[60:63], s71 offen lds
    s_add_u32 s76, s76, 12288
mega_kernel_skip126:
    ds_read_b128 v[112:115], v22 offset:0
    ds_read_b128 v[116:119], v22 offset:6144
    ds_read_b128 v[120:123], v22 offset:1024
    ds_read_b128 v[124:127], v22 offset:7168
    s_waitcnt lgkmcnt(3)
    v_mfma_f32_16x16x32_bf16 v[32:35], v[112:115], a[0:3], 0
    v_mfma_f32_16x16x32_bf16 v[36:39], v[112:115], a[24:27], 0
    v_mfma_f32_16x16x32_bf16 v[40:43], v[112:115], a[48:51], 0
    v_mfma_f32_16x16x32_bf16 v[44:47], v[112:115], a[72:75], 0
    v_mfma_f32_16x16x32_bf16 v[48:51], v[112:115], a[96:99], 0
    v_mfma_f32_16x16x32_bf16 v[52:55], v[112:115], a[120:123], 0
    v_mfma_f32_16x16x32_bf16 v[56:59], v[112:115], a[144:147], 0
    v_mfma_f32_16x16x32_bf16 v[60:63], v[112:115], a[168:171], 0
    v_mfma_f32_16x16x32_bf16 v[64:67], v[112:115], a[192:195], 0
    v_mfma_f32_16x16x32_bf16 v[68:71], v[112:115], a[216:219], 0
    ds_read_b128 v[112:115], v22 offset:2048
    s_waitcnt lgkmcnt(3)
    v_mfma_f32_16x16x32_bf16 v[72:75], v[116:119], a[0:3], 0
    v_mfma_f32_16x16x32_bf16 v[76:79], v[116:119], a[24:27], 0
    v_mfma_f32_16x16x32_bf16 v[80:83], v[116:119], a[48:51], 0
    v_mfma_f32_16x16x32_bf16 v[84:87], v[116:119], a[72:75], 0
    v_mfma_f32_16x16x32_bf16 v[88:91], v[116:119], a[96:99], 0
    v_mfma_f32_16x16x32_bf16 v[92:95], v[116:119], a[120:123], 0
    v_mfma_f32_16x16x32_bf16 v[96:99], v[116:119], a[144:147], 0
    v_mfma_f32_16x16x32_bf16 v[100:103], v[116:119], a[168:171], 0
    v_mfma_f32_16x16x32_bf16 v[104:107], v[116:119], a[192:195], 0
    v_mfma_f32_16x16x32_bf16 v[108:111], v[116:119], a[216:219], 0
    ds_read_b128 v[116:119], v22 offset:8192
    s_waitcnt lgkmcnt(3)
    v_mfma_f32_16x16x32_bf16 v[32:35], v[120:123], a[4:7], v[32:35]
    v_mfma_f32_16x16x32_bf16 v[36:39], v[120:123], a[28:31], v[36:39]
    v_mfma_f32_16x16x32_bf16 v[40:43], v[120:123], a[52:55], v[40:43]
    v_mfma_f32_16x16x32_bf16 v[44:47], v[120:123], a[76:79], v[44:47]
    v_mfma_f32_16x16x32_bf16 v[48:51], v[120:123], a[100:103], v[48:51]
    v_mfma_f32_16x16x32_bf16 v[52:55], v[120:123], a[124:127], v[52:55]
    v_mfma_f32_16x16x32_bf16 v[56:59], v[120:123], a[148:151], v[56:59]
    v_mfma_f32_16x16x32_bf16 v[60:63], v[120:123], a[172:175], v[60:63]
    v_mfma_f32_16x16x32_bf16 v[64:67], v[120:123], a[196:199], v[64:67]
    v_mfma_f32_16x16x32_bf16 v[68:71], v[120:123], a[220:223], v[68:71]
    ds_read_b128 v[120:123], v22 offset:3072
    s_waitcnt lgkmcnt(3)
    v_mfma_f32_16x16x32_bf16 v[72:75], v[124:127], a[4:7], v[72:75]
    v_mfma_f32_16x16x32_bf16 v[76:79], v[124:127], a[28:31], v[76:79]
    v_mfma_f32_16x16x32_bf16 v[80:83], v[124:127], a[52:55], v[80:83]
    v_mfma_f32_16x16x32_bf16 v[84:87], v[124:127], a[76:79], v[84:87]
    v_mfma_f32_16x16x32_bf16 v[88:91], v[124:127], a[100:103], v[88:91]
    v_mfma_f32_16x16x32_bf16 v[92:95], v[124:127], a[124:127], v[92:95]
    v_mfma_f32_16x16x32_bf16 v[96:99], v[124:127], a[148:151], v[96:99]
    v_mfma_f32_16x16x32_bf16 v[100:103], v[124:127], a[172:175], v[100:103]
    v_mfma_f32_16x16x32_bf16 v[104:107], v[124:127], a[196:199], v[104:107]
    v_mfma_f32_16x16x32_bf16 v[108:111], v[124:127], a[220:223], v[108:111]
    ds_read_b128 v[124:127], v22 offset:9216
    s_waitcnt lgkmcnt(3)
    v_mfma_f32_16x16x32_bf16 v[32:35], v[112:115], a[8:11], v[32:35]
    v_mfma_f32_16x16x32_bf16 v[36:39], v[112:115], a[32:35], v[36:39]
    v_mfma_f32_16x16x32_bf16 v[40:43], v[112:115], a[56:59], v[40:43]
    v_mfma_f32_16x16x32_bf16 v[44:47], v[112:115], a[80:83], v[44:47]
    v_mfma_f32_16x16x32_bf16 v[48:51], v[112:115], a[104:107], v[48:51]
    v_mfma_f32_16x16x32_bf16 v[52:55], v[112:115], a[128:131], v[52:55]
    v_mfma_f32_16x16x32_bf16 v[56:59], v[112:115], a[152:155], v[56:59]
    v_mfma_f32_16x16x32_bf16 v[60:63], v[112:115], a[176:179], v[60:63]
    v_mfma_f32_16x16x32_bf16 v[64:67], v[112:115], a[200:203], v[64:67]
    v_mfma_f32_16x16x32_bf16 v[68:71], v[112:115], a[224:227], v[68:71]
    ds_read_b128 v[112:115], v22 offset:4096
    s_waitcnt lgkmcnt(3)
    v_mfma_f32_16x16x32_bf16 v[72:75], v[116:119], a[8:11], v[72:75]
    v_mfma_f32_16x16x32_bf16 v[76:79], v[116:119], a[32:35], v[76:79]
    v_mfma_f32_16x16x32_bf16 v[80:83], v[116:119], a[56:59], v[80:83]
    v_mfma_f32_16x16x32_bf16 v[84:87], v[116:119], a[80:83], v[84:87]
    v_mfma_f32_16x16x32_bf16 v[88:91], v[116:119], a[104:107], v[88:91]
    v_mfma_f32_16x16x32_bf16 v[92:95], v[116:119], a[128:131], v[92:95]
    v_mfma_f32_16x16x32_bf16 v[96:99], v[116:119], a[152:155], v[96:99]
    v_mfma_f32_16x16x32_bf16 v[100:103], v[116:119], a[176:179], v[100:103]
    v_mfma_f32_16x16x32_bf16 v[104:107], v[116:119], a[200:203], v[104:107]
    v_mfma_f32_16x16x32_bf16 v[108:111], v[116:119], a[224:227], v[108:111]
    ds_read_b128 v[116:119], v22 offset:10240
    s_waitcnt lgkmcnt(3)
    v_mfma_f32_16x16x32_bf16 v[32:35], v[120:123], a[12:15], v[32:35]
    v_mfma_f32_16x16x32_bf16 v[36:39], v[120:123], a[36:39], v[36:39]
    v_mfma_f32_16x16x32_bf16 v[40:43], v[120:123], a[60:63], v[40:43]
    v_mfma_f32_16x16x32_bf16 v[44:47], v[120:123], a[84:87], v[44:47]
    v_mfma_f32_16x16x32_bf16 v[48:51], v[120:123], a[108:111], v[48:51]
    v_mfma_f32_16x16x32_bf16 v[52:55], v[120:123], a[132:135], v[52:55]
    v_mfma_f32_16x16x32_bf16 v[56:59], v[120:123], a[156:159], v[56:59]
    v_mfma_f32_16x16x32_bf16 v[60:63], v[120:123], a[180:183], v[60:63]
    v_mfma_f32_16x16x32_bf16 v[64:67], v[120:123], a[204:207], v[64:67]
    v_mfma_f32_16x16x32_bf16 v[68:71], v[120:123], a[228:231], v[68:71]
    ds_read_b128 v[120:123], v22 offset:5120
    s_waitcnt lgkmcnt(3)
    v_mfma_f32_16x16x32_bf16 v[72:75], v[124:127], a[12:15], v[72:75]
    v_mfma_f32_16x16x32_bf16 v[76:79], v[124:127], a[36:39], v[76:79]
    v_mfma_f32_16x16x32_bf16 v[80:83], v[124:127], a[60:63], v[80:83]
    v_mfma_f32_16x16x32_bf16 v[84:87], v[124:127], a[84:87], v[84:87]
    v_mfma_f32_16x16x32_bf16 v[88:91], v[124:127], a[108:111], v[88:91]
    v_mfma_f32_16x16x32_bf16 v[92:95], v[124:127], a[132:135], v[92:95]
    v_mfma_f32_16x16x32_bf16 v[96:99], v[124:127], a[156:159], v[96:99]
    v_mfma_f32_16x16x32_bf16 v[100:103], v[124:127], a[180:183], v[100:103]
    v_mfma_f32_16x16x32_bf16 v[104:107], v[124:127], a[204:207], v[104:107]
    v_mfma_f32_16x16x32_bf16 v[108:111], v[124:127], a[228:231], v[108:111]
    ds_read_b128 v[124:127], v22 offset:11264
    s_waitcnt lgkmcnt(3)
    v_mfma_f32_16x16x32_bf16 v[32:35], v[112:115], a[16:19], v[32:35]
    v_mfma_f32_16x16x32_bf16 v[36:39], v[112:115], a[40:43], v[36:39]
    v_mfma_f32_16x16x32_bf16 v[40:43], v[112:115], a[64:67], v[40:43]
    v_mfma_f32_16x16x32_bf16 v[44:47], v[112:115], a[88:91], v[44:47]
    v_mfma_f32_16x16x32_bf16 v[48:51], v[112:115], a[112:115], v[48:51]
    v_mfma_f32_16x16x32_bf16 v[52:55], v[112:115], a[136:139], v[52:55]
    v_mfma_f32_16x16x32_bf16 v[56:59], v[112:115], a[160:163], v[56:59]
    v_mfma_f32_16x16x32_bf16 v[60:63], v[112:115], a[184:187], v[60:63]
    v_mfma_f32_16x16x32_bf16 v[64:67], v[112:115], a[208:211], v[64:67]
    v_mfma_f32_16x16x32_bf16 v[68:71], v[112:115], a[232:235], v[68:71]
    s_waitcnt lgkmcnt(2)
    v_mfma_f32_16x16x32_bf16 v[72:75], v[116:119], a[16:19], v[72:75]
    v_mfma_f32_16x16x32_bf16 v[76:79], v[116:119], a[40:43], v[76:79]
    v_mfma_f32_16x16x32_bf16 v[80:83], v[116:119], a[64:67], v[80:83]
    v_mfma_f32_16x16x32_bf16 v[84:87], v[116:119], a[88:91], v[84:87]
    v_mfma_f32_16x16x32_bf16 v[88:91], v[116:119], a[112:115], v[88:91]
    v_mfma_f32_16x16x32_bf16 v[92:95], v[116:119], a[136:139], v[92:95]
    v_mfma_f32_16x16x32_bf16 v[96:99], v[116:119], a[160:163], v[96:99]
    v_mfma_f32_16x16x32_bf16 v[100:103], v[116:119], a[184:187], v[100:103]
    v_mfma_f32_16x16x32_bf16 v[104:107], v[116:119], a[208:211], v[104:107]
    v_mfma_f32_16x16x32_bf16 v[108:111], v[116:119], a[232:235], v[108:111]
    s_waitcnt lgkmcnt(1)
    v_mfma_f32_16x16x32_bf16 v[32:35], v[120:123], a[20:23], v[32:35]
    v_mfma_f32_16x16x32_bf16 v[36:39], v[120:123], a[44:47], v[36:39]
    v_mfma_f32_16x16x32_bf16 v[40:43], v[120:123], a[68:71], v[40:43]
    v_mfma_f32_16x16x32_bf16 v[44:47], v[120:123], a[92:95], v[44:47]
    v_mfma_f32_16x16x32_bf16 v[48:51], v[120:123], a[116:119], v[48:51]
    v_mfma_f32_16x16x32_bf16 v[52:55], v[120:123], a[140:143], v[52:55]
    v_mfma_f32_16x16x32_bf16 v[56:59], v[120:123], a[164:167], v[56:59]
    v_mfma_f32_16x16x32_bf16 v[60:63], v[120:123], a[188:191], v[60:63]
    v_mfma_f32_16x16x32_bf16 v[64:67], v[120:123], a[212:215], v[64:67]
    v_mfma_f32_16x16x32_bf16 v[68:71], v[120:123], a[236:239], v[68:71]
    s_waitcnt lgkmcnt(0)
    v_mfma_f32_16x16x32_bf16 v[72:75], v[124:127], a[20:23], v[72:75]
    v_mfma_f32_16x16x32_bf16 v[76:79], v[124:127], a[44:47], v[76:79]
    v_mfma_f32_16x16x32_bf16 v[80:83], v[124:127], a[68:71], v[80:83]
    v_mfma_f32_16x16x32_bf16 v[84:87], v[124:127], a[92:95], v[84:87]
    v_mfma_f32_16x16x32_bf16 v[88:91], v[124:127], a[116:119], v[88:91]
    v_mfma_f32_16x16x32_bf16 v[92:95], v[124:127], a[140:143], v[92:95]
    v_mfma_f32_16x16x32_bf16 v[96:99], v[124:127], a[164:167], v[96:99]
    v_mfma_f32_16x16x32_bf16 v[100:103], v[124:127], a[188:191], v[100:103]
    v_mfma_f32_16x16x32_bf16 v[104:107], v[124:127], a[212:215], v[104:107]
    v_mfma_f32_16x16x32_bf16 v[108:111], v[124:127], a[236:239], v[108:111]
    s_nop 7
    s_lshl_b32 s3, s75, 5
    s_add_u32 s3, s3, s16
    s_mul_i32 s3, s3, 640
    s_add_u32 s3, s3, s19
    s_lshl_b32 s3, s3, 6
    s_add_u32 s3, s3, 83378176
    v_cvt_pk_bf16_f32 v128, v32, v33
    v_cvt_pk_bf16_f32 v129, v34, v35
    v_cvt_pk_bf16_f32 v130, v72, v73
    v_cvt_pk_bf16_f32 v131, v74, v75
    ds_write_b128 v27, v[128:131] offset:0
    v_cvt_pk_bf16_f32 v132, v36, v37
    v_cvt_pk_bf16_f32 v133, v38, v39
    v_cvt_pk_bf16_f32 v134, v76, v77
    v_cvt_pk_bf16_f32 v135, v78, v79
    ds_write_b128 v27, v[132:135] offset:64
    v_cvt_pk_bf16_f32 v136, v40, v41
    v_cvt_pk_bf16_f32 v137, v42, v43
    v_cvt_pk_bf16_f32 v138, v80, v81
    v_cvt_pk_bf16_f32 v139, v82, v83
    ds_write_b128 v27, v[136:139] offset:128
    v_cvt_pk_bf16_f32 v140, v44, v45
    v_cvt_pk_bf16_f32 v141, v46, v47
    v_cvt_pk_bf16_f32 v142, v84, v85
    v_cvt_pk_bf16_f32 v143, v86, v87
    ds_write_b128 v27, v[140:143] offset:192
    v_cvt_pk_bf16_f32 v128, v48, v49
    v_cvt_pk_bf16_f32 v129, v50, v51
    v_cvt_pk_bf16_f32 v130, v88, v89
    v_cvt_pk_bf16_f32 v131, v90, v91
    ds_write_b128 v27, v[128:131] offset:4096
    v_cvt_pk_bf16_f32 v132, v52, v53
    v_cvt_pk_bf16_f32 v133, v54, v55
    v_cvt_pk_bf16_f32 v134, v92, v93
    v_cvt_pk_bf16_f32 v135, v94, v95
    ds_write_b128 v27, v[132:135] offset:4160
    v_cvt_pk_bf16_f32 v136, v56, v57
    v_cvt_pk_bf16_f32 v137, v58, v59
    v_cvt_pk_bf16_f32 v138, v96, v97
    v_cvt_pk_bf16_f32 v139, v98, v99
    ds_write_b128 v27, v[136:139] offset:4224
    v_cvt_pk_bf16_f32 v140, v60, v61
    v_cvt_pk_bf16_f32 v141, v62, v63
    v_cvt_pk_bf16_f32 v142, v100, v101
    v_cvt_pk_bf16_f32 v143, v102, v103
    ds_write_b128 v27, v[140:143] offset:4288
    v_cvt_pk_bf16_f32 v128, v64, v65
    v_cvt_pk_bf16_f32 v129, v66, v67
    v_cvt_pk_bf16_f32 v130, v104, v105
    v_cvt_pk_bf16_f32 v131, v106, v107
    ds_write_b128 v28, v[128:131] offset:8192
    v_cvt_pk_bf16_f32 v132, v68, v69
    v_cvt_pk_bf16_f32 v133, v70, v71
    v_cvt_pk_bf16_f32 v134, v108, v109
    v_cvt_pk_bf16_f32 v135, v110, v111
    ds_write_b128 v28, v[132:135] offset:8256
    s_waitcnt lgkmcnt(0)
    ds_read_b128 v[152:155], v29 offset:0
    ds_read_b128 v[156:159], v29 offset:1024
    ds_read_b128 v[160:163], v29 offset:2048
    ds_read_b128 v[164:167], v29 offset:3072
    ds_read_b128 v[168:171], v29 offset:4096
    ds_read_b128 v[172:175], v29 offset:5120
    ds_read_b128 v[176:179], v29 offset:6144
    ds_read_b128 v[180:183], v29 offset:7168
    ds_read_b128 v[184:187], v29 offset:8192
    ds_read_b128 v[188:191], v29 offset:9216
    s_waitcnt lgkmcnt(9)
    s_add_u32 s71, s3, 0
    buffer_store_dwordx4 v[152:155], v20, s[60:63], s71 offen sc1
    s_waitcnt lgkmcnt(8)
    s_add_u32 s71, s3, 1024
    buffer_store_dwordx4 v[156:159], v20, s[60:63], s71 offen sc1
    s_waitcnt lgkmcnt(7)
    s_add_u32 s71, s3, 2048
    buffer_store_dwordx4 v[160:163], v20, s[60:63], s71 offen sc1
    s_waitcnt lgkmcnt(6)
    s_add_u32 s71, s3, 3072
    buffer_store_dwordx4 v[164:167], v20, s[60:63], s71 offen sc1
    s_waitcnt lgkmcnt(5)
    s_add_u32 s71, s3, 4096
    buffer_store_dwordx4 v[168:171], v20, s[60:63], s71 offen sc1
    s_waitcnt lgkmcnt(4)
    s_add_u32 s71, s3, 5120
    buffer_store_dwordx4 v[172:175], v20, s[60:63], s71 offen sc1
    s_waitcnt lgkmcnt(3)
    s_add_u32 s71, s3, 6144
    buffer_store_dwordx4 v[176:179], v20, s[60:63], s71 offen sc1
    s_waitcnt lgkmcnt(2)
    s_add_u32 s71, s3, 7168
    buffer_store_dwordx4 v[180:183], v20, s[60:63], s71 offen sc1
    s_waitcnt lgkmcnt(1)
    s_add_u32 s71, s3, 8192
    buffer_store_dwordx4 v[184:187], v20, s[60:63], s71 offen sc1
    s_waitcnt lgkmcnt(0)
    s_add_u32 s71, s3, 9216
    buffer_store_dwordx4 v[188:191], v20, s[60:63], s71 offen sc1
    s_nop 1
    s_add_u32 s75, s75, 1
    s_cmp_gt_u32 s75, 2
    s_cbranch_scc1 mega_kernel_ef131
    s_waitcnt vmcnt(0)
    s_barrier
    s_cmp_lg_u32 s74, 0
    s_cbranch_scc1 mega_kernel_pf132
    v_mov_b32 v150, s75
    v_mov_b32 v151, 0
    s_lshl_b32 s71, s17, 2
    s_add_u32 s71, s71, 204500992
    s_mov_b64 exec, 1
    buffer_store_dword v150, v151, s[60:63], s71 offen sc1
    s_mov_b64 exec, -1
mega_kernel_pf132:
    s_add_u32 s68, s75, 1
    s_cmp_ge_u32 s29, s68
    s_cbranch_scc1 mega_kernel_wf133
    s_mov_b32 s69, 0
mega_kernel_wfl134:
    s_mov_b32 s71, 204500992
    buffer_load_dwordx2 v[150:151], v25, s[60:63], s71 offen sc1
    s_waitcnt vmcnt(0)
    v_min_u32 v150, v150, v151
    s_nop 0
    v_readfirstlane_b32 s29, v150
    s_add_u32 s69, s69, 1
    s_cmp_ge_u32 s69, 262144
    s_cbranch_scc1 mega_kernel_wf133
    s_cmp_lt_u32 s29, s68
    s_cbranch_scc1 mega_kernel_wfl134
mega_kernel_wf133:
    s_add_u32 m0, s77, 0
    s_add_u32 s71, s76, 0
    buffer_load_dwordx4 v20, s[60:63], s71 offen lds
    s_add_u32 m0, s77, 1024
    s_add_u32 s71, s76, 1024
    buffer_load_dwordx4 v20, s[60:63], s71 offen lds
    s_add_u32 m0, s77, 2048
    s_add_u32 s71, s76, 2048
    buffer_load_dwordx4 v20, s[60:63], s71 offen lds
    s_add_u32 s76, s76, 12288
    s_waitcnt vmcnt(0)
mega_kernel_ef131:
    s_cmp_lt_u32 s75, 64
    s_cbranch_scc1 mega_kernel_loop116
    s_waitcnt vmcnt(0)
    s_barrier
    s_cmp_lg_u32 s74, 0
    s_cbranch_scc1 mega_kernel_pf135
    v_mov_b32 v150, s75
    v_mov_b32 v151, 0
    s_lshl_b32 s71, s17, 2
    s_add_u32 s71, s71, 204500992
    s_mov_b64 exec, 1
    buffer_store_dword v150, v151, s[60:63], s71 offen sc1
    s_mov_b64 exec, -1
mega_kernel_pf135:
    s_branch mega_T3_LA
    s_branch mega_kernel_tsk136
mega_T3_LQ:
    s_branch mega_kernel_qkv2
mega_T3_LV:
    s_branch mega_kernel_vo3
mega_T3_LA:
    s_branch mega_kernel_attn4
mega_T3_LU:
    s_branch mega_kernel_up5
mega_T3_LD:
    s_branch mega_kernel_down6
mega_T3_done:
    s_branch mega_kernel_done1
mega_kernel_tsk136:
mega_kernel_attn4:
    s_load_dwordx2 s[10:11], s[0:1], 0
    s_load_dwordx2 s[12:13], s[0:1], 112
    s_waitcnt lgkmcnt(0)
    s_mov_b32 s64, s10
    s_and_b32 s65, s11, 0xffff
    s_mov_b32 s66, 2621440
    s_mov_b32 s67, 0x00020000
    s_mov_b32 s88, s12
    s_and_b32 s89, s13, 0xffff
    s_mov_b32 s90, 256
    s_mov_b32 s91, 0x00020000
    s_mov_b32 s43, 0
    s_mov_b32 s42, 0
    v_mov_b32 v6, 192
    s_mov_b32 s69, 0
mega_kernel_cw138:
    buffer_load_dword v5, v6, s[88:91], 0 offen sc1
    s_add_u32 s69, s69, 1
    s_cmp_ge_u32 s69, 1048576
    s_cbranch_scc1 mega_kernel_cwo139
    s_waitcnt vmcnt(0)
    v_cmp_gt_u32 vcc, 256, v5
    s_cbranch_vccz mega_kernel_cwo139
    s_sleep 8
    s_branch mega_kernel_cw138
mega_kernel_cwo139:
mega_kernel_attn_top137:
    s_barrier
    s_cmp_lg_u32 s74, 0
    s_cbranch_scc1 mega_kernel_grab140
    v_mov_b32 v5, 1
    v_mov_b32 v6, 0
    s_mov_b64 exec, 1
    buffer_atomic_add v5, v6, s[88:91], 0 offen sc0 sc1
    s_waitcnt vmcnt(0)
    v_mov_b32 v6, 0x20000
    ds_write_b32 v6, v5
    s_mov_b64 exec, -1
    s_waitcnt lgkmcnt(0)
mega_kernel_grab140:
    s_barrier
    v_mov_b32 v6, 0x20000
    ds_read_b32 v5, v6
    s_waitcnt lgkmcnt(0)
    v_readfirstlane_b32 s19, v5
    s_cmp_ge_u32 s19, 1024
    s_cbranch_scc1 mega_kernel_done1
    s_lshr_b32 s20, s19, 4
    s_and_b32 s21, s19, 1
    s_mul_i32 s21, s21, 320
    s_bfe_u32 s18, s19, 0x30001
    v_min_u32 v5, 23, v2
    v_lshlrev_b32 v5, 2, v5
    s_add_u32 s68, s20, 1
    s_cmp_ge_u32 s43, s68
    s_cbranch_scc1 mega_kernel_wn141
    s_mov_b32 s69, 0
mega_kernel_wnl142:
    s_mov_b32 s71, 204500992
    buffer_load_dword v6, v5, s[60:63], s71 offen sc1
    s_add_u32 s69, s69, 1
    s_cmp_ge_u32 s69, 262144
    s_cbranch_scc1 mega_kernel_wnb143
    s_waitcnt vmcnt(0)
    v_cmp_gt_u32 vcc, s68, v6
    s_cbranch_vccnz mega_kernel_wnl142
mega_kernel_wnb143:
    s_mov_b32 s43, s68
    s_add_u32 s71, s68, 8
    v_cmp_gt_u32 vcc, s71, v6
    s_cbranch_vccnz mega_kernel_wn141
    s_mov_b32 s43, s71
mega_kernel_wn141:
    v_and_b32 v5, 63, v2
    v_min_u32 v5, 55, v5
    v_add_u32 v5, 24, v5
    v_add_u32 v6, 24, v5
    v_cmp_le_u32 vcc, 48, v5
    s_nop 1
    v_cndmask_b32 v5, v5, v6, vcc
    v_lshlrev_b32 v5, 2, v5
    s_cmp_ge_u32 s42, s68
    s_cbranch_scc1 mega_kernel_wn144
    s_mov_b32 s69, 0
mega_kernel_wnl145:
    s_mov_b32 s71, 204500992
    buffer_load_dword v6, v5, s[60:63], s71 offen sc1
    s_add_u32 s69, s69, 1
    s_cmp_ge_u32 s69, 262144
    s_cbranch_scc1 mega_kernel_wnb146
    s_waitcnt vmcnt(0)
    v_cmp_gt_u32 vcc, s68, v6
    s_cbranch_vccnz mega_kernel_wnl145
mega_kernel_wnb146:
    s_mov_b32 s42, s68
    s_add_u32 s71, s68, 8
    v_cmp_gt_u32 vcc, s71, v6
    s_cbranch_vccnz mega_kernel_wn144
    s_mov_b32 s42, s71
mega_kernel_wn144:
    v_cmp_le_u32 s[84:85], 32, v2
    v_lshlrev_b32 v5, 2, v4
    v_sub_u32 v5, v5, v3
    v_cmp_ge_i32 s[44:45], 0, v5
    v_cmp_ge_i32 s[46:47], -1, v5
    v_cmp_ge_i32 s[48:49], -2, v5
    v_cmp_ge_i32 s[50:51], -3, v5
    v_lshlrev_b32 v6, 4, v2
    v_and_b32 v7, 7, v3
    v_mul_u32_u24 v7, 384, v7
    v_lshl_add_u32 v7, v4, 4, v7
    v_lshlrev_b32 v252, 6, v3
    v_lshl_add_u32 v252, v4, 4, v252
    v_and_b32 v253, 1, v4
    v_lshlrev_b32 v253, 3, v253
    v_lshl_add_u32 v253, v3, 4, v253
    v_mov_b32 v254, 0xff800000
    s_lshl_b32 s22, s18, 2
    s_add_u32 s22, s22, s74
    v_mov_b32 v100, 0
    v_mov_b32 v101, 0
    v_mov_b32 v102, 0
    v_mov_b32 v103, 0
    v_mov_b32 v104, 0
    v_mov_b32 v105, 0
    v_mov_b32 v106, 0
    v_mov_b32 v107, 0
    v_mov_b32 v108, 0
    v_mov_b32 v109, 0
    v_mov_b32 v110, 0
    v_mov_b32 v111, 0
    v_mov_b32 v112, 0
    v_mov_b32 v113, 0
    v_mov_b32 v114, 0
    v_mov_b32 v115, 0
    v_mov_b32 v116, 0
    v_mov_b32 v117, 0
    v_mov_b32 v118, 0
    v_mov_b32 v119, 0
    v_mov_b32 v120, 0
    v_mov_b32 v121, 0
    v_mov_b32 v122, 0
    v_mov_b32 v123, 0
    v_mov_b32 v124, 0
    v_mov_b32 v125, 0
    v_mov_b32 v126, 0
    v_mov_b32 v127, 0
    v_mov_b32 v128, 0
    v_mov_b32 v129, 0
    v_mov_b32 v130, 0
    v_mov_b32 v131, 0
    v_mov_b32 v132, 0
    v_mov_b32 v133, 0
    v_mov_b32 v134, 0
    v_mov_b32 v135, 0
    v_mov_b32 v136, 0
    v_mov_b32 v137, 0
    v_mov_b32 v138, 0
    v_mov_b32 v139, 0
    v_mov_b32 v140, 0
    v_mov_b32 v141, 0
    v_mov_b32 v142, 0
    v_mov_b32 v143, 0
    v_mov_b32 v144, 0
    v_mov_b32 v145, 0
    v_mov_b32 v146, 0
    v_mov_b32 v147, 0
    v_mov_b32 v148, 0
    v_mov_b32 v149, 0
    v_mov_b32 v150, 0
    v_mov_b32 v151, 0
    v_mov_b32 v152, 0
    v_mov_b32 v153, 0
    v_mov_b32 v154, 0
    v_mov_b32 v155, 0
    v_mov_b32 v156, 0
    v_mov_b32 v157, 0
    v_mov_b32 v158, 0
    v_mov_b32 v159, 0
    v_mov_b32 v160, 0
    v_mov_b32 v161, 0
    v_mov_b32 v162, 0
    v_mov_b32 v163, 0
    v_mov_b32 v164, 0
    v_mov_b32 v165, 0
    v_mov_b32 v166, 0
    v_mov_b32 v167, 0
    v_mov_b32 v168, 0
    v_mov_b32 v169, 0
    v_mov_b32 v170, 0
    v_mov_b32 v171, 0
    v_mov_b32 v172, 0
    v_mov_b32 v173, 0
    v_mov_b32 v174, 0
    v_mov_b32 v175, 0
    v_mov_b32 v176, 0
    v_mov_b32 v177, 0
    v_mov_b32 v178, 0
    v_mov_b32 v179, 0
    s_add_u32 s68, s20, 2
    s_min_u32 s68, s68, 64
    s_mov_b32 s3, 204502272
    v_mov_b32 v90, 0
    s_mov_b32 s69, 0
mega_kernel_wr147:
    buffer_load_dword v91, v90, s[60:63], s3 offen sc1
    s_add_u32 s69, s69, 1
    s_cmp_ge_u32 s69, 1048576
    s_cbranch_scc1 mega_kernel_wr2148
    s_waitcnt vmcnt(0)
    v_cmp_gt_u32 vcc, s68, v91
    s_cbranch_vccz mega_kernel_wr2148
    s_sleep 32
    s_branch mega_kernel_wr147
mega_kernel_wr2148:
    s_cmp_lg_u32 s20, 63
    s_cbranch_scc1 mega_kernel_wr3149
    v_mov_b32 v90, 0
    s_mov_b32 s3, 204501408
mega_kernel_wr4150:
    buffer_load_dword v91, v90, s[60:63], s3 offen sc1
    s_add_u32 s69, s69, 1
    s_cmp_ge_u32 s69, 1048576
    s_cbranch_scc1 mega_kernel_wr3149
    s_waitcnt vmcnt(0)
    v_cmp_gt_u32 vcc, 0xa0, v91
    s_cbranch_vccnz mega_kernel_wr4150
mega_kernel_wr3149:
    s_mul_i32 s24, s20, 12288
    s_mul_i32 s3, s22, 786432
    s_add_u32 s24, s24, s3
    s_add_u32 s25, s24, 7880704
    s_add_u32 s26, s24, 33046528
    s_lshl_b32 s27, s20, 5
    s_add_u32 s27, s27, s22
    s_mul_i32 s28, s27, 3072
    s_add_u32 s28, s28, 190869504
    s_mul_i32 s29, s27, 640
    s_add_u32 s29, s29, s21
    s_lshl_b32 s30, s29, 6
    s_add_u32 s30, s30, 83378176
    s_lshl_b32 s31, s29, 4
    s_add_u32 s31, s31, 167264256
    s_add_u32 s71, s25, 0
    buffer_load_dwordx4 v[20:23], v6, s[60:63], s71 offen
    s_add_u32 s71, s25, 1024
    buffer_load_dwordx4 v[24:27], v6, s[60:63], s71 offen
    s_add_u32 s71, s25, 2048
    buffer_load_dwordx4 v[28:31], v6, s[60:63], s71 offen
    s_add_u32 s71, s25, 3072
    buffer_load_dwordx4 v[32:35], v6, s[60:63], s71 offen
    s_add_u32 s71, s25, 4096
    buffer_load_dwordx4 v[36:39], v6, s[60:63], s71 offen
    s_add_u32 s71, s25, 5120
    buffer_load_dwordx4 v[40:43], v6, s[60:63], s71 offen
    s_add_u32 s71, s25, 6144
    buffer_load_dwordx4 v[44:47], v6, s[60:63], s71 offen
    s_add_u32 s71, s25, 7168
    buffer_load_dwordx4 v[48:51], v6, s[60:63], s71 offen
    s_add_u32 s71, s25, 8192
    buffer_load_dwordx4 v[52:55], v6, s[60:63], s71 offen
    s_add_u32 s71, s25, 9216
    buffer_load_dwordx4 v[56:59], v6, s[60:63], s71 offen
    s_add_u32 s71, s25, 10240
    buffer_load_dwordx4 v[60:63], v6, s[60:63], s71 offen
    s_add_u32 s71, s25, 11264
    buffer_load_dwordx4 v[64:67], v6, s[60:63], s71 offen
    s_add_u32 s71, s26, 0
    buffer_load_dwordx4 v[204:207], v6, s[60:63], s71 offen
    s_add_u32 s71, s26, 1024
    buffer_load_dwordx4 v[208:211], v6, s[60:63], s71 offen
    s_add_u32 s71, s26, 2048
    buffer_load_dwordx4 v[212:215], v6, s[60:63], s71 offen
    s_add_u32 s71, s26, 3072
    buffer_load_dwordx4 v[216:219], v6, s[60:63], s71 offen
    s_add_u32 s71, s26, 4096
    buffer_load_dwordx4 v[220:223], v6, s[60:63], s71 offen
    s_add_u32 s71, s26, 5120
    buffer_load_dwordx4 v[224:227], v6, s[60:63], s71 offen
    s_add_u32 s71, s26, 6144
    buffer_load_dwordx4 v[228:231], v6, s[60:63], s71 offen
    s_add_u32 s71, s26, 7168
    buffer_load_dwordx4 v[232:235], v6, s[60:63], s71 offen
    s_add_u32 s71, s26, 8192
    buffer_load_dwordx4 v[236:239], v6, s[60:63], s71 offen
    s_add_u32 s71, s26, 9216
    buffer_load_dwordx4 v[240:243], v6, s[60:63], s71 offen
    s_add_u32 s71, s26, 10240
    buffer_load_dwordx4 v[244:247], v6, s[60:63], s71 offen
    s_add_u32 s71, s26, 11264
    buffer_load_dwordx4 v[248:251], v6, s[60:63], s71 offen
    s_add_u32 s71, s30, 0
    buffer_load_dwordx4 a[0:3], v252, s[60:63], s71 offen
    s_add_u32 s71, s30, 1024
    buffer_load_dwordx4 a[4:7], v252, s[60:63], s71 offen
    s_add_u32 s71, s30, 2048
    buffer_load_dwordx4 a[8:11], v252, s[60:63], s71 offen
    s_add_u32 s71, s30, 3072
    buffer_load_dwordx4 a[12:15], v252, s[60:63], s71 offen
    s_add_u32 s71, s30, 4096
    buffer_load_dwordx4 a[16:19], v252, s[60:63], s71 offen
    s_add_u32 s71, s30, 5120
    buffer_load_dwordx4 a[20:23], v252, s[60:63], s71 offen
    s_add_u32 s71, s30, 6144
    buffer_load_dwordx4 a[24:27], v252, s[60:63], s71 offen
    s_add_u32 s71, s30, 7168
    buffer_load_dwordx4 a[28:31], v252, s[60:63], s71 offen
    s_add_u32 s71, s30, 8192
    buffer_load_dwordx4 a[32:35], v252, s[60:63], s71 offen
    s_add_u32 s71, s30, 9216
    buffer_load_dwordx4 a[36:39], v252, s[60:63], s71 offen
    buffer_load_dwordx4 v[180:183], v7, s[60:63], s28 offen offset:0
    buffer_load_dwordx4 v[184:187], v7, s[60:63], s28 offen offset:64
    buffer_load_dwordx4 v[188:191], v7, s[60:63], s28 offen offset:128
    buffer_load_dwordx4 v[192:195], v7, s[60:63], s28 offen offset:192
    buffer_load_dwordx4 v[196:199], v7, s[60:63], s28 offen offset:256
    buffer_load_dwordx4 v[200:203], v7, s[60:63], s28 offen offset:320
    buffer_load_dwordx2 a[40:41], v253, s[60:63], s31 offen offset:0
    buffer_load_dwordx2 a[42:43], v253, s[60:63], s31 offen offset:256
    buffer_load_dwordx2 a[44:45], v253, s[60:63], s31 offen offset:512
    buffer_load_dwordx2 a[46:47], v253, s[60:63], s31 offen offset:768
    buffer_load_dwordx2 a[48:49], v253, s[60:63], s31 offen offset:1024
    buffer_load_dwordx2 a[50:51], v253, s[60:63], s31 offen offset:1280
    buffer_load_dwordx2 a[52:53], v253, s[60:63], s31 offen offset:1536
    buffer_load_dwordx2 a[54:55], v253, s[60:63], s31 offen offset:1792
    buffer_load_dwordx2 a[56:57], v253, s[60:63], s31 offen offset:2048
    buffer_load_dwordx2 a[58:59], v253, s[60:63], s31 offen offset:2304
    s_add_u32 s31, s31, 2560
    s_add_u32 s71, s30, 10240
    buffer_load_dwordx4 a[184:187], v252, s[60:63], s71 offen
    buffer_load_dwordx2 a[224:225], v253, s[60:63], s31 offen offset:0
    s_add_u32 s71, s30, 11264
    buffer_load_dwordx4 a[188:191], v252, s[60:63], s71 offen
    buffer_load_dwordx2 a[226:227], v253, s[60:63], s31 offen offset:256
    s_add_u32 s71, s30, 12288
    buffer_load_dwordx4 a[192:195], v252, s[60:63], s71 offen
    buffer_load_dwordx2 a[228:229], v253, s[60:63], s31 offen offset:512
    s_add_u32 s71, s30, 13312
    buffer_load_dwordx4 a[196:199], v252, s[60:63], s71 offen
    buffer_load_dwordx2 a[230:231], v253, s[60:63], s31 offen offset:768
    s_add_u32 s71, s30, 14336
    buffer_load_dwordx4 a[200:203], v252, s[60:63], s71 offen
    buffer_load_dwordx2 a[232:233], v253, s[60:63], s31 offen offset:1024
    s_add_u32 s71, s30, 15360
    buffer_load_dwordx4 a[204:207], v252, s[60:63], s71 offen
    buffer_load_dwordx2 a[234:235], v253, s[60:63], s31 offen offset:1280
    s_add_u32 s71, s30, 16384
    buffer_load_dwordx4 a[208:211], v252, s[60:63], s71 offen
    buffer_load_dwordx2 a[236:237], v253, s[60:63], s31 offen offset:1536
    s_add_u32 s71, s30, 17408
    buffer_load_dwordx4 a[212:215], v252, s[60:63], s71 offen
    buffer_load_dwordx2 a[238:239], v253, s[60:63], s31 offen offset:1792
    s_add_u32 s71, s30, 18432
    buffer_load_dwordx4 a[216:219], v252, s[60:63], s71 offen
    buffer_load_dwordx2 a[240:241], v253, s[60:63], s31 offen offset:2048
    s_add_u32 s71, s30, 19456
    buffer_load_dwordx4 a[220:223], v252, s[60:63], s71 offen
    buffer_load_dwordx2 a[242:243], v253, s[60:63], s31 offen offset:2304
    s_waitcnt vmcnt(30)
    v_mfma_f32_16x16x32_bf16 v[68:71], v[180:183], v[20:23], 0
    v_mfma_f32_16x16x32_bf16 v[72:75], v[204:207], v[20:23], 0
    v_mfma_f32_16x16x32_bf16 v[76:79], v[180:183], v[44:47], 0
    v_mfma_f32_16x16x32_bf16 v[80:83], v[204:207], v[44:47], 0
    v_mfma_f32_16x16x32_bf16 v[84:87], v[228:231], v[44:47], 0
    v_mfma_f32_16x16x32_bf16 v[68:71], v[184:187], v[24:27], v[68:71]
    v_mfma_f32_16x16x32_bf16 v[72:75], v[208:211], v[24:27], v[72:75]
    v_mfma_f32_16x16x32_bf16 v[76:79], v[184:187], v[48:51], v[76:79]
    v_mfma_f32_16x16x32_bf16 v[80:83], v[208:211], v[48:51], v[80:83]
    v_mfma_f32_16x16x32_bf16 v[84:87], v[232:235], v[48:51], v[84:87]
    v_mfma_f32_16x16x32_bf16 v[68:71], v[188:191], v[28:31], v[68:71]
    v_mfma_f32_16x16x32_bf16 v[72:75], v[212:215], v[28:31], v[72:75]
    v_mfma_f32_16x16x32_bf16 v[76:79], v[188:191], v[52:55], v[76:79]
    v_mfma_f32_16x16x32_bf16 v[80:83], v[212:215], v[52:55], v[80:83]
    v_mfma_f32_16x16x32_bf16 v[84:87], v[236:239], v[52:55], v[84:87]
    v_mfma_f32_16x16x32_bf16 v[68:71], v[192:195], v[32:35], v[68:71]
    v_mfma_f32_16x16x32_bf16 v[72:75], v[216:219], v[32:35], v[72:75]
    v_mfma_f32_16x16x32_bf16 v[76:79], v[192:195], v[56:59], v[76:79]
    v_mfma_f32_16x16x32_bf16 v[80:83], v[216:219], v[56:59], v[80:83]
    v_mfma_f32_16x16x32_bf16 v[84:87], v[240:243], v[56:59], v[84:87]
    v_mfma_f32_16x16x32_bf16 v[68:71], v[196:199], v[36:39], v[68:71]
    v_mfma_f32_16x16x32_bf16 v[72:75], v[220:223], v[36:39], v[72:75]
    v_mfma_f32_16x16x32_bf16 v[76:79], v[196:199], v[60:63], v[76:79]
    v_mfma_f32_16x16x32_bf16 v[80:83], v[220:223], v[60:63], v[80:83]
    v_mfma_f32_16x16x32_bf16 v[84:87], v[244:247], v[60:63], v[84:87]
    v_mfma_f32_16x16x32_bf16 v[68:71], v[200:203], v[40:43], v[68:71]
    v_mfma_f32_16x16x32_bf16 v[72:75], v[224:227], v[40:43], v[72:75]
    v_mfma_f32_16x16x32_bf16 v[76:79], v[200:203], v[64:67], v[76:79]
    v_mfma_f32_16x16x32_bf16 v[80:83], v[224:227], v[64:67], v[80:83]
    v_mfma_f32_16x16x32_bf16 v[84:87], v[248:251], v[64:67], v[84:87]
    s_nop 7
    v_cvt_pk_bf16_f32 v88, v68, v69
    v_lshlrev_b32 v68, 16, v88
    v_and_b32 v69, 0xffff0000, v88
    v_mul_f32 v68, 0x3d93cd3a, v68
    v_mul_f32 v69, 0x3d93cd3a, v69
    v_cvt_pk_bf16_f32 v88, v68, v69
    v_lshlrev_b32 v68, 16, v88
    v_and_b32 v69, 0xffff0000, v88
    v_cvt_pk_bf16_f32 v88, v70, v71
    v_lshlrev_b32 v70, 16, v88
    v_and_b32 v71, 0xffff0000, v88
    v_mul_f32 v70, 0x3d93cd3a, v70
    v_mul_f32 v71, 0x3d93cd3a, v71
    v_cvt_pk_bf16_f32 v88, v70, v71
    v_lshlrev_b32 v70, 16, v88
    v_and_b32 v71, 0xffff0000, v88
    v_cvt_pk_bf16_f32 v88, v72, v73
    v_lshlrev_b32 v72, 16, v88
    v_and_b32 v73, 0xffff0000, v88
    v_mul_f32 v72, 0x3d93cd3a, v72
    v_mul_f32 v73, 0x3d93cd3a, v73
    v_cvt_pk_bf16_f32 v88, v72, v73
    v_lshlrev_b32 v72, 16, v88
    v_and_b32 v73, 0xffff0000, v88
    v_cvt_pk_bf16_f32 v88, v74, v75
    v_lshlrev_b32 v74, 16, v88
    v_and_b32 v75, 0xffff0000, v88
    v_mul_f32 v74, 0x3d93cd3a, v74
    v_mul_f32 v75, 0x3d93cd3a, v75
    v_cvt_pk_bf16_f32 v88, v74, v75
    v_lshlrev_b32 v74, 16, v88
    v_and_b32 v75, 0xffff0000, v88
    v_cvt_pk_bf16_f32 v88, v76, v77
    v_lshlrev_b32 v76, 16, v88
    v_and_b32 v77, 0xffff0000, v88
    v_mul_f32 v76, 0x3d93cd3a, v76
    v_mul_f32 v77, 0x3d93cd3a, v77
    v_cvt_pk_bf16_f32 v88, v76, v77
    v_lshlrev_b32 v76, 16, v88
    v_and_b32 v77, 0xffff0000, v88
    v_cvt_pk_bf16_f32 v88, v78, v79
    v_lshlrev_b32 v78, 16, v88
    v_and_b32 v79, 0xffff0000, v88
    v_mul_f32 v78, 0x3d93cd3a, v78
    v_mul_f32 v79, 0x3d93cd3a, v79
    v_cvt_pk_bf16_f32 v88, v78, v79
    v_lshlrev_b32 v78, 16, v88
    v_and_b32 v79, 0xffff0000, v88
    v_cvt_pk_bf16_f32 v88, v80, v81
    v_lshlrev_b32 v80, 16, v88
    v_and_b32 v81, 0xffff0000, v88
    v_mul_f32 v80, 0x3d93cd3a, v80
    v_mul_f32 v81, 0x3d93cd3a, v81
    v_cvt_pk_bf16_f32 v88, v80, v81
    v_lshlrev_b32 v80, 16, v88
    v_and_b32 v81, 0xffff0000, v88
    v_cvt_pk_bf16_f32 v88, v82, v83
    v_lshlrev_b32 v82, 16, v88
    v_and_b32 v83, 0xffff0000, v88
    v_mul_f32 v82, 0x3d93cd3a, v82
    v_mul_f32 v83, 0x3d93cd3a, v83
    v_cvt_pk_bf16_f32 v88, v82, v83
    v_lshlrev_b32 v82, 16, v88
    v_and_b32 v83, 0xffff0000, v88
    v_cvt_pk_bf16_f32 v88, v84, v85
    v_lshlrev_b32 v84, 16, v88
    v_and_b32 v85, 0xffff0000, v88
    v_mul_f32 v84, 0x3d93cd3a, v84
    v_mul_f32 v85, 0x3d93cd3a, v85
    v_cvt_pk_bf16_f32 v88, v84, v85
    v_lshlrev_b32 v84, 16, v88
    v_and_b32 v85, 0xffff0000, v88
    v_cvt_pk_bf16_f32 v88, v86, v87
    v_lshlrev_b32 v86, 16, v88
    v_and_b32 v87, 0xffff0000, v88
    v_mul_f32 v86, 0x3d93cd3a, v86
    v_mul_f32 v87, 0x3d93cd3a, v87
    v_cvt_pk_bf16_f32 v88, v86, v87
    v_lshlrev_b32 v86, 16, v88
    v_and_b32 v87, 0xffff0000, v88
    v_cndmask_b32 v68, v68, v254, s[84:85]
    v_cndmask_b32 v69, v69, v254, s[84:85]
    v_cndmask_b32 v70, v70, v254, s[84:85]
    v_cndmask_b32 v71, v71, v254, s[84:85]
    v_cndmask_b32 v72, v254, v72, s[44:45]
    v_cndmask_b32 v73, v254, v73, s[46:47]
    v_cndmask_b32 v74, v254, v74, s[48:49]
    v_cndmask_b32 v75, v254, v75, s[50:51]
    v_cndmask_b32 v76, v76, v254, s[84:85]
    v_cndmask_b32 v77, v77, v254, s[84:85]
    v_cndmask_b32 v78, v78, v254, s[84:85]
    v_cndmask_b32 v79, v79, v254, s[84:85]
    v_cndmask_b32 v84, v254, v84, s[44:45]
    v_cndmask_b32 v85, v254, v85, s[46:47]
    v_cndmask_b32 v86, v254, v86, s[48:49]
    v_cndmask_b32 v87, v254, v87, s[50:51]
    v_max3_f32 v88, v68, v69, v70
    v_max3_f32 v88, v88, v71, v72
    v_max3_f32 v88, v88, v73, v74
    v_max_f32 v88, v88, v75
    v_mov_b32 v89, v88
    s_nop 1
    v_permlane16_swap_b32 v88, v89
    s_nop 1
    v_max_f32 v88, v88, v89
    v_mov_b32 v89, v88
    s_nop 1
    v_permlane32_swap_b32 v88, v89
    s_nop 1
    v_max_f32 v88, v88, v89
    v_mul_f32 v88, 0xbfb8aa3b, v88
    s_mov_b32 s3, 0x3fb8aa3b
    v_fma_f32 v68, v68, s3, v88
    v_fma_f32 v69, v69, s3, v88
    v_fma_f32 v70, v70, s3, v88
    v_fma_f32 v71, v71, s3, v88
    v_fma_f32 v72, v72, s3, v88
    v_fma_f32 v73, v73, s3, v88
    v_fma_f32 v74, v74, s3, v88
    v_fma_f32 v75, v75, s3, v88
    v_exp_f32 v68, v68
    v_exp_f32 v69, v69
    v_exp_f32 v70, v70
    v_exp_f32 v71, v71
    v_exp_f32 v72, v72
    v_exp_f32 v73, v73
    v_exp_f32 v74, v74
    v_exp_f32 v75, v75
    s_nop 0
    v_add_f32 v89, v68, v69
    v_add_f32 v89, v89, v70
    v_add_f32 v89, v89, v71
    v_add_f32 v89, v89, v72
    v_add_f32 v89, v89, v73
    v_add_f32 v89, v89, v74
    v_add_f32 v89, v89, v75
    v_mov_b32 v90, v89
    s_nop 1
    v_permlane16_swap_b32 v89, v90
    s_nop 1
    v_add_f32 v89, v89, v90
    v_mov_b32 v90, v89
    s_nop 1
    v_permlane32_swap_b32 v89, v90
    s_nop 1
    v_add_f32 v89, v89, v90
    v_rcp_f32 v89, v89
    s_nop 0
    v_mul_f32 v68, v68, v89
    v_mul_f32 v69, v69, v89
    v_mul_f32 v70, v70, v89
    v_mul_f32 v71, v71, v89
    v_mul_f32 v72, v72, v89
    v_mul_f32 v73, v73, v89
    v_mul_f32 v74, v74, v89
    v_mul_f32 v75, v75, v89
    v_cvt_pk_bf16_f32 v8, v68, v69
    v_cvt_pk_bf16_f32 v9, v70, v71
    v_cvt_pk_bf16_f32 v10, v72, v73
    v_cvt_pk_bf16_f32 v11, v74, v75
    v_mov_b32 v12, 0
    v_mov_b32 v13, 0
    v_max3_f32 v88, v76, v77, v78
    v_max3_f32 v88, v88, v79, v80
    v_max3_f32 v88, v88, v81, v82
    v_max3_f32 v88, v88, v83, v84
    v_max3_f32 v88, v88, v85, v86
    v_max_f32 v88, v88, v87
    v_mov_b32 v89, v88
    s_nop 1
    v_permlane16_swap_b32 v88, v89
    s_nop 1
    v_max_f32 v88, v88, v89
    v_mov_b32 v89, v88
    s_nop 1
    v_permlane32_swap_b32 v88, v89
    s_nop 1
    v_max_f32 v88, v88, v89
    v_mul_f32 v88, 0xbfb8aa3b, v88
    s_mov_b32 s3, 0x3fb8aa3b
    v_fma_f32 v76, v76, s3, v88
    v_fma_f32 v77, v77, s3, v88
    v_fma_f32 v78, v78, s3, v88
    v_fma_f32 v79, v79, s3, v88
    v_fma_f32 v80, v80, s3, v88
    v_fma_f32 v81, v81, s3, v88
    v_fma_f32 v82, v82, s3, v88
    v_fma_f32 v83, v83, s3, v88
    v_fma_f32 v84, v84, s3, v88
    v_fma_f32 v85, v85, s3, v88
    v_fma_f32 v86, v86, s3, v88
    v_fma_f32 v87, v87, s3, v88
    v_exp_f32 v76, v76
    v_exp_f32 v77, v77
    v_exp_f32 v78, v78
    v_exp_f32 v79, v79
    v_exp_f32 v80, v80
    v_exp_f32 v81, v81
    v_exp_f32 v82, v82
    v_exp_f32 v83, v83
    v_exp_f32 v84, v84
    v_exp_f32 v85, v85
    v_exp_f32 v86, v86
    v_exp_f32 v87, v87
    s_nop 0
    v_add_f32 v89, v76, v77
    v_add_f32 v89, v89, v78
    v_add_f32 v89, v89, v79
    v_add_f32 v89, v89, v80
    v_add_f32 v89, v89, v81
    v_add_f32 v89, v89, v82
    v_add_f32 v89, v89, v83
    v_add_f32 v89, v89, v84
    v_add_f32 v89, v89, v85
    v_add_f32 v89, v89, v86
    v_add_f32 v89, v89, v87
    v_mov_b32 v90, v89
    s_nop 1
    v_permlane16_swap_b32 v89, v90
    s_nop 1
    v_add_f32 v89, v89, v90
    v_mov_b32 v90, v89
    s_nop 1
    v_permlane32_swap_b32 v89, v90
    s_nop 1
    v_add_f32 v89, v89, v90
    v_rcp_f32 v89, v89
    s_nop 0
    v_mul_f32 v76, v76, v89
    v_mul_f32 v77, v77, v89
    v_mul_f32 v78, v78, v89
    v_mul_f32 v79, v79, v89
    v_mul_f32 v80, v80, v89
    v_mul_f32 v81, v81, v89
    v_mul_f32 v82, v82, v89
    v_mul_f32 v83, v83, v89
    v_mul_f32 v84, v84, v89
    v_mul_f32 v85, v85, v89
    v_mul_f32 v86, v86, v89
    v_mul_f32 v87, v87, v89
    v_cvt_pk_bf16_f32 v14, v76, v77
    v_cvt_pk_bf16_f32 v15, v78, v79
    v_cvt_pk_bf16_f32 v16, v80, v81
    v_cvt_pk_bf16_f32 v17, v82, v83
    v_cvt_pk_bf16_f32 v18, v84, v85
    v_cvt_pk_bf16_f32 v19, v86, v87
    s_waitcnt vmcnt(20)
    s_nop 1
    v_mfma_f32_16x16x32_bf16 v[100:103], a[0:3], v[10:13], 0
    v_mfma_f32_16x16x32_bf16 v[104:107], a[0:3], v[16:19], 0
    v_mfma_f32_16x16x32_bf16 v[108:111], a[4:7], v[10:13], 0
    v_mfma_f32_16x16x32_bf16 v[112:115], a[4:7], v[16:19], 0
    v_mfma_f32_16x16x32_bf16 v[116:119], a[8:11], v[10:13], 0
    v_mfma_f32_16x16x32_bf16 v[120:123], a[8:11], v[16:19], 0
    v_mfma_f32_16x16x32_bf16 v[124:127], a[12:15], v[10:13], 0
    v_mfma_f32_16x16x32_bf16 v[128:131], a[12:15], v[16:19], 0
    v_mfma_f32_16x16x32_bf16 v[132:135], a[16:19], v[10:13], 0
    v_mfma_f32_16x16x32_bf16 v[136:139], a[16:19], v[16:19], 0
    v_mfma_f32_16x16x32_bf16 v[140:143], a[20:23], v[10:13], 0
    v_mfma_f32_16x16x32_bf16 v[144:147], a[20:23], v[16:19], 0
    v_mfma_f32_16x16x32_bf16 v[148:151], a[24:27], v[10:13], 0
    v_mfma_f32_16x16x32_bf16 v[152:155], a[24:27], v[16:19], 0
    v_mfma_f32_16x16x32_bf16 v[156:159], a[28:31], v[10:13], 0
    v_mfma_f32_16x16x32_bf16 v[160:163], a[28:31], v[16:19], 0
    v_mfma_f32_16x16x32_bf16 v[164:167], a[32:35], v[10:13], 0
    v_mfma_f32_16x16x32_bf16 v[168:171], a[32:35], v[16:19], 0
    v_mfma_f32_16x16x32_bf16 v[172:175], a[36:39], v[10:13], 0
    v_mfma_f32_16x16x32_bf16 v[176:179], a[36:39], v[16:19], 0
    v_mfma_f32_16x16x16_bf16 v[100:103], a[40:41], v[8:9], v[100:103]
    v_mfma_f32_16x16x16_bf16 v[104:107], a[40:41], v[14:15], v[104:107]
    v_mfma_f32_16x16x16_bf16 v[108:111], a[42:43], v[8:9], v[108:111]
    v_mfma_f32_16x16x16_bf16 v[112:115], a[42:43], v[14:15], v[112:115]
    v_mfma_f32_16x16x16_bf16 v[116:119], a[44:45], v[8:9], v[116:119]
    v_mfma_f32_16x16x16_bf16 v[120:123], a[44:45], v[14:15], v[120:123]
    v_mfma_f32_16x16x16_bf16 v[124:127], a[46:47], v[8:9], v[124:127]
    v_mfma_f32_16x16x16_bf16 v[128:131], a[46:47], v[14:15], v[128:131]
    v_mfma_f32_16x16x16_bf16 v[132:135], a[48:49], v[8:9], v[132:135]
    v_mfma_f32_16x16x16_bf16 v[136:139], a[48:49], v[14:15], v[136:139]
    v_mfma_f32_16x16x16_bf16 v[140:143], a[50:51], v[8:9], v[140:143]
    v_mfma_f32_16x16x16_bf16 v[144:147], a[50:51], v[14:15], v[144:147]
    v_mfma_f32_16x16x16_bf16 v[148:151], a[52:53], v[8:9], v[148:151]
    v_mfma_f32_16x16x16_bf16 v[152:155], a[52:53], v[14:15], v[152:155]
    v_mfma_f32_16x16x16_bf16 v[156:159], a[54:55], v[8:9], v[156:159]
    v_mfma_f32_16x16x16_bf16 v[160:163], a[54:55], v[14:15], v[160:163]
    v_mfma_f32_16x16x16_bf16 v[164:167], a[56:57], v[8:9], v[164:167]
    v_mfma_f32_16x16x16_bf16 v[168:171], a[56:57], v[14:15], v[168:171]
    v_mfma_f32_16x16x16_bf16 v[172:175], a[58:59], v[8:9], v[172:175]
    v_mfma_f32_16x16x16_bf16 v[176:179], a[58:59], v[14:15], v[176:179]
    s_nop 7
    v_lshlrev_b32 v93, 4, v2
    s_mul_i32 s3, s74, 20480
    v_add_u32 v94, s3, v93
    ds_write_b128 v94, v[100:103] offset:0
    ds_write_b128 v94, v[104:107] offset:1024
    ds_write_b128 v94, v[108:111] offset:2048
    ds_write_b128 v94, v[112:115] offset:3072
    ds_write_b128 v94, v[116:119] offset:4096
    ds_write_b128 v94, v[120:123] offset:5120
    ds_write_b128 v94, v[124:127] offset:6144
    ds_write_b128 v94, v[128:131] offset:7168
    ds_write_b128 v94, v[132:135] offset:8192
    ds_write_b128 v94, v[136:139] offset:9216
    ds_write_b128 v94, v[140:143] offset:10240
    ds_write_b128 v94, v[144:147] offset:11264
    ds_write_b128 v94, v[148:151] offset:12288
    ds_write_b128 v94, v[152:155] offset:13312
    ds_write_b128 v94, v[156:159] offset:14336
    ds_write_b128 v94, v[160:163] offset:15360
    ds_write_b128 v94, v[164:167] offset:16384
    ds_write_b128 v94, v[168:171] offset:17408
    ds_write_b128 v94, v[172:175] offset:18432
    ds_write_b128 v94, v[176:179] offset:19456
    s_waitcnt lgkmcnt(0)
    s_barrier
    s_mul_i32 s3, s74, 5120
    v_add_u32 v94, s3, v93
    v_add_u32 v92, 40960, v94
    ds_read_b128 v[100:103], v94 offset:0
    ds_read_b128 v[104:107], v94 offset:20480
    ds_read_b128 v[108:111], v92 offset:0
    ds_read_b128 v[112:115], v92 offset:20480
    ds_read_b128 v[116:119], v94 offset:1024
    ds_read_b128 v[120:123], v94 offset:21504
    ds_read_b128 v[124:127], v92 offset:1024
    ds_read_b128 v[128:131], v92 offset:21504
    ds_read_b128 v[132:135], v94 offset:2048
    ds_read_b128 v[136:139], v94 offset:22528
    ds_read_b128 v[140:143], v92 offset:2048
    ds_read_b128 v[144:147], v92 offset:22528
    ds_read_b128 v[148:151], v94 offset:3072
    ds_read_b128 v[152:155], v94 offset:23552
    ds_read_b128 v[156:159], v92 offset:3072
    ds_read_b128 v[160:163], v92 offset:23552
    ds_read_b128 v[164:167], v94 offset:4096
    ds_read_b128 v[168:171], v94 offset:24576
    ds_read_b128 v[172:175], v92 offset:4096
    ds_read_b128 v[176:179], v92 offset:24576
    v_lshlrev_b32 v95, 2, v2
    s_lshr_b32 s31, s21, 3
    s_mul_i32 s30, s74, 5
    s_add_u32 s31, s31, s30
    s_lshl_b32 s31, s31, 10
    s_mul_i32 s32, s20, 81920
    s_add_u32 s32, s32, s31
    s_add_u32 s32, s32, 205549568
    s_waitcnt lgkmcnt(0)
    v_add_f32 v100, v100, v104
    v_add_f32 v108, v108, v112
    v_add_f32 v100, v100, v108
    v_add_f32 v101, v101, v105
    v_add_f32 v109, v109, v113
    v_add_f32 v101, v101, v109
    v_add_f32 v102, v102, v106
    v_add_f32 v110, v110, v114
    v_add_f32 v102, v102, v110
    v_add_f32 v103, v103, v107
    v_add_f32 v111, v111, v115
    v_add_f32 v103, v103, v111
    buffer_atomic_add_f32 v100, v95, s[60:63], s32 offen offset:0
    buffer_atomic_add_f32 v101, v95, s[60:63], s32 offen offset:256
    buffer_atomic_add_f32 v102, v95, s[60:63], s32 offen offset:512
    buffer_atomic_add_f32 v103, v95, s[60:63], s32 offen offset:768
    s_add_u32 s32, s32, 1024
    v_add_f32 v116, v116, v120
    v_add_f32 v124, v124, v128
    v_add_f32 v116, v116, v124
    v_add_f32 v117, v117, v121
    v_add_f32 v125, v125, v129
    v_add_f32 v117, v117, v125
    v_add_f32 v118, v118, v122
    v_add_f32 v126, v126, v130
    v_add_f32 v118, v118, v126
    v_add_f32 v119, v119, v123
    v_add_f32 v127, v127, v131
    v_add_f32 v119, v119, v127
    buffer_atomic_add_f32 v116, v95, s[60:63], s32 offen offset:0
    buffer_atomic_add_f32 v117, v95, s[60:63], s32 offen offset:256
    buffer_atomic_add_f32 v118, v95, s[60:63], s32 offen offset:512
    buffer_atomic_add_f32 v119, v95, s[60:63], s32 offen offset:768
    s_add_u32 s32, s32, 1024
    v_add_f32 v132, v132, v136
    v_add_f32 v140, v140, v144
    v_add_f32 v132, v132, v140
    v_add_f32 v133, v133, v137
    v_add_f32 v141, v141, v145
    v_add_f32 v133, v133, v141
    v_add_f32 v134, v134, v138
    v_add_f32 v142, v142, v146
    v_add_f32 v134, v134, v142
    v_add_f32 v135, v135, v139
    v_add_f32 v143, v143, v147
    v_add_f32 v135, v135, v143
    buffer_atomic_add_f32 v132, v95, s[60:63], s32 offen offset:0
    buffer_atomic_add_f32 v133, v95, s[60:63], s32 offen offset:256
    buffer_atomic_add_f32 v134, v95, s[60:63], s32 offen offset:512
    buffer_atomic_add_f32 v135, v95, s[60:63], s32 offen offset:768
    s_add_u32 s32, s32, 1024
    v_add_f32 v148, v148, v152
    v_add_f32 v156, v156, v160
    v_add_f32 v148, v148, v156
    v_add_f32 v149, v149, v153
    v_add_f32 v157, v157, v161
    v_add_f32 v149, v149, v157
    v_add_f32 v150, v150, v154
    v_add_f32 v158, v158, v162
    v_add_f32 v150, v150, v158
    v_add_f32 v151, v151, v155
    v_add_f32 v159, v159, v163
    v_add_f32 v151, v151, v159
    buffer_atomic_add_f32 v148, v95, s[60:63], s32 offen offset:0
    buffer_atomic_add_f32 v149, v95, s[60:63], s32 offen offset:256
    buffer_atomic_add_f32 v150, v95, s[60:63], s32 offen offset:512
    buffer_atomic_add_f32 v151, v95, s[60:63], s32 offen offset:768
    s_add_u32 s32, s32, 1024
    v_add_f32 v164, v164, v168
    v_add_f32 v172, v172, v176
    v_add_f32 v164, v164, v172
    v_add_f32 v165, v165, v169
    v_add_f32 v173, v173, v177
    v_add_f32 v165, v165, v173
    v_add_f32 v166, v166, v170
    v_add_f32 v174, v174, v178
    v_add_f32 v166, v166, v174
    v_add_f32 v167, v167, v171
    v_add_f32 v175, v175, v179
    v_add_f32 v167, v167, v175
    buffer_atomic_add_f32 v164, v95, s[60:63], s32 offen offset:0
    buffer_atomic_add_f32 v165, v95, s[60:63], s32 offen offset:256
    buffer_atomic_add_f32 v166, v95, s[60:63], s32 offen offset:512
    buffer_atomic_add_f32 v167, v95, s[60:63], s32 offen offset:768
    s_add_u32 s32, s32, 1024
    s_add_u32 s21, s21, 160
    s_waitcnt vmcnt(0)
    s_nop 1
    v_mfma_f32_16x16x32_bf16 v[100:103], a[184:187], v[10:13], 0
    v_mfma_f32_16x16x32_bf16 v[104:107], a[184:187], v[16:19], 0
    v_mfma_f32_16x16x32_bf16 v[108:111], a[188:191], v[10:13], 0
    v_mfma_f32_16x16x32_bf16 v[112:115], a[188:191], v[16:19], 0
    v_mfma_f32_16x16x32_bf16 v[116:119], a[192:195], v[10:13], 0
    v_mfma_f32_16x16x32_bf16 v[120:123], a[192:195], v[16:19], 0
    v_mfma_f32_16x16x32_bf16 v[124:127], a[196:199], v[10:13], 0
    v_mfma_f32_16x16x32_bf16 v[128:131], a[196:199], v[16:19], 0
    v_mfma_f32_16x16x32_bf16 v[132:135], a[200:203], v[10:13], 0
    v_mfma_f32_16x16x32_bf16 v[136:139], a[200:203], v[16:19], 0
    v_mfma_f32_16x16x32_bf16 v[140:143], a[204:207], v[10:13], 0
    v_mfma_f32_16x16x32_bf16 v[144:147], a[204:207], v[16:19], 0
    v_mfma_f32_16x16x32_bf16 v[148:151], a[208:211], v[10:13], 0
    v_mfma_f32_16x16x32_bf16 v[152:155], a[208:211], v[16:19], 0
    v_mfma_f32_16x16x32_bf16 v[156:159], a[212:215], v[10:13], 0
    v_mfma_f32_16x16x32_bf16 v[160:163], a[212:215], v[16:19], 0
    v_mfma_f32_16x16x32_bf16 v[164:167], a[216:219], v[10:13], 0
    v_mfma_f32_16x16x32_bf16 v[168:171], a[216:219], v[16:19], 0
    v_mfma_f32_16x16x32_bf16 v[172:175], a[220:223], v[10:13], 0
    v_mfma_f32_16x16x32_bf16 v[176:179], a[220:223], v[16:19], 0
    v_mfma_f32_16x16x16_bf16 v[100:103], a[224:225], v[8:9], v[100:103]
    v_mfma_f32_16x16x16_bf16 v[104:107], a[224:225], v[14:15], v[104:107]
    v_mfma_f32_16x16x16_bf16 v[108:111], a[226:227], v[8:9], v[108:111]
    v_mfma_f32_16x16x16_bf16 v[112:115], a[226:227], v[14:15], v[112:115]
    v_mfma_f32_16x16x16_bf16 v[116:119], a[228:229], v[8:9], v[116:119]
    v_mfma_f32_16x16x16_bf16 v[120:123], a[228:229], v[14:15], v[120:123]
    v_mfma_f32_16x16x16_bf16 v[124:127], a[230:231], v[8:9], v[124:127]
    v_mfma_f32_16x16x16_bf16 v[128:131], a[230:231], v[14:15], v[128:131]
    v_mfma_f32_16x16x16_bf16 v[132:135], a[232:233], v[8:9], v[132:135]
    v_mfma_f32_16x16x16_bf16 v[136:139], a[232:233], v[14:15], v[136:139]
    v_mfma_f32_16x16x16_bf16 v[140:143], a[234:235], v[8:9], v[140:143]
    v_mfma_f32_16x16x16_bf16 v[144:147], a[234:235], v[14:15], v[144:147]
    v_mfma_f32_16x16x16_bf16 v[148:151], a[236:237], v[8:9], v[148:151]
    v_mfma_f32_16x16x16_bf16 v[152:155], a[236:237], v[14:15], v[152:155]
    v_mfma_f32_16x16x16_bf16 v[156:159], a[238:239], v[8:9], v[156:159]
    v_mfma_f32_16x16x16_bf16 v[160:163], a[238:239], v[14:15], v[160:163]
    v_mfma_f32_16x16x16_bf16 v[164:167], a[240:241], v[8:9], v[164:167]
    v_mfma_f32_16x16x16_bf16 v[168:171], a[240:241], v[14:15], v[168:171]
    v_mfma_f32_16x16x16_bf16 v[172:175], a[242:243], v[8:9], v[172:175]
    v_mfma_f32_16x16x16_bf16 v[176:179], a[242:243], v[14:15], v[176:179]
    s_barrier
    s_nop 7
    v_lshlrev_b32 v93, 4, v2
    s_mul_i32 s3, s74, 20480
    v_add_u32 v94, s3, v93
    ds_write_b128 v94, v[100:103] offset:0
    ds_write_b128 v94, v[104:107] offset:1024
    ds_write_b128 v94, v[108:111] offset:2048
    ds_write_b128 v94, v[112:115] offset:3072
    ds_write_b128 v94, v[116:119] offset:4096
    ds_write_b128 v94, v[120:123] offset:5120
    ds_write_b128 v94, v[124:127] offset:6144
    ds_write_b128 v94, v[128:131] offset:7168
    ds_write_b128 v94, v[132:135] offset:8192
    ds_write_b128 v94, v[136:139] offset:9216
    ds_write_b128 v94, v[140:143] offset:10240
    ds_write_b128 v94, v[144:147] offset:11264
    ds_write_b128 v94, v[148:151] offset:12288
    ds_write_b128 v94, v[152:155] offset:13312
    ds_write_b128 v94, v[156:159] offset:14336
    ds_write_b128 v94, v[160:163] offset:15360
    ds_write_b128 v94, v[164:167] offset:16384
    ds_write_b128 v94, v[168:171] offset:17408
    ds_write_b128 v94, v[172:175] offset:18432
    ds_write_b128 v94, v[176:179] offset:19456
    s_waitcnt lgkmcnt(0)
    s_barrier
    s_mul_i32 s3, s74, 5120
    v_add_u32 v94, s3, v93
    v_add_u32 v92, 40960, v94
    ds_read_b128 v[100:103], v94 offset:0
    ds_read_b128 v[104:107], v94 offset:20480
    ds_read_b128 v[108:111], v92 offset:0
    ds_read_b128 v[112:115], v92 offset:20480
    ds_read_b128 v[116:119], v94 offset:1024
    ds_read_b128 v[120:123], v94 offset:21504
    ds_read_b128 v[124:127], v92 offset:1024
    ds_read_b128 v[128:131], v92 offset:21504
    ds_read_b128 v[132:135], v94 offset:2048
    ds_read_b128 v[136:139], v94 offset:22528
    ds_read_b128 v[140:143], v92 offset:2048
    ds_read_b128 v[144:147], v92 offset:22528
    ds_read_b128 v[148:151], v94 offset:3072
    ds_read_b128 v[152:155], v94 offset:23552
    ds_read_b128 v[156:159], v92 offset:3072
    ds_read_b128 v[160:163], v92 offset:23552
    ds_read_b128 v[164:167], v94 offset:4096
    ds_read_b128 v[168:171], v94 offset:24576
    ds_read_b128 v[172:175], v92 offset:4096
    ds_read_b128 v[176:179], v92 offset:24576
    v_lshlrev_b32 v95, 2, v2
    s_lshr_b32 s31, s21, 3
    s_mul_i32 s30, s74, 5
    s_add_u32 s31, s31, s30
    s_lshl_b32 s31, s31, 10
    s_mul_i32 s32, s20, 81920
    s_add_u32 s32, s32, s31
    s_add_u32 s32, s32, 205549568
    s_waitcnt lgkmcnt(0)
    v_add_f32 v100, v100, v104
    v_add_f32 v108, v108, v112
    v_add_f32 v100, v100, v108
    v_add_f32 v101, v101, v105
    v_add_f32 v109, v109, v113
    v_add_f32 v101, v101, v109
    v_add_f32 v102, v102, v106
    v_add_f32 v110, v110, v114
    v_add_f32 v102, v102, v110
    v_add_f32 v103, v103, v107
    v_add_f32 v111, v111, v115
    v_add_f32 v103, v103, v111
    buffer_atomic_add_f32 v100, v95, s[60:63], s32 offen offset:0
    buffer_atomic_add_f32 v101, v95, s[60:63], s32 offen offset:256
    buffer_atomic_add_f32 v102, v95, s[60:63], s32 offen offset:512
    buffer_atomic_add_f32 v103, v95, s[60:63], s32 offen offset:768
    s_add_u32 s32, s32, 1024
    v_add_f32 v116, v116, v120
    v_add_f32 v124, v124, v128
    v_add_f32 v116, v116, v124
    v_add_f32 v117, v117, v121
    v_add_f32 v125, v125, v129
    v_add_f32 v117, v117, v125
    v_add_f32 v118, v118, v122
    v_add_f32 v126, v126, v130
    v_add_f32 v118, v118, v126
    v_add_f32 v119, v119, v123
    v_add_f32 v127, v127, v131
    v_add_f32 v119, v119, v127
    buffer_atomic_add_f32 v116, v95, s[60:63], s32 offen offset:0
    buffer_atomic_add_f32 v117, v95, s[60:63], s32 offen offset:256
    buffer_atomic_add_f32 v118, v95, s[60:63], s32 offen offset:512
    buffer_atomic_add_f32 v119, v95, s[60:63], s32 offen offset:768
    s_add_u32 s32, s32, 1024
    v_add_f32 v132, v132, v136
    v_add_f32 v140, v140, v144
    v_add_f32 v132, v132, v140
    v_add_f32 v133, v133, v137
    v_add_f32 v141, v141, v145
    v_add_f32 v133, v133, v141
    v_add_f32 v134, v134, v138
    v_add_f32 v142, v142, v146
    v_add_f32 v134, v134, v142
    v_add_f32 v135, v135, v139
    v_add_f32 v143, v143, v147
    v_add_f32 v135, v135, v143
    buffer_atomic_add_f32 v132, v95, s[60:63], s32 offen offset:0
    buffer_atomic_add_f32 v133, v95, s[60:63], s32 offen offset:256
    buffer_atomic_add_f32 v134, v95, s[60:63], s32 offen offset:512
    buffer_atomic_add_f32 v135, v95, s[60:63], s32 offen offset:768
    s_add_u32 s32, s32, 1024
    v_add_f32 v148, v148, v152
    v_add_f32 v156, v156, v160
    v_add_f32 v148, v148, v156
    v_add_f32 v149, v149, v153
    v_add_f32 v157, v157, v161
    v_add_f32 v149, v149, v157
    v_add_f32 v150, v150, v154
    v_add_f32 v158, v158, v162
    v_add_f32 v150, v150, v158
    v_add_f32 v151, v151, v155
    v_add_f32 v159, v159, v163
    v_add_f32 v151, v151, v159
    buffer_atomic_add_f32 v148, v95, s[60:63], s32 offen offset:0
    buffer_atomic_add_f32 v149, v95, s[60:63], s32 offen offset:256
    buffer_atomic_add_f32 v150, v95, s[60:63], s32 offen offset:512
    buffer_atomic_add_f32 v151, v95, s[60:63], s32 offen offset:768
    s_add_u32 s32, s32, 1024
    v_add_f32 v164, v164, v168
    v_add_f32 v172, v172, v176
    v_add_f32 v164, v164, v172
    v_add_f32 v165, v165, v169
    v_add_f32 v173, v173, v177
    v_add_f32 v165, v165, v173
    v_add_f32 v166, v166, v170
    v_add_f32 v174, v174, v178
    v_add_f32 v166, v166, v174
    v_add_f32 v167, v167, v171
    v_add_f32 v175, v175, v179
    v_add_f32 v167, v167, v175
    buffer_atomic_add_f32 v164, v95, s[60:63], s32 offen offset:0
    buffer_atomic_add_f32 v165, v95, s[60:63], s32 offen offset:256
    buffer_atomic_add_f32 v166, v95, s[60:63], s32 offen offset:512
    buffer_atomic_add_f32 v167, v95, s[60:63], s32 offen offset:768
    s_add_u32 s32, s32, 1024
    s_add_u32 s21, s21, 160
    s_waitcnt vmcnt(0)
    s_barrier
    s_cmp_lg_u32 s74, 0
    s_cbranch_scc1 mega_kernel_segc151
    v_mov_b32 v5, 1
    v_mov_b32 v6, 0
    s_lshl_b32 s71, s20, 2
    s_add_u32 s71, s71, 204501504
    s_mov_b64 exec, 1
    buffer_atomic_add v5, v6, s[60:63], s71 offen sc0 sc1
    s_waitcnt vmcnt(0)
    v_mov_b32 v6, 0x20004
    ds_write_b32 v6, v5
    s_mov_b64 exec, -1
    s_waitcnt lgkmcnt(0)
mega_kernel_segc151:
    s_barrier
    v_mov_b32 v6, 0x20004
    ds_read_b32 v5, v6
    s_waitcnt lgkmcnt(0)
    v_readfirstlane_b32 s3, v5
    s_cmp_lg_u32 s3, 15
    s_cbranch_scc1 mega_kernel_attn_top137
    s_lshl_b32 s58, s20, 1
    s_and_b32 s3, s74, 1
    s_add_u32 s58, s58, s3
    s_lshr_b32 s57, s74, 1
    s_lshl_b32 s3, s58, 4
    v_add_u32 v5, s3, v3
    s_movk_i32 s3, 1280
    v_mul_lo_u32 v5, v5, s3
    v_lshl_add_u32 v5, v4, 4, v5
    s_mul_i32 s3, s57, 640
    v_add_u32 v5, s3, v5
    s_lshr_b32 s3, s58, 1
    s_mul_i32 s3, s3, 81920
    s_and_b32 s71, s58, 1
    s_lshl_b32 s71, s71, 10
    s_add_u32 s3, s3, s71
    s_mul_i32 s71, s57, 40960
    s_add_u32 s3, s3, s71
    v_lshrrev_b32 v14, 1, v4
    v_lshlrev_b32 v14, 11, v14
    v_and_b32 v15, 1, v4
    v_lshl_add_u32 v15, v15, 5, v3
    v_lshl_add_u32 v14, v15, 2, v14
    v_add_u32 v14, s3, v14
    v_lshlrev_b32 v12, 5, v4
    s_mul_i32 s3, s57, 1280
    v_add_u32 v12, s3, v12
    buffer_load_dwordx4 v[40:43], v5, s[64:67], 0 offen offset:0
    s_mov_b32 s71, 205549568
    buffer_load_dword v120, v14, s[60:63], s71 offen offset:0
    buffer_load_dword v121, v14, s[60:63], s71 offen offset:256
    buffer_load_dword v122, v14, s[60:63], s71 offen offset:512
    buffer_load_dword v123, v14, s[60:63], s71 offen offset:768
    buffer_load_dword v124, v14, s[60:63], s71 offen offset:64
    buffer_load_dword v125, v14, s[60:63], s71 offen offset:320
    buffer_load_dword v126, v14, s[60:63], s71 offen offset:576
    buffer_load_dword v127, v14, s[60:63], s71 offen offset:832
    s_mov_b32 s71, 5120
    buffer_load_dwordx4 a[0:3], v12, s[60:63], s71 offen
    buffer_load_dwordx4 a[4:7], v12, s[60:63], s71 offen offset:16
    buffer_load_dwordx4 v[44:47], v5, s[64:67], 0 offen offset:64
    s_mov_b32 s71, 205553664
    buffer_load_dword v128, v14, s[60:63], s71 offen offset:0
    buffer_load_dword v129, v14, s[60:63], s71 offen offset:256
    buffer_load_dword v130, v14, s[60:63], s71 offen offset:512
    buffer_load_dword v131, v14, s[60:63], s71 offen offset:768
    buffer_load_dword v132, v14, s[60:63], s71 offen offset:64
    buffer_load_dword v133, v14, s[60:63], s71 offen offset:320
    buffer_load_dword v134, v14, s[60:63], s71 offen offset:576
    buffer_load_dword v135, v14, s[60:63], s71 offen offset:832
    s_mov_b32 s71, 5248
    buffer_load_dwordx4 a[8:11], v12, s[60:63], s71 offen
    buffer_load_dwordx4 a[12:15], v12, s[60:63], s71 offen offset:16
    buffer_load_dwordx4 v[48:51], v5, s[64:67], 0 offen offset:128
    s_mov_b32 s71, 205557760
    buffer_load_dword v136, v14, s[60:63], s71 offen offset:0
    buffer_load_dword v137, v14, s[60:63], s71 offen offset:256
    buffer_load_dword v138, v14, s[60:63], s71 offen offset:512
    buffer_load_dword v139, v14, s[60:63], s71 offen offset:768
    buffer_load_dword v140, v14, s[60:63], s71 offen offset:64
    buffer_load_dword v141, v14, s[60:63], s71 offen offset:320
    buffer_load_dword v142, v14, s[60:63], s71 offen offset:576
    buffer_load_dword v143, v14, s[60:63], s71 offen offset:832
    s_mov_b32 s71, 5376
    buffer_load_dwordx4 a[16:19], v12, s[60:63], s71 offen
    buffer_load_dwordx4 a[20:23], v12, s[60:63], s71 offen offset:16
    buffer_load_dwordx4 v[52:55], v5, s[64:67], 0 offen offset:192
    s_mov_b32 s71, 205561856
    buffer_load_dword v144, v14, s[60:63], s71 offen offset:0
    buffer_load_dword v145, v14, s[60:63], s71 offen offset:256
    buffer_load_dword v146, v14, s[60:63], s71 offen offset:512
    buffer_load_dword v147, v14, s[60:63], s71 offen offset:768
    buffer_load_dword v148, v14, s[60:63], s71 offen offset:64
    buffer_load_dword v149, v14, s[60:63], s71 offen offset:320
    buffer_load_dword v150, v14, s[60:63], s71 offen offset:576
    buffer_load_dword v151, v14, s[60:63], s71 offen offset:832
    s_mov_b32 s71, 5504
    buffer_load_dwordx4 a[24:27], v12, s[60:63], s71 offen
    buffer_load_dwordx4 a[28:31], v12, s[60:63], s71 offen offset:16
    buffer_load_dwordx4 v[56:59], v5, s[64:67], 0 offen offset:256
    s_mov_b32 s71, 205565952
    buffer_load_dword v152, v14, s[60:63], s71 offen offset:0
    buffer_load_dword v153, v14, s[60:63], s71 offen offset:256
    buffer_load_dword v154, v14, s[60:63], s71 offen offset:512
    buffer_load_dword v155, v14, s[60:63], s71 offen offset:768
    buffer_load_dword v156, v14, s[60:63], s71 offen offset:64
    buffer_load_dword v157, v14, s[60:63], s71 offen offset:320
    buffer_load_dword v158, v14, s[60:63], s71 offen offset:576
    buffer_load_dword v159, v14, s[60:63], s71 offen offset:832
    s_mov_b32 s71, 5632
    buffer_load_dwordx4 a[32:35], v12, s[60:63], s71 offen
    buffer_load_dwordx4 a[36:39], v12, s[60:63], s71 offen offset:16
    buffer_load_dwordx4 v[60:63], v5, s[64:67], 0 offen offset:320
    s_mov_b32 s71, 205570048
    buffer_load_dword v160, v14, s[60:63], s71 offen offset:0
    buffer_load_dword v161, v14, s[60:63], s71 offen offset:256
    buffer_load_dword v162, v14, s[60:63], s71 offen offset:512
    buffer_load_dword v163, v14, s[60:63], s71 offen offset:768
    buffer_load_dword v164, v14, s[60:63], s71 offen offset:64
    buffer_load_dword v165, v14, s[60:63], s71 offen offset:320
    buffer_load_dword v166, v14, s[60:63], s71 offen offset:576
    buffer_load_dword v167, v14, s[60:63], s71 offen offset:832
    s_mov_b32 s71, 5760
    buffer_load_dwordx4 a[40:43], v12, s[60:63], s71 offen
    buffer_load_dwordx4 a[44:47], v12, s[60:63], s71 offen offset:16
    buffer_load_dwordx4 v[64:67], v5, s[64:67], 0 offen offset:384
    s_mov_b32 s71, 205574144
    buffer_load_dword v168, v14, s[60:63], s71 offen offset:0
    buffer_load_dword v169, v14, s[60:63], s71 offen offset:256
    buffer_load_dword v170, v14, s[60:63], s71 offen offset:512
    buffer_load_dword v171, v14, s[60:63], s71 offen offset:768
    buffer_load_dword v172, v14, s[60:63], s71 offen offset:64
    buffer_load_dword v173, v14, s[60:63], s71 offen offset:320
    buffer_load_dword v174, v14, s[60:63], s71 offen offset:576
    buffer_load_dword v175, v14, s[60:63], s71 offen offset:832
    s_mov_b32 s71, 5888
    buffer_load_dwordx4 a[48:51], v12, s[60:63], s71 offen
    buffer_load_dwordx4 a[52:55], v12, s[60:63], s71 offen offset:16
    buffer_load_dwordx4 v[68:71], v5, s[64:67], 0 offen offset:448
    s_mov_b32 s71, 205578240
    buffer_load_dword v176, v14, s[60:63], s71 offen offset:0
    buffer_load_dword v177, v14, s[60:63], s71 offen offset:256
    buffer_load_dword v178, v14, s[60:63], s71 offen offset:512
    buffer_load_dword v179, v14, s[60:63], s71 offen offset:768
    buffer_load_dword v180, v14, s[60:63], s71 offen offset:64
    buffer_load_dword v181, v14, s[60:63], s71 offen offset:320
    buffer_load_dword v182, v14, s[60:63], s71 offen offset:576
    buffer_load_dword v183, v14, s[60:63], s71 offen offset:832
    s_mov_b32 s71, 6016
    buffer_load_dwordx4 a[56:59], v12, s[60:63], s71 offen
    buffer_load_dwordx4 a[60:63], v12, s[60:63], s71 offen offset:16
    buffer_load_dwordx4 v[72:75], v5, s[64:67], 0 offen offset:512
    s_mov_b32 s71, 205582336
    buffer_load_dword v184, v14, s[60:63], s71 offen offset:0
    buffer_load_dword v185, v14, s[60:63], s71 offen offset:256
    buffer_load_dword v186, v14, s[60:63], s71 offen offset:512
    buffer_load_dword v187, v14, s[60:63], s71 offen offset:768
    buffer_load_dword v188, v14, s[60:63], s71 offen offset:64
    buffer_load_dword v189, v14, s[60:63], s71 offen offset:320
    buffer_load_dword v190, v14, s[60:63], s71 offen offset:576
    buffer_load_dword v191, v14, s[60:63], s71 offen offset:832
    s_mov_b32 s71, 6144
    buffer_load_dwordx4 a[64:67], v12, s[60:63], s71 offen
    buffer_load_dwordx4 a[68:71], v12, s[60:63], s71 offen offset:16
    buffer_load_dwordx4 v[76:79], v5, s[64:67], 0 offen offset:576
    s_mov_b32 s71, 205586432
    buffer_load_dword v192, v14, s[60:63], s71 offen offset:0
    buffer_load_dword v193, v14, s[60:63], s71 offen offset:256
    buffer_load_dword v194, v14, s[60:63], s71 offen offset:512
    buffer_load_dword v195, v14, s[60:63], s71 offen offset:768
    buffer_load_dword v196, v14, s[60:63], s71 offen offset:64
    buffer_load_dword v197, v14, s[60:63], s71 offen offset:320
    buffer_load_dword v198, v14, s[60:63], s71 offen offset:576
    buffer_load_dword v199, v14, s[60:63], s71 offen offset:832
    s_mov_b32 s71, 6272
    buffer_load_dwordx4 a[72:75], v12, s[60:63], s71 offen
    buffer_load_dwordx4 a[76:79], v12, s[60:63], s71 offen offset:16
    s_waitcnt vmcnt(0)
    s_mov_b32 s71, 7680
    buffer_load_dwordx4 a[80:83], v12, s[60:63], s71 offen
    buffer_load_dwordx4 a[84:87], v12, s[60:63], s71 offen offset:16
    s_mov_b32 s71, 10240
    buffer_load_dwordx4 a[160:163], v12, s[60:63], s71 offen
    buffer_load_dwordx4 a[164:167], v12, s[60:63], s71 offen offset:16
    s_mov_b32 s71, 7808
    buffer_load_dwordx4 a[88:91], v12, s[60:63], s71 offen
    buffer_load_dwordx4 a[92:95], v12, s[60:63], s71 offen offset:16
    s_mov_b32 s71, 10368
    buffer_load_dwordx4 a[168:171], v12, s[60:63], s71 offen
    buffer_load_dwordx4 a[172:175], v12, s[60:63], s71 offen offset:16
    s_mov_b32 s71, 7936
    buffer_load_dwordx4 a[96:99], v12, s[60:63], s71 offen
    buffer_load_dwordx4 a[100:103], v12, s[60:63], s71 offen offset:16
    s_mov_b32 s71, 10496
    buffer_load_dwordx4 a[176:179], v12, s[60:63], s71 offen
    buffer_load_dwordx4 a[180:183], v12, s[60:63], s71 offen offset:16
    s_mov_b32 s71, 8064
    buffer_load_dwordx4 a[104:107], v12, s[60:63], s71 offen
    buffer_load_dwordx4 a[108:111], v12, s[60:63], s71 offen offset:16
    s_mov_b32 s71, 10624
    buffer_load_dwordx4 a[184:187], v12, s[60:63], s71 offen
    buffer_load_dwordx4 a[188:191], v12, s[60:63], s71 offen offset:16
    s_mov_b32 s71, 8192
    buffer_load_dwordx4 a[112:115], v12, s[60:63], s71 offen
    buffer_load_dwordx4 a[116:119], v12, s[60:63], s71 offen offset:16
    s_mov_b32 s71, 10752
    buffer_load_dwordx4 a[192:195], v12, s[60:63], s71 offen
    buffer_load_dwordx4 a[196:199], v12, s[60:63], s71 offen offset:16
    s_mov_b32 s71, 8320
    buffer_load_dwordx4 a[120:123], v12, s[60:63], s71 offen
    buffer_load_dwordx4 a[124:127], v12, s[60:63], s71 offen offset:16
    s_mov_b32 s71, 10880
    buffer_load_dwordx4 a[200:203], v12, s[60:63], s71 offen
    buffer_load_dwordx4 a[204:207], v12, s[60:63], s71 offen offset:16
    s_mov_b32 s71, 8448
    buffer_load_dwordx4 a[128:131], v12, s[60:63], s71 offen
    buffer_load_dwordx4 a[132:135], v12, s[60:63], s71 offen offset:16
    s_mov_b32 s71, 11008
    buffer_load_dwordx4 a[208:211], v12, s[60:63], s71 offen
    buffer_load_dwordx4 a[212:215], v12, s[60:63], s71 offen offset:16
    s_mov_b32 s71, 8576
    buffer_load_dwordx4 a[136:139], v12, s[60:63], s71 offen
    buffer_load_dwordx4 a[140:143], v12, s[60:63], s71 offen offset:16
    s_mov_b32 s71, 11136
    buffer_load_dwordx4 a[216:219], v12, s[60:63], s71 offen
    buffer_load_dwordx4 a[220:223], v12, s[60:63], s71 offen offset:16
    s_mov_b32 s71, 8704
    buffer_load_dwordx4 a[144:147], v12, s[60:63], s71 offen
    buffer_load_dwordx4 a[148:151], v12, s[60:63], s71 offen offset:16
    s_mov_b32 s71, 11264
    buffer_load_dwordx4 a[224:227], v12, s[60:63], s71 offen
    buffer_load_dwordx4 a[228:231], v12, s[60:63], s71 offen offset:16
    s_mov_b32 s71, 8832
    buffer_load_dwordx4 a[152:155], v12, s[60:63], s71 offen
    buffer_load_dwordx4 a[156:159], v12, s[60:63], s71 offen offset:16
    s_mov_b32 s71, 11392
    buffer_load_dwordx4 a[232:235], v12, s[60:63], s71 offen
    buffer_load_dwordx4 a[236:239], v12, s[60:63], s71 offen offset:16
    v_mov_b32 v6, 0
    v_mov_b32 v7, 0
    v_cvt_pk_bf16_f32 v8, v120, v121
    v_accvgpr_read_b32 v9, a0
    v_accvgpr_read_b32 v10, a1
    v_lshlrev_b32 v120, 16, v8
    v_and_b32 v121, 0xffff0000, v8
    v_mul_f32 v120, v120, v9
    v_mul_f32 v121, v121, v10
    v_cvt_pk_bf16_f32 v8, v120, v121
    v_lshlrev_b32 v120, 16, v8
    v_and_b32 v121, 0xffff0000, v8
    v_lshlrev_b32 v9, 16, v40
    v_and_b32 v10, 0xffff0000, v40
    v_add_f32 v120, v120, v9
    v_add_f32 v121, v121, v10
    v_cvt_pk_bf16_f32 v40, v120, v121
    v_lshlrev_b32 v120, 16, v40
    v_and_b32 v121, 0xffff0000, v40
    v_add_f32 v6, v6, v120
    v_add_f32 v7, v7, v121
    v_cvt_pk_bf16_f32 v8, v122, v123
    v_accvgpr_read_b32 v9, a2
    v_accvgpr_read_b32 v10, a3
    v_lshlrev_b32 v122, 16, v8
    v_and_b32 v123, 0xffff0000, v8
    v_mul_f32 v122, v122, v9
    v_mul_f32 v123, v123, v10
    v_cvt_pk_bf16_f32 v8, v122, v123
    v_lshlrev_b32 v122, 16, v8
    v_and_b32 v123, 0xffff0000, v8
    v_lshlrev_b32 v9, 16, v41
    v_and_b32 v10, 0xffff0000, v41
    v_add_f32 v122, v122, v9
    v_add_f32 v123, v123, v10
    v_cvt_pk_bf16_f32 v41, v122, v123
    v_lshlrev_b32 v122, 16, v41
    v_and_b32 v123, 0xffff0000, v41
    v_add_f32 v6, v6, v122
    v_add_f32 v7, v7, v123
    v_cvt_pk_bf16_f32 v8, v124, v125
    v_accvgpr_read_b32 v9, a4
    v_accvgpr_read_b32 v10, a5
    v_lshlrev_b32 v124, 16, v8
    v_and_b32 v125, 0xffff0000, v8
    v_mul_f32 v124, v124, v9
    v_mul_f32 v125, v125, v10
    v_cvt_pk_bf16_f32 v8, v124, v125
    v_lshlrev_b32 v124, 16, v8
    v_and_b32 v125, 0xffff0000, v8
    v_lshlrev_b32 v9, 16, v42
    v_and_b32 v10, 0xffff0000, v42
    v_add_f32 v124, v124, v9
    v_add_f32 v125, v125, v10
    v_cvt_pk_bf16_f32 v42, v124, v125
    v_lshlrev_b32 v124, 16, v42
    v_and_b32 v125, 0xffff0000, v42
    v_add_f32 v6, v6, v124
    v_add_f32 v7, v7, v125
    v_cvt_pk_bf16_f32 v8, v126, v127
    v_accvgpr_read_b32 v9, a6
    v_accvgpr_read_b32 v10, a7
    v_lshlrev_b32 v126, 16, v8
    v_and_b32 v127, 0xffff0000, v8
    v_mul_f32 v126, v126, v9
    v_mul_f32 v127, v127, v10
    v_cvt_pk_bf16_f32 v8, v126, v127
    v_lshlrev_b32 v126, 16, v8
    v_and_b32 v127, 0xffff0000, v8
    v_lshlrev_b32 v9, 16, v43
    v_and_b32 v10, 0xffff0000, v43
    v_add_f32 v126, v126, v9
    v_add_f32 v127, v127, v10
    v_cvt_pk_bf16_f32 v43, v126, v127
    v_lshlrev_b32 v126, 16, v43
    v_and_b32 v127, 0xffff0000, v43
    v_add_f32 v6, v6, v126
    v_add_f32 v7, v7, v127
    s_mov_b32 s71, 5259264
    buffer_store_dwordx4 v[40:43], v5, s[60:63], s71 offen offset:0 sc1
    v_cvt_pk_bf16_f32 v8, v128, v129
    v_accvgpr_read_b32 v9, a8
    v_accvgpr_read_b32 v10, a9
    v_lshlrev_b32 v128, 16, v8
    v_and_b32 v129, 0xffff0000, v8
    v_mul_f32 v128, v128, v9
    v_mul_f32 v129, v129, v10
    v_cvt_pk_bf16_f32 v8, v128, v129
    v_lshlrev_b32 v128, 16, v8
    v_and_b32 v129, 0xffff0000, v8
    v_lshlrev_b32 v9, 16, v44
    v_and_b32 v10, 0xffff0000, v44
    v_add_f32 v128, v128, v9
    v_add_f32 v129, v129, v10
    v_cvt_pk_bf16_f32 v44, v128, v129
    v_lshlrev_b32 v128, 16, v44
    v_and_b32 v129, 0xffff0000, v44
    v_add_f32 v6, v6, v128
    v_add_f32 v7, v7, v129
    v_cvt_pk_bf16_f32 v8, v130, v131
    v_accvgpr_read_b32 v9, a10
    v_accvgpr_read_b32 v10, a11
    v_lshlrev_b32 v130, 16, v8
    v_and_b32 v131, 0xffff0000, v8
    v_mul_f32 v130, v130, v9
    v_mul_f32 v131, v131, v10
    v_cvt_pk_bf16_f32 v8, v130, v131
    v_lshlrev_b32 v130, 16, v8
    v_and_b32 v131, 0xffff0000, v8
    v_lshlrev_b32 v9, 16, v45
    v_and_b32 v10, 0xffff0000, v45
    v_add_f32 v130, v130, v9
    v_add_f32 v131, v131, v10
    v_cvt_pk_bf16_f32 v45, v130, v131
    v_lshlrev_b32 v130, 16, v45
    v_and_b32 v131, 0xffff0000, v45
    v_add_f32 v6, v6, v130
    v_add_f32 v7, v7, v131
    v_cvt_pk_bf16_f32 v8, v132, v133
    v_accvgpr_read_b32 v9, a12
    v_accvgpr_read_b32 v10, a13
    v_lshlrev_b32 v132, 16, v8
    v_and_b32 v133, 0xffff0000, v8
    v_mul_f32 v132, v132, v9
    v_mul_f32 v133, v133, v10
    v_cvt_pk_bf16_f32 v8, v132, v133
    v_lshlrev_b32 v132, 16, v8
    v_and_b32 v133, 0xffff0000, v8
    v_lshlrev_b32 v9, 16, v46
    v_and_b32 v10, 0xffff0000, v46
    v_add_f32 v132, v132, v9
    v_add_f32 v133, v133, v10
    v_cvt_pk_bf16_f32 v46, v132, v133
    v_lshlrev_b32 v132, 16, v46
    v_and_b32 v133, 0xffff0000, v46
    v_add_f32 v6, v6, v132
    v_add_f32 v7, v7, v133
    v_cvt_pk_bf16_f32 v8, v134, v135
    v_accvgpr_read_b32 v9, a14
    v_accvgpr_read_b32 v10, a15
    v_lshlrev_b32 v134, 16, v8
    v_and_b32 v135, 0xffff0000, v8
    v_mul_f32 v134, v134, v9
    v_mul_f32 v135, v135, v10
    v_cvt_pk_bf16_f32 v8, v134, v135
    v_lshlrev_b32 v134, 16, v8
    v_and_b32 v135, 0xffff0000, v8
    v_lshlrev_b32 v9, 16, v47
    v_and_b32 v10, 0xffff0000, v47
    v_add_f32 v134, v134, v9
    v_add_f32 v135, v135, v10
    v_cvt_pk_bf16_f32 v47, v134, v135
    v_lshlrev_b32 v134, 16, v47
    v_and_b32 v135, 0xffff0000, v47
    v_add_f32 v6, v6, v134
    v_add_f32 v7, v7, v135
    s_mov_b32 s71, 5259264
    buffer_store_dwordx4 v[44:47], v5, s[60:63], s71 offen offset:64 sc1
    v_cvt_pk_bf16_f32 v8, v136, v137
    v_accvgpr_read_b32 v9, a16
    v_accvgpr_read_b32 v10, a17
    v_lshlrev_b32 v136, 16, v8
    v_and_b32 v137, 0xffff0000, v8
    v_mul_f32 v136, v136, v9
    v_mul_f32 v137, v137, v10
    v_cvt_pk_bf16_f32 v8, v136, v137
    v_lshlrev_b32 v136, 16, v8
    v_and_b32 v137, 0xffff0000, v8
    v_lshlrev_b32 v9, 16, v48
    v_and_b32 v10, 0xffff0000, v48
    v_add_f32 v136, v136, v9
    v_add_f32 v137, v137, v10
    v_cvt_pk_bf16_f32 v48, v136, v137
    v_lshlrev_b32 v136, 16, v48
    v_and_b32 v137, 0xffff0000, v48
    v_add_f32 v6, v6, v136
    v_add_f32 v7, v7, v137
    v_cvt_pk_bf16_f32 v8, v138, v139
    v_accvgpr_read_b32 v9, a18
    v_accvgpr_read_b32 v10, a19
    v_lshlrev_b32 v138, 16, v8
    v_and_b32 v139, 0xffff0000, v8
    v_mul_f32 v138, v138, v9
    v_mul_f32 v139, v139, v10
    v_cvt_pk_bf16_f32 v8, v138, v139
    v_lshlrev_b32 v138, 16, v8
    v_and_b32 v139, 0xffff0000, v8
    v_lshlrev_b32 v9, 16, v49
    v_and_b32 v10, 0xffff0000, v49
    v_add_f32 v138, v138, v9
    v_add_f32 v139, v139, v10
    v_cvt_pk_bf16_f32 v49, v138, v139
    v_lshlrev_b32 v138, 16, v49
    v_and_b32 v139, 0xffff0000, v49
    v_add_f32 v6, v6, v138
    v_add_f32 v7, v7, v139
    v_cvt_pk_bf16_f32 v8, v140, v141
    v_accvgpr_read_b32 v9, a20
    v_accvgpr_read_b32 v10, a21
    v_lshlrev_b32 v140, 16, v8
    v_and_b32 v141, 0xffff0000, v8
    v_mul_f32 v140, v140, v9
    v_mul_f32 v141, v141, v10
    v_cvt_pk_bf16_f32 v8, v140, v141
    v_lshlrev_b32 v140, 16, v8
    v_and_b32 v141, 0xffff0000, v8
    v_lshlrev_b32 v9, 16, v50
    v_and_b32 v10, 0xffff0000, v50
    v_add_f32 v140, v140, v9
    v_add_f32 v141, v141, v10
    v_cvt_pk_bf16_f32 v50, v140, v141
    v_lshlrev_b32 v140, 16, v50
    v_and_b32 v141, 0xffff0000, v50
    v_add_f32 v6, v6, v140
    v_add_f32 v7, v7, v141
    v_cvt_pk_bf16_f32 v8, v142, v143
    v_accvgpr_read_b32 v9, a22
    v_accvgpr_read_b32 v10, a23
    v_lshlrev_b32 v142, 16, v8
    v_and_b32 v143, 0xffff0000, v8
    v_mul_f32 v142, v142, v9
    v_mul_f32 v143, v143, v10
    v_cvt_pk_bf16_f32 v8, v142, v143
    v_lshlrev_b32 v142, 16, v8
    v_and_b32 v143, 0xffff0000, v8
    v_lshlrev_b32 v9, 16, v51
    v_and_b32 v10, 0xffff0000, v51
    v_add_f32 v142, v142, v9
    v_add_f32 v143, v143, v10
    v_cvt_pk_bf16_f32 v51, v142, v143
    v_lshlrev_b32 v142, 16, v51
    v_and_b32 v143, 0xffff0000, v51
    v_add_f32 v6, v6, v142
    v_add_f32 v7, v7, v143
    s_mov_b32 s71, 5259264
    buffer_store_dwordx4 v[48:51], v5, s[60:63], s71 offen offset:128 sc1
    v_cvt_pk_bf16_f32 v8, v144, v145
    v_accvgpr_read_b32 v9, a24
    v_accvgpr_read_b32 v10, a25
    v_lshlrev_b32 v144, 16, v8
    v_and_b32 v145, 0xffff0000, v8
    v_mul_f32 v144, v144, v9
    v_mul_f32 v145, v145, v10
    v_cvt_pk_bf16_f32 v8, v144, v145
    v_lshlrev_b32 v144, 16, v8
    v_and_b32 v145, 0xffff0000, v8
    v_lshlrev_b32 v9, 16, v52
    v_and_b32 v10, 0xffff0000, v52
    v_add_f32 v144, v144, v9
    v_add_f32 v145, v145, v10
    v_cvt_pk_bf16_f32 v52, v144, v145
    v_lshlrev_b32 v144, 16, v52
    v_and_b32 v145, 0xffff0000, v52
    v_add_f32 v6, v6, v144
    v_add_f32 v7, v7, v145
    v_cvt_pk_bf16_f32 v8, v146, v147
    v_accvgpr_read_b32 v9, a26
    v_accvgpr_read_b32 v10, a27
    v_lshlrev_b32 v146, 16, v8
    v_and_b32 v147, 0xffff0000, v8
    v_mul_f32 v146, v146, v9
    v_mul_f32 v147, v147, v10
    v_cvt_pk_bf16_f32 v8, v146, v147
    v_lshlrev_b32 v146, 16, v8
    v_and_b32 v147, 0xffff0000, v8
    v_lshlrev_b32 v9, 16, v53
    v_and_b32 v10, 0xffff0000, v53
    v_add_f32 v146, v146, v9
    v_add_f32 v147, v147, v10
    v_cvt_pk_bf16_f32 v53, v146, v147
    v_lshlrev_b32 v146, 16, v53
    v_and_b32 v147, 0xffff0000, v53
    v_add_f32 v6, v6, v146
    v_add_f32 v7, v7, v147
    v_cvt_pk_bf16_f32 v8, v148, v149
    v_accvgpr_read_b32 v9, a28
    v_accvgpr_read_b32 v10, a29
    v_lshlrev_b32 v148, 16, v8
    v_and_b32 v149, 0xffff0000, v8
    v_mul_f32 v148, v148, v9
    v_mul_f32 v149, v149, v10
    v_cvt_pk_bf16_f32 v8, v148, v149
    v_lshlrev_b32 v148, 16, v8
    v_and_b32 v149, 0xffff0000, v8
    v_lshlrev_b32 v9, 16, v54
    v_and_b32 v10, 0xffff0000, v54
    v_add_f32 v148, v148, v9
    v_add_f32 v149, v149, v10
    v_cvt_pk_bf16_f32 v54, v148, v149
    v_lshlrev_b32 v148, 16, v54
    v_and_b32 v149, 0xffff0000, v54
    v_add_f32 v6, v6, v148
    v_add_f32 v7, v7, v149
    v_cvt_pk_bf16_f32 v8, v150, v151
    v_accvgpr_read_b32 v9, a30
    v_accvgpr_read_b32 v10, a31
    v_lshlrev_b32 v150, 16, v8
    v_and_b32 v151, 0xffff0000, v8
    v_mul_f32 v150, v150, v9
    v_mul_f32 v151, v151, v10
    v_cvt_pk_bf16_f32 v8, v150, v151
    v_lshlrev_b32 v150, 16, v8
    v_and_b32 v151, 0xffff0000, v8
    v_lshlrev_b32 v9, 16, v55
    v_and_b32 v10, 0xffff0000, v55
    v_add_f32 v150, v150, v9
    v_add_f32 v151, v151, v10
    v_cvt_pk_bf16_f32 v55, v150, v151
    v_lshlrev_b32 v150, 16, v55
    v_and_b32 v151, 0xffff0000, v55
    v_add_f32 v6, v6, v150
    v_add_f32 v7, v7, v151
    s_mov_b32 s71, 5259264
    buffer_store_dwordx4 v[52:55], v5, s[60:63], s71 offen offset:192 sc1
    v_cvt_pk_bf16_f32 v8, v152, v153
    v_accvgpr_read_b32 v9, a32
    v_accvgpr_read_b32 v10, a33
    v_lshlrev_b32 v152, 16, v8
    v_and_b32 v153, 0xffff0000, v8
    v_mul_f32 v152, v152, v9
    v_mul_f32 v153, v153, v10
    v_cvt_pk_bf16_f32 v8, v152, v153
    v_lshlrev_b32 v152, 16, v8
    v_and_b32 v153, 0xffff0000, v8
    v_lshlrev_b32 v9, 16, v56
    v_and_b32 v10, 0xffff0000, v56
    v_add_f32 v152, v152, v9
    v_add_f32 v153, v153, v10
    v_cvt_pk_bf16_f32 v56, v152, v153
    v_lshlrev_b32 v152, 16, v56
    v_and_b32 v153, 0xffff0000, v56
    v_add_f32 v6, v6, v152
    v_add_f32 v7, v7, v153
    v_cvt_pk_bf16_f32 v8, v154, v155
    v_accvgpr_read_b32 v9, a34
    v_accvgpr_read_b32 v10, a35
    v_lshlrev_b32 v154, 16, v8
    v_and_b32 v155, 0xffff0000, v8
    v_mul_f32 v154, v154, v9
    v_mul_f32 v155, v155, v10
    v_cvt_pk_bf16_f32 v8, v154, v155
    v_lshlrev_b32 v154, 16, v8
    v_and_b32 v155, 0xffff0000, v8
    v_lshlrev_b32 v9, 16, v57
    v_and_b32 v10, 0xffff0000, v57
    v_add_f32 v154, v154, v9
    v_add_f32 v155, v155, v10
    v_cvt_pk_bf16_f32 v57, v154, v155
    v_lshlrev_b32 v154, 16, v57
    v_and_b32 v155, 0xffff0000, v57
    v_add_f32 v6, v6, v154
    v_add_f32 v7, v7, v155
    v_cvt_pk_bf16_f32 v8, v156, v157
    v_accvgpr_read_b32 v9, a36
    v_accvgpr_read_b32 v10, a37
    v_lshlrev_b32 v156, 16, v8
    v_and_b32 v157, 0xffff0000, v8
    v_mul_f32 v156, v156, v9
    v_mul_f32 v157, v157, v10
    v_cvt_pk_bf16_f32 v8, v156, v157
    v_lshlrev_b32 v156, 16, v8
    v_and_b32 v157, 0xffff0000, v8
    v_lshlrev_b32 v9, 16, v58
    v_and_b32 v10, 0xffff0000, v58
    v_add_f32 v156, v156, v9
    v_add_f32 v157, v157, v10
    v_cvt_pk_bf16_f32 v58, v156, v157
    v_lshlrev_b32 v156, 16, v58
    v_and_b32 v157, 0xffff0000, v58
    v_add_f32 v6, v6, v156
    v_add_f32 v7, v7, v157
    v_cvt_pk_bf16_f32 v8, v158, v159
    v_accvgpr_read_b32 v9, a38
    v_accvgpr_read_b32 v10, a39
    v_lshlrev_b32 v158, 16, v8
    v_and_b32 v159, 0xffff0000, v8
    v_mul_f32 v158, v158, v9
    v_mul_f32 v159, v159, v10
    v_cvt_pk_bf16_f32 v8, v158, v159
    v_lshlrev_b32 v158, 16, v8
    v_and_b32 v159, 0xffff0000, v8
    v_lshlrev_b32 v9, 16, v59
    v_and_b32 v10, 0xffff0000, v59
    v_add_f32 v158, v158, v9
    v_add_f32 v159, v159, v10
    v_cvt_pk_bf16_f32 v59, v158, v159
    v_lshlrev_b32 v158, 16, v59
    v_and_b32 v159, 0xffff0000, v59
    v_add_f32 v6, v6, v158
    v_add_f32 v7, v7, v159
    s_mov_b32 s71, 5259264
    buffer_store_dwordx4 v[56:59], v5, s[60:63], s71 offen offset:256 sc1
    v_cvt_pk_bf16_f32 v8, v160, v161
    v_accvgpr_read_b32 v9, a40
    v_accvgpr_read_b32 v10, a41
    v_lshlrev_b32 v160, 16, v8
    v_and_b32 v161, 0xffff0000, v8
    v_mul_f32 v160, v160, v9
    v_mul_f32 v161, v161, v10
    v_cvt_pk_bf16_f32 v8, v160, v161
    v_lshlrev_b32 v160, 16, v8
    v_and_b32 v161, 0xffff0000, v8
    v_lshlrev_b32 v9, 16, v60
    v_and_b32 v10, 0xffff0000, v60
    v_add_f32 v160, v160, v9
    v_add_f32 v161, v161, v10
    v_cvt_pk_bf16_f32 v60, v160, v161
    v_lshlrev_b32 v160, 16, v60
    v_and_b32 v161, 0xffff0000, v60
    v_add_f32 v6, v6, v160
    v_add_f32 v7, v7, v161
    v_cvt_pk_bf16_f32 v8, v162, v163
    v_accvgpr_read_b32 v9, a42
    v_accvgpr_read_b32 v10, a43
    v_lshlrev_b32 v162, 16, v8
    v_and_b32 v163, 0xffff0000, v8
    v_mul_f32 v162, v162, v9
    v_mul_f32 v163, v163, v10
    v_cvt_pk_bf16_f32 v8, v162, v163
    v_lshlrev_b32 v162, 16, v8
    v_and_b32 v163, 0xffff0000, v8
    v_lshlrev_b32 v9, 16, v61
    v_and_b32 v10, 0xffff0000, v61
    v_add_f32 v162, v162, v9
    v_add_f32 v163, v163, v10
    v_cvt_pk_bf16_f32 v61, v162, v163
    v_lshlrev_b32 v162, 16, v61
    v_and_b32 v163, 0xffff0000, v61
    v_add_f32 v6, v6, v162
    v_add_f32 v7, v7, v163
    v_cvt_pk_bf16_f32 v8, v164, v165
    v_accvgpr_read_b32 v9, a44
    v_accvgpr_read_b32 v10, a45
    v_lshlrev_b32 v164, 16, v8
    v_and_b32 v165, 0xffff0000, v8
    v_mul_f32 v164, v164, v9
    v_mul_f32 v165, v165, v10
    v_cvt_pk_bf16_f32 v8, v164, v165
    v_lshlrev_b32 v164, 16, v8
    v_and_b32 v165, 0xffff0000, v8
    v_lshlrev_b32 v9, 16, v62
    v_and_b32 v10, 0xffff0000, v62
    v_add_f32 v164, v164, v9
    v_add_f32 v165, v165, v10
    v_cvt_pk_bf16_f32 v62, v164, v165
    v_lshlrev_b32 v164, 16, v62
    v_and_b32 v165, 0xffff0000, v62
    v_add_f32 v6, v6, v164
    v_add_f32 v7, v7, v165
    v_cvt_pk_bf16_f32 v8, v166, v167
    v_accvgpr_read_b32 v9, a46
    v_accvgpr_read_b32 v10, a47
    v_lshlrev_b32 v166, 16, v8
    v_and_b32 v167, 0xffff0000, v8
    v_mul_f32 v166, v166, v9
    v_mul_f32 v167, v167, v10
    v_cvt_pk_bf16_f32 v8, v166, v167
    v_lshlrev_b32 v166, 16, v8
    v_and_b32 v167, 0xffff0000, v8
    v_lshlrev_b32 v9, 16, v63
    v_and_b32 v10, 0xffff0000, v63
    v_add_f32 v166, v166, v9
    v_add_f32 v167, v167, v10
    v_cvt_pk_bf16_f32 v63, v166, v167
    v_lshlrev_b32 v166, 16, v63
    v_and_b32 v167, 0xffff0000, v63
    v_add_f32 v6, v6, v166
    v_add_f32 v7, v7, v167
    s_mov_b32 s71, 5259264
    buffer_store_dwordx4 v[60:63], v5, s[60:63], s71 offen offset:320 sc1
    v_cvt_pk_bf16_f32 v8, v168, v169
    v_accvgpr_read_b32 v9, a48
    v_accvgpr_read_b32 v10, a49
    v_lshlrev_b32 v168, 16, v8
    v_and_b32 v169, 0xffff0000, v8
    v_mul_f32 v168, v168, v9
    v_mul_f32 v169, v169, v10
    v_cvt_pk_bf16_f32 v8, v168, v169
    v_lshlrev_b32 v168, 16, v8
    v_and_b32 v169, 0xffff0000, v8
    v_lshlrev_b32 v9, 16, v64
    v_and_b32 v10, 0xffff0000, v64
    v_add_f32 v168, v168, v9
    v_add_f32 v169, v169, v10
    v_cvt_pk_bf16_f32 v64, v168, v169
    v_lshlrev_b32 v168, 16, v64
    v_and_b32 v169, 0xffff0000, v64
    v_add_f32 v6, v6, v168
    v_add_f32 v7, v7, v169
    v_cvt_pk_bf16_f32 v8, v170, v171
    v_accvgpr_read_b32 v9, a50
    v_accvgpr_read_b32 v10, a51
    v_lshlrev_b32 v170, 16, v8
    v_and_b32 v171, 0xffff0000, v8
    v_mul_f32 v170, v170, v9
    v_mul_f32 v171, v171, v10
    v_cvt_pk_bf16_f32 v8, v170, v171
    v_lshlrev_b32 v170, 16, v8
    v_and_b32 v171, 0xffff0000, v8
    v_lshlrev_b32 v9, 16, v65
    v_and_b32 v10, 0xffff0000, v65
    v_add_f32 v170, v170, v9
    v_add_f32 v171, v171, v10
    v_cvt_pk_bf16_f32 v65, v170, v171
    v_lshlrev_b32 v170, 16, v65
    v_and_b32 v171, 0xffff0000, v65
    v_add_f32 v6, v6, v170
    v_add_f32 v7, v7, v171
    v_cvt_pk_bf16_f32 v8, v172, v173
    v_accvgpr_read_b32 v9, a52
    v_accvgpr_read_b32 v10, a53
    v_lshlrev_b32 v172, 16, v8
    v_and_b32 v173, 0xffff0000, v8
    v_mul_f32 v172, v172, v9
    v_mul_f32 v173, v173, v10
    v_cvt_pk_bf16_f32 v8, v172, v173
    v_lshlrev_b32 v172, 16, v8
    v_and_b32 v173, 0xffff0000, v8
    v_lshlrev_b32 v9, 16, v66
    v_and_b32 v10, 0xffff0000, v66
    v_add_f32 v172, v172, v9
    v_add_f32 v173, v173, v10
    v_cvt_pk_bf16_f32 v66, v172, v173
    v_lshlrev_b32 v172, 16, v66
    v_and_b32 v173, 0xffff0000, v66
    v_add_f32 v6, v6, v172
    v_add_f32 v7, v7, v173
    v_cvt_pk_bf16_f32 v8, v174, v175
    v_accvgpr_read_b32 v9, a54
    v_accvgpr_read_b32 v10, a55
    v_lshlrev_b32 v174, 16, v8
    v_and_b32 v175, 0xffff0000, v8
    v_mul_f32 v174, v174, v9
    v_mul_f32 v175, v175, v10
    v_cvt_pk_bf16_f32 v8, v174, v175
    v_lshlrev_b32 v174, 16, v8
    v_and_b32 v175, 0xffff0000, v8
    v_lshlrev_b32 v9, 16, v67
    v_and_b32 v10, 0xffff0000, v67
    v_add_f32 v174, v174, v9
    v_add_f32 v175, v175, v10
    v_cvt_pk_bf16_f32 v67, v174, v175
    v_lshlrev_b32 v174, 16, v67
    v_and_b32 v175, 0xffff0000, v67
    v_add_f32 v6, v6, v174
    v_add_f32 v7, v7, v175
    s_mov_b32 s71, 5259264
    buffer_store_dwordx4 v[64:67], v5, s[60:63], s71 offen offset:384 sc1
    v_cvt_pk_bf16_f32 v8, v176, v177
    v_accvgpr_read_b32 v9, a56
    v_accvgpr_read_b32 v10, a57
    v_lshlrev_b32 v176, 16, v8
    v_and_b32 v177, 0xffff0000, v8
    v_mul_f32 v176, v176, v9
    v_mul_f32 v177, v177, v10
    v_cvt_pk_bf16_f32 v8, v176, v177
    v_lshlrev_b32 v176, 16, v8
    v_and_b32 v177, 0xffff0000, v8
    v_lshlrev_b32 v9, 16, v68
    v_and_b32 v10, 0xffff0000, v68
    v_add_f32 v176, v176, v9
    v_add_f32 v177, v177, v10
    v_cvt_pk_bf16_f32 v68, v176, v177
    v_lshlrev_b32 v176, 16, v68
    v_and_b32 v177, 0xffff0000, v68
    v_add_f32 v6, v6, v176
    v_add_f32 v7, v7, v177
    v_cvt_pk_bf16_f32 v8, v178, v179
    v_accvgpr_read_b32 v9, a58
    v_accvgpr_read_b32 v10, a59
    v_lshlrev_b32 v178, 16, v8
    v_and_b32 v179, 0xffff0000, v8
    v_mul_f32 v178, v178, v9
    v_mul_f32 v179, v179, v10
    v_cvt_pk_bf16_f32 v8, v178, v179
    v_lshlrev_b32 v178, 16, v8
    v_and_b32 v179, 0xffff0000, v8
    v_lshlrev_b32 v9, 16, v69
    v_and_b32 v10, 0xffff0000, v69
    v_add_f32 v178, v178, v9
    v_add_f32 v179, v179, v10
    v_cvt_pk_bf16_f32 v69, v178, v179
    v_lshlrev_b32 v178, 16, v69
    v_and_b32 v179, 0xffff0000, v69
    v_add_f32 v6, v6, v178
    v_add_f32 v7, v7, v179
    v_cvt_pk_bf16_f32 v8, v180, v181
    v_accvgpr_read_b32 v9, a60
    v_accvgpr_read_b32 v10, a61
    v_lshlrev_b32 v180, 16, v8
    v_and_b32 v181, 0xffff0000, v8
    v_mul_f32 v180, v180, v9
    v_mul_f32 v181, v181, v10
    v_cvt_pk_bf16_f32 v8, v180, v181
    v_lshlrev_b32 v180, 16, v8
    v_and_b32 v181, 0xffff0000, v8
    v_lshlrev_b32 v9, 16, v70
    v_and_b32 v10, 0xffff0000, v70
    v_add_f32 v180, v180, v9
    v_add_f32 v181, v181, v10
    v_cvt_pk_bf16_f32 v70, v180, v181
    v_lshlrev_b32 v180, 16, v70
    v_and_b32 v181, 0xffff0000, v70
    v_add_f32 v6, v6, v180
    v_add_f32 v7, v7, v181
    v_cvt_pk_bf16_f32 v8, v182, v183
    v_accvgpr_read_b32 v9, a62
    v_accvgpr_read_b32 v10, a63
    v_lshlrev_b32 v182, 16, v8
    v_and_b32 v183, 0xffff0000, v8
    v_mul_f32 v182, v182, v9
    v_mul_f32 v183, v183, v10
    v_cvt_pk_bf16_f32 v8, v182, v183
    v_lshlrev_b32 v182, 16, v8
    v_and_b32 v183, 0xffff0000, v8
    v_lshlrev_b32 v9, 16, v71
    v_and_b32 v10, 0xffff0000, v71
    v_add_f32 v182, v182, v9
    v_add_f32 v183, v183, v10
    v_cvt_pk_bf16_f32 v71, v182, v183
    v_lshlrev_b32 v182, 16, v71
    v_and_b32 v183, 0xffff0000, v71
    v_add_f32 v6, v6, v182
    v_add_f32 v7, v7, v183
    s_mov_b32 s71, 5259264
    buffer_store_dwordx4 v[68:71], v5, s[60:63], s71 offen offset:448 sc1
    v_cvt_pk_bf16_f32 v8, v184, v185
    v_accvgpr_read_b32 v9, a64
    v_accvgpr_read_b32 v10, a65
    v_lshlrev_b32 v184, 16, v8
    v_and_b32 v185, 0xffff0000, v8
    v_mul_f32 v184, v184, v9
    v_mul_f32 v185, v185, v10
    v_cvt_pk_bf16_f32 v8, v184, v185
    v_lshlrev_b32 v184, 16, v8
    v_and_b32 v185, 0xffff0000, v8
    v_lshlrev_b32 v9, 16, v72
    v_and_b32 v10, 0xffff0000, v72
    v_add_f32 v184, v184, v9
    v_add_f32 v185, v185, v10
    v_cvt_pk_bf16_f32 v72, v184, v185
    v_lshlrev_b32 v184, 16, v72
    v_and_b32 v185, 0xffff0000, v72
    v_add_f32 v6, v6, v184
    v_add_f32 v7, v7, v185
    v_cvt_pk_bf16_f32 v8, v186, v187
    v_accvgpr_read_b32 v9, a66
    v_accvgpr_read_b32 v10, a67
    v_lshlrev_b32 v186, 16, v8
    v_and_b32 v187, 0xffff0000, v8
    v_mul_f32 v186, v186, v9
    v_mul_f32 v187, v187, v10
    v_cvt_pk_bf16_f32 v8, v186, v187
    v_lshlrev_b32 v186, 16, v8
    v_and_b32 v187, 0xffff0000, v8
    v_lshlrev_b32 v9, 16, v73
    v_and_b32 v10, 0xffff0000, v73
    v_add_f32 v186, v186, v9
    v_add_f32 v187, v187, v10
    v_cvt_pk_bf16_f32 v73, v186, v187
    v_lshlrev_b32 v186, 16, v73
    v_and_b32 v187, 0xffff0000, v73
    v_add_f32 v6, v6, v186
    v_add_f32 v7, v7, v187
    v_cvt_pk_bf16_f32 v8, v188, v189
    v_accvgpr_read_b32 v9, a68
    v_accvgpr_read_b32 v10, a69
    v_lshlrev_b32 v188, 16, v8
    v_and_b32 v189, 0xffff0000, v8
    v_mul_f32 v188, v188, v9
    v_mul_f32 v189, v189, v10
    v_cvt_pk_bf16_f32 v8, v188, v189
    v_lshlrev_b32 v188, 16, v8
    v_and_b32 v189, 0xffff0000, v8
    v_lshlrev_b32 v9, 16, v74
    v_and_b32 v10, 0xffff0000, v74
    v_add_f32 v188, v188, v9
    v_add_f32 v189, v189, v10
    v_cvt_pk_bf16_f32 v74, v188, v189
    v_lshlrev_b32 v188, 16, v74
    v_and_b32 v189, 0xffff0000, v74
    v_add_f32 v6, v6, v188
    v_add_f32 v7, v7, v189
    v_cvt_pk_bf16_f32 v8, v190, v191
    v_accvgpr_read_b32 v9, a70
    v_accvgpr_read_b32 v10, a71
    v_lshlrev_b32 v190, 16, v8
    v_and_b32 v191, 0xffff0000, v8
    v_mul_f32 v190, v190, v9
    v_mul_f32 v191, v191, v10
    v_cvt_pk_bf16_f32 v8, v190, v191
    v_lshlrev_b32 v190, 16, v8
    v_and_b32 v191, 0xffff0000, v8
    v_lshlrev_b32 v9, 16, v75
    v_and_b32 v10, 0xffff0000, v75
    v_add_f32 v190, v190, v9
    v_add_f32 v191, v191, v10
    v_cvt_pk_bf16_f32 v75, v190, v191
    v_lshlrev_b32 v190, 16, v75
    v_and_b32 v191, 0xffff0000, v75
    v_add_f32 v6, v6, v190
    v_add_f32 v7, v7, v191
    s_mov_b32 s71, 5259264
    buffer_store_dwordx4 v[72:75], v5, s[60:63], s71 offen offset:512 sc1
    v_cvt_pk_bf16_f32 v8, v192, v193
    v_accvgpr_read_b32 v9, a72
    v_accvgpr_read_b32 v10, a73
    v_lshlrev_b32 v192, 16, v8
    v_and_b32 v193, 0xffff0000, v8
    v_mul_f32 v192, v192, v9
    v_mul_f32 v193, v193, v10
    v_cvt_pk_bf16_f32 v8, v192, v193
    v_lshlrev_b32 v192, 16, v8
    v_and_b32 v193, 0xffff0000, v8
    v_lshlrev_b32 v9, 16, v76
    v_and_b32 v10, 0xffff0000, v76
    v_add_f32 v192, v192, v9
    v_add_f32 v193, v193, v10
    v_cvt_pk_bf16_f32 v76, v192, v193
    v_lshlrev_b32 v192, 16, v76
    v_and_b32 v193, 0xffff0000, v76
    v_add_f32 v6, v6, v192
    v_add_f32 v7, v7, v193
    v_cvt_pk_bf16_f32 v8, v194, v195
    v_accvgpr_read_b32 v9, a74
    v_accvgpr_read_b32 v10, a75
    v_lshlrev_b32 v194, 16, v8
    v_and_b32 v195, 0xffff0000, v8
    v_mul_f32 v194, v194, v9
    v_mul_f32 v195, v195, v10
    v_cvt_pk_bf16_f32 v8, v194, v195
    v_lshlrev_b32 v194, 16, v8
    v_and_b32 v195, 0xffff0000, v8
    v_lshlrev_b32 v9, 16, v77
    v_and_b32 v10, 0xffff0000, v77
    v_add_f32 v194, v194, v9
    v_add_f32 v195, v195, v10
    v_cvt_pk_bf16_f32 v77, v194, v195
    v_lshlrev_b32 v194, 16, v77
    v_and_b32 v195, 0xffff0000, v77
    v_add_f32 v6, v6, v194
    v_add_f32 v7, v7, v195
    v_cvt_pk_bf16_f32 v8, v196, v197
    v_accvgpr_read_b32 v9, a76
    v_accvgpr_read_b32 v10, a77
    v_lshlrev_b32 v196, 16, v8
    v_and_b32 v197, 0xffff0000, v8
    v_mul_f32 v196, v196, v9
    v_mul_f32 v197, v197, v10
    v_cvt_pk_bf16_f32 v8, v196, v197
    v_lshlrev_b32 v196, 16, v8
    v_and_b32 v197, 0xffff0000, v8
    v_lshlrev_b32 v9, 16, v78
    v_and_b32 v10, 0xffff0000, v78
    v_add_f32 v196, v196, v9
    v_add_f32 v197, v197, v10
    v_cvt_pk_bf16_f32 v78, v196, v197
    v_lshlrev_b32 v196, 16, v78
    v_and_b32 v197, 0xffff0000, v78
    v_add_f32 v6, v6, v196
    v_add_f32 v7, v7, v197
    v_cvt_pk_bf16_f32 v8, v198, v199
    v_accvgpr_read_b32 v9, a78
    v_accvgpr_read_b32 v10, a79
    v_lshlrev_b32 v198, 16, v8
    v_and_b32 v199, 0xffff0000, v8
    v_mul_f32 v198, v198, v9
    v_mul_f32 v199, v199, v10
    v_cvt_pk_bf16_f32 v8, v198, v199
    v_lshlrev_b32 v198, 16, v8
    v_and_b32 v199, 0xffff0000, v8
    v_lshlrev_b32 v9, 16, v79
    v_and_b32 v10, 0xffff0000, v79
    v_add_f32 v198, v198, v9
    v_add_f32 v199, v199, v10
    v_cvt_pk_bf16_f32 v79, v198, v199
    v_lshlrev_b32 v198, 16, v79
    v_and_b32 v199, 0xffff0000, v79
    v_add_f32 v6, v6, v198
    v_add_f32 v7, v7, v199
    s_mov_b32 s71, 5259264
    buffer_store_dwordx4 v[76:79], v5, s[60:63], s71 offen offset:576 sc1
    v_add_f32 v6, v6, v7
    v_mov_b32 v7, v6
    s_nop 1
    v_permlane16_swap_b32 v6, v7
    s_nop 1
    v_add_f32 v6, v6, v7
    v_mov_b32 v7, v6
    s_nop 1
    v_permlane32_swap_b32 v6, v7
    s_nop 1
    v_add_f32 v6, v6, v7
    v_lshlrev_b32 v15, 2, v2
    s_lshl_b32 s3, s74, 8
    s_add_u32 s3, s3, 0x21000
    v_add_u32 v16, s3, v15
    s_xor_b32 s3, s74, 2
    s_lshl_b32 s3, s3, 8
    s_add_u32 s3, s3, 0x21000
    v_add_u32 v17, s3, v15
    ds_write_b32 v16, v6
    s_waitcnt lgkmcnt(0)
    s_barrier
    ds_read_b32 v7, v17
    s_waitcnt lgkmcnt(0)
    v_add_f32 v6, v6, v7
    v_mul_f32 v6, 0x3acccccd, v6
    v_mov_b32 v10, 0
    v_mov_b32 v11, 0
    v_sub_f32 v120, v120, v6
    v_sub_f32 v121, v121, v6
    v_fmac_f32 v10, v120, v120
    v_fmac_f32 v11, v121, v121
    v_sub_f32 v122, v122, v6
    v_sub_f32 v123, v123, v6
    v_fmac_f32 v10, v122, v122
    v_fmac_f32 v11, v123, v123
    v_sub_f32 v124, v124, v6
    v_sub_f32 v125, v125, v6
    v_fmac_f32 v10, v124, v124
    v_fmac_f32 v11, v125, v125
    v_sub_f32 v126, v126, v6
    v_sub_f32 v127, v127, v6
    v_fmac_f32 v10, v126, v126
    v_fmac_f32 v11, v127, v127
    v_sub_f32 v128, v128, v6
    v_sub_f32 v129, v129, v6
    v_fmac_f32 v10, v128, v128
    v_fmac_f32 v11, v129, v129
    v_sub_f32 v130, v130, v6
    v_sub_f32 v131, v131, v6
    v_fmac_f32 v10, v130, v130
    v_fmac_f32 v11, v131, v131
    v_sub_f32 v132, v132, v6
    v_sub_f32 v133, v133, v6
    v_fmac_f32 v10, v132, v132
    v_fmac_f32 v11, v133, v133
    v_sub_f32 v134, v134, v6
    v_sub_f32 v135, v135, v6
    v_fmac_f32 v10, v134, v134
    v_fmac_f32 v11, v135, v135
    v_sub_f32 v136, v136, v6
    v_sub_f32 v137, v137, v6
    v_fmac_f32 v10, v136, v136
    v_fmac_f32 v11, v137, v137
    v_sub_f32 v138, v138, v6
    v_sub_f32 v139, v139, v6
    v_fmac_f32 v10, v138, v138
    v_fmac_f32 v11, v139, v139
    v_sub_f32 v140, v140, v6
    v_sub_f32 v141, v141, v6
    v_fmac_f32 v10, v140, v140
    v_fmac_f32 v11, v141, v141
    v_sub_f32 v142, v142, v6
    v_sub_f32 v143, v143, v6
    v_fmac_f32 v10, v142, v142
    v_fmac_f32 v11, v143, v143
    v_sub_f32 v144, v144, v6
    v_sub_f32 v145, v145, v6
    v_fmac_f32 v10, v144, v144
    v_fmac_f32 v11, v145, v145
    v_sub_f32 v146, v146, v6
    v_sub_f32 v147, v147, v6
    v_fmac_f32 v10, v146, v146
    v_fmac_f32 v11, v147, v147
    v_sub_f32 v148, v148, v6
    v_sub_f32 v149, v149, v6
    v_fmac_f32 v10, v148, v148
    v_fmac_f32 v11, v149, v149
    v_sub_f32 v150, v150, v6
    v_sub_f32 v151, v151, v6
    v_fmac_f32 v10, v150, v150
    v_fmac_f32 v11, v151, v151
    v_sub_f32 v152, v152, v6
    v_sub_f32 v153, v153, v6
    v_fmac_f32 v10, v152, v152
    v_fmac_f32 v11, v153, v153
    v_sub_f32 v154, v154, v6
    v_sub_f32 v155, v155, v6
    v_fmac_f32 v10, v154, v154
    v_fmac_f32 v11, v155, v155
    v_sub_f32 v156, v156, v6
    v_sub_f32 v157, v157, v6
    v_fmac_f32 v10, v156, v156
    v_fmac_f32 v11, v157, v157
    v_sub_f32 v158, v158, v6
    v_sub_f32 v159, v159, v6
    v_fmac_f32 v10, v158, v158
    v_fmac_f32 v11, v159, v159
    v_sub_f32 v160, v160, v6
    v_sub_f32 v161, v161, v6
    v_fmac_f32 v10, v160, v160
    v_fmac_f32 v11, v161, v161
    v_sub_f32 v162, v162, v6
    v_sub_f32 v163, v163, v6
    v_fmac_f32 v10, v162, v162
    v_fmac_f32 v11, v163, v163
    v_sub_f32 v164, v164, v6
    v_sub_f32 v165, v165, v6
    v_fmac_f32 v10, v164, v164
    v_fmac_f32 v11, v165, v165
    v_sub_f32 v166, v166, v6
    v_sub_f32 v167, v167, v6
    v_fmac_f32 v10, v166, v166
    v_fmac_f32 v11, v167, v167
    v_sub_f32 v168, v168, v6
    v_sub_f32 v169, v169, v6
    v_fmac_f32 v10, v168, v168
    v_fmac_f32 v11, v169, v169
    v_sub_f32 v170, v170, v6
    v_sub_f32 v171, v171, v6
    v_fmac_f32 v10, v170, v170
    v_fmac_f32 v11, v171, v171
    v_sub_f32 v172, v172, v6
    v_sub_f32 v173, v173, v6
    v_fmac_f32 v10, v172, v172
    v_fmac_f32 v11, v173, v173
    v_sub_f32 v174, v174, v6
    v_sub_f32 v175, v175, v6
    v_fmac_f32 v10, v174, v174
    v_fmac_f32 v11, v175, v175
    v_sub_f32 v176, v176, v6
    v_sub_f32 v177, v177, v6
    v_fmac_f32 v10, v176, v176
    v_fmac_f32 v11, v177, v177
    v_sub_f32 v178, v178, v6
    v_sub_f32 v179, v179, v6
    v_fmac_f32 v10, v178, v178
    v_fmac_f32 v11, v179, v179
    v_sub_f32 v180, v180, v6
    v_sub_f32 v181, v181, v6
    v_fmac_f32 v10, v180, v180
    v_fmac_f32 v11, v181, v181
    v_sub_f32 v182, v182, v6
    v_sub_f32 v183, v183, v6
    v_fmac_f32 v10, v182, v182
    v_fmac_f32 v11, v183, v183
    v_sub_f32 v184, v184, v6
    v_sub_f32 v185, v185, v6
    v_fmac_f32 v10, v184, v184
    v_fmac_f32 v11, v185, v185
    v_sub_f32 v186, v186, v6
    v_sub_f32 v187, v187, v6
    v_fmac_f32 v10, v186, v186
    v_fmac_f32 v11, v187, v187
    v_sub_f32 v188, v188, v6
    v_sub_f32 v189, v189, v6
    v_fmac_f32 v10, v188, v188
    v_fmac_f32 v11, v189, v189
    v_sub_f32 v190, v190, v6
    v_sub_f32 v191, v191, v6
    v_fmac_f32 v10, v190, v190
    v_fmac_f32 v11, v191, v191
    v_sub_f32 v192, v192, v6
    v_sub_f32 v193, v193, v6
    v_fmac_f32 v10, v192, v192
    v_fmac_f32 v11, v193, v193
    v_sub_f32 v194, v194, v6
    v_sub_f32 v195, v195, v6
    v_fmac_f32 v10, v194, v194
    v_fmac_f32 v11, v195, v195
    v_sub_f32 v196, v196, v6
    v_sub_f32 v197, v197, v6
    v_fmac_f32 v10, v196, v196
    v_fmac_f32 v11, v197, v197
    v_sub_f32 v198, v198, v6
    v_sub_f32 v199, v199, v6
    v_fmac_f32 v10, v198, v198
    v_fmac_f32 v11, v199, v199
    v_add_f32 v10, v10, v11
    v_mov_b32 v11, v10
    s_nop 1
    v_permlane16_swap_b32 v10, v11
    s_nop 1
    v_add_f32 v10, v10, v11
    v_mov_b32 v11, v10
    s_nop 1
    v_permlane32_swap_b32 v10, v11
    s_nop 1
    v_add_f32 v10, v10, v11
    ds_write_b32 v16, v10 offset:1024
    s_waitcnt lgkmcnt(0)
    s_barrier
    ds_read_b32 v11, v17 offset:1024
    s_waitcnt lgkmcnt(0)
    v_add_f32 v10, v10, v11
    v_mov_b32 v11, 0x3727c5ac
    v_fmac_f32 v11, 0x3acccccd, v10
    v_rsq_f32 v11, v11
    s_mul_i32 s3, s58, 20480
    s_mul_i32 s71, s57, 10240
    s_add_u32 s3, s3, s71
    s_add_u32 s3, s3, 2637824
    v_lshlrev_b32 v13, 4, v2
    s_waitcnt vmcnt(0)
    v_accvgpr_read_b32 v8, a80
    v_accvgpr_read_b32 v9, a81
    v_accvgpr_read_b32 v18, a160
    v_accvgpr_read_b32 v19, a161
    v_mul_f32 v120, v120, v11
    v_mul_f32 v121, v121, v11
    v_fma_f32 v8, v120, v18, v8
    v_fma_f32 v9, v121, v19, v9
    v_cvt_pk_bf16_f32 v40, v8, v9
    v_accvgpr_read_b32 v8, a82
    v_accvgpr_read_b32 v9, a83
    v_accvgpr_read_b32 v18, a162
    v_accvgpr_read_b32 v19, a163
    v_mul_f32 v122, v122, v11
    v_mul_f32 v123, v123, v11
    v_fma_f32 v8, v122, v18, v8
    v_fma_f32 v9, v123, v19, v9
    v_cvt_pk_bf16_f32 v41, v8, v9
    v_accvgpr_read_b32 v8, a84
    v_accvgpr_read_b32 v9, a85
    v_accvgpr_read_b32 v18, a164
    v_accvgpr_read_b32 v19, a165
    v_mul_f32 v124, v124, v11
    v_mul_f32 v125, v125, v11
    v_fma_f32 v8, v124, v18, v8
    v_fma_f32 v9, v125, v19, v9
    v_cvt_pk_bf16_f32 v42, v8, v9
    v_accvgpr_read_b32 v8, a86
    v_accvgpr_read_b32 v9, a87
    v_accvgpr_read_b32 v18, a166
    v_accvgpr_read_b32 v19, a167
    v_mul_f32 v126, v126, v11
    v_mul_f32 v127, v127, v11
    v_fma_f32 v8, v126, v18, v8
    v_fma_f32 v9, v127, v19, v9
    v_cvt_pk_bf16_f32 v43, v8, v9
    buffer_store_dwordx4 v[40:43], v13, s[60:63], s3 offen offset:0 sc1
    v_accvgpr_read_b32 v8, a88
    v_accvgpr_read_b32 v9, a89
    v_accvgpr_read_b32 v18, a168
    v_accvgpr_read_b32 v19, a169
    v_mul_f32 v128, v128, v11
    v_mul_f32 v129, v129, v11
    v_fma_f32 v8, v128, v18, v8
    v_fma_f32 v9, v129, v19, v9
    v_cvt_pk_bf16_f32 v44, v8, v9
    v_accvgpr_read_b32 v8, a90
    v_accvgpr_read_b32 v9, a91
    v_accvgpr_read_b32 v18, a170
    v_accvgpr_read_b32 v19, a171
    v_mul_f32 v130, v130, v11
    v_mul_f32 v131, v131, v11
    v_fma_f32 v8, v130, v18, v8
    v_fma_f32 v9, v131, v19, v9
    v_cvt_pk_bf16_f32 v45, v8, v9
    v_accvgpr_read_b32 v8, a92
    v_accvgpr_read_b32 v9, a93
    v_accvgpr_read_b32 v18, a172
    v_accvgpr_read_b32 v19, a173
    v_mul_f32 v132, v132, v11
    v_mul_f32 v133, v133, v11
    v_fma_f32 v8, v132, v18, v8
    v_fma_f32 v9, v133, v19, v9
    v_cvt_pk_bf16_f32 v46, v8, v9
    v_accvgpr_read_b32 v8, a94
    v_accvgpr_read_b32 v9, a95
    v_accvgpr_read_b32 v18, a174
    v_accvgpr_read_b32 v19, a175
    v_mul_f32 v134, v134, v11
    v_mul_f32 v135, v135, v11
    v_fma_f32 v8, v134, v18, v8
    v_fma_f32 v9, v135, v19, v9
    v_cvt_pk_bf16_f32 v47, v8, v9
    buffer_store_dwordx4 v[44:47], v13, s[60:63], s3 offen offset:1024 sc1
    v_accvgpr_read_b32 v8, a96
    v_accvgpr_read_b32 v9, a97
    v_accvgpr_read_b32 v18, a176
    v_accvgpr_read_b32 v19, a177
    v_mul_f32 v136, v136, v11
    v_mul_f32 v137, v137, v11
    v_fma_f32 v8, v136, v18, v8
    v_fma_f32 v9, v137, v19, v9
    v_cvt_pk_bf16_f32 v48, v8, v9
    v_accvgpr_read_b32 v8, a98
    v_accvgpr_read_b32 v9, a99
    v_accvgpr_read_b32 v18, a178
    v_accvgpr_read_b32 v19, a179
    v_mul_f32 v138, v138, v11
    v_mul_f32 v139, v139, v11
    v_fma_f32 v8, v138, v18, v8
    v_fma_f32 v9, v139, v19, v9
    v_cvt_pk_bf16_f32 v49, v8, v9
    v_accvgpr_read_b32 v8, a100
    v_accvgpr_read_b32 v9, a101
    v_accvgpr_read_b32 v18, a180
    v_accvgpr_read_b32 v19, a181
    v_mul_f32 v140, v140, v11
    v_mul_f32 v141, v141, v11
    v_fma_f32 v8, v140, v18, v8
    v_fma_f32 v9, v141, v19, v9
    v_cvt_pk_bf16_f32 v50, v8, v9
    v_accvgpr_read_b32 v8, a102
    v_accvgpr_read_b32 v9, a103
    v_accvgpr_read_b32 v18, a182
    v_accvgpr_read_b32 v19, a183
    v_mul_f32 v142, v142, v11
    v_mul_f32 v143, v143, v11
    v_fma_f32 v8, v142, v18, v8
    v_fma_f32 v9, v143, v19, v9
    v_cvt_pk_bf16_f32 v51, v8, v9
    buffer_store_dwordx4 v[48:51], v13, s[60:63], s3 offen offset:2048 sc1
    v_accvgpr_read_b32 v8, a104
    v_accvgpr_read_b32 v9, a105
    v_accvgpr_read_b32 v18, a184
    v_accvgpr_read_b32 v19, a185
    v_mul_f32 v144, v144, v11
    v_mul_f32 v145, v145, v11
    v_fma_f32 v8, v144, v18, v8
    v_fma_f32 v9, v145, v19, v9
    v_cvt_pk_bf16_f32 v52, v8, v9
    v_accvgpr_read_b32 v8, a106
    v_accvgpr_read_b32 v9, a107
    v_accvgpr_read_b32 v18, a186
    v_accvgpr_read_b32 v19, a187
    v_mul_f32 v146, v146, v11
    v_mul_f32 v147, v147, v11
    v_fma_f32 v8, v146, v18, v8
    v_fma_f32 v9, v147, v19, v9
    v_cvt_pk_bf16_f32 v53, v8, v9
    v_accvgpr_read_b32 v8, a108
    v_accvgpr_read_b32 v9, a109
    v_accvgpr_read_b32 v18, a188
    v_accvgpr_read_b32 v19, a189
    v_mul_f32 v148, v148, v11
    v_mul_f32 v149, v149, v11
    v_fma_f32 v8, v148, v18, v8
    v_fma_f32 v9, v149, v19, v9
    v_cvt_pk_bf16_f32 v54, v8, v9
    v_accvgpr_read_b32 v8, a110
    v_accvgpr_read_b32 v9, a111
    v_accvgpr_read_b32 v18, a190
    v_accvgpr_read_b32 v19, a191
    v_mul_f32 v150, v150, v11
    v_mul_f32 v151, v151, v11
    v_fma_f32 v8, v150, v18, v8
    v_fma_f32 v9, v151, v19, v9
    v_cvt_pk_bf16_f32 v55, v8, v9
    buffer_store_dwordx4 v[52:55], v13, s[60:63], s3 offen offset:3072 sc1
    s_add_u32 s3, s3, 4096
    v_accvgpr_read_b32 v8, a112
    v_accvgpr_read_b32 v9, a113
    v_accvgpr_read_b32 v18, a192
    v_accvgpr_read_b32 v19, a193
    v_mul_f32 v152, v152, v11
    v_mul_f32 v153, v153, v11
    v_fma_f32 v8, v152, v18, v8
    v_fma_f32 v9, v153, v19, v9
    v_cvt_pk_bf16_f32 v56, v8, v9
    v_accvgpr_read_b32 v8, a114
    v_accvgpr_read_b32 v9, a115
    v_accvgpr_read_b32 v18, a194
    v_accvgpr_read_b32 v19, a195
    v_mul_f32 v154, v154, v11
    v_mul_f32 v155, v155, v11
    v_fma_f32 v8, v154, v18, v8
    v_fma_f32 v9, v155, v19, v9
    v_cvt_pk_bf16_f32 v57, v8, v9
    v_accvgpr_read_b32 v8, a116
    v_accvgpr_read_b32 v9, a117
    v_accvgpr_read_b32 v18, a196
    v_accvgpr_read_b32 v19, a197
    v_mul_f32 v156, v156, v11
    v_mul_f32 v157, v157, v11
    v_fma_f32 v8, v156, v18, v8
    v_fma_f32 v9, v157, v19, v9
    v_cvt_pk_bf16_f32 v58, v8, v9
    v_accvgpr_read_b32 v8, a118
    v_accvgpr_read_b32 v9, a119
    v_accvgpr_read_b32 v18, a198
    v_accvgpr_read_b32 v19, a199
    v_mul_f32 v158, v158, v11
    v_mul_f32 v159, v159, v11
    v_fma_f32 v8, v158, v18, v8
    v_fma_f32 v9, v159, v19, v9
    v_cvt_pk_bf16_f32 v59, v8, v9
    buffer_store_dwordx4 v[56:59], v13, s[60:63], s3 offen offset:0 sc1
    v_accvgpr_read_b32 v8, a120
    v_accvgpr_read_b32 v9, a121
    v_accvgpr_read_b32 v18, a200
    v_accvgpr_read_b32 v19, a201
    v_mul_f32 v160, v160, v11
    v_mul_f32 v161, v161, v11
    v_fma_f32 v8, v160, v18, v8
    v_fma_f32 v9, v161, v19, v9
    v_cvt_pk_bf16_f32 v60, v8, v9
    v_accvgpr_read_b32 v8, a122
    v_accvgpr_read_b32 v9, a123
    v_accvgpr_read_b32 v18, a202
    v_accvgpr_read_b32 v19, a203
    v_mul_f32 v162, v162, v11
    v_mul_f32 v163, v163, v11
    v_fma_f32 v8, v162, v18, v8
    v_fma_f32 v9, v163, v19, v9
    v_cvt_pk_bf16_f32 v61, v8, v9
    v_accvgpr_read_b32 v8, a124
    v_accvgpr_read_b32 v9, a125
    v_accvgpr_read_b32 v18, a204
    v_accvgpr_read_b32 v19, a205
    v_mul_f32 v164, v164, v11
    v_mul_f32 v165, v165, v11
    v_fma_f32 v8, v164, v18, v8
    v_fma_f32 v9, v165, v19, v9
    v_cvt_pk_bf16_f32 v62, v8, v9
    v_accvgpr_read_b32 v8, a126
    v_accvgpr_read_b32 v9, a127
    v_accvgpr_read_b32 v18, a206
    v_accvgpr_read_b32 v19, a207
    v_mul_f32 v166, v166, v11
    v_mul_f32 v167, v167, v11
    v_fma_f32 v8, v166, v18, v8
    v_fma_f32 v9, v167, v19, v9
    v_cvt_pk_bf16_f32 v63, v8, v9
    buffer_store_dwordx4 v[60:63], v13, s[60:63], s3 offen offset:1024 sc1
    v_accvgpr_read_b32 v8, a128
    v_accvgpr_read_b32 v9, a129
    v_accvgpr_read_b32 v18, a208
    v_accvgpr_read_b32 v19, a209
    v_mul_f32 v168, v168, v11
    v_mul_f32 v169, v169, v11
    v_fma_f32 v8, v168, v18, v8
    v_fma_f32 v9, v169, v19, v9
    v_cvt_pk_bf16_f32 v64, v8, v9
    v_accvgpr_read_b32 v8, a130
    v_accvgpr_read_b32 v9, a131
    v_accvgpr_read_b32 v18, a210
    v_accvgpr_read_b32 v19, a211
    v_mul_f32 v170, v170, v11
    v_mul_f32 v171, v171, v11
    v_fma_f32 v8, v170, v18, v8
    v_fma_f32 v9, v171, v19, v9
    v_cvt_pk_bf16_f32 v65, v8, v9
    v_accvgpr_read_b32 v8, a132
    v_accvgpr_read_b32 v9, a133
    v_accvgpr_read_b32 v18, a212
    v_accvgpr_read_b32 v19, a213
    v_mul_f32 v172, v172, v11
    v_mul_f32 v173, v173, v11
    v_fma_f32 v8, v172, v18, v8
    v_fma_f32 v9, v173, v19, v9
    v_cvt_pk_bf16_f32 v66, v8, v9
    v_accvgpr_read_b32 v8, a134
    v_accvgpr_read_b32 v9, a135
    v_accvgpr_read_b32 v18, a214
    v_accvgpr_read_b32 v19, a215
    v_mul_f32 v174, v174, v11
    v_mul_f32 v175, v175, v11
    v_fma_f32 v8, v174, v18, v8
    v_fma_f32 v9, v175, v19, v9
    v_cvt_pk_bf16_f32 v67, v8, v9
    buffer_store_dwordx4 v[64:67], v13, s[60:63], s3 offen offset:2048 sc1
    v_accvgpr_read_b32 v8, a136
    v_accvgpr_read_b32 v9, a137
    v_accvgpr_read_b32 v18, a216
    v_accvgpr_read_b32 v19, a217
    v_mul_f32 v176, v176, v11
    v_mul_f32 v177, v177, v11
    v_fma_f32 v8, v176, v18, v8
    v_fma_f32 v9, v177, v19, v9
    v_cvt_pk_bf16_f32 v68, v8, v9
    v_accvgpr_read_b32 v8, a138
    v_accvgpr_read_b32 v9, a139
    v_accvgpr_read_b32 v18, a218
    v_accvgpr_read_b32 v19, a219
    v_mul_f32 v178, v178, v11
    v_mul_f32 v179, v179, v11
    v_fma_f32 v8, v178, v18, v8
    v_fma_f32 v9, v179, v19, v9
    v_cvt_pk_bf16_f32 v69, v8, v9
    v_accvgpr_read_b32 v8, a140
    v_accvgpr_read_b32 v9, a141
    v_accvgpr_read_b32 v18, a220
    v_accvgpr_read_b32 v19, a221
    v_mul_f32 v180, v180, v11
    v_mul_f32 v181, v181, v11
    v_fma_f32 v8, v180, v18, v8
    v_fma_f32 v9, v181, v19, v9
    v_cvt_pk_bf16_f32 v70, v8, v9
    v_accvgpr_read_b32 v8, a142
    v_accvgpr_read_b32 v9, a143
    v_accvgpr_read_b32 v18, a222
    v_accvgpr_read_b32 v19, a223
    v_mul_f32 v182, v182, v11
    v_mul_f32 v183, v183, v11
    v_fma_f32 v8, v182, v18, v8
    v_fma_f32 v9, v183, v19, v9
    v_cvt_pk_bf16_f32 v71, v8, v9
    buffer_store_dwordx4 v[68:71], v13, s[60:63], s3 offen offset:3072 sc1
    s_add_u32 s3, s3, 4096
    v_accvgpr_read_b32 v8, a144
    v_accvgpr_read_b32 v9, a145
    v_accvgpr_read_b32 v18, a224
    v_accvgpr_read_b32 v19, a225
    v_mul_f32 v184, v184, v11
    v_mul_f32 v185, v185, v11
    v_fma_f32 v8, v184, v18, v8
    v_fma_f32 v9, v185, v19, v9
    v_cvt_pk_bf16_f32 v72, v8, v9
    v_accvgpr_read_b32 v8, a146
    v_accvgpr_read_b32 v9, a147
    v_accvgpr_read_b32 v18, a226
    v_accvgpr_read_b32 v19, a227
    v_mul_f32 v186, v186, v11
    v_mul_f32 v187, v187, v11
    v_fma_f32 v8, v186, v18, v8
    v_fma_f32 v9, v187, v19, v9
    v_cvt_pk_bf16_f32 v73, v8, v9
    v_accvgpr_read_b32 v8, a148
    v_accvgpr_read_b32 v9, a149
    v_accvgpr_read_b32 v18, a228
    v_accvgpr_read_b32 v19, a229
    v_mul_f32 v188, v188, v11
    v_mul_f32 v189, v189, v11
    v_fma_f32 v8, v188, v18, v8
    v_fma_f32 v9, v189, v19, v9
    v_cvt_pk_bf16_f32 v74, v8, v9
    v_accvgpr_read_b32 v8, a150
    v_accvgpr_read_b32 v9, a151
    v_accvgpr_read_b32 v18, a230
    v_accvgpr_read_b32 v19, a231
    v_mul_f32 v190, v190, v11
    v_mul_f32 v191, v191, v11
    v_fma_f32 v8, v190, v18, v8
    v_fma_f32 v9, v191, v19, v9
    v_cvt_pk_bf16_f32 v75, v8, v9
    buffer_store_dwordx4 v[72:75], v13, s[60:63], s3 offen offset:0 sc1
    v_accvgpr_read_b32 v8, a152
    v_accvgpr_read_b32 v9, a153
    v_accvgpr_read_b32 v18, a232
    v_accvgpr_read_b32 v19, a233
    v_mul_f32 v192, v192, v11
    v_mul_f32 v193, v193, v11
    v_fma_f32 v8, v192, v18, v8
    v_fma_f32 v9, v193, v19, v9
    v_cvt_pk_bf16_f32 v76, v8, v9
    v_accvgpr_read_b32 v8, a154
    v_accvgpr_read_b32 v9, a155
    v_accvgpr_read_b32 v18, a234
    v_accvgpr_read_b32 v19, a235
    v_mul_f32 v194, v194, v11
    v_mul_f32 v195, v195, v11
    v_fma_f32 v8, v194, v18, v8
    v_fma_f32 v9, v195, v19, v9
    v_cvt_pk_bf16_f32 v77, v8, v9
    v_accvgpr_read_b32 v8, a156
    v_accvgpr_read_b32 v9, a157
    v_accvgpr_read_b32 v18, a236
    v_accvgpr_read_b32 v19, a237
    v_mul_f32 v196, v196, v11
    v_mul_f32 v197, v197, v11
    v_fma_f32 v8, v196, v18, v8
    v_fma_f32 v9, v197, v19, v9
    v_cvt_pk_bf16_f32 v78, v8, v9
    v_accvgpr_read_b32 v8, a158
    v_accvgpr_read_b32 v9, a159
    v_accvgpr_read_b32 v18, a238
    v_accvgpr_read_b32 v19, a239
    v_mul_f32 v198, v198, v11
    v_mul_f32 v199, v199, v11
    v_fma_f32 v8, v198, v18, v8
    v_fma_f32 v9, v199, v19, v9
    v_cvt_pk_bf16_f32 v79, v8, v9
    buffer_store_dwordx4 v[76:79], v13, s[60:63], s3 offen offset:1024 sc1
    s_waitcnt vmcnt(0)
    s_barrier
    s_add_u32 s68, s20, 192
    s_mov_b32 s59, 1
    s_cmp_lg_u32 s74, 0
    s_cbranch_scc1 mega_kernel_pf152
    v_mov_b32 v5, s59
    v_mov_b32 v6, 0
    s_lshl_b32 s71, s68, 2
    s_add_u32 s71, s71, 204500992
    s_mov_b64 exec, 1
    buffer_store_dword v5, v6, s[60:63], s71 offen sc1
    s_mov_b64 exec, -1
mega_kernel_pf152:
    s_branch mega_kernel_attn_top137
mega_kernel_up5:
    s_load_dwordx2 s[10:11], s[0:1], 64
    s_load_dwordx2 s[12:13], s[0:1], 72
    s_sub_u32 s18, s2, 208
    s_cmp_ge_u32 s18, 12
    s_cselect_b32 s15, 1, 0
    s_mul_i32 s16, s15, 12
    s_sub_u32 s16, s18, s16
    s_lshl_b32 s19, s16, 7
    s_lshl_b32 s3, s74, 5
    s_add_u32 s19, s19, s3
    s_waitcnt lgkmcnt(0)
    s_mov_b32 s64, s10
    s_and_b32 s65, s11, 0xffff
    s_mov_b32 s66, 1966080
    s_mov_b32 s67, 0x00020000
    s_mov_b32 s84, s12
    s_and_b32 s85, s13, 0xffff
    s_mov_b32 s86, 1966080
    s_mov_b32 s87, 0x00020000
    s_movk_i32 s3, 24576
    v_mul_lo_u32 v5, v4, s3
    v_lshl_add_u32 v5, v3, 2, v5
    s_lshl_b32 s70, s19, 1
    s_add_u32 s71, s70, 0
    buffer_load_dword v32, v5, s[64:67], s71 offen
    s_add_u32 s71, s70, 3072
    buffer_load_dword v33, v5, s[64:67], s71 offen
    s_add_u32 s71, s70, 6144
    buffer_load_dword v34, v5, s[64:67], s71 offen
    s_add_u32 s71, s70, 9216
    buffer_load_dword v35, v5, s[64:67], s71 offen
    s_add_u32 s71, s70, 12288
    buffer_load_dword v36, v5, s[64:67], s71 offen
    s_add_u32 s71, s70, 15360
    buffer_load_dword v37, v5, s[64:67], s71 offen
    s_add_u32 s71, s70, 18432
    buffer_load_dword v38, v5, s[64:67], s71 offen
    s_add_u32 s71, s70, 21504
    buffer_load_dword v39, v5, s[64:67], s71 offen
    s_add_u32 s71, s70, 98304
    buffer_load_dword v40, v5, s[64:67], s71 offen
    s_add_u32 s71, s70, 101376
    buffer_load_dword v41, v5, s[64:67], s71 offen
    s_add_u32 s71, s70, 104448
    buffer_load_dword v42, v5, s[64:67], s71 offen
    s_add_u32 s71, s70, 107520
    buffer_load_dword v43, v5, s[64:67], s71 offen
    s_add_u32 s71, s70, 110592
    buffer_load_dword v44, v5, s[64:67], s71 offen
    s_add_u32 s71, s70, 113664
    buffer_load_dword v45, v5, s[64:67], s71 offen
    s_add_u32 s71, s70, 116736
    buffer_load_dword v46, v5, s[64:67], s71 offen
    s_add_u32 s71, s70, 119808
    buffer_load_dword v47, v5, s[64:67], s71 offen
    s_add_u32 s71, s70, 196608
    buffer_load_dword v48, v5, s[64:67], s71 offen
    s_add_u32 s71, s70, 199680
    buffer_load_dword v49, v5, s[64:67], s71 offen
    s_add_u32 s71, s70, 202752
    buffer_load_dword v50, v5, s[64:67], s71 offen
    s_add_u32 s71, s70, 205824
    buffer_load_dword v51, v5, s[64:67], s71 offen
    s_add_u32 s71, s70, 208896
    buffer_load_dword v52, v5, s[64:67], s71 offen
    s_add_u32 s71, s70, 211968
    buffer_load_dword v53, v5, s[64:67], s71 offen
    s_add_u32 s71, s70, 215040
    buffer_load_dword v54, v5, s[64:67], s71 offen
    s_add_u32 s71, s70, 218112
    buffer_load_dword v55, v5, s[64:67], s71 offen
    s_add_u32 s71, s70, 294912
    buffer_load_dword v56, v5, s[64:67], s71 offen
    s_add_u32 s71, s70, 297984
    buffer_load_dword v57, v5, s[64:67], s71 offen
    s_add_u32 s71, s70, 301056
    buffer_load_dword v58, v5, s[64:67], s71 offen
    s_add_u32 s71, s70, 304128
    buffer_load_dword v59, v5, s[64:67], s71 offen
    s_add_u32 s71, s70, 307200
    buffer_load_dword v60, v5, s[64:67], s71 offen
    s_add_u32 s71, s70, 310272
    buffer_load_dword v61, v5, s[64:67], s71 offen
    s_add_u32 s71, s70, 313344
    buffer_load_dword v62, v5, s[64:67], s71 offen
    s_add_u32 s71, s70, 316416
    buffer_load_dword v63, v5, s[64:67], s71 offen
    s_add_u32 s71, s70, 393216
    buffer_load_dword v64, v5, s[64:67], s71 offen
    s_add_u32 s71, s70, 396288
    buffer_load_dword v65, v5, s[64:67], s71 offen
    s_add_u32 s71, s70, 399360
    buffer_load_dword v66, v5, s[64:67], s71 offen
    s_add_u32 s71, s70, 402432
    buffer_load_dword v67, v5, s[64:67], s71 offen
    s_add_u32 s71, s70, 405504
    buffer_load_dword v68, v5, s[64:67], s71 offen
    s_add_u32 s71, s70, 408576
    buffer_load_dword v69, v5, s[64:67], s71 offen
    s_add_u32 s71, s70, 411648
    buffer_load_dword v70, v5, s[64:67], s71 offen
    s_add_u32 s71, s70, 414720
    buffer_load_dword v71, v5, s[64:67], s71 offen
    s_add_u32 s71, s70, 491520
    buffer_load_dword v72, v5, s[64:67], s71 offen
    s_add_u32 s71, s70, 494592
    buffer_load_dword v73, v5, s[64:67], s71 offen
    s_add_u32 s71, s70, 497664
    buffer_load_dword v74, v5, s[64:67], s71 offen
    s_add_u32 s71, s70, 500736
    buffer_load_dword v75, v5, s[64:67], s71 offen
    s_add_u32 s71, s70, 503808
    buffer_load_dword v76, v5, s[64:67], s71 offen
    s_add_u32 s71, s70, 506880
    buffer_load_dword v77, v5, s[64:67], s71 offen
    s_add_u32 s71, s70, 509952
    buffer_load_dword v78, v5, s[64:67], s71 offen
    s_add_u32 s71, s70, 513024
    buffer_load_dword v79, v5, s[64:67], s71 offen
    s_add_u32 s71, s70, 589824
    buffer_load_dword v80, v5, s[64:67], s71 offen
    s_add_u32 s71, s70, 592896
    buffer_load_dword v81, v5, s[64:67], s71 offen
    s_add_u32 s71, s70, 595968
    buffer_load_dword v82, v5, s[64:67], s71 offen
    s_add_u32 s71, s70, 599040
    buffer_load_dword v83, v5, s[64:67], s71 offen
    s_add_u32 s71, s70, 602112
    buffer_load_dword v84, v5, s[64:67], s71 offen
    s_add_u32 s71, s70, 605184
    buffer_load_dword v85, v5, s[64:67], s71 offen
    s_add_u32 s71, s70, 608256
    buffer_load_dword v86, v5, s[64:67], s71 offen
    s_add_u32 s71, s70, 611328
    buffer_load_dword v87, v5, s[64:67], s71 offen
    s_add_u32 s71, s70, 688128
    buffer_load_dword v88, v5, s[64:67], s71 offen
    s_add_u32 s71, s70, 691200
    buffer_load_dword v89, v5, s[64:67], s71 offen
    s_add_u32 s71, s70, 694272
    buffer_load_dword v90, v5, s[64:67], s71 offen
    s_add_u32 s71, s70, 697344
    buffer_load_dword v91, v5, s[64:67], s71 offen
    s_add_u32 s71, s70, 700416
    buffer_load_dword v92, v5, s[64:67], s71 offen
    s_add_u32 s71, s70, 703488
    buffer_load_dword v93, v5, s[64:67], s71 offen
    s_add_u32 s71, s70, 706560
    buffer_load_dword v94, v5, s[64:67], s71 offen
    s_add_u32 s71, s70, 709632
    buffer_load_dword v95, v5, s[64:67], s71 offen
    s_add_u32 s71, s70, 786432
    buffer_load_dword v96, v5, s[64:67], s71 offen
    s_add_u32 s71, s70, 789504
    buffer_load_dword v97, v5, s[64:67], s71 offen
    s_add_u32 s71, s70, 792576
    buffer_load_dword v98, v5, s[64:67], s71 offen
    s_add_u32 s71, s70, 795648
    buffer_load_dword v99, v5, s[64:67], s71 offen
    s_add_u32 s71, s70, 798720
    buffer_load_dword v100, v5, s[64:67], s71 offen
    s_add_u32 s71, s70, 801792
    buffer_load_dword v101, v5, s[64:67], s71 offen
    s_add_u32 s71, s70, 804864
    buffer_load_dword v102, v5, s[64:67], s71 offen
    s_add_u32 s71, s70, 807936
    buffer_load_dword v103, v5, s[64:67], s71 offen
    s_add_u32 s71, s70, 884736
    buffer_load_dword v104, v5, s[64:67], s71 offen
    s_add_u32 s71, s70, 887808
    buffer_load_dword v105, v5, s[64:67], s71 offen
    s_add_u32 s71, s70, 890880
    buffer_load_dword v106, v5, s[64:67], s71 offen
    s_add_u32 s71, s70, 893952
    buffer_load_dword v107, v5, s[64:67], s71 offen
    s_add_u32 s71, s70, 897024
    buffer_load_dword v108, v5, s[64:67], s71 offen
    s_add_u32 s71, s70, 900096
    buffer_load_dword v109, v5, s[64:67], s71 offen
    s_add_u32 s71, s70, 903168
    buffer_load_dword v110, v5, s[64:67], s71 offen
    s_add_u32 s71, s70, 906240
    buffer_load_dword v111, v5, s[64:67], s71 offen
    s_add_u32 s71, s70, 983040
    buffer_load_dword v112, v5, s[64:67], s71 offen
    s_add_u32 s71, s70, 986112
    buffer_load_dword v113, v5, s[64:67], s71 offen
    s_add_u32 s71, s70, 989184
    buffer_load_dword v114, v5, s[64:67], s71 offen
    s_add_u32 s71, s70, 992256
    buffer_load_dword v115, v5, s[64:67], s71 offen
    s_add_u32 s71, s70, 995328
    buffer_load_dword v116, v5, s[64:67], s71 offen
    s_add_u32 s71, s70, 998400
    buffer_load_dword v117, v5, s[64:67], s71 offen
    s_add_u32 s71, s70, 1001472
    buffer_load_dword v118, v5, s[64:67], s71 offen
    s_add_u32 s71, s70, 1004544
    buffer_load_dword v119, v5, s[64:67], s71 offen
    s_add_u32 s71, s70, 1081344
    buffer_load_dword v120, v5, s[64:67], s71 offen
    s_add_u32 s71, s70, 1084416
    buffer_load_dword v121, v5, s[64:67], s71 offen
    s_add_u32 s71, s70, 1087488
    buffer_load_dword v122, v5, s[64:67], s71 offen
    s_add_u32 s71, s70, 1090560
    buffer_load_dword v123, v5, s[64:67], s71 offen
    s_add_u32 s71, s70, 1093632
    buffer_load_dword v124, v5, s[64:67], s71 offen
    s_add_u32 s71, s70, 1096704
    buffer_load_dword v125, v5, s[64:67], s71 offen
    s_add_u32 s71, s70, 1099776
    buffer_load_dword v126, v5, s[64:67], s71 offen
    s_add_u32 s71, s70, 1102848
    buffer_load_dword v127, v5, s[64:67], s71 offen
    s_waitcnt vmcnt(63)
    v_perm_b32 v28, v33, v32, s72
    v_perm_b32 v29, v35, v34, s72
    v_perm_b32 v30, v37, v36, s72
    v_perm_b32 v31, v39, v38, s72
    v_accvgpr_write_b32 a0, v28
    v_accvgpr_write_b32 a1, v29
    v_accvgpr_write_b32 a2, v30
    v_accvgpr_write_b32 a3, v31
    v_perm_b32 v28, v33, v32, s73
    v_perm_b32 v29, v35, v34, s73
    v_perm_b32 v30, v37, v36, s73
    v_perm_b32 v31, v39, v38, s73
    v_accvgpr_write_b32 a80, v28
    v_accvgpr_write_b32 a81, v29
    v_accvgpr_write_b32 a82, v30
    v_accvgpr_write_b32 a83, v31
    v_perm_b32 v28, v41, v40, s72
    v_perm_b32 v29, v43, v42, s72
    v_perm_b32 v30, v45, v44, s72
    v_perm_b32 v31, v47, v46, s72
    v_accvgpr_write_b32 a4, v28
    v_accvgpr_write_b32 a5, v29
    v_accvgpr_write_b32 a6, v30
    v_accvgpr_write_b32 a7, v31
    v_perm_b32 v28, v41, v40, s73
    v_perm_b32 v29, v43, v42, s73
    v_perm_b32 v30, v45, v44, s73
    v_perm_b32 v31, v47, v46, s73
    v_accvgpr_write_b32 a84, v28
    v_accvgpr_write_b32 a85, v29
    v_accvgpr_write_b32 a86, v30
    v_accvgpr_write_b32 a87, v31
    v_perm_b32 v28, v49, v48, s72
    v_perm_b32 v29, v51, v50, s72
    v_perm_b32 v30, v53, v52, s72
    v_perm_b32 v31, v55, v54, s72
    v_accvgpr_write_b32 a8, v28
    v_accvgpr_write_b32 a9, v29
    v_accvgpr_write_b32 a10, v30
    v_accvgpr_write_b32 a11, v31
    v_perm_b32 v28, v49, v48, s73
    v_perm_b32 v29, v51, v50, s73
    v_perm_b32 v30, v53, v52, s73
    v_perm_b32 v31, v55, v54, s73
    v_accvgpr_write_b32 a88, v28
    v_accvgpr_write_b32 a89, v29
    v_accvgpr_write_b32 a90, v30
    v_accvgpr_write_b32 a91, v31
    v_perm_b32 v28, v57, v56, s72
    v_perm_b32 v29, v59, v58, s72
    v_perm_b32 v30, v61, v60, s72
    v_perm_b32 v31, v63, v62, s72
    v_accvgpr_write_b32 a12, v28
    v_accvgpr_write_b32 a13, v29
    v_accvgpr_write_b32 a14, v30
    v_accvgpr_write_b32 a15, v31
    v_perm_b32 v28, v57, v56, s73
    v_perm_b32 v29, v59, v58, s73
    v_perm_b32 v30, v61, v60, s73
    v_perm_b32 v31, v63, v62, s73
    v_accvgpr_write_b32 a92, v28
    v_accvgpr_write_b32 a93, v29
    v_accvgpr_write_b32 a94, v30
    v_accvgpr_write_b32 a95, v31
    s_add_u32 s71, s70, 1179648
    buffer_load_dword v32, v5, s[64:67], s71 offen
    s_add_u32 s71, s70, 1182720
    buffer_load_dword v33, v5, s[64:67], s71 offen
    s_add_u32 s71, s70, 1185792
    buffer_load_dword v34, v5, s[64:67], s71 offen
    s_add_u32 s71, s70, 1188864
    buffer_load_dword v35, v5, s[64:67], s71 offen
    s_add_u32 s71, s70, 1191936
    buffer_load_dword v36, v5, s[64:67], s71 offen
    s_add_u32 s71, s70, 1195008
    buffer_load_dword v37, v5, s[64:67], s71 offen
    s_add_u32 s71, s70, 1198080
    buffer_load_dword v38, v5, s[64:67], s71 offen
    s_add_u32 s71, s70, 1201152
    buffer_load_dword v39, v5, s[64:67], s71 offen
    s_add_u32 s71, s70, 1277952
    buffer_load_dword v40, v5, s[64:67], s71 offen
    s_add_u32 s71, s70, 1281024
    buffer_load_dword v41, v5, s[64:67], s71 offen
    s_add_u32 s71, s70, 1284096
    buffer_load_dword v42, v5, s[64:67], s71 offen
    s_add_u32 s71, s70, 1287168
    buffer_load_dword v43, v5, s[64:67], s71 offen
    s_add_u32 s71, s70, 1290240
    buffer_load_dword v44, v5, s[64:67], s71 offen
    s_add_u32 s71, s70, 1293312
    buffer_load_dword v45, v5, s[64:67], s71 offen
    s_add_u32 s71, s70, 1296384
    buffer_load_dword v46, v5, s[64:67], s71 offen
    s_add_u32 s71, s70, 1299456
    buffer_load_dword v47, v5, s[64:67], s71 offen
    s_add_u32 s71, s70, 1376256
    buffer_load_dword v48, v5, s[64:67], s71 offen
    s_add_u32 s71, s70, 1379328
    buffer_load_dword v49, v5, s[64:67], s71 offen
    s_add_u32 s71, s70, 1382400
    buffer_load_dword v50, v5, s[64:67], s71 offen
    s_add_u32 s71, s70, 1385472
    buffer_load_dword v51, v5, s[64:67], s71 offen
    s_add_u32 s71, s70, 1388544
    buffer_load_dword v52, v5, s[64:67], s71 offen
    s_add_u32 s71, s70, 1391616
    buffer_load_dword v53, v5, s[64:67], s71 offen
    s_add_u32 s71, s70, 1394688
    buffer_load_dword v54, v5, s[64:67], s71 offen
    s_add_u32 s71, s70, 1397760
    buffer_load_dword v55, v5, s[64:67], s71 offen
    s_add_u32 s71, s70, 1474560
    buffer_load_dword v56, v5, s[64:67], s71 offen
    s_add_u32 s71, s70, 1477632
    buffer_load_dword v57, v5, s[64:67], s71 offen
    s_add_u32 s71, s70, 1480704
    buffer_load_dword v58, v5, s[64:67], s71 offen
    s_add_u32 s71, s70, 1483776
    buffer_load_dword v59, v5, s[64:67], s71 offen
    s_add_u32 s71, s70, 1486848
    buffer_load_dword v60, v5, s[64:67], s71 offen
    s_add_u32 s71, s70, 1489920
    buffer_load_dword v61, v5, s[64:67], s71 offen
    s_add_u32 s71, s70, 1492992
    buffer_load_dword v62, v5, s[64:67], s71 offen
    s_add_u32 s71, s70, 1496064
    buffer_load_dword v63, v5, s[64:67], s71 offen
    s_waitcnt vmcnt(63)
    v_perm_b32 v28, v65, v64, s72
    v_perm_b32 v29, v67, v66, s72
    v_perm_b32 v30, v69, v68, s72
    v_perm_b32 v31, v71, v70, s72
    v_accvgpr_write_b32 a16, v28
    v_accvgpr_write_b32 a17, v29
    v_accvgpr_write_b32 a18, v30
    v_accvgpr_write_b32 a19, v31
    v_perm_b32 v28, v65, v64, s73
    v_perm_b32 v29, v67, v66, s73
    v_perm_b32 v30, v69, v68, s73
    v_perm_b32 v31, v71, v70, s73
    v_accvgpr_write_b32 a96, v28
    v_accvgpr_write_b32 a97, v29
    v_accvgpr_write_b32 a98, v30
    v_accvgpr_write_b32 a99, v31
    v_perm_b32 v28, v73, v72, s72
    v_perm_b32 v29, v75, v74, s72
    v_perm_b32 v30, v77, v76, s72
    v_perm_b32 v31, v79, v78, s72
    v_accvgpr_write_b32 a20, v28
    v_accvgpr_write_b32 a21, v29
    v_accvgpr_write_b32 a22, v30
    v_accvgpr_write_b32 a23, v31
    v_perm_b32 v28, v73, v72, s73
    v_perm_b32 v29, v75, v74, s73
    v_perm_b32 v30, v77, v76, s73
    v_perm_b32 v31, v79, v78, s73
    v_accvgpr_write_b32 a100, v28
    v_accvgpr_write_b32 a101, v29
    v_accvgpr_write_b32 a102, v30
    v_accvgpr_write_b32 a103, v31
    v_perm_b32 v28, v81, v80, s72
    v_perm_b32 v29, v83, v82, s72
    v_perm_b32 v30, v85, v84, s72
    v_perm_b32 v31, v87, v86, s72
    v_accvgpr_write_b32 a24, v28
    v_accvgpr_write_b32 a25, v29
    v_accvgpr_write_b32 a26, v30
    v_accvgpr_write_b32 a27, v31
    v_perm_b32 v28, v81, v80, s73
    v_perm_b32 v29, v83, v82, s73
    v_perm_b32 v30, v85, v84, s73
    v_perm_b32 v31, v87, v86, s73
    v_accvgpr_write_b32 a104, v28
    v_accvgpr_write_b32 a105, v29
    v_accvgpr_write_b32 a106, v30
    v_accvgpr_write_b32 a107, v31
    v_perm_b32 v28, v89, v88, s72
    v_perm_b32 v29, v91, v90, s72
    v_perm_b32 v30, v93, v92, s72
    v_perm_b32 v31, v95, v94, s72
    v_accvgpr_write_b32 a28, v28
    v_accvgpr_write_b32 a29, v29
    v_accvgpr_write_b32 a30, v30
    v_accvgpr_write_b32 a31, v31
    v_perm_b32 v28, v89, v88, s73
    v_perm_b32 v29, v91, v90, s73
    v_perm_b32 v30, v93, v92, s73
    v_perm_b32 v31, v95, v94, s73
    v_accvgpr_write_b32 a108, v28
    v_accvgpr_write_b32 a109, v29
    v_accvgpr_write_b32 a110, v30
    v_accvgpr_write_b32 a111, v31
    s_add_u32 s71, s70, 1572864
    buffer_load_dword v64, v5, s[64:67], s71 offen
    s_add_u32 s71, s70, 1575936
    buffer_load_dword v65, v5, s[64:67], s71 offen
    s_add_u32 s71, s70, 1579008
    buffer_load_dword v66, v5, s[64:67], s71 offen
    s_add_u32 s71, s70, 1582080
    buffer_load_dword v67, v5, s[64:67], s71 offen
    s_add_u32 s71, s70, 1585152
    buffer_load_dword v68, v5, s[64:67], s71 offen
    s_add_u32 s71, s70, 1588224
    buffer_load_dword v69, v5, s[64:67], s71 offen
    s_add_u32 s71, s70, 1591296
    buffer_load_dword v70, v5, s[64:67], s71 offen
    s_add_u32 s71, s70, 1594368
    buffer_load_dword v71, v5, s[64:67], s71 offen
    s_add_u32 s71, s70, 1671168
    buffer_load_dword v72, v5, s[64:67], s71 offen
    s_add_u32 s71, s70, 1674240
    buffer_load_dword v73, v5, s[64:67], s71 offen
    s_add_u32 s71, s70, 1677312
    buffer_load_dword v74, v5, s[64:67], s71 offen
    s_add_u32 s71, s70, 1680384
    buffer_load_dword v75, v5, s[64:67], s71 offen
    s_add_u32 s71, s70, 1683456
    buffer_load_dword v76, v5, s[64:67], s71 offen
    s_add_u32 s71, s70, 1686528
    buffer_load_dword v77, v5, s[64:67], s71 offen
    s_add_u32 s71, s70, 1689600
    buffer_load_dword v78, v5, s[64:67], s71 offen
    s_add_u32 s71, s70, 1692672
    buffer_load_dword v79, v5, s[64:67], s71 offen
    s_add_u32 s71, s70, 1769472
    buffer_load_dword v80, v5, s[64:67], s71 offen
    s_add_u32 s71, s70, 1772544
    buffer_load_dword v81, v5, s[64:67], s71 offen
    s_add_u32 s71, s70, 1775616
    buffer_load_dword v82, v5, s[64:67], s71 offen
    s_add_u32 s71, s70, 1778688
    buffer_load_dword v83, v5, s[64:67], s71 offen
    s_add_u32 s71, s70, 1781760
    buffer_load_dword v84, v5, s[64:67], s71 offen
    s_add_u32 s71, s70, 1784832
    buffer_load_dword v85, v5, s[64:67], s71 offen
    s_add_u32 s71, s70, 1787904
    buffer_load_dword v86, v5, s[64:67], s71 offen
    s_add_u32 s71, s70, 1790976
    buffer_load_dword v87, v5, s[64:67], s71 offen
    s_add_u32 s71, s70, 1867776
    buffer_load_dword v88, v5, s[64:67], s71 offen
    s_add_u32 s71, s70, 1870848
    buffer_load_dword v89, v5, s[64:67], s71 offen
    s_add_u32 s71, s70, 1873920
    buffer_load_dword v90, v5, s[64:67], s71 offen
    s_add_u32 s71, s70, 1876992
    buffer_load_dword v91, v5, s[64:67], s71 offen
    s_add_u32 s71, s70, 1880064
    buffer_load_dword v92, v5, s[64:67], s71 offen
    s_add_u32 s71, s70, 1883136
    buffer_load_dword v93, v5, s[64:67], s71 offen
    s_add_u32 s71, s70, 1886208
    buffer_load_dword v94, v5, s[64:67], s71 offen
    s_add_u32 s71, s70, 1889280
    buffer_load_dword v95, v5, s[64:67], s71 offen
    s_waitcnt vmcnt(63)
    v_perm_b32 v28, v97, v96, s72
    v_perm_b32 v29, v99, v98, s72
    v_perm_b32 v30, v101, v100, s72
    v_perm_b32 v31, v103, v102, s72
    v_accvgpr_write_b32 a32, v28
    v_accvgpr_write_b32 a33, v29
    v_accvgpr_write_b32 a34, v30
    v_accvgpr_write_b32 a35, v31
    v_perm_b32 v28, v97, v96, s73
    v_perm_b32 v29, v99, v98, s73
    v_perm_b32 v30, v101, v100, s73
    v_perm_b32 v31, v103, v102, s73
    v_accvgpr_write_b32 a112, v28
    v_accvgpr_write_b32 a113, v29
    v_accvgpr_write_b32 a114, v30
    v_accvgpr_write_b32 a115, v31
    v_perm_b32 v28, v105, v104, s72
    v_perm_b32 v29, v107, v106, s72
    v_perm_b32 v30, v109, v108, s72
    v_perm_b32 v31, v111, v110, s72
    v_accvgpr_write_b32 a36, v28
    v_accvgpr_write_b32 a37, v29
    v_accvgpr_write_b32 a38, v30
    v_accvgpr_write_b32 a39, v31
    v_perm_b32 v28, v105, v104, s73
    v_perm_b32 v29, v107, v106, s73
    v_perm_b32 v30, v109, v108, s73
    v_perm_b32 v31, v111, v110, s73
    v_accvgpr_write_b32 a116, v28
    v_accvgpr_write_b32 a117, v29
    v_accvgpr_write_b32 a118, v30
    v_accvgpr_write_b32 a119, v31
    v_perm_b32 v28, v113, v112, s72
    v_perm_b32 v29, v115, v114, s72
    v_perm_b32 v30, v117, v116, s72
    v_perm_b32 v31, v119, v118, s72
    v_accvgpr_write_b32 a40, v28
    v_accvgpr_write_b32 a41, v29
    v_accvgpr_write_b32 a42, v30
    v_accvgpr_write_b32 a43, v31
    v_perm_b32 v28, v113, v112, s73
    v_perm_b32 v29, v115, v114, s73
    v_perm_b32 v30, v117, v116, s73
    v_perm_b32 v31, v119, v118, s73
    v_accvgpr_write_b32 a120, v28
    v_accvgpr_write_b32 a121, v29
    v_accvgpr_write_b32 a122, v30
    v_accvgpr_write_b32 a123, v31
    v_perm_b32 v28, v121, v120, s72
    v_perm_b32 v29, v123, v122, s72
    v_perm_b32 v30, v125, v124, s72
    v_perm_b32 v31, v127, v126, s72
    v_accvgpr_write_b32 a44, v28
    v_accvgpr_write_b32 a45, v29
    v_accvgpr_write_b32 a46, v30
    v_accvgpr_write_b32 a47, v31
    v_perm_b32 v28, v121, v120, s73
    v_perm_b32 v29, v123, v122, s73
    v_perm_b32 v30, v125, v124, s73
    v_perm_b32 v31, v127, v126, s73
    v_accvgpr_write_b32 a124, v28
    v_accvgpr_write_b32 a125, v29
    v_accvgpr_write_b32 a126, v30
    v_accvgpr_write_b32 a127, v31
    s_waitcnt vmcnt(32)
    v_perm_b32 v28, v33, v32, s72
    v_perm_b32 v29, v35, v34, s72
    v_perm_b32 v30, v37, v36, s72
    v_perm_b32 v31, v39, v38, s72
    v_accvgpr_write_b32 a48, v28
    v_accvgpr_write_b32 a49, v29
    v_accvgpr_write_b32 a50, v30
    v_accvgpr_write_b32 a51, v31
    v_perm_b32 v28, v33, v32, s73
    v_perm_b32 v29, v35, v34, s73
    v_perm_b32 v30, v37, v36, s73
    v_perm_b32 v31, v39, v38, s73
    v_accvgpr_write_b32 a128, v28
    v_accvgpr_write_b32 a129, v29
    v_accvgpr_write_b32 a130, v30
    v_accvgpr_write_b32 a131, v31
    v_perm_b32 v28, v41, v40, s72
    v_perm_b32 v29, v43, v42, s72
    v_perm_b32 v30, v45, v44, s72
    v_perm_b32 v31, v47, v46, s72
    v_accvgpr_write_b32 a52, v28
    v_accvgpr_write_b32 a53, v29
    v_accvgpr_write_b32 a54, v30
    v_accvgpr_write_b32 a55, v31
    v_perm_b32 v28, v41, v40, s73
    v_perm_b32 v29, v43, v42, s73
    v_perm_b32 v30, v45, v44, s73
    v_perm_b32 v31, v47, v46, s73
    v_accvgpr_write_b32 a132, v28
    v_accvgpr_write_b32 a133, v29
    v_accvgpr_write_b32 a134, v30
    v_accvgpr_write_b32 a135, v31
    v_perm_b32 v28, v49, v48, s72
    v_perm_b32 v29, v51, v50, s72
    v_perm_b32 v30, v53, v52, s72
    v_perm_b32 v31, v55, v54, s72
    v_accvgpr_write_b32 a56, v28
    v_accvgpr_write_b32 a57, v29
    v_accvgpr_write_b32 a58, v30
    v_accvgpr_write_b32 a59, v31
    v_perm_b32 v28, v49, v48, s73
    v_perm_b32 v29, v51, v50, s73
    v_perm_b32 v30, v53, v52, s73
    v_perm_b32 v31, v55, v54, s73
    v_accvgpr_write_b32 a136, v28
    v_accvgpr_write_b32 a137, v29
    v_accvgpr_write_b32 a138, v30
    v_accvgpr_write_b32 a139, v31
    v_perm_b32 v28, v57, v56, s72
    v_perm_b32 v29, v59, v58, s72
    v_perm_b32 v30, v61, v60, s72
    v_perm_b32 v31, v63, v62, s72
    v_accvgpr_write_b32 a60, v28
    v_accvgpr_write_b32 a61, v29
    v_accvgpr_write_b32 a62, v30
    v_accvgpr_write_b32 a63, v31
    v_perm_b32 v28, v57, v56, s73
    v_perm_b32 v29, v59, v58, s73
    v_perm_b32 v30, v61, v60, s73
    v_perm_b32 v31, v63, v62, s73
    v_accvgpr_write_b32 a140, v28
    v_accvgpr_write_b32 a141, v29
    v_accvgpr_write_b32 a142, v30
    v_accvgpr_write_b32 a143, v31
    s_waitcnt vmcnt(0)
    v_perm_b32 v28, v65, v64, s72
    v_perm_b32 v29, v67, v66, s72
    v_perm_b32 v30, v69, v68, s72
    v_perm_b32 v31, v71, v70, s72
    v_accvgpr_write_b32 a64, v28
    v_accvgpr_write_b32 a65, v29
    v_accvgpr_write_b32 a66, v30
    v_accvgpr_write_b32 a67, v31
    v_perm_b32 v28, v65, v64, s73
    v_perm_b32 v29, v67, v66, s73
    v_perm_b32 v30, v69, v68, s73
    v_perm_b32 v31, v71, v70, s73
    v_accvgpr_write_b32 a144, v28
    v_accvgpr_write_b32 a145, v29
    v_accvgpr_write_b32 a146, v30
    v_accvgpr_write_b32 a147, v31
    v_perm_b32 v28, v73, v72, s72
    v_perm_b32 v29, v75, v74, s72
    v_perm_b32 v30, v77, v76, s72
    v_perm_b32 v31, v79, v78, s72
    v_accvgpr_write_b32 a68, v28
    v_accvgpr_write_b32 a69, v29
    v_accvgpr_write_b32 a70, v30
    v_accvgpr_write_b32 a71, v31
    v_perm_b32 v28, v73, v72, s73
    v_perm_b32 v29, v75, v74, s73
    v_perm_b32 v30, v77, v76, s73
    v_perm_b32 v31, v79, v78, s73
    v_accvgpr_write_b32 a148, v28
    v_accvgpr_write_b32 a149, v29
    v_accvgpr_write_b32 a150, v30
    v_accvgpr_write_b32 a151, v31
    v_perm_b32 v28, v81, v80, s72
    v_perm_b32 v29, v83, v82, s72
    v_perm_b32 v30, v85, v84, s72
    v_perm_b32 v31, v87, v86, s72
    v_accvgpr_write_b32 a72, v28
    v_accvgpr_write_b32 a73, v29
    v_accvgpr_write_b32 a74, v30
    v_accvgpr_write_b32 a75, v31
    v_perm_b32 v28, v81, v80, s73
    v_perm_b32 v29, v83, v82, s73
    v_perm_b32 v30, v85, v84, s73
    v_perm_b32 v31, v87, v86, s73
    v_accvgpr_write_b32 a152, v28
    v_accvgpr_write_b32 a153, v29
    v_accvgpr_write_b32 a154, v30
    v_accvgpr_write_b32 a155, v31
    v_perm_b32 v28, v89, v88, s72
    v_perm_b32 v29, v91, v90, s72
    v_perm_b32 v30, v93, v92, s72
    v_perm_b32 v31, v95, v94, s72
    v_accvgpr_write_b32 a76, v28
    v_accvgpr_write_b32 a77, v29
    v_accvgpr_write_b32 a78, v30
    v_accvgpr_write_b32 a79, v31
    v_perm_b32 v28, v89, v88, s73
    v_perm_b32 v29, v91, v90, s73
    v_perm_b32 v30, v93, v92, s73
    v_perm_b32 v31, v95, v94, s73
    v_accvgpr_write_b32 a156, v28
    v_accvgpr_write_b32 a157, v29
    v_accvgpr_write_b32 a158, v30
    v_accvgpr_write_b32 a159, v31
    s_add_u32 s71, s70, 0
    buffer_load_dword v32, v5, s[84:87], s71 offen
    s_add_u32 s71, s70, 3072
    buffer_load_dword v33, v5, s[84:87], s71 offen
    s_add_u32 s71, s70, 6144
    buffer_load_dword v34, v5, s[84:87], s71 offen
    s_add_u32 s71, s70, 9216
    buffer_load_dword v35, v5, s[84:87], s71 offen
    s_add_u32 s71, s70, 12288
    buffer_load_dword v36, v5, s[84:87], s71 offen
    s_add_u32 s71, s70, 15360
    buffer_load_dword v37, v5, s[84:87], s71 offen
    s_add_u32 s71, s70, 18432
    buffer_load_dword v38, v5, s[84:87], s71 offen
    s_add_u32 s71, s70, 21504
    buffer_load_dword v39, v5, s[84:87], s71 offen
    s_add_u32 s71, s70, 98304
    buffer_load_dword v40, v5, s[84:87], s71 offen
    s_add_u32 s71, s70, 101376
    buffer_load_dword v41, v5, s[84:87], s71 offen
    s_add_u32 s71, s70, 104448
    buffer_load_dword v42, v5, s[84:87], s71 offen
    s_add_u32 s71, s70, 107520
    buffer_load_dword v43, v5, s[84:87], s71 offen
    s_add_u32 s71, s70, 110592
    buffer_load_dword v44, v5, s[84:87], s71 offen
    s_add_u32 s71, s70, 113664
    buffer_load_dword v45, v5, s[84:87], s71 offen
    s_add_u32 s71, s70, 116736
    buffer_load_dword v46, v5, s[84:87], s71 offen
    s_add_u32 s71, s70, 119808
    buffer_load_dword v47, v5, s[84:87], s71 offen
    s_add_u32 s71, s70, 196608
    buffer_load_dword v48, v5, s[84:87], s71 offen
    s_add_u32 s71, s70, 199680
    buffer_load_dword v49, v5, s[84:87], s71 offen
    s_add_u32 s71, s70, 202752
    buffer_load_dword v50, v5, s[84:87], s71 offen
    s_add_u32 s71, s70, 205824
    buffer_load_dword v51, v5, s[84:87], s71 offen
    s_add_u32 s71, s70, 208896
    buffer_load_dword v52, v5, s[84:87], s71 offen
    s_add_u32 s71, s70, 211968
    buffer_load_dword v53, v5, s[84:87], s71 offen
    s_add_u32 s71, s70, 215040
    buffer_load_dword v54, v5, s[84:87], s71 offen
    s_add_u32 s71, s70, 218112
    buffer_load_dword v55, v5, s[84:87], s71 offen
    s_add_u32 s71, s70, 294912
    buffer_load_dword v56, v5, s[84:87], s71 offen
    s_add_u32 s71, s70, 297984
    buffer_load_dword v57, v5, s[84:87], s71 offen
    s_add_u32 s71, s70, 301056
    buffer_load_dword v58, v5, s[84:87], s71 offen
    s_add_u32 s71, s70, 304128
    buffer_load_dword v59, v5, s[84:87], s71 offen
    s_add_u32 s71, s70, 307200
    buffer_load_dword v60, v5, s[84:87], s71 offen
    s_add_u32 s71, s70, 310272
    buffer_load_dword v61, v5, s[84:87], s71 offen
    s_add_u32 s71, s70, 313344
    buffer_load_dword v62, v5, s[84:87], s71 offen
    s_add_u32 s71, s70, 316416
    buffer_load_dword v63, v5, s[84:87], s71 offen
    s_add_u32 s71, s70, 393216
    buffer_load_dword v64, v5, s[84:87], s71 offen
    s_add_u32 s71, s70, 396288
    buffer_load_dword v65, v5, s[84:87], s71 offen
    s_add_u32 s71, s70, 399360
    buffer_load_dword v66, v5, s[84:87], s71 offen
    s_add_u32 s71, s70, 402432
    buffer_load_dword v67, v5, s[84:87], s71 offen
    s_add_u32 s71, s70, 405504
    buffer_load_dword v68, v5, s[84:87], s71 offen
    s_add_u32 s71, s70, 408576
    buffer_load_dword v69, v5, s[84:87], s71 offen
    s_add_u32 s71, s70, 411648
    buffer_load_dword v70, v5, s[84:87], s71 offen
    s_add_u32 s71, s70, 414720
    buffer_load_dword v71, v5, s[84:87], s71 offen
    s_add_u32 s71, s70, 491520
    buffer_load_dword v72, v5, s[84:87], s71 offen
    s_add_u32 s71, s70, 494592
    buffer_load_dword v73, v5, s[84:87], s71 offen
    s_add_u32 s71, s70, 497664
    buffer_load_dword v74, v5, s[84:87], s71 offen
    s_add_u32 s71, s70, 500736
    buffer_load_dword v75, v5, s[84:87], s71 offen
    s_add_u32 s71, s70, 503808
    buffer_load_dword v76, v5, s[84:87], s71 offen
    s_add_u32 s71, s70, 506880
    buffer_load_dword v77, v5, s[84:87], s71 offen
    s_add_u32 s71, s70, 509952
    buffer_load_dword v78, v5, s[84:87], s71 offen
    s_add_u32 s71, s70, 513024
    buffer_load_dword v79, v5, s[84:87], s71 offen
    s_add_u32 s71, s70, 589824
    buffer_load_dword v80, v5, s[84:87], s71 offen
    s_add_u32 s71, s70, 592896
    buffer_load_dword v81, v5, s[84:87], s71 offen
    s_add_u32 s71, s70, 595968
    buffer_load_dword v82, v5, s[84:87], s71 offen
    s_add_u32 s71, s70, 599040
    buffer_load_dword v83, v5, s[84:87], s71 offen
    s_add_u32 s71, s70, 602112
    buffer_load_dword v84, v5, s[84:87], s71 offen
    s_add_u32 s71, s70, 605184
    buffer_load_dword v85, v5, s[84:87], s71 offen
    s_add_u32 s71, s70, 608256
    buffer_load_dword v86, v5, s[84:87], s71 offen
    s_add_u32 s71, s70, 611328
    buffer_load_dword v87, v5, s[84:87], s71 offen
    s_add_u32 s71, s70, 688128
    buffer_load_dword v88, v5, s[84:87], s71 offen
    s_add_u32 s71, s70, 691200
    buffer_load_dword v89, v5, s[84:87], s71 offen
    s_add_u32 s71, s70, 694272
    buffer_load_dword v90, v5, s[84:87], s71 offen
    s_add_u32 s71, s70, 697344
    buffer_load_dword v91, v5, s[84:87], s71 offen
    s_add_u32 s71, s70, 700416
    buffer_load_dword v92, v5, s[84:87], s71 offen
    s_add_u32 s71, s70, 703488
    buffer_load_dword v93, v5, s[84:87], s71 offen
    s_add_u32 s71, s70, 706560
    buffer_load_dword v94, v5, s[84:87], s71 offen
    s_add_u32 s71, s70, 709632
    buffer_load_dword v95, v5, s[84:87], s71 offen
    s_add_u32 s71, s70, 786432
    buffer_load_dword v96, v5, s[84:87], s71 offen
    s_add_u32 s71, s70, 789504
    buffer_load_dword v97, v5, s[84:87], s71 offen
    s_add_u32 s71, s70, 792576
    buffer_load_dword v98, v5, s[84:87], s71 offen
    s_add_u32 s71, s70, 795648
    buffer_load_dword v99, v5, s[84:87], s71 offen
    s_add_u32 s71, s70, 798720
    buffer_load_dword v100, v5, s[84:87], s71 offen
    s_add_u32 s71, s70, 801792
    buffer_load_dword v101, v5, s[84:87], s71 offen
    s_add_u32 s71, s70, 804864
    buffer_load_dword v102, v5, s[84:87], s71 offen
    s_add_u32 s71, s70, 807936
    buffer_load_dword v103, v5, s[84:87], s71 offen
    s_add_u32 s71, s70, 884736
    buffer_load_dword v104, v5, s[84:87], s71 offen
    s_add_u32 s71, s70, 887808
    buffer_load_dword v105, v5, s[84:87], s71 offen
    s_add_u32 s71, s70, 890880
    buffer_load_dword v106, v5, s[84:87], s71 offen
    s_add_u32 s71, s70, 893952
    buffer_load_dword v107, v5, s[84:87], s71 offen
    s_add_u32 s71, s70, 897024
    buffer_load_dword v108, v5, s[84:87], s71 offen
    s_add_u32 s71, s70, 900096
    buffer_load_dword v109, v5, s[84:87], s71 offen
    s_add_u32 s71, s70, 903168
    buffer_load_dword v110, v5, s[84:87], s71 offen
    s_add_u32 s71, s70, 906240
    buffer_load_dword v111, v5, s[84:87], s71 offen
    s_add_u32 s71, s70, 983040
    buffer_load_dword v112, v5, s[84:87], s71 offen
    s_add_u32 s71, s70, 986112
    buffer_load_dword v113, v5, s[84:87], s71 offen
    s_add_u32 s71, s70, 989184
    buffer_load_dword v114, v5, s[84:87], s71 offen
    s_add_u32 s71, s70, 992256
    buffer_load_dword v115, v5, s[84:87], s71 offen
    s_add_u32 s71, s70, 995328
    buffer_load_dword v116, v5, s[84:87], s71 offen
    s_add_u32 s71, s70, 998400
    buffer_load_dword v117, v5, s[84:87], s71 offen
    s_add_u32 s71, s70, 1001472
    buffer_load_dword v118, v5, s[84:87], s71 offen
    s_add_u32 s71, s70, 1004544
    buffer_load_dword v119, v5, s[84:87], s71 offen
    s_add_u32 s71, s70, 1081344
    buffer_load_dword v120, v5, s[84:87], s71 offen
    s_add_u32 s71, s70, 1084416
    buffer_load_dword v121, v5, s[84:87], s71 offen
    s_add_u32 s71, s70, 1087488
    buffer_load_dword v122, v5, s[84:87], s71 offen
    s_add_u32 s71, s70, 1090560
    buffer_load_dword v123, v5, s[84:87], s71 offen
    s_add_u32 s71, s70, 1093632
    buffer_load_dword v124, v5, s[84:87], s71 offen
    s_add_u32 s71, s70, 1096704
    buffer_load_dword v125, v5, s[84:87], s71 offen
    s_add_u32 s71, s70, 1099776
    buffer_load_dword v126, v5, s[84:87], s71 offen
    s_add_u32 s71, s70, 1102848
    buffer_load_dword v127, v5, s[84:87], s71 offen
    s_waitcnt vmcnt(63)
    v_perm_b32 v28, v33, v32, s72
    v_perm_b32 v29, v35, v34, s72
    v_perm_b32 v30, v37, v36, s72
    v_perm_b32 v31, v39, v38, s72
    v_accvgpr_write_b32 a160, v28
    v_accvgpr_write_b32 a161, v29
    v_accvgpr_write_b32 a162, v30
    v_accvgpr_write_b32 a163, v31
    v_perm_b32 v28, v33, v32, s73
    v_perm_b32 v29, v35, v34, s73
    v_perm_b32 v30, v37, v36, s73
    v_perm_b32 v31, v39, v38, s73
    v_accvgpr_write_b32 a240, v28
    v_accvgpr_write_b32 a241, v29
    v_accvgpr_write_b32 a242, v30
    v_accvgpr_write_b32 a243, v31
    v_perm_b32 v28, v41, v40, s72
    v_perm_b32 v29, v43, v42, s72
    v_perm_b32 v30, v45, v44, s72
    v_perm_b32 v31, v47, v46, s72
    v_accvgpr_write_b32 a164, v28
    v_accvgpr_write_b32 a165, v29
    v_accvgpr_write_b32 a166, v30
    v_accvgpr_write_b32 a167, v31
    v_perm_b32 v28, v41, v40, s73
    v_perm_b32 v29, v43, v42, s73
    v_perm_b32 v30, v45, v44, s73
    v_perm_b32 v31, v47, v46, s73
    v_accvgpr_write_b32 a244, v28
    v_accvgpr_write_b32 a245, v29
    v_accvgpr_write_b32 a246, v30
    v_accvgpr_write_b32 a247, v31
    v_perm_b32 v28, v49, v48, s72
    v_perm_b32 v29, v51, v50, s72
    v_perm_b32 v30, v53, v52, s72
    v_perm_b32 v31, v55, v54, s72
    v_accvgpr_write_b32 a168, v28
    v_accvgpr_write_b32 a169, v29
    v_accvgpr_write_b32 a170, v30
    v_accvgpr_write_b32 a171, v31
    v_perm_b32 v28, v49, v48, s73
    v_perm_b32 v29, v51, v50, s73
    v_perm_b32 v30, v53, v52, s73
    v_perm_b32 v31, v55, v54, s73
    v_accvgpr_write_b32 a248, v28
    v_accvgpr_write_b32 a249, v29
    v_accvgpr_write_b32 a250, v30
    v_accvgpr_write_b32 a251, v31
    v_perm_b32 v28, v57, v56, s72
    v_perm_b32 v29, v59, v58, s72
    v_perm_b32 v30, v61, v60, s72
    v_perm_b32 v31, v63, v62, s72
    v_accvgpr_write_b32 a172, v28
    v_accvgpr_write_b32 a173, v29
    v_accvgpr_write_b32 a174, v30
    v_accvgpr_write_b32 a175, v31
    v_perm_b32 v28, v57, v56, s73
    v_perm_b32 v29, v59, v58, s73
    v_perm_b32 v30, v61, v60, s73
    v_perm_b32 v31, v63, v62, s73
    v_accvgpr_write_b32 a252, v28
    v_accvgpr_write_b32 a253, v29
    v_accvgpr_write_b32 a254, v30
    v_accvgpr_write_b32 a255, v31
    s_add_u32 s71, s70, 1179648
    buffer_load_dword v32, v5, s[84:87], s71 offen
    s_add_u32 s71, s70, 1182720
    buffer_load_dword v33, v5, s[84:87], s71 offen
    s_add_u32 s71, s70, 1185792
    buffer_load_dword v34, v5, s[84:87], s71 offen
    s_add_u32 s71, s70, 1188864
    buffer_load_dword v35, v5, s[84:87], s71 offen
    s_add_u32 s71, s70, 1191936
    buffer_load_dword v36, v5, s[84:87], s71 offen
    s_add_u32 s71, s70, 1195008
    buffer_load_dword v37, v5, s[84:87], s71 offen
    s_add_u32 s71, s70, 1198080
    buffer_load_dword v38, v5, s[84:87], s71 offen
    s_add_u32 s71, s70, 1201152
    buffer_load_dword v39, v5, s[84:87], s71 offen
    s_add_u32 s71, s70, 1277952
    buffer_load_dword v40, v5, s[84:87], s71 offen
    s_add_u32 s71, s70, 1281024
    buffer_load_dword v41, v5, s[84:87], s71 offen
    s_add_u32 s71, s70, 1284096
    buffer_load_dword v42, v5, s[84:87], s71 offen
    s_add_u32 s71, s70, 1287168
    buffer_load_dword v43, v5, s[84:87], s71 offen
    s_add_u32 s71, s70, 1290240
    buffer_load_dword v44, v5, s[84:87], s71 offen
    s_add_u32 s71, s70, 1293312
    buffer_load_dword v45, v5, s[84:87], s71 offen
    s_add_u32 s71, s70, 1296384
    buffer_load_dword v46, v5, s[84:87], s71 offen
    s_add_u32 s71, s70, 1299456
    buffer_load_dword v47, v5, s[84:87], s71 offen
    s_add_u32 s71, s70, 1376256
    buffer_load_dword v48, v5, s[84:87], s71 offen
    s_add_u32 s71, s70, 1379328
    buffer_load_dword v49, v5, s[84:87], s71 offen
    s_add_u32 s71, s70, 1382400
    buffer_load_dword v50, v5, s[84:87], s71 offen
    s_add_u32 s71, s70, 1385472
    buffer_load_dword v51, v5, s[84:87], s71 offen
    s_add_u32 s71, s70, 1388544
    buffer_load_dword v52, v5, s[84:87], s71 offen
    s_add_u32 s71, s70, 1391616
    buffer_load_dword v53, v5, s[84:87], s71 offen
    s_add_u32 s71, s70, 1394688
    buffer_load_dword v54, v5, s[84:87], s71 offen
    s_add_u32 s71, s70, 1397760
    buffer_load_dword v55, v5, s[84:87], s71 offen
    s_add_u32 s71, s70, 1474560
    buffer_load_dword v56, v5, s[84:87], s71 offen
    s_add_u32 s71, s70, 1477632
    buffer_load_dword v57, v5, s[84:87], s71 offen
    s_add_u32 s71, s70, 1480704
    buffer_load_dword v58, v5, s[84:87], s71 offen
    s_add_u32 s71, s70, 1483776
    buffer_load_dword v59, v5, s[84:87], s71 offen
    s_add_u32 s71, s70, 1486848
    buffer_load_dword v60, v5, s[84:87], s71 offen
    s_add_u32 s71, s70, 1489920
    buffer_load_dword v61, v5, s[84:87], s71 offen
    s_add_u32 s71, s70, 1492992
    buffer_load_dword v62, v5, s[84:87], s71 offen
    s_add_u32 s71, s70, 1496064
    buffer_load_dword v63, v5, s[84:87], s71 offen
    s_waitcnt vmcnt(63)
    v_perm_b32 v28, v65, v64, s72
    v_perm_b32 v29, v67, v66, s72
    v_perm_b32 v30, v69, v68, s72
    v_perm_b32 v31, v71, v70, s72
    v_accvgpr_write_b32 a176, v28
    v_accvgpr_write_b32 a177, v29
    v_accvgpr_write_b32 a178, v30
    v_accvgpr_write_b32 a179, v31
    v_perm_b32 v192, v65, v64, s73
    v_perm_b32 v193, v67, v66, s73
    v_perm_b32 v194, v69, v68, s73
    v_perm_b32 v195, v71, v70, s73
    v_perm_b32 v28, v73, v72, s72
    v_perm_b32 v29, v75, v74, s72
    v_perm_b32 v30, v77, v76, s72
    v_perm_b32 v31, v79, v78, s72
    v_accvgpr_write_b32 a180, v28
    v_accvgpr_write_b32 a181, v29
    v_accvgpr_write_b32 a182, v30
    v_accvgpr_write_b32 a183, v31
    v_perm_b32 v196, v73, v72, s73
    v_perm_b32 v197, v75, v74, s73
    v_perm_b32 v198, v77, v76, s73
    v_perm_b32 v199, v79, v78, s73
    v_perm_b32 v28, v81, v80, s72
    v_perm_b32 v29, v83, v82, s72
    v_perm_b32 v30, v85, v84, s72
    v_perm_b32 v31, v87, v86, s72
    v_accvgpr_write_b32 a184, v28
    v_accvgpr_write_b32 a185, v29
    v_accvgpr_write_b32 a186, v30
    v_accvgpr_write_b32 a187, v31
    v_perm_b32 v200, v81, v80, s73
    v_perm_b32 v201, v83, v82, s73
    v_perm_b32 v202, v85, v84, s73
    v_perm_b32 v203, v87, v86, s73
    v_perm_b32 v28, v89, v88, s72
    v_perm_b32 v29, v91, v90, s72
    v_perm_b32 v30, v93, v92, s72
    v_perm_b32 v31, v95, v94, s72
    v_accvgpr_write_b32 a188, v28
    v_accvgpr_write_b32 a189, v29
    v_accvgpr_write_b32 a190, v30
    v_accvgpr_write_b32 a191, v31
    v_perm_b32 v204, v89, v88, s73
    v_perm_b32 v205, v91, v90, s73
    v_perm_b32 v206, v93, v92, s73
    v_perm_b32 v207, v95, v94, s73
    s_add_u32 s71, s70, 1572864
    buffer_load_dword v64, v5, s[84:87], s71 offen
    s_add_u32 s71, s70, 1575936
    buffer_load_dword v65, v5, s[84:87], s71 offen
    s_add_u32 s71, s70, 1579008
    buffer_load_dword v66, v5, s[84:87], s71 offen
    s_add_u32 s71, s70, 1582080
    buffer_load_dword v67, v5, s[84:87], s71 offen
    s_add_u32 s71, s70, 1585152
    buffer_load_dword v68, v5, s[84:87], s71 offen
    s_add_u32 s71, s70, 1588224
    buffer_load_dword v69, v5, s[84:87], s71 offen
    s_add_u32 s71, s70, 1591296
    buffer_load_dword v70, v5, s[84:87], s71 offen
    s_add_u32 s71, s70, 1594368
    buffer_load_dword v71, v5, s[84:87], s71 offen
    s_add_u32 s71, s70, 1671168
    buffer_load_dword v72, v5, s[84:87], s71 offen
    s_add_u32 s71, s70, 1674240
    buffer_load_dword v73, v5, s[84:87], s71 offen
    s_add_u32 s71, s70, 1677312
    buffer_load_dword v74, v5, s[84:87], s71 offen
    s_add_u32 s71, s70, 1680384
    buffer_load_dword v75, v5, s[84:87], s71 offen
    s_add_u32 s71, s70, 1683456
    buffer_load_dword v76, v5, s[84:87], s71 offen
    s_add_u32 s71, s70, 1686528
    buffer_load_dword v77, v5, s[84:87], s71 offen
    s_add_u32 s71, s70, 1689600
    buffer_load_dword v78, v5, s[84:87], s71 offen
    s_add_u32 s71, s70, 1692672
    buffer_load_dword v79, v5, s[84:87], s71 offen
    s_add_u32 s71, s70, 1769472
    buffer_load_dword v80, v5, s[84:87], s71 offen
    s_add_u32 s71, s70, 1772544
    buffer_load_dword v81, v5, s[84:87], s71 offen
    s_add_u32 s71, s70, 1775616
    buffer_load_dword v82, v5, s[84:87], s71 offen
    s_add_u32 s71, s70, 1778688
    buffer_load_dword v83, v5, s[84:87], s71 offen
    s_add_u32 s71, s70, 1781760
    buffer_load_dword v84, v5, s[84:87], s71 offen
    s_add_u32 s71, s70, 1784832
    buffer_load_dword v85, v5, s[84:87], s71 offen
    s_add_u32 s71, s70, 1787904
    buffer_load_dword v86, v5, s[84:87], s71 offen
    s_add_u32 s71, s70, 1790976
    buffer_load_dword v87, v5, s[84:87], s71 offen
    s_add_u32 s71, s70, 1867776
    buffer_load_dword v88, v5, s[84:87], s71 offen
    s_add_u32 s71, s70, 1870848
    buffer_load_dword v89, v5, s[84:87], s71 offen
    s_add_u32 s71, s70, 1873920
    buffer_load_dword v90, v5, s[84:87], s71 offen
    s_add_u32 s71, s70, 1876992
    buffer_load_dword v91, v5, s[84:87], s71 offen
    s_add_u32 s71, s70, 1880064
    buffer_load_dword v92, v5, s[84:87], s71 offen
    s_add_u32 s71, s70, 1883136
    buffer_load_dword v93, v5, s[84:87], s71 offen
    s_add_u32 s71, s70, 1886208
    buffer_load_dword v94, v5, s[84:87], s71 offen
    s_add_u32 s71, s70, 1889280
    buffer_load_dword v95, v5, s[84:87], s71 offen
    s_waitcnt vmcnt(63)
    v_perm_b32 v28, v97, v96, s72
    v_perm_b32 v29, v99, v98, s72
    v_perm_b32 v30, v101, v100, s72
    v_perm_b32 v31, v103, v102, s72
    v_accvgpr_write_b32 a192, v28
    v_accvgpr_write_b32 a193, v29
    v_accvgpr_write_b32 a194, v30
    v_accvgpr_write_b32 a195, v31
    v_perm_b32 v208, v97, v96, s73
    v_perm_b32 v209, v99, v98, s73
    v_perm_b32 v210, v101, v100, s73
    v_perm_b32 v211, v103, v102, s73
    v_perm_b32 v28, v105, v104, s72
    v_perm_b32 v29, v107, v106, s72
    v_perm_b32 v30, v109, v108, s72
    v_perm_b32 v31, v111, v110, s72
    v_accvgpr_write_b32 a196, v28
    v_accvgpr_write_b32 a197, v29
    v_accvgpr_write_b32 a198, v30
    v_accvgpr_write_b32 a199, v31
    v_perm_b32 v212, v105, v104, s73
    v_perm_b32 v213, v107, v106, s73
    v_perm_b32 v214, v109, v108, s73
    v_perm_b32 v215, v111, v110, s73
    v_perm_b32 v28, v113, v112, s72
    v_perm_b32 v29, v115, v114, s72
    v_perm_b32 v30, v117, v116, s72
    v_perm_b32 v31, v119, v118, s72
    v_accvgpr_write_b32 a200, v28
    v_accvgpr_write_b32 a201, v29
    v_accvgpr_write_b32 a202, v30
    v_accvgpr_write_b32 a203, v31
    v_perm_b32 v216, v113, v112, s73
    v_perm_b32 v217, v115, v114, s73
    v_perm_b32 v218, v117, v116, s73
    v_perm_b32 v219, v119, v118, s73
    v_perm_b32 v28, v121, v120, s72
    v_perm_b32 v29, v123, v122, s72
    v_perm_b32 v30, v125, v124, s72
    v_perm_b32 v31, v127, v126, s72
    v_accvgpr_write_b32 a204, v28
    v_accvgpr_write_b32 a205, v29
    v_accvgpr_write_b32 a206, v30
    v_accvgpr_write_b32 a207, v31
    v_perm_b32 v220, v121, v120, s73
    v_perm_b32 v221, v123, v122, s73
    v_perm_b32 v222, v125, v124, s73
    v_perm_b32 v223, v127, v126, s73
    s_waitcnt vmcnt(32)
    v_perm_b32 v28, v33, v32, s72
    v_perm_b32 v29, v35, v34, s72
    v_perm_b32 v30, v37, v36, s72
    v_perm_b32 v31, v39, v38, s72
    v_accvgpr_write_b32 a208, v28
    v_accvgpr_write_b32 a209, v29
    v_accvgpr_write_b32 a210, v30
    v_accvgpr_write_b32 a211, v31
    v_perm_b32 v224, v33, v32, s73
    v_perm_b32 v225, v35, v34, s73
    v_perm_b32 v226, v37, v36, s73
    v_perm_b32 v227, v39, v38, s73
    v_perm_b32 v28, v41, v40, s72
    v_perm_b32 v29, v43, v42, s72
    v_perm_b32 v30, v45, v44, s72
    v_perm_b32 v31, v47, v46, s72
    v_accvgpr_write_b32 a212, v28
    v_accvgpr_write_b32 a213, v29
    v_accvgpr_write_b32 a214, v30
    v_accvgpr_write_b32 a215, v31
    v_perm_b32 v228, v41, v40, s73
    v_perm_b32 v229, v43, v42, s73
    v_perm_b32 v230, v45, v44, s73
    v_perm_b32 v231, v47, v46, s73
    v_perm_b32 v28, v49, v48, s72
    v_perm_b32 v29, v51, v50, s72
    v_perm_b32 v30, v53, v52, s72
    v_perm_b32 v31, v55, v54, s72
    v_accvgpr_write_b32 a216, v28
    v_accvgpr_write_b32 a217, v29
    v_accvgpr_write_b32 a218, v30
    v_accvgpr_write_b32 a219, v31
    v_perm_b32 v232, v49, v48, s73
    v_perm_b32 v233, v51, v50, s73
    v_perm_b32 v234, v53, v52, s73
    v_perm_b32 v235, v55, v54, s73
    v_perm_b32 v28, v57, v56, s72
    v_perm_b32 v29, v59, v58, s72
    v_perm_b32 v30, v61, v60, s72
    v_perm_b32 v31, v63, v62, s72
    v_accvgpr_write_b32 a220, v28
    v_accvgpr_write_b32 a221, v29
    v_accvgpr_write_b32 a222, v30
    v_accvgpr_write_b32 a223, v31
    v_perm_b32 v236, v57, v56, s73
    v_perm_b32 v237, v59, v58, s73
    v_perm_b32 v238, v61, v60, s73
    v_perm_b32 v239, v63, v62, s73
    s_waitcnt vmcnt(0)
    v_perm_b32 v28, v65, v64, s72
    v_perm_b32 v29, v67, v66, s72
    v_perm_b32 v30, v69, v68, s72
    v_perm_b32 v31, v71, v70, s72
    v_accvgpr_write_b32 a224, v28
    v_accvgpr_write_b32 a225, v29
    v_accvgpr_write_b32 a226, v30
    v_accvgpr_write_b32 a227, v31
    v_perm_b32 v240, v65, v64, s73
    v_perm_b32 v241, v67, v66, s73
    v_perm_b32 v242, v69, v68, s73
    v_perm_b32 v243, v71, v70, s73
    v_perm_b32 v28, v73, v72, s72
    v_perm_b32 v29, v75, v74, s72
    v_perm_b32 v30, v77, v76, s72
    v_perm_b32 v31, v79, v78, s72
    v_accvgpr_write_b32 a228, v28
    v_accvgpr_write_b32 a229, v29
    v_accvgpr_write_b32 a230, v30
    v_accvgpr_write_b32 a231, v31
    v_perm_b32 v244, v73, v72, s73
    v_perm_b32 v245, v75, v74, s73
    v_perm_b32 v246, v77, v76, s73
    v_perm_b32 v247, v79, v78, s73
    v_perm_b32 v28, v81, v80, s72
    v_perm_b32 v29, v83, v82, s72
    v_perm_b32 v30, v85, v84, s72
    v_perm_b32 v31, v87, v86, s72
    v_accvgpr_write_b32 a232, v28
    v_accvgpr_write_b32 a233, v29
    v_accvgpr_write_b32 a234, v30
    v_accvgpr_write_b32 a235, v31
    v_perm_b32 v248, v81, v80, s73
    v_perm_b32 v249, v83, v82, s73
    v_perm_b32 v250, v85, v84, s73
    v_perm_b32 v251, v87, v86, s73
    v_perm_b32 v28, v89, v88, s72
    v_perm_b32 v29, v91, v90, s72
    v_perm_b32 v30, v93, v92, s72
    v_perm_b32 v31, v95, v94, s72
    v_accvgpr_write_b32 a236, v28
    v_accvgpr_write_b32 a237, v29
    v_accvgpr_write_b32 a238, v30
    v_accvgpr_write_b32 a239, v31
    v_perm_b32 v252, v89, v88, s73
    v_perm_b32 v253, v91, v90, s73
    v_perm_b32 v254, v93, v92, s73
    v_perm_b32 v255, v95, v94, s73
    v_mov_b32 v21, v20
    s_mul_i32 s20, s15, 40960
    s_add_u32 s20, s20, 2637824
    v_lshrrev_b32 v23, 2, v3
    v_lshlrev_b32 v23, 8, v23
    v_lshl_add_u32 v23, v4, 6, v23
    v_and_b32 v24, 3, v3
    v_lshl_add_u32 v23, v24, 2, v23
    s_lshr_b32 s21, s19, 5
    s_lshl_b32 s21, s21, 10
    s_add_u32 s21, s21, 197160960
    s_add_u32 s17, s18, 256
    v_mov_b32 v25, 0
    s_lshl_b32 s3, s74, 12
    s_add_u32 s3, s3, 81920
    v_add_u32 v27, s3, v23
    v_add_u32 v28, s3, v20
    v_mov_b32 v101, 192
    s_mov_b32 s69, 0
mega_kernel_cw153:
    buffer_load_dword v100, v101, s[88:91], 0 offen sc1
    s_add_u32 s69, s69, 1
    s_cmp_ge_u32 s69, 1048576
    s_cbranch_scc1 mega_kernel_cwo154
    s_waitcnt vmcnt(0)
    v_cmp_gt_u32 vcc, 256, v100
    s_cbranch_vccz mega_kernel_cwo154
    s_sleep 8
    s_branch mega_kernel_cw153
mega_kernel_cwo154:
    s_mul_i32 s79, s74, 10240
    s_add_u32 s76, s20, s79
    s_mov_b32 s77, s79
    s_mov_b32 s75, 0
mega_kernel_loop155:
    s_lshl_b32 s3, s75, 1
    s_add_u32 s3, s3, s15
    s_lshl_b32 s3, s3, 2
    s_add_u32 s3, s3, 204501760
    s_mov_b32 s69, 0
mega_kernel_upw156:
    buffer_load_dword v26, v25, s[60:63], s3 offen sc1
    s_add_u32 s69, s69, 1
    s_cmp_ge_u32 s69, 1048576
    s_cbranch_scc1 mega_kernel_upok157
    s_waitcnt vmcnt(0)
    v_cmp_eq_u32 vcc, 0, v26
    s_cbranch_vccz mega_kernel_upok157
    s_sleep 16
    s_branch mega_kernel_upw156
mega_kernel_upok157:
    s_add_u32 m0, s77, 0
    s_add_u32 s71, s76, 0
    buffer_load_dwordx4 v20, s[60:63], s71 offen lds
    s_add_u32 m0, s77, 1024
    s_add_u32 s71, s76, 1024
    buffer_load_dwordx4 v20, s[60:63], s71 offen lds
    s_add_u32 m0, s77, 2048
    s_add_u32 s71, s76, 2048
    buffer_load_dwordx4 v20, s[60:63], s71 offen lds
    s_add_u32 m0, s77, 3072
    s_add_u32 s71, s76, 3072
    buffer_load_dwordx4 v20, s[60:63], s71 offen lds
    s_add_u32 m0, s77, 4096
    s_add_u32 s71, s76, 4096
    buffer_load_dwordx4 v20, s[60:63], s71 offen lds
    s_add_u32 m0, s77, 5120
    s_add_u32 s71, s76, 5120
    buffer_load_dwordx4 v20, s[60:63], s71 offen lds
    s_add_u32 m0, s77, 6144
    s_add_u32 s71, s76, 6144
    buffer_load_dwordx4 v20, s[60:63], s71 offen lds
    s_add_u32 m0, s77, 7168
    s_add_u32 s71, s76, 7168
    buffer_load_dwordx4 v20, s[60:63], s71 offen lds
    s_add_u32 m0, s77, 8192
    s_add_u32 s71, s76, 8192
    buffer_load_dwordx4 v20, s[60:63], s71 offen lds
    s_add_u32 m0, s77, 9216
    s_add_u32 s71, s76, 9216
    buffer_load_dwordx4 v20, s[60:63], s71 offen lds
    s_add_u32 s76, s76, 81920
    s_waitcnt vmcnt(0)
    s_barrier
    ds_read_b128 v[64:67], v21 offset:0
    ds_read_b128 v[68:71], v21 offset:20480
    ds_read_b128 v[72:75], v21 offset:1024
    ds_read_b128 v[76:79], v21 offset:21504
    s_waitcnt lgkmcnt(3)
    v_mfma_f32_16x16x32_bf16 v[32:35], v[64:67], a[0:3], 0
    v_mfma_f32_16x16x32_bf16 v[36:39], v[64:67], a[80:83], 0
    v_mfma_f32_16x16x32_bf16 v[40:43], v[64:67], a[160:163], 0
    v_mfma_f32_16x16x32_bf16 v[44:47], v[64:67], a[240:243], 0
    ds_read_b128 v[64:67], v21 offset:2048
    s_waitcnt lgkmcnt(3)
    v_mfma_f32_16x16x32_bf16 v[48:51], v[68:71], a[0:3], 0
    v_mfma_f32_16x16x32_bf16 v[52:55], v[68:71], a[80:83], 0
    v_mfma_f32_16x16x32_bf16 v[56:59], v[68:71], a[160:163], 0
    v_mfma_f32_16x16x32_bf16 v[60:63], v[68:71], a[240:243], 0
    ds_read_b128 v[68:71], v21 offset:22528
    s_waitcnt lgkmcnt(3)
    v_mfma_f32_16x16x32_bf16 v[32:35], v[72:75], a[4:7], v[32:35]
    v_mfma_f32_16x16x32_bf16 v[36:39], v[72:75], a[84:87], v[36:39]
    v_mfma_f32_16x16x32_bf16 v[40:43], v[72:75], a[164:167], v[40:43]
    v_mfma_f32_16x16x32_bf16 v[44:47], v[72:75], a[244:247], v[44:47]
    ds_read_b128 v[72:75], v21 offset:3072
    s_waitcnt lgkmcnt(3)
    v_mfma_f32_16x16x32_bf16 v[48:51], v[76:79], a[4:7], v[48:51]
    v_mfma_f32_16x16x32_bf16 v[52:55], v[76:79], a[84:87], v[52:55]
    v_mfma_f32_16x16x32_bf16 v[56:59], v[76:79], a[164:167], v[56:59]
    v_mfma_f32_16x16x32_bf16 v[60:63], v[76:79], a[244:247], v[60:63]
    ds_read_b128 v[76:79], v21 offset:23552
    s_waitcnt lgkmcnt(3)
    v_mfma_f32_16x16x32_bf16 v[32:35], v[64:67], a[8:11], v[32:35]
    v_mfma_f32_16x16x32_bf16 v[36:39], v[64:67], a[88:91], v[36:39]
    v_mfma_f32_16x16x32_bf16 v[40:43], v[64:67], a[168:171], v[40:43]
    v_mfma_f32_16x16x32_bf16 v[44:47], v[64:67], a[248:251], v[44:47]
    ds_read_b128 v[64:67], v21 offset:4096
    s_waitcnt lgkmcnt(3)
    v_mfma_f32_16x16x32_bf16 v[48:51], v[68:71], a[8:11], v[48:51]
    v_mfma_f32_16x16x32_bf16 v[52:55], v[68:71], a[88:91], v[52:55]
    v_mfma_f32_16x16x32_bf16 v[56:59], v[68:71], a[168:171], v[56:59]
    v_mfma_f32_16x16x32_bf16 v[60:63], v[68:71], a[248:251], v[60:63]
    ds_read_b128 v[68:71], v21 offset:24576
    s_waitcnt lgkmcnt(3)
    v_mfma_f32_16x16x32_bf16 v[32:35], v[72:75], a[12:15], v[32:35]
    v_mfma_f32_16x16x32_bf16 v[36:39], v[72:75], a[92:95], v[36:39]
    v_mfma_f32_16x16x32_bf16 v[40:43], v[72:75], a[172:175], v[40:43]
    v_mfma_f32_16x16x32_bf16 v[44:47], v[72:75], a[252:255], v[44:47]
    ds_read_b128 v[72:75], v21 offset:5120
    s_waitcnt lgkmcnt(3)
    v_mfma_f32_16x16x32_bf16 v[48:51], v[76:79], a[12:15], v[48:51]
    v_mfma_f32_16x16x32_bf16 v[52:55], v[76:79], a[92:95], v[52:55]
    v_mfma_f32_16x16x32_bf16 v[56:59], v[76:79], a[172:175], v[56:59]
    v_mfma_f32_16x16x32_bf16 v[60:63], v[76:79], a[252:255], v[60:63]
    ds_read_b128 v[76:79], v21 offset:25600
    s_waitcnt lgkmcnt(3)
    v_mfma_f32_16x16x32_bf16 v[32:35], v[64:67], a[16:19], v[32:35]
    v_mfma_f32_16x16x32_bf16 v[36:39], v[64:67], a[96:99], v[36:39]
    v_mfma_f32_16x16x32_bf16 v[40:43], v[64:67], a[176:179], v[40:43]
    v_mfma_f32_16x16x32_bf16 v[44:47], v[64:67], v[192:195], v[44:47]
    ds_read_b128 v[64:67], v21 offset:6144
    s_waitcnt lgkmcnt(3)
    v_mfma_f32_16x16x32_bf16 v[48:51], v[68:71], a[16:19], v[48:51]
    v_mfma_f32_16x16x32_bf16 v[52:55], v[68:71], a[96:99], v[52:55]
    v_mfma_f32_16x16x32_bf16 v[56:59], v[68:71], a[176:179], v[56:59]
    v_mfma_f32_16x16x32_bf16 v[60:63], v[68:71], v[192:195], v[60:63]
    ds_read_b128 v[68:71], v21 offset:26624
    s_waitcnt lgkmcnt(3)
    v_mfma_f32_16x16x32_bf16 v[32:35], v[72:75], a[20:23], v[32:35]
    v_mfma_f32_16x16x32_bf16 v[36:39], v[72:75], a[100:103], v[36:39]
    v_mfma_f32_16x16x32_bf16 v[40:43], v[72:75], a[180:183], v[40:43]
    v_mfma_f32_16x16x32_bf16 v[44:47], v[72:75], v[196:199], v[44:47]
    ds_read_b128 v[72:75], v21 offset:7168
    s_waitcnt lgkmcnt(3)
    v_mfma_f32_16x16x32_bf16 v[48:51], v[76:79], a[20:23], v[48:51]
    v_mfma_f32_16x16x32_bf16 v[52:55], v[76:79], a[100:103], v[52:55]
    v_mfma_f32_16x16x32_bf16 v[56:59], v[76:79], a[180:183], v[56:59]
    v_mfma_f32_16x16x32_bf16 v[60:63], v[76:79], v[196:199], v[60:63]
    ds_read_b128 v[76:79], v21 offset:27648
    s_waitcnt lgkmcnt(3)
    v_mfma_f32_16x16x32_bf16 v[32:35], v[64:67], a[24:27], v[32:35]
    v_mfma_f32_16x16x32_bf16 v[36:39], v[64:67], a[104:107], v[36:39]
    v_mfma_f32_16x16x32_bf16 v[40:43], v[64:67], a[184:187], v[40:43]
    v_mfma_f32_16x16x32_bf16 v[44:47], v[64:67], v[200:203], v[44:47]
    ds_read_b128 v[64:67], v21 offset:8192
    s_waitcnt lgkmcnt(3)
    v_mfma_f32_16x16x32_bf16 v[48:51], v[68:71], a[24:27], v[48:51]
    v_mfma_f32_16x16x32_bf16 v[52:55], v[68:71], a[104:107], v[52:55]
    v_mfma_f32_16x16x32_bf16 v[56:59], v[68:71], a[184:187], v[56:59]
    v_mfma_f32_16x16x32_bf16 v[60:63], v[68:71], v[200:203], v[60:63]
    ds_read_b128 v[68:71], v21 offset:28672
    s_waitcnt lgkmcnt(3)
    v_mfma_f32_16x16x32_bf16 v[32:35], v[72:75], a[28:31], v[32:35]
    v_mfma_f32_16x16x32_bf16 v[36:39], v[72:75], a[108:111], v[36:39]
    v_mfma_f32_16x16x32_bf16 v[40:43], v[72:75], a[188:191], v[40:43]
    v_mfma_f32_16x16x32_bf16 v[44:47], v[72:75], v[204:207], v[44:47]
    ds_read_b128 v[72:75], v21 offset:9216
    s_waitcnt lgkmcnt(3)
    v_mfma_f32_16x16x32_bf16 v[48:51], v[76:79], a[28:31], v[48:51]
    v_mfma_f32_16x16x32_bf16 v[52:55], v[76:79], a[108:111], v[52:55]
    v_mfma_f32_16x16x32_bf16 v[56:59], v[76:79], a[188:191], v[56:59]
    v_mfma_f32_16x16x32_bf16 v[60:63], v[76:79], v[204:207], v[60:63]
    ds_read_b128 v[76:79], v21 offset:29696
    s_waitcnt lgkmcnt(3)
    v_mfma_f32_16x16x32_bf16 v[32:35], v[64:67], a[32:35], v[32:35]
    v_mfma_f32_16x16x32_bf16 v[36:39], v[64:67], a[112:115], v[36:39]
    v_mfma_f32_16x16x32_bf16 v[40:43], v[64:67], a[192:195], v[40:43]
    v_mfma_f32_16x16x32_bf16 v[44:47], v[64:67], v[208:211], v[44:47]
    ds_read_b128 v[64:67], v21 offset:10240
    s_waitcnt lgkmcnt(3)
    v_mfma_f32_16x16x32_bf16 v[48:51], v[68:71], a[32:35], v[48:51]
    v_mfma_f32_16x16x32_bf16 v[52:55], v[68:71], a[112:115], v[52:55]
    v_mfma_f32_16x16x32_bf16 v[56:59], v[68:71], a[192:195], v[56:59]
    v_mfma_f32_16x16x32_bf16 v[60:63], v[68:71], v[208:211], v[60:63]
    ds_read_b128 v[68:71], v21 offset:30720
    s_waitcnt lgkmcnt(3)
    v_mfma_f32_16x16x32_bf16 v[32:35], v[72:75], a[36:39], v[32:35]
    v_mfma_f32_16x16x32_bf16 v[36:39], v[72:75], a[116:119], v[36:39]
    v_mfma_f32_16x16x32_bf16 v[40:43], v[72:75], a[196:199], v[40:43]
    v_mfma_f32_16x16x32_bf16 v[44:47], v[72:75], v[212:215], v[44:47]
    ds_read_b128 v[72:75], v21 offset:11264
    s_waitcnt lgkmcnt(3)
    v_mfma_f32_16x16x32_bf16 v[48:51], v[76:79], a[36:39], v[48:51]
    v_mfma_f32_16x16x32_bf16 v[52:55], v[76:79], a[116:119], v[52:55]
    v_mfma_f32_16x16x32_bf16 v[56:59], v[76:79], a[196:199], v[56:59]
    v_mfma_f32_16x16x32_bf16 v[60:63], v[76:79], v[212:215], v[60:63]
    ds_read_b128 v[76:79], v21 offset:31744
    s_waitcnt lgkmcnt(3)
    v_mfma_f32_16x16x32_bf16 v[32:35], v[64:67], a[40:43], v[32:35]
    v_mfma_f32_16x16x32_bf16 v[36:39], v[64:67], a[120:123], v[36:39]
    v_mfma_f32_16x16x32_bf16 v[40:43], v[64:67], a[200:203], v[40:43]
    v_mfma_f32_16x16x32_bf16 v[44:47], v[64:67], v[216:219], v[44:47]
    ds_read_b128 v[64:67], v21 offset:12288
    s_waitcnt lgkmcnt(3)
    v_mfma_f32_16x16x32_bf16 v[48:51], v[68:71], a[40:43], v[48:51]
    v_mfma_f32_16x16x32_bf16 v[52:55], v[68:71], a[120:123], v[52:55]
    v_mfma_f32_16x16x32_bf16 v[56:59], v[68:71], a[200:203], v[56:59]
    v_mfma_f32_16x16x32_bf16 v[60:63], v[68:71], v[216:219], v[60:63]
    ds_read_b128 v[68:71], v21 offset:32768
    s_waitcnt lgkmcnt(3)
    v_mfma_f32_16x16x32_bf16 v[32:35], v[72:75], a[44:47], v[32:35]
    v_mfma_f32_16x16x32_bf16 v[36:39], v[72:75], a[124:127], v[36:39]
    v_mfma_f32_16x16x32_bf16 v[40:43], v[72:75], a[204:207], v[40:43]
    v_mfma_f32_16x16x32_bf16 v[44:47], v[72:75], v[220:223], v[44:47]
    ds_read_b128 v[72:75], v21 offset:13312
    s_waitcnt lgkmcnt(3)
    v_mfma_f32_16x16x32_bf16 v[48:51], v[76:79], a[44:47], v[48:51]
    v_mfma_f32_16x16x32_bf16 v[52:55], v[76:79], a[124:127], v[52:55]
    v_mfma_f32_16x16x32_bf16 v[56:59], v[76:79], a[204:207], v[56:59]
    v_mfma_f32_16x16x32_bf16 v[60:63], v[76:79], v[220:223], v[60:63]
    ds_read_b128 v[76:79], v21 offset:33792
    s_waitcnt lgkmcnt(3)
    v_mfma_f32_16x16x32_bf16 v[32:35], v[64:67], a[48:51], v[32:35]
    v_mfma_f32_16x16x32_bf16 v[36:39], v[64:67], a[128:131], v[36:39]
    v_mfma_f32_16x16x32_bf16 v[40:43], v[64:67], a[208:211], v[40:43]
    v_mfma_f32_16x16x32_bf16 v[44:47], v[64:67], v[224:227], v[44:47]
    ds_read_b128 v[64:67], v21 offset:14336
    s_waitcnt lgkmcnt(3)
    v_mfma_f32_16x16x32_bf16 v[48:51], v[68:71], a[48:51], v[48:51]
    v_mfma_f32_16x16x32_bf16 v[52:55], v[68:71], a[128:131], v[52:55]
    v_mfma_f32_16x16x32_bf16 v[56:59], v[68:71], a[208:211], v[56:59]
    v_mfma_f32_16x16x32_bf16 v[60:63], v[68:71], v[224:227], v[60:63]
    ds_read_b128 v[68:71], v21 offset:34816
    s_waitcnt lgkmcnt(3)
    v_mfma_f32_16x16x32_bf16 v[32:35], v[72:75], a[52:55], v[32:35]
    v_mfma_f32_16x16x32_bf16 v[36:39], v[72:75], a[132:135], v[36:39]
    v_mfma_f32_16x16x32_bf16 v[40:43], v[72:75], a[212:215], v[40:43]
    v_mfma_f32_16x16x32_bf16 v[44:47], v[72:75], v[228:231], v[44:47]
    ds_read_b128 v[72:75], v21 offset:15360
    s_waitcnt lgkmcnt(3)
    v_mfma_f32_16x16x32_bf16 v[48:51], v[76:79], a[52:55], v[48:51]
    v_mfma_f32_16x16x32_bf16 v[52:55], v[76:79], a[132:135], v[52:55]
    v_mfma_f32_16x16x32_bf16 v[56:59], v[76:79], a[212:215], v[56:59]
    v_mfma_f32_16x16x32_bf16 v[60:63], v[76:79], v[228:231], v[60:63]
    ds_read_b128 v[76:79], v21 offset:35840
    s_waitcnt lgkmcnt(3)
    v_mfma_f32_16x16x32_bf16 v[32:35], v[64:67], a[56:59], v[32:35]
    v_mfma_f32_16x16x32_bf16 v[36:39], v[64:67], a[136:139], v[36:39]
    v_mfma_f32_16x16x32_bf16 v[40:43], v[64:67], a[216:219], v[40:43]
    v_mfma_f32_16x16x32_bf16 v[44:47], v[64:67], v[232:235], v[44:47]
    ds_read_b128 v[64:67], v21 offset:16384
    s_waitcnt lgkmcnt(3)
    v_mfma_f32_16x16x32_bf16 v[48:51], v[68:71], a[56:59], v[48:51]
    v_mfma_f32_16x16x32_bf16 v[52:55], v[68:71], a[136:139], v[52:55]
    v_mfma_f32_16x16x32_bf16 v[56:59], v[68:71], a[216:219], v[56:59]
    v_mfma_f32_16x16x32_bf16 v[60:63], v[68:71], v[232:235], v[60:63]
    ds_read_b128 v[68:71], v21 offset:36864
    s_waitcnt lgkmcnt(3)
    v_mfma_f32_16x16x32_bf16 v[32:35], v[72:75], a[60:63], v[32:35]
    v_mfma_f32_16x16x32_bf16 v[36:39], v[72:75], a[140:143], v[36:39]
    v_mfma_f32_16x16x32_bf16 v[40:43], v[72:75], a[220:223], v[40:43]
    v_mfma_f32_16x16x32_bf16 v[44:47], v[72:75], v[236:239], v[44:47]
    ds_read_b128 v[72:75], v21 offset:17408
    s_waitcnt lgkmcnt(3)
    v_mfma_f32_16x16x32_bf16 v[48:51], v[76:79], a[60:63], v[48:51]
    v_mfma_f32_16x16x32_bf16 v[52:55], v[76:79], a[140:143], v[52:55]
    v_mfma_f32_16x16x32_bf16 v[56:59], v[76:79], a[220:223], v[56:59]
    v_mfma_f32_16x16x32_bf16 v[60:63], v[76:79], v[236:239], v[60:63]
    ds_read_b128 v[76:79], v21 offset:37888
    s_waitcnt lgkmcnt(3)
    v_mfma_f32_16x16x32_bf16 v[32:35], v[64:67], a[64:67], v[32:35]
    v_mfma_f32_16x16x32_bf16 v[36:39], v[64:67], a[144:147], v[36:39]
    v_mfma_f32_16x16x32_bf16 v[40:43], v[64:67], a[224:227], v[40:43]
    v_mfma_f32_16x16x32_bf16 v[44:47], v[64:67], v[240:243], v[44:47]
    ds_read_b128 v[64:67], v21 offset:18432
    s_waitcnt lgkmcnt(3)
    v_mfma_f32_16x16x32_bf16 v[48:51], v[68:71], a[64:67], v[48:51]
    v_mfma_f32_16x16x32_bf16 v[52:55], v[68:71], a[144:147], v[52:55]
    v_mfma_f32_16x16x32_bf16 v[56:59], v[68:71], a[224:227], v[56:59]
    v_mfma_f32_16x16x32_bf16 v[60:63], v[68:71], v[240:243], v[60:63]
    ds_read_b128 v[68:71], v21 offset:38912
    s_waitcnt lgkmcnt(3)
    v_mfma_f32_16x16x32_bf16 v[32:35], v[72:75], a[68:71], v[32:35]
    v_mfma_f32_16x16x32_bf16 v[36:39], v[72:75], a[148:151], v[36:39]
    v_mfma_f32_16x16x32_bf16 v[40:43], v[72:75], a[228:231], v[40:43]
    v_mfma_f32_16x16x32_bf16 v[44:47], v[72:75], v[244:247], v[44:47]
    ds_read_b128 v[72:75], v21 offset:19456
    s_waitcnt lgkmcnt(3)
    v_mfma_f32_16x16x32_bf16 v[48:51], v[76:79], a[68:71], v[48:51]
    v_mfma_f32_16x16x32_bf16 v[52:55], v[76:79], a[148:151], v[52:55]
    v_mfma_f32_16x16x32_bf16 v[56:59], v[76:79], a[228:231], v[56:59]
    v_mfma_f32_16x16x32_bf16 v[60:63], v[76:79], v[244:247], v[60:63]
    ds_read_b128 v[76:79], v21 offset:39936
    s_waitcnt lgkmcnt(3)
    v_mfma_f32_16x16x32_bf16 v[32:35], v[64:67], a[72:75], v[32:35]
    v_mfma_f32_16x16x32_bf16 v[36:39], v[64:67], a[152:155], v[36:39]
    v_mfma_f32_16x16x32_bf16 v[40:43], v[64:67], a[232:235], v[40:43]
    v_mfma_f32_16x16x32_bf16 v[44:47], v[64:67], v[248:251], v[44:47]
    s_waitcnt lgkmcnt(2)
    v_mfma_f32_16x16x32_bf16 v[48:51], v[68:71], a[72:75], v[48:51]
    v_mfma_f32_16x16x32_bf16 v[52:55], v[68:71], a[152:155], v[52:55]
    v_mfma_f32_16x16x32_bf16 v[56:59], v[68:71], a[232:235], v[56:59]
    v_mfma_f32_16x16x32_bf16 v[60:63], v[68:71], v[248:251], v[60:63]
    s_waitcnt lgkmcnt(1)
    v_mfma_f32_16x16x32_bf16 v[32:35], v[72:75], a[76:79], v[32:35]
    v_mfma_f32_16x16x32_bf16 v[36:39], v[72:75], a[156:159], v[36:39]
    v_mfma_f32_16x16x32_bf16 v[40:43], v[72:75], a[236:239], v[40:43]
    v_mfma_f32_16x16x32_bf16 v[44:47], v[72:75], v[252:255], v[44:47]
    s_waitcnt lgkmcnt(0)
    v_mfma_f32_16x16x32_bf16 v[48:51], v[76:79], a[76:79], v[48:51]
    v_mfma_f32_16x16x32_bf16 v[52:55], v[76:79], a[156:159], v[52:55]
    v_mfma_f32_16x16x32_bf16 v[56:59], v[76:79], a[236:239], v[56:59]
    v_mfma_f32_16x16x32_bf16 v[60:63], v[76:79], v[252:255], v[60:63]
    s_nop 7
    s_lshl_b32 s3, s75, 1
    s_add_u32 s3, s3, s15
    s_mul_i32 s3, s3, 98304
    s_add_u32 s3, s3, s21
    v_cvt_pk_bf16_f32 v80, v32, v36
    v_cvt_pk_bf16_f32 v81, v40, v44
    v_lshlrev_b32 v82, 16, v80
    v_and_b32 v83, 0xffff0000, v80
    v_mul_f32 v84, 0xbfb8aa3b, v82
    v_mul_f32 v85, 0xbfb8aa3b, v83
    v_exp_f32 v84, v84
    v_exp_f32 v85, v85
    s_nop 0
    v_add_f32 v84, 1.0, v84
    v_add_f32 v85, 1.0, v85
    v_rcp_f32 v84, v84
    v_rcp_f32 v85, v85
    s_nop 0
    v_mul_f32 v82, v82, v84
    v_mul_f32 v83, v83, v85
    v_cvt_pk_bf16_f32 v80, v82, v83
    v_lshlrev_b32 v82, 16, v80
    v_and_b32 v83, 0xffff0000, v80
    v_lshlrev_b32 v84, 16, v81
    v_and_b32 v85, 0xffff0000, v81
    v_mul_f32 v82, v82, v84
    v_mul_f32 v83, v83, v85
    v_cvt_pk_bf16_f32 v88, v82, v83
    ds_write_b32 v27, v88 offset:0
    v_cvt_pk_bf16_f32 v80, v33, v37
    v_cvt_pk_bf16_f32 v81, v41, v45
    v_lshlrev_b32 v82, 16, v80
    v_and_b32 v83, 0xffff0000, v80
    v_mul_f32 v84, 0xbfb8aa3b, v82
    v_mul_f32 v85, 0xbfb8aa3b, v83
    v_exp_f32 v84, v84
    v_exp_f32 v85, v85
    s_nop 0
    v_add_f32 v84, 1.0, v84
    v_add_f32 v85, 1.0, v85
    v_rcp_f32 v84, v84
    v_rcp_f32 v85, v85
    s_nop 0
    v_mul_f32 v82, v82, v84
    v_mul_f32 v83, v83, v85
    v_cvt_pk_bf16_f32 v80, v82, v83
    v_lshlrev_b32 v82, 16, v80
    v_and_b32 v83, 0xffff0000, v80
    v_lshlrev_b32 v84, 16, v81
    v_and_b32 v85, 0xffff0000, v81
    v_mul_f32 v82, v82, v84
    v_mul_f32 v83, v83, v85
    v_cvt_pk_bf16_f32 v89, v82, v83
    ds_write_b32 v27, v89 offset:16
    v_cvt_pk_bf16_f32 v80, v34, v38
    v_cvt_pk_bf16_f32 v81, v42, v46
    v_lshlrev_b32 v82, 16, v80
    v_and_b32 v83, 0xffff0000, v80
    v_mul_f32 v84, 0xbfb8aa3b, v82
    v_mul_f32 v85, 0xbfb8aa3b, v83
    v_exp_f32 v84, v84
    v_exp_f32 v85, v85
    s_nop 0
    v_add_f32 v84, 1.0, v84
    v_add_f32 v85, 1.0, v85
    v_rcp_f32 v84, v84
    v_rcp_f32 v85, v85
    s_nop 0
    v_mul_f32 v82, v82, v84
    v_mul_f32 v83, v83, v85
    v_cvt_pk_bf16_f32 v80, v82, v83
    v_lshlrev_b32 v82, 16, v80
    v_and_b32 v83, 0xffff0000, v80
    v_lshlrev_b32 v84, 16, v81
    v_and_b32 v85, 0xffff0000, v81
    v_mul_f32 v82, v82, v84
    v_mul_f32 v83, v83, v85
    v_cvt_pk_bf16_f32 v90, v82, v83
    ds_write_b32 v27, v90 offset:32
    v_cvt_pk_bf16_f32 v80, v35, v39
    v_cvt_pk_bf16_f32 v81, v43, v47
    v_lshlrev_b32 v82, 16, v80
    v_and_b32 v83, 0xffff0000, v80
    v_mul_f32 v84, 0xbfb8aa3b, v82
    v_mul_f32 v85, 0xbfb8aa3b, v83
    v_exp_f32 v84, v84
    v_exp_f32 v85, v85
    s_nop 0
    v_add_f32 v84, 1.0, v84
    v_add_f32 v85, 1.0, v85
    v_rcp_f32 v84, v84
    v_rcp_f32 v85, v85
    s_nop 0
    v_mul_f32 v82, v82, v84
    v_mul_f32 v83, v83, v85
    v_cvt_pk_bf16_f32 v80, v82, v83
    v_lshlrev_b32 v82, 16, v80
    v_and_b32 v83, 0xffff0000, v80
    v_lshlrev_b32 v84, 16, v81
    v_and_b32 v85, 0xffff0000, v81
    v_mul_f32 v82, v82, v84
    v_mul_f32 v83, v83, v85
    v_cvt_pk_bf16_f32 v91, v82, v83
    ds_write_b32 v27, v91 offset:48
    v_cvt_pk_bf16_f32 v80, v48, v52
    v_cvt_pk_bf16_f32 v81, v56, v60
    v_lshlrev_b32 v82, 16, v80
    v_and_b32 v83, 0xffff0000, v80
    v_mul_f32 v84, 0xbfb8aa3b, v82
    v_mul_f32 v85, 0xbfb8aa3b, v83
    v_exp_f32 v84, v84
    v_exp_f32 v85, v85
    s_nop 0
    v_add_f32 v84, 1.0, v84
    v_add_f32 v85, 1.0, v85
    v_rcp_f32 v84, v84
    v_rcp_f32 v85, v85
    s_nop 0
    v_mul_f32 v82, v82, v84
    v_mul_f32 v83, v83, v85
    v_cvt_pk_bf16_f32 v80, v82, v83
    v_lshlrev_b32 v82, 16, v80
    v_and_b32 v83, 0xffff0000, v80
    v_lshlrev_b32 v84, 16, v81
    v_and_b32 v85, 0xffff0000, v81
    v_mul_f32 v82, v82, v84
    v_mul_f32 v83, v83, v85
    v_cvt_pk_bf16_f32 v92, v82, v83
    ds_write_b32 v27, v92 offset:1024
    v_cvt_pk_bf16_f32 v80, v49, v53
    v_cvt_pk_bf16_f32 v81, v57, v61
    v_lshlrev_b32 v82, 16, v80
    v_and_b32 v83, 0xffff0000, v80
    v_mul_f32 v84, 0xbfb8aa3b, v82
    v_mul_f32 v85, 0xbfb8aa3b, v83
    v_exp_f32 v84, v84
    v_exp_f32 v85, v85
    s_nop 0
    v_add_f32 v84, 1.0, v84
    v_add_f32 v85, 1.0, v85
    v_rcp_f32 v84, v84
    v_rcp_f32 v85, v85
    s_nop 0
    v_mul_f32 v82, v82, v84
    v_mul_f32 v83, v83, v85
    v_cvt_pk_bf16_f32 v80, v82, v83
    v_lshlrev_b32 v82, 16, v80
    v_and_b32 v83, 0xffff0000, v80
    v_lshlrev_b32 v84, 16, v81
    v_and_b32 v85, 0xffff0000, v81
    v_mul_f32 v82, v82, v84
    v_mul_f32 v83, v83, v85
    v_cvt_pk_bf16_f32 v93, v82, v83
    ds_write_b32 v27, v93 offset:1040
    v_cvt_pk_bf16_f32 v80, v50, v54
    v_cvt_pk_bf16_f32 v81, v58, v62
    v_lshlrev_b32 v82, 16, v80
    v_and_b32 v83, 0xffff0000, v80
    v_mul_f32 v84, 0xbfb8aa3b, v82
    v_mul_f32 v85, 0xbfb8aa3b, v83
    v_exp_f32 v84, v84
    v_exp_f32 v85, v85
    s_nop 0
    v_add_f32 v84, 1.0, v84
    v_add_f32 v85, 1.0, v85
    v_rcp_f32 v84, v84
    v_rcp_f32 v85, v85
    s_nop 0
    v_mul_f32 v82, v82, v84
    v_mul_f32 v83, v83, v85
    v_cvt_pk_bf16_f32 v80, v82, v83
    v_lshlrev_b32 v82, 16, v80
    v_and_b32 v83, 0xffff0000, v80
    v_lshlrev_b32 v84, 16, v81
    v_and_b32 v85, 0xffff0000, v81
    v_mul_f32 v82, v82, v84
    v_mul_f32 v83, v83, v85
    v_cvt_pk_bf16_f32 v94, v82, v83
    ds_write_b32 v27, v94 offset:1056
    v_cvt_pk_bf16_f32 v80, v51, v55
    v_cvt_pk_bf16_f32 v81, v59, v63
    v_lshlrev_b32 v82, 16, v80
    v_and_b32 v83, 0xffff0000, v80
    v_mul_f32 v84, 0xbfb8aa3b, v82
    v_mul_f32 v85, 0xbfb8aa3b, v83
    v_exp_f32 v84, v84
    v_exp_f32 v85, v85
    s_nop 0
    v_add_f32 v84, 1.0, v84
    v_add_f32 v85, 1.0, v85
    v_rcp_f32 v84, v84
    v_rcp_f32 v85, v85
    s_nop 0
    v_mul_f32 v82, v82, v84
    v_mul_f32 v83, v83, v85
    v_cvt_pk_bf16_f32 v80, v82, v83
    v_lshlrev_b32 v82, 16, v80
    v_and_b32 v83, 0xffff0000, v80
    v_lshlrev_b32 v84, 16, v81
    v_and_b32 v85, 0xffff0000, v81
    v_mul_f32 v82, v82, v84
    v_mul_f32 v83, v83, v85
    v_cvt_pk_bf16_f32 v95, v82, v83
    ds_write_b32 v27, v95 offset:1072
    s_waitcnt lgkmcnt(0)
    ds_read_b128 v[100:103], v28 offset:0
    ds_read_b128 v[104:107], v28 offset:1024
    s_waitcnt lgkmcnt(0)
    s_add_u32 s71, s3, 0
    buffer_store_dwordx4 v[100:103], v20, s[60:63], s71 offen sc1
    s_add_u32 s71, s3, 49152
    buffer_store_dwordx4 v[104:107], v20, s[60:63], s71 offen sc1
    s_add_u32 s75, s75, 1
    s_waitcnt vmcnt(0)
    s_barrier
    s_cmp_lg_u32 s74, 0
    s_cbranch_scc1 mega_kernel_pf158
    v_mov_b32 v150, s75
    v_mov_b32 v151, 0
    s_lshl_b32 s71, s17, 2
    s_add_u32 s71, s71, 204500992
    s_mov_b64 exec, 1
    buffer_store_dword v150, v151, s[60:63], s71 offen sc1
    s_mov_b64 exec, -1
mega_kernel_pf158:
    s_cmp_lt_u32 s75, 32
    s_cbranch_scc1 mega_kernel_loop155
    s_branch mega_kernel_done1
mega_kernel_down6:
    s_load_dwordx2 s[10:11], s[0:1], 80
    s_load_dwordx2 s[12:13], s[0:1], 104
    s_sub_u32 s18, s2, 232
    s_mul_hi_u32 s15, s18, 0x33333334
    s_mul_i32 s16, s15, 5
    s_sub_u32 s16, s18, s16
    s_lshl_b32 s19, s16, 7
    s_lshl_b32 s3, s74, 5
    s_add_u32 s19, s19, s3
    s_waitcnt lgkmcnt(0)
    s_mov_b32 s64, s10
    s_and_b32 s65, s11, 0xffff
    s_mov_b32 s66, 1966080
    s_mov_b32 s67, 0x00020000
    s_mov_b32 s84, s12
    s_and_b32 s85, s13, 0xffff
    s_mov_b32 s86, 2621440
    s_mov_b32 s87, 0x00020000
    s_movk_i32 s3, 10240
    v_mul_lo_u32 v5, v4, s3
    v_lshl_add_u32 v5, v3, 2, v5
    s_lshl_b32 s70, s19, 1
    v_lshlrev_b32 v6, 3, v3
    s_lshl_b32 s3, s19, 2
    s_add_u32 s3, s3, 12800
    v_mov_b32 v101, 128
    s_mov_b32 s69, 0
mega_kernel_cw159:
    buffer_load_dword v100, v101, s[88:91], 0 offen sc1
    s_add_u32 s69, s69, 1
    s_cmp_ge_u32 s69, 1048576
    s_cbranch_scc1 mega_kernel_cwo160
    s_waitcnt vmcnt(0)
    v_cmp_gt_u32 vcc, 30, v100
    s_cbranch_vccz mega_kernel_cwo160
    s_sleep 8
    s_branch mega_kernel_cw159
mega_kernel_cwo160:
    buffer_load_dwordx2 v[26:27], v6, s[60:63], s3 offen
    s_add_u32 s71, s70, 0
    buffer_load_dword v32, v5, s[64:67], s71 offen
    s_add_u32 s71, s70, 1280
    buffer_load_dword v33, v5, s[64:67], s71 offen
    s_add_u32 s71, s70, 2560
    buffer_load_dword v34, v5, s[64:67], s71 offen
    s_add_u32 s71, s70, 3840
    buffer_load_dword v35, v5, s[64:67], s71 offen
    s_add_u32 s71, s70, 5120
    buffer_load_dword v36, v5, s[64:67], s71 offen
    s_add_u32 s71, s70, 6400
    buffer_load_dword v37, v5, s[64:67], s71 offen
    s_add_u32 s71, s70, 7680
    buffer_load_dword v38, v5, s[64:67], s71 offen
    s_add_u32 s71, s70, 8960
    buffer_load_dword v39, v5, s[64:67], s71 offen
    s_add_u32 s71, s70, 40960
    buffer_load_dword v40, v5, s[64:67], s71 offen
    s_add_u32 s71, s70, 42240
    buffer_load_dword v41, v5, s[64:67], s71 offen
    s_add_u32 s71, s70, 43520
    buffer_load_dword v42, v5, s[64:67], s71 offen
    s_add_u32 s71, s70, 44800
    buffer_load_dword v43, v5, s[64:67], s71 offen
    s_add_u32 s71, s70, 46080
    buffer_load_dword v44, v5, s[64:67], s71 offen
    s_add_u32 s71, s70, 47360
    buffer_load_dword v45, v5, s[64:67], s71 offen
    s_add_u32 s71, s70, 48640
    buffer_load_dword v46, v5, s[64:67], s71 offen
    s_add_u32 s71, s70, 49920
    buffer_load_dword v47, v5, s[64:67], s71 offen
    s_add_u32 s71, s70, 81920
    buffer_load_dword v48, v5, s[64:67], s71 offen
    s_add_u32 s71, s70, 83200
    buffer_load_dword v49, v5, s[64:67], s71 offen
    s_add_u32 s71, s70, 84480
    buffer_load_dword v50, v5, s[64:67], s71 offen
    s_add_u32 s71, s70, 85760
    buffer_load_dword v51, v5, s[64:67], s71 offen
    s_add_u32 s71, s70, 87040
    buffer_load_dword v52, v5, s[64:67], s71 offen
    s_add_u32 s71, s70, 88320
    buffer_load_dword v53, v5, s[64:67], s71 offen
    s_add_u32 s71, s70, 89600
    buffer_load_dword v54, v5, s[64:67], s71 offen
    s_add_u32 s71, s70, 90880
    buffer_load_dword v55, v5, s[64:67], s71 offen
    s_add_u32 s71, s70, 122880
    buffer_load_dword v56, v5, s[64:67], s71 offen
    s_add_u32 s71, s70, 124160
    buffer_load_dword v57, v5, s[64:67], s71 offen
    s_add_u32 s71, s70, 125440
    buffer_load_dword v58, v5, s[64:67], s71 offen
    s_add_u32 s71, s70, 126720
    buffer_load_dword v59, v5, s[64:67], s71 offen
    s_add_u32 s71, s70, 128000
    buffer_load_dword v60, v5, s[64:67], s71 offen
    s_add_u32 s71, s70, 129280
    buffer_load_dword v61, v5, s[64:67], s71 offen
    s_add_u32 s71, s70, 130560
    buffer_load_dword v62, v5, s[64:67], s71 offen
    s_add_u32 s71, s70, 131840
    buffer_load_dword v63, v5, s[64:67], s71 offen
    s_add_u32 s71, s70, 163840
    buffer_load_dword v64, v5, s[64:67], s71 offen
    s_add_u32 s71, s70, 165120
    buffer_load_dword v65, v5, s[64:67], s71 offen
    s_add_u32 s71, s70, 166400
    buffer_load_dword v66, v5, s[64:67], s71 offen
    s_add_u32 s71, s70, 167680
    buffer_load_dword v67, v5, s[64:67], s71 offen
    s_add_u32 s71, s70, 168960
    buffer_load_dword v68, v5, s[64:67], s71 offen
    s_add_u32 s71, s70, 170240
    buffer_load_dword v69, v5, s[64:67], s71 offen
    s_add_u32 s71, s70, 171520
    buffer_load_dword v70, v5, s[64:67], s71 offen
    s_add_u32 s71, s70, 172800
    buffer_load_dword v71, v5, s[64:67], s71 offen
    s_add_u32 s71, s70, 204800
    buffer_load_dword v72, v5, s[64:67], s71 offen
    s_add_u32 s71, s70, 206080
    buffer_load_dword v73, v5, s[64:67], s71 offen
    s_add_u32 s71, s70, 207360
    buffer_load_dword v74, v5, s[64:67], s71 offen
    s_add_u32 s71, s70, 208640
    buffer_load_dword v75, v5, s[64:67], s71 offen
    s_add_u32 s71, s70, 209920
    buffer_load_dword v76, v5, s[64:67], s71 offen
    s_add_u32 s71, s70, 211200
    buffer_load_dword v77, v5, s[64:67], s71 offen
    s_add_u32 s71, s70, 212480
    buffer_load_dword v78, v5, s[64:67], s71 offen
    s_add_u32 s71, s70, 213760
    buffer_load_dword v79, v5, s[64:67], s71 offen
    s_add_u32 s71, s70, 245760
    buffer_load_dword v80, v5, s[64:67], s71 offen
    s_add_u32 s71, s70, 247040
    buffer_load_dword v81, v5, s[64:67], s71 offen
    s_add_u32 s71, s70, 248320
    buffer_load_dword v82, v5, s[64:67], s71 offen
    s_add_u32 s71, s70, 249600
    buffer_load_dword v83, v5, s[64:67], s71 offen
    s_add_u32 s71, s70, 250880
    buffer_load_dword v84, v5, s[64:67], s71 offen
    s_add_u32 s71, s70, 252160
    buffer_load_dword v85, v5, s[64:67], s71 offen
    s_add_u32 s71, s70, 253440
    buffer_load_dword v86, v5, s[64:67], s71 offen
    s_add_u32 s71, s70, 254720
    buffer_load_dword v87, v5, s[64:67], s71 offen
    s_add_u32 s71, s70, 286720
    buffer_load_dword v88, v5, s[64:67], s71 offen
    s_add_u32 s71, s70, 288000
    buffer_load_dword v89, v5, s[64:67], s71 offen
    s_add_u32 s71, s70, 289280
    buffer_load_dword v90, v5, s[64:67], s71 offen
    s_add_u32 s71, s70, 290560
    buffer_load_dword v91, v5, s[64:67], s71 offen
    s_add_u32 s71, s70, 291840
    buffer_load_dword v92, v5, s[64:67], s71 offen
    s_add_u32 s71, s70, 293120
    buffer_load_dword v93, v5, s[64:67], s71 offen
    s_add_u32 s71, s70, 294400
    buffer_load_dword v94, v5, s[64:67], s71 offen
    s_add_u32 s71, s70, 295680
    buffer_load_dword v95, v5, s[64:67], s71 offen
    s_add_u32 s71, s70, 327680
    buffer_load_dword v96, v5, s[64:67], s71 offen
    s_add_u32 s71, s70, 328960
    buffer_load_dword v97, v5, s[64:67], s71 offen
    s_add_u32 s71, s70, 330240
    buffer_load_dword v98, v5, s[64:67], s71 offen
    s_add_u32 s71, s70, 331520
    buffer_load_dword v99, v5, s[64:67], s71 offen
    s_add_u32 s71, s70, 332800
    buffer_load_dword v100, v5, s[64:67], s71 offen
    s_add_u32 s71, s70, 334080
    buffer_load_dword v101, v5, s[64:67], s71 offen
    s_add_u32 s71, s70, 335360
    buffer_load_dword v102, v5, s[64:67], s71 offen
    s_add_u32 s71, s70, 336640
    buffer_load_dword v103, v5, s[64:67], s71 offen
    s_add_u32 s71, s70, 368640
    buffer_load_dword v104, v5, s[64:67], s71 offen
    s_add_u32 s71, s70, 369920
    buffer_load_dword v105, v5, s[64:67], s71 offen
    s_add_u32 s71, s70, 371200
    buffer_load_dword v106, v5, s[64:67], s71 offen
    s_add_u32 s71, s70, 372480
    buffer_load_dword v107, v5, s[64:67], s71 offen
    s_add_u32 s71, s70, 373760
    buffer_load_dword v108, v5, s[64:67], s71 offen
    s_add_u32 s71, s70, 375040
    buffer_load_dword v109, v5, s[64:67], s71 offen
    s_add_u32 s71, s70, 376320
    buffer_load_dword v110, v5, s[64:67], s71 offen
    s_add_u32 s71, s70, 377600
    buffer_load_dword v111, v5, s[64:67], s71 offen
    s_add_u32 s71, s70, 409600
    buffer_load_dword v112, v5, s[64:67], s71 offen
    s_add_u32 s71, s70, 410880
    buffer_load_dword v113, v5, s[64:67], s71 offen
    s_add_u32 s71, s70, 412160
    buffer_load_dword v114, v5, s[64:67], s71 offen
    s_add_u32 s71, s70, 413440
    buffer_load_dword v115, v5, s[64:67], s71 offen
    s_add_u32 s71, s70, 414720
    buffer_load_dword v116, v5, s[64:67], s71 offen
    s_add_u32 s71, s70, 416000
    buffer_load_dword v117, v5, s[64:67], s71 offen
    s_add_u32 s71, s70, 417280
    buffer_load_dword v118, v5, s[64:67], s71 offen
    s_add_u32 s71, s70, 418560
    buffer_load_dword v119, v5, s[64:67], s71 offen
    s_add_u32 s71, s70, 450560
    buffer_load_dword v120, v5, s[64:67], s71 offen
    s_add_u32 s71, s70, 451840
    buffer_load_dword v121, v5, s[64:67], s71 offen
    s_add_u32 s71, s70, 453120
    buffer_load_dword v122, v5, s[64:67], s71 offen
    s_add_u32 s71, s70, 454400
    buffer_load_dword v123, v5, s[64:67], s71 offen
    s_add_u32 s71, s70, 455680
    buffer_load_dword v124, v5, s[64:67], s71 offen
    s_add_u32 s71, s70, 456960
    buffer_load_dword v125, v5, s[64:67], s71 offen
    s_add_u32 s71, s70, 458240
    buffer_load_dword v126, v5, s[64:67], s71 offen
    s_add_u32 s71, s70, 459520
    buffer_load_dword v127, v5, s[64:67], s71 offen
    s_waitcnt vmcnt(63)
    v_perm_b32 v28, v33, v32, s72
    v_perm_b32 v29, v35, v34, s72
    v_perm_b32 v30, v37, v36, s72
    v_perm_b32 v31, v39, v38, s72
    v_accvgpr_write_b32 a0, v28
    v_accvgpr_write_b32 a1, v29
    v_accvgpr_write_b32 a2, v30
    v_accvgpr_write_b32 a3, v31
    v_perm_b32 v28, v33, v32, s73
    v_perm_b32 v29, v35, v34, s73
    v_perm_b32 v30, v37, v36, s73
    v_perm_b32 v31, v39, v38, s73
    v_accvgpr_write_b32 a192, v28
    v_accvgpr_write_b32 a193, v29
    v_accvgpr_write_b32 a194, v30
    v_accvgpr_write_b32 a195, v31
    v_perm_b32 v28, v41, v40, s72
    v_perm_b32 v29, v43, v42, s72
    v_perm_b32 v30, v45, v44, s72
    v_perm_b32 v31, v47, v46, s72
    v_accvgpr_write_b32 a4, v28
    v_accvgpr_write_b32 a5, v29
    v_accvgpr_write_b32 a6, v30
    v_accvgpr_write_b32 a7, v31
    v_perm_b32 v28, v41, v40, s73
    v_perm_b32 v29, v43, v42, s73
    v_perm_b32 v30, v45, v44, s73
    v_perm_b32 v31, v47, v46, s73
    v_accvgpr_write_b32 a196, v28
    v_accvgpr_write_b32 a197, v29
    v_accvgpr_write_b32 a198, v30
    v_accvgpr_write_b32 a199, v31
    v_perm_b32 v28, v49, v48, s72
    v_perm_b32 v29, v51, v50, s72
    v_perm_b32 v30, v53, v52, s72
    v_perm_b32 v31, v55, v54, s72
    v_accvgpr_write_b32 a8, v28
    v_accvgpr_write_b32 a9, v29
    v_accvgpr_write_b32 a10, v30
    v_accvgpr_write_b32 a11, v31
    v_perm_b32 v28, v49, v48, s73
    v_perm_b32 v29, v51, v50, s73
    v_perm_b32 v30, v53, v52, s73
    v_perm_b32 v31, v55, v54, s73
    v_accvgpr_write_b32 a200, v28
    v_accvgpr_write_b32 a201, v29
    v_accvgpr_write_b32 a202, v30
    v_accvgpr_write_b32 a203, v31
    v_perm_b32 v28, v57, v56, s72
    v_perm_b32 v29, v59, v58, s72
    v_perm_b32 v30, v61, v60, s72
    v_perm_b32 v31, v63, v62, s72
    v_accvgpr_write_b32 a12, v28
    v_accvgpr_write_b32 a13, v29
    v_accvgpr_write_b32 a14, v30
    v_accvgpr_write_b32 a15, v31
    v_perm_b32 v28, v57, v56, s73
    v_perm_b32 v29, v59, v58, s73
    v_perm_b32 v30, v61, v60, s73
    v_perm_b32 v31, v63, v62, s73
    v_accvgpr_write_b32 a204, v28
    v_accvgpr_write_b32 a205, v29
    v_accvgpr_write_b32 a206, v30
    v_accvgpr_write_b32 a207, v31
    s_add_u32 s71, s70, 491520
    buffer_load_dword v32, v5, s[64:67], s71 offen
    s_add_u32 s71, s70, 492800
    buffer_load_dword v33, v5, s[64:67], s71 offen
    s_add_u32 s71, s70, 494080
    buffer_load_dword v34, v5, s[64:67], s71 offen
    s_add_u32 s71, s70, 495360
    buffer_load_dword v35, v5, s[64:67], s71 offen
    s_add_u32 s71, s70, 496640
    buffer_load_dword v36, v5, s[64:67], s71 offen
    s_add_u32 s71, s70, 497920
    buffer_load_dword v37, v5, s[64:67], s71 offen
    s_add_u32 s71, s70, 499200
    buffer_load_dword v38, v5, s[64:67], s71 offen
    s_add_u32 s71, s70, 500480
    buffer_load_dword v39, v5, s[64:67], s71 offen
    s_add_u32 s71, s70, 532480
    buffer_load_dword v40, v5, s[64:67], s71 offen
    s_add_u32 s71, s70, 533760
    buffer_load_dword v41, v5, s[64:67], s71 offen
    s_add_u32 s71, s70, 535040
    buffer_load_dword v42, v5, s[64:67], s71 offen
    s_add_u32 s71, s70, 536320
    buffer_load_dword v43, v5, s[64:67], s71 offen
    s_add_u32 s71, s70, 537600
    buffer_load_dword v44, v5, s[64:67], s71 offen
    s_add_u32 s71, s70, 538880
    buffer_load_dword v45, v5, s[64:67], s71 offen
    s_add_u32 s71, s70, 540160
    buffer_load_dword v46, v5, s[64:67], s71 offen
    s_add_u32 s71, s70, 541440
    buffer_load_dword v47, v5, s[64:67], s71 offen
    s_add_u32 s71, s70, 573440
    buffer_load_dword v48, v5, s[64:67], s71 offen
    s_add_u32 s71, s70, 574720
    buffer_load_dword v49, v5, s[64:67], s71 offen
    s_add_u32 s71, s70, 576000
    buffer_load_dword v50, v5, s[64:67], s71 offen
    s_add_u32 s71, s70, 577280
    buffer_load_dword v51, v5, s[64:67], s71 offen
    s_add_u32 s71, s70, 578560
    buffer_load_dword v52, v5, s[64:67], s71 offen
    s_add_u32 s71, s70, 579840
    buffer_load_dword v53, v5, s[64:67], s71 offen
    s_add_u32 s71, s70, 581120
    buffer_load_dword v54, v5, s[64:67], s71 offen
    s_add_u32 s71, s70, 582400
    buffer_load_dword v55, v5, s[64:67], s71 offen
    s_add_u32 s71, s70, 614400
    buffer_load_dword v56, v5, s[64:67], s71 offen
    s_add_u32 s71, s70, 615680
    buffer_load_dword v57, v5, s[64:67], s71 offen
    s_add_u32 s71, s70, 616960
    buffer_load_dword v58, v5, s[64:67], s71 offen
    s_add_u32 s71, s70, 618240
    buffer_load_dword v59, v5, s[64:67], s71 offen
    s_add_u32 s71, s70, 619520
    buffer_load_dword v60, v5, s[64:67], s71 offen
    s_add_u32 s71, s70, 620800
    buffer_load_dword v61, v5, s[64:67], s71 offen
    s_add_u32 s71, s70, 622080
    buffer_load_dword v62, v5, s[64:67], s71 offen
    s_add_u32 s71, s70, 623360
    buffer_load_dword v63, v5, s[64:67], s71 offen
    s_waitcnt vmcnt(63)
    v_perm_b32 v28, v65, v64, s72
    v_perm_b32 v29, v67, v66, s72
    v_perm_b32 v30, v69, v68, s72
    v_perm_b32 v31, v71, v70, s72
    v_accvgpr_write_b32 a16, v28
    v_accvgpr_write_b32 a17, v29
    v_accvgpr_write_b32 a18, v30
    v_accvgpr_write_b32 a19, v31
    v_perm_b32 v28, v65, v64, s73
    v_perm_b32 v29, v67, v66, s73
    v_perm_b32 v30, v69, v68, s73
    v_perm_b32 v31, v71, v70, s73
    v_accvgpr_write_b32 a208, v28
    v_accvgpr_write_b32 a209, v29
    v_accvgpr_write_b32 a210, v30
    v_accvgpr_write_b32 a211, v31
    v_perm_b32 v28, v73, v72, s72
    v_perm_b32 v29, v75, v74, s72
    v_perm_b32 v30, v77, v76, s72
    v_perm_b32 v31, v79, v78, s72
    v_accvgpr_write_b32 a20, v28
    v_accvgpr_write_b32 a21, v29
    v_accvgpr_write_b32 a22, v30
    v_accvgpr_write_b32 a23, v31
    v_perm_b32 v28, v73, v72, s73
    v_perm_b32 v29, v75, v74, s73
    v_perm_b32 v30, v77, v76, s73
    v_perm_b32 v31, v79, v78, s73
    v_accvgpr_write_b32 a212, v28
    v_accvgpr_write_b32 a213, v29
    v_accvgpr_write_b32 a214, v30
    v_accvgpr_write_b32 a215, v31
    v_perm_b32 v28, v81, v80, s72
    v_perm_b32 v29, v83, v82, s72
    v_perm_b32 v30, v85, v84, s72
    v_perm_b32 v31, v87, v86, s72
    v_accvgpr_write_b32 a24, v28
    v_accvgpr_write_b32 a25, v29
    v_accvgpr_write_b32 a26, v30
    v_accvgpr_write_b32 a27, v31
    v_perm_b32 v28, v81, v80, s73
    v_perm_b32 v29, v83, v82, s73
    v_perm_b32 v30, v85, v84, s73
    v_perm_b32 v31, v87, v86, s73
    v_accvgpr_write_b32 a216, v28
    v_accvgpr_write_b32 a217, v29
    v_accvgpr_write_b32 a218, v30
    v_accvgpr_write_b32 a219, v31
    v_perm_b32 v28, v89, v88, s72
    v_perm_b32 v29, v91, v90, s72
    v_perm_b32 v30, v93, v92, s72
    v_perm_b32 v31, v95, v94, s72
    v_accvgpr_write_b32 a28, v28
    v_accvgpr_write_b32 a29, v29
    v_accvgpr_write_b32 a30, v30
    v_accvgpr_write_b32 a31, v31
    v_perm_b32 v28, v89, v88, s73
    v_perm_b32 v29, v91, v90, s73
    v_perm_b32 v30, v93, v92, s73
    v_perm_b32 v31, v95, v94, s73
    v_accvgpr_write_b32 a220, v28
    v_accvgpr_write_b32 a221, v29
    v_accvgpr_write_b32 a222, v30
    v_accvgpr_write_b32 a223, v31
    s_add_u32 s71, s70, 655360
    buffer_load_dword v64, v5, s[64:67], s71 offen
    s_add_u32 s71, s70, 656640
    buffer_load_dword v65, v5, s[64:67], s71 offen
    s_add_u32 s71, s70, 657920
    buffer_load_dword v66, v5, s[64:67], s71 offen
    s_add_u32 s71, s70, 659200
    buffer_load_dword v67, v5, s[64:67], s71 offen
    s_add_u32 s71, s70, 660480
    buffer_load_dword v68, v5, s[64:67], s71 offen
    s_add_u32 s71, s70, 661760
    buffer_load_dword v69, v5, s[64:67], s71 offen
    s_add_u32 s71, s70, 663040
    buffer_load_dword v70, v5, s[64:67], s71 offen
    s_add_u32 s71, s70, 664320
    buffer_load_dword v71, v5, s[64:67], s71 offen
    s_add_u32 s71, s70, 696320
    buffer_load_dword v72, v5, s[64:67], s71 offen
    s_add_u32 s71, s70, 697600
    buffer_load_dword v73, v5, s[64:67], s71 offen
    s_add_u32 s71, s70, 698880
    buffer_load_dword v74, v5, s[64:67], s71 offen
    s_add_u32 s71, s70, 700160
    buffer_load_dword v75, v5, s[64:67], s71 offen
    s_add_u32 s71, s70, 701440
    buffer_load_dword v76, v5, s[64:67], s71 offen
    s_add_u32 s71, s70, 702720
    buffer_load_dword v77, v5, s[64:67], s71 offen
    s_add_u32 s71, s70, 704000
    buffer_load_dword v78, v5, s[64:67], s71 offen
    s_add_u32 s71, s70, 705280
    buffer_load_dword v79, v5, s[64:67], s71 offen
    s_add_u32 s71, s70, 737280
    buffer_load_dword v80, v5, s[64:67], s71 offen
    s_add_u32 s71, s70, 738560
    buffer_load_dword v81, v5, s[64:67], s71 offen
    s_add_u32 s71, s70, 739840
    buffer_load_dword v82, v5, s[64:67], s71 offen
    s_add_u32 s71, s70, 741120
    buffer_load_dword v83, v5, s[64:67], s71 offen
    s_add_u32 s71, s70, 742400
    buffer_load_dword v84, v5, s[64:67], s71 offen
    s_add_u32 s71, s70, 743680
    buffer_load_dword v85, v5, s[64:67], s71 offen
    s_add_u32 s71, s70, 744960
    buffer_load_dword v86, v5, s[64:67], s71 offen
    s_add_u32 s71, s70, 746240
    buffer_load_dword v87, v5, s[64:67], s71 offen
    s_add_u32 s71, s70, 778240
    buffer_load_dword v88, v5, s[64:67], s71 offen
    s_add_u32 s71, s70, 779520
    buffer_load_dword v89, v5, s[64:67], s71 offen
    s_add_u32 s71, s70, 780800
    buffer_load_dword v90, v5, s[64:67], s71 offen
    s_add_u32 s71, s70, 782080
    buffer_load_dword v91, v5, s[64:67], s71 offen
    s_add_u32 s71, s70, 783360
    buffer_load_dword v92, v5, s[64:67], s71 offen
    s_add_u32 s71, s70, 784640
    buffer_load_dword v93, v5, s[64:67], s71 offen
    s_add_u32 s71, s70, 785920
    buffer_load_dword v94, v5, s[64:67], s71 offen
    s_add_u32 s71, s70, 787200
    buffer_load_dword v95, v5, s[64:67], s71 offen
    s_waitcnt vmcnt(63)
    v_perm_b32 v28, v97, v96, s72
    v_perm_b32 v29, v99, v98, s72
    v_perm_b32 v30, v101, v100, s72
    v_perm_b32 v31, v103, v102, s72
    v_accvgpr_write_b32 a32, v28
    v_accvgpr_write_b32 a33, v29
    v_accvgpr_write_b32 a34, v30
    v_accvgpr_write_b32 a35, v31
    v_perm_b32 v28, v97, v96, s73
    v_perm_b32 v29, v99, v98, s73
    v_perm_b32 v30, v101, v100, s73
    v_perm_b32 v31, v103, v102, s73
    v_accvgpr_write_b32 a224, v28
    v_accvgpr_write_b32 a225, v29
    v_accvgpr_write_b32 a226, v30
    v_accvgpr_write_b32 a227, v31
    v_perm_b32 v28, v105, v104, s72
    v_perm_b32 v29, v107, v106, s72
    v_perm_b32 v30, v109, v108, s72
    v_perm_b32 v31, v111, v110, s72
    v_accvgpr_write_b32 a36, v28
    v_accvgpr_write_b32 a37, v29
    v_accvgpr_write_b32 a38, v30
    v_accvgpr_write_b32 a39, v31
    v_perm_b32 v28, v105, v104, s73
    v_perm_b32 v29, v107, v106, s73
    v_perm_b32 v30, v109, v108, s73
    v_perm_b32 v31, v111, v110, s73
    v_accvgpr_write_b32 a228, v28
    v_accvgpr_write_b32 a229, v29
    v_accvgpr_write_b32 a230, v30
    v_accvgpr_write_b32 a231, v31
    v_perm_b32 v28, v113, v112, s72
    v_perm_b32 v29, v115, v114, s72
    v_perm_b32 v30, v117, v116, s72
    v_perm_b32 v31, v119, v118, s72
    v_accvgpr_write_b32 a40, v28
    v_accvgpr_write_b32 a41, v29
    v_accvgpr_write_b32 a42, v30
    v_accvgpr_write_b32 a43, v31
    v_perm_b32 v28, v113, v112, s73
    v_perm_b32 v29, v115, v114, s73
    v_perm_b32 v30, v117, v116, s73
    v_perm_b32 v31, v119, v118, s73
    v_accvgpr_write_b32 a232, v28
    v_accvgpr_write_b32 a233, v29
    v_accvgpr_write_b32 a234, v30
    v_accvgpr_write_b32 a235, v31
    v_perm_b32 v28, v121, v120, s72
    v_perm_b32 v29, v123, v122, s72
    v_perm_b32 v30, v125, v124, s72
    v_perm_b32 v31, v127, v126, s72
    v_accvgpr_write_b32 a44, v28
    v_accvgpr_write_b32 a45, v29
    v_accvgpr_write_b32 a46, v30
    v_accvgpr_write_b32 a47, v31
    v_perm_b32 v28, v121, v120, s73
    v_perm_b32 v29, v123, v122, s73
    v_perm_b32 v30, v125, v124, s73
    v_perm_b32 v31, v127, v126, s73
    v_accvgpr_write_b32 a236, v28
    v_accvgpr_write_b32 a237, v29
    v_accvgpr_write_b32 a238, v30
    v_accvgpr_write_b32 a239, v31
    s_add_u32 s71, s70, 819200
    buffer_load_dword v96, v5, s[64:67], s71 offen
    s_add_u32 s71, s70, 820480
    buffer_load_dword v97, v5, s[64:67], s71 offen
    s_add_u32 s71, s70, 821760
    buffer_load_dword v98, v5, s[64:67], s71 offen
    s_add_u32 s71, s70, 823040
    buffer_load_dword v99, v5, s[64:67], s71 offen
    s_add_u32 s71, s70, 824320
    buffer_load_dword v100, v5, s[64:67], s71 offen
    s_add_u32 s71, s70, 825600
    buffer_load_dword v101, v5, s[64:67], s71 offen
    s_add_u32 s71, s70, 826880
    buffer_load_dword v102, v5, s[64:67], s71 offen
    s_add_u32 s71, s70, 828160
    buffer_load_dword v103, v5, s[64:67], s71 offen
    s_add_u32 s71, s70, 860160
    buffer_load_dword v104, v5, s[64:67], s71 offen
    s_add_u32 s71, s70, 861440
    buffer_load_dword v105, v5, s[64:67], s71 offen
    s_add_u32 s71, s70, 862720
    buffer_load_dword v106, v5, s[64:67], s71 offen
    s_add_u32 s71, s70, 864000
    buffer_load_dword v107, v5, s[64:67], s71 offen
    s_add_u32 s71, s70, 865280
    buffer_load_dword v108, v5, s[64:67], s71 offen
    s_add_u32 s71, s70, 866560
    buffer_load_dword v109, v5, s[64:67], s71 offen
    s_add_u32 s71, s70, 867840
    buffer_load_dword v110, v5, s[64:67], s71 offen
    s_add_u32 s71, s70, 869120
    buffer_load_dword v111, v5, s[64:67], s71 offen
    s_add_u32 s71, s70, 901120
    buffer_load_dword v112, v5, s[64:67], s71 offen
    s_add_u32 s71, s70, 902400
    buffer_load_dword v113, v5, s[64:67], s71 offen
    s_add_u32 s71, s70, 903680
    buffer_load_dword v114, v5, s[64:67], s71 offen
    s_add_u32 s71, s70, 904960
    buffer_load_dword v115, v5, s[64:67], s71 offen
    s_add_u32 s71, s70, 906240
    buffer_load_dword v116, v5, s[64:67], s71 offen
    s_add_u32 s71, s70, 907520
    buffer_load_dword v117, v5, s[64:67], s71 offen
    s_add_u32 s71, s70, 908800
    buffer_load_dword v118, v5, s[64:67], s71 offen
    s_add_u32 s71, s70, 910080
    buffer_load_dword v119, v5, s[64:67], s71 offen
    s_add_u32 s71, s70, 942080
    buffer_load_dword v120, v5, s[64:67], s71 offen
    s_add_u32 s71, s70, 943360
    buffer_load_dword v121, v5, s[64:67], s71 offen
    s_add_u32 s71, s70, 944640
    buffer_load_dword v122, v5, s[64:67], s71 offen
    s_add_u32 s71, s70, 945920
    buffer_load_dword v123, v5, s[64:67], s71 offen
    s_add_u32 s71, s70, 947200
    buffer_load_dword v124, v5, s[64:67], s71 offen
    s_add_u32 s71, s70, 948480
    buffer_load_dword v125, v5, s[64:67], s71 offen
    s_add_u32 s71, s70, 949760
    buffer_load_dword v126, v5, s[64:67], s71 offen
    s_add_u32 s71, s70, 951040
    buffer_load_dword v127, v5, s[64:67], s71 offen
    s_waitcnt vmcnt(63)
    v_perm_b32 v28, v33, v32, s72
    v_perm_b32 v29, v35, v34, s72
    v_perm_b32 v30, v37, v36, s72
    v_perm_b32 v31, v39, v38, s72
    v_accvgpr_write_b32 a48, v28
    v_accvgpr_write_b32 a49, v29
    v_accvgpr_write_b32 a50, v30
    v_accvgpr_write_b32 a51, v31
    v_perm_b32 v28, v33, v32, s73
    v_perm_b32 v29, v35, v34, s73
    v_perm_b32 v30, v37, v36, s73
    v_perm_b32 v31, v39, v38, s73
    v_accvgpr_write_b32 a240, v28
    v_accvgpr_write_b32 a241, v29
    v_accvgpr_write_b32 a242, v30
    v_accvgpr_write_b32 a243, v31
    v_perm_b32 v28, v41, v40, s72
    v_perm_b32 v29, v43, v42, s72
    v_perm_b32 v30, v45, v44, s72
    v_perm_b32 v31, v47, v46, s72
    v_accvgpr_write_b32 a52, v28
    v_accvgpr_write_b32 a53, v29
    v_accvgpr_write_b32 a54, v30
    v_accvgpr_write_b32 a55, v31
    v_perm_b32 v28, v41, v40, s73
    v_perm_b32 v29, v43, v42, s73
    v_perm_b32 v30, v45, v44, s73
    v_perm_b32 v31, v47, v46, s73
    v_accvgpr_write_b32 a244, v28
    v_accvgpr_write_b32 a245, v29
    v_accvgpr_write_b32 a246, v30
    v_accvgpr_write_b32 a247, v31
    v_perm_b32 v28, v49, v48, s72
    v_perm_b32 v29, v51, v50, s72
    v_perm_b32 v30, v53, v52, s72
    v_perm_b32 v31, v55, v54, s72
    v_accvgpr_write_b32 a56, v28
    v_accvgpr_write_b32 a57, v29
    v_accvgpr_write_b32 a58, v30
    v_accvgpr_write_b32 a59, v31
    v_perm_b32 v28, v49, v48, s73
    v_perm_b32 v29, v51, v50, s73
    v_perm_b32 v30, v53, v52, s73
    v_perm_b32 v31, v55, v54, s73
    v_accvgpr_write_b32 a248, v28
    v_accvgpr_write_b32 a249, v29
    v_accvgpr_write_b32 a250, v30
    v_accvgpr_write_b32 a251, v31
    v_perm_b32 v28, v57, v56, s72
    v_perm_b32 v29, v59, v58, s72
    v_perm_b32 v30, v61, v60, s72
    v_perm_b32 v31, v63, v62, s72
    v_accvgpr_write_b32 a60, v28
    v_accvgpr_write_b32 a61, v29
    v_accvgpr_write_b32 a62, v30
    v_accvgpr_write_b32 a63, v31
    v_perm_b32 v28, v57, v56, s73
    v_perm_b32 v29, v59, v58, s73
    v_perm_b32 v30, v61, v60, s73
    v_perm_b32 v31, v63, v62, s73
    v_accvgpr_write_b32 a252, v28
    v_accvgpr_write_b32 a253, v29
    v_accvgpr_write_b32 a254, v30
    v_accvgpr_write_b32 a255, v31
    s_add_u32 s71, s70, 983040
    buffer_load_dword v32, v5, s[64:67], s71 offen
    s_add_u32 s71, s70, 984320
    buffer_load_dword v33, v5, s[64:67], s71 offen
    s_add_u32 s71, s70, 985600
    buffer_load_dword v34, v5, s[64:67], s71 offen
    s_add_u32 s71, s70, 986880
    buffer_load_dword v35, v5, s[64:67], s71 offen
    s_add_u32 s71, s70, 988160
    buffer_load_dword v36, v5, s[64:67], s71 offen
    s_add_u32 s71, s70, 989440
    buffer_load_dword v37, v5, s[64:67], s71 offen
    s_add_u32 s71, s70, 990720
    buffer_load_dword v38, v5, s[64:67], s71 offen
    s_add_u32 s71, s70, 992000
    buffer_load_dword v39, v5, s[64:67], s71 offen
    s_add_u32 s71, s70, 1024000
    buffer_load_dword v40, v5, s[64:67], s71 offen
    s_add_u32 s71, s70, 1025280
    buffer_load_dword v41, v5, s[64:67], s71 offen
    s_add_u32 s71, s70, 1026560
    buffer_load_dword v42, v5, s[64:67], s71 offen
    s_add_u32 s71, s70, 1027840
    buffer_load_dword v43, v5, s[64:67], s71 offen
    s_add_u32 s71, s70, 1029120
    buffer_load_dword v44, v5, s[64:67], s71 offen
    s_add_u32 s71, s70, 1030400
    buffer_load_dword v45, v5, s[64:67], s71 offen
    s_add_u32 s71, s70, 1031680
    buffer_load_dword v46, v5, s[64:67], s71 offen
    s_add_u32 s71, s70, 1032960
    buffer_load_dword v47, v5, s[64:67], s71 offen
    s_add_u32 s71, s70, 1064960
    buffer_load_dword v48, v5, s[64:67], s71 offen
    s_add_u32 s71, s70, 1066240
    buffer_load_dword v49, v5, s[64:67], s71 offen
    s_add_u32 s71, s70, 1067520
    buffer_load_dword v50, v5, s[64:67], s71 offen
    s_add_u32 s71, s70, 1068800
    buffer_load_dword v51, v5, s[64:67], s71 offen
    s_add_u32 s71, s70, 1070080
    buffer_load_dword v52, v5, s[64:67], s71 offen
    s_add_u32 s71, s70, 1071360
    buffer_load_dword v53, v5, s[64:67], s71 offen
    s_add_u32 s71, s70, 1072640
    buffer_load_dword v54, v5, s[64:67], s71 offen
    s_add_u32 s71, s70, 1073920
    buffer_load_dword v55, v5, s[64:67], s71 offen
    s_add_u32 s71, s70, 1105920
    buffer_load_dword v56, v5, s[64:67], s71 offen
    s_add_u32 s71, s70, 1107200
    buffer_load_dword v57, v5, s[64:67], s71 offen
    s_add_u32 s71, s70, 1108480
    buffer_load_dword v58, v5, s[64:67], s71 offen
    s_add_u32 s71, s70, 1109760
    buffer_load_dword v59, v5, s[64:67], s71 offen
    s_add_u32 s71, s70, 1111040
    buffer_load_dword v60, v5, s[64:67], s71 offen
    s_add_u32 s71, s70, 1112320
    buffer_load_dword v61, v5, s[64:67], s71 offen
    s_add_u32 s71, s70, 1113600
    buffer_load_dword v62, v5, s[64:67], s71 offen
    s_add_u32 s71, s70, 1114880
    buffer_load_dword v63, v5, s[64:67], s71 offen
    s_waitcnt vmcnt(63)
    v_perm_b32 v28, v65, v64, s72
    v_perm_b32 v29, v67, v66, s72
    v_perm_b32 v30, v69, v68, s72
    v_perm_b32 v31, v71, v70, s72
    v_accvgpr_write_b32 a64, v28
    v_accvgpr_write_b32 a65, v29
    v_accvgpr_write_b32 a66, v30
    v_accvgpr_write_b32 a67, v31
    v_perm_b32 v128, v65, v64, s73
    v_perm_b32 v129, v67, v66, s73
    v_perm_b32 v130, v69, v68, s73
    v_perm_b32 v131, v71, v70, s73
    v_perm_b32 v28, v73, v72, s72
    v_perm_b32 v29, v75, v74, s72
    v_perm_b32 v30, v77, v76, s72
    v_perm_b32 v31, v79, v78, s72
    v_accvgpr_write_b32 a68, v28
    v_accvgpr_write_b32 a69, v29
    v_accvgpr_write_b32 a70, v30
    v_accvgpr_write_b32 a71, v31
    v_perm_b32 v132, v73, v72, s73
    v_perm_b32 v133, v75, v74, s73
    v_perm_b32 v134, v77, v76, s73
    v_perm_b32 v135, v79, v78, s73
    v_perm_b32 v28, v81, v80, s72
    v_perm_b32 v29, v83, v82, s72
    v_perm_b32 v30, v85, v84, s72
    v_perm_b32 v31, v87, v86, s72
    v_accvgpr_write_b32 a72, v28
    v_accvgpr_write_b32 a73, v29
    v_accvgpr_write_b32 a74, v30
    v_accvgpr_write_b32 a75, v31
    v_perm_b32 v136, v81, v80, s73
    v_perm_b32 v137, v83, v82, s73
    v_perm_b32 v138, v85, v84, s73
    v_perm_b32 v139, v87, v86, s73
    v_perm_b32 v28, v89, v88, s72
    v_perm_b32 v29, v91, v90, s72
    v_perm_b32 v30, v93, v92, s72
    v_perm_b32 v31, v95, v94, s72
    v_accvgpr_write_b32 a76, v28
    v_accvgpr_write_b32 a77, v29
    v_accvgpr_write_b32 a78, v30
    v_accvgpr_write_b32 a79, v31
    v_perm_b32 v140, v89, v88, s73
    v_perm_b32 v141, v91, v90, s73
    v_perm_b32 v142, v93, v92, s73
    v_perm_b32 v143, v95, v94, s73
    s_add_u32 s71, s70, 1146880
    buffer_load_dword v64, v5, s[64:67], s71 offen
    s_add_u32 s71, s70, 1148160
    buffer_load_dword v65, v5, s[64:67], s71 offen
    s_add_u32 s71, s70, 1149440
    buffer_load_dword v66, v5, s[64:67], s71 offen
    s_add_u32 s71, s70, 1150720
    buffer_load_dword v67, v5, s[64:67], s71 offen
    s_add_u32 s71, s70, 1152000
    buffer_load_dword v68, v5, s[64:67], s71 offen
    s_add_u32 s71, s70, 1153280
    buffer_load_dword v69, v5, s[64:67], s71 offen
    s_add_u32 s71, s70, 1154560
    buffer_load_dword v70, v5, s[64:67], s71 offen
    s_add_u32 s71, s70, 1155840
    buffer_load_dword v71, v5, s[64:67], s71 offen
    s_add_u32 s71, s70, 1187840
    buffer_load_dword v72, v5, s[64:67], s71 offen
    s_add_u32 s71, s70, 1189120
    buffer_load_dword v73, v5, s[64:67], s71 offen
    s_add_u32 s71, s70, 1190400
    buffer_load_dword v74, v5, s[64:67], s71 offen
    s_add_u32 s71, s70, 1191680
    buffer_load_dword v75, v5, s[64:67], s71 offen
    s_add_u32 s71, s70, 1192960
    buffer_load_dword v76, v5, s[64:67], s71 offen
    s_add_u32 s71, s70, 1194240
    buffer_load_dword v77, v5, s[64:67], s71 offen
    s_add_u32 s71, s70, 1195520
    buffer_load_dword v78, v5, s[64:67], s71 offen
    s_add_u32 s71, s70, 1196800
    buffer_load_dword v79, v5, s[64:67], s71 offen
    s_add_u32 s71, s70, 1228800
    buffer_load_dword v80, v5, s[64:67], s71 offen
    s_add_u32 s71, s70, 1230080
    buffer_load_dword v81, v5, s[64:67], s71 offen
    s_add_u32 s71, s70, 1231360
    buffer_load_dword v82, v5, s[64:67], s71 offen
    s_add_u32 s71, s70, 1232640
    buffer_load_dword v83, v5, s[64:67], s71 offen
    s_add_u32 s71, s70, 1233920
    buffer_load_dword v84, v5, s[64:67], s71 offen
    s_add_u32 s71, s70, 1235200
    buffer_load_dword v85, v5, s[64:67], s71 offen
    s_add_u32 s71, s70, 1236480
    buffer_load_dword v86, v5, s[64:67], s71 offen
    s_add_u32 s71, s70, 1237760
    buffer_load_dword v87, v5, s[64:67], s71 offen
    s_add_u32 s71, s70, 1269760
    buffer_load_dword v88, v5, s[64:67], s71 offen
    s_add_u32 s71, s70, 1271040
    buffer_load_dword v89, v5, s[64:67], s71 offen
    s_add_u32 s71, s70, 1272320
    buffer_load_dword v90, v5, s[64:67], s71 offen
    s_add_u32 s71, s70, 1273600
    buffer_load_dword v91, v5, s[64:67], s71 offen
    s_add_u32 s71, s70, 1274880
    buffer_load_dword v92, v5, s[64:67], s71 offen
    s_add_u32 s71, s70, 1276160
    buffer_load_dword v93, v5, s[64:67], s71 offen
    s_add_u32 s71, s70, 1277440
    buffer_load_dword v94, v5, s[64:67], s71 offen
    s_add_u32 s71, s70, 1278720
    buffer_load_dword v95, v5, s[64:67], s71 offen
    s_waitcnt vmcnt(63)
    v_perm_b32 v28, v97, v96, s72
    v_perm_b32 v29, v99, v98, s72
    v_perm_b32 v30, v101, v100, s72
    v_perm_b32 v31, v103, v102, s72
    v_accvgpr_write_b32 a80, v28
    v_accvgpr_write_b32 a81, v29
    v_accvgpr_write_b32 a82, v30
    v_accvgpr_write_b32 a83, v31
    v_perm_b32 v144, v97, v96, s73
    v_perm_b32 v145, v99, v98, s73
    v_perm_b32 v146, v101, v100, s73
    v_perm_b32 v147, v103, v102, s73
    v_perm_b32 v28, v105, v104, s72
    v_perm_b32 v29, v107, v106, s72
    v_perm_b32 v30, v109, v108, s72
    v_perm_b32 v31, v111, v110, s72
    v_accvgpr_write_b32 a84, v28
    v_accvgpr_write_b32 a85, v29
    v_accvgpr_write_b32 a86, v30
    v_accvgpr_write_b32 a87, v31
    v_perm_b32 v148, v105, v104, s73
    v_perm_b32 v149, v107, v106, s73
    v_perm_b32 v150, v109, v108, s73
    v_perm_b32 v151, v111, v110, s73
    v_perm_b32 v28, v113, v112, s72
    v_perm_b32 v29, v115, v114, s72
    v_perm_b32 v30, v117, v116, s72
    v_perm_b32 v31, v119, v118, s72
    v_accvgpr_write_b32 a88, v28
    v_accvgpr_write_b32 a89, v29
    v_accvgpr_write_b32 a90, v30
    v_accvgpr_write_b32 a91, v31
    v_perm_b32 v152, v113, v112, s73
    v_perm_b32 v153, v115, v114, s73
    v_perm_b32 v154, v117, v116, s73
    v_perm_b32 v155, v119, v118, s73
    v_perm_b32 v28, v121, v120, s72
    v_perm_b32 v29, v123, v122, s72
    v_perm_b32 v30, v125, v124, s72
    v_perm_b32 v31, v127, v126, s72
    v_accvgpr_write_b32 a92, v28
    v_accvgpr_write_b32 a93, v29
    v_accvgpr_write_b32 a94, v30
    v_accvgpr_write_b32 a95, v31
    v_perm_b32 v156, v121, v120, s73
    v_perm_b32 v157, v123, v122, s73
    v_perm_b32 v158, v125, v124, s73
    v_perm_b32 v159, v127, v126, s73
    s_add_u32 s71, s70, 1310720
    buffer_load_dword v96, v5, s[64:67], s71 offen
    s_add_u32 s71, s70, 1312000
    buffer_load_dword v97, v5, s[64:67], s71 offen
    s_add_u32 s71, s70, 1313280
    buffer_load_dword v98, v5, s[64:67], s71 offen
    s_add_u32 s71, s70, 1314560
    buffer_load_dword v99, v5, s[64:67], s71 offen
    s_add_u32 s71, s70, 1315840
    buffer_load_dword v100, v5, s[64:67], s71 offen
    s_add_u32 s71, s70, 1317120
    buffer_load_dword v101, v5, s[64:67], s71 offen
    s_add_u32 s71, s70, 1318400
    buffer_load_dword v102, v5, s[64:67], s71 offen
    s_add_u32 s71, s70, 1319680
    buffer_load_dword v103, v5, s[64:67], s71 offen
    s_add_u32 s71, s70, 1351680
    buffer_load_dword v104, v5, s[64:67], s71 offen
    s_add_u32 s71, s70, 1352960
    buffer_load_dword v105, v5, s[64:67], s71 offen
    s_add_u32 s71, s70, 1354240
    buffer_load_dword v106, v5, s[64:67], s71 offen
    s_add_u32 s71, s70, 1355520
    buffer_load_dword v107, v5, s[64:67], s71 offen
    s_add_u32 s71, s70, 1356800
    buffer_load_dword v108, v5, s[64:67], s71 offen
    s_add_u32 s71, s70, 1358080
    buffer_load_dword v109, v5, s[64:67], s71 offen
    s_add_u32 s71, s70, 1359360
    buffer_load_dword v110, v5, s[64:67], s71 offen
    s_add_u32 s71, s70, 1360640
    buffer_load_dword v111, v5, s[64:67], s71 offen
    s_add_u32 s71, s70, 1392640
    buffer_load_dword v112, v5, s[64:67], s71 offen
    s_add_u32 s71, s70, 1393920
    buffer_load_dword v113, v5, s[64:67], s71 offen
    s_add_u32 s71, s70, 1395200
    buffer_load_dword v114, v5, s[64:67], s71 offen
    s_add_u32 s71, s70, 1396480
    buffer_load_dword v115, v5, s[64:67], s71 offen
    s_add_u32 s71, s70, 1397760
    buffer_load_dword v116, v5, s[64:67], s71 offen
    s_add_u32 s71, s70, 1399040
    buffer_load_dword v117, v5, s[64:67], s71 offen
    s_add_u32 s71, s70, 1400320
    buffer_load_dword v118, v5, s[64:67], s71 offen
    s_add_u32 s71, s70, 1401600
    buffer_load_dword v119, v5, s[64:67], s71 offen
    s_add_u32 s71, s70, 1433600
    buffer_load_dword v120, v5, s[64:67], s71 offen
    s_add_u32 s71, s70, 1434880
    buffer_load_dword v121, v5, s[64:67], s71 offen
    s_add_u32 s71, s70, 1436160
    buffer_load_dword v122, v5, s[64:67], s71 offen
    s_add_u32 s71, s70, 1437440
    buffer_load_dword v123, v5, s[64:67], s71 offen
    s_add_u32 s71, s70, 1438720
    buffer_load_dword v124, v5, s[64:67], s71 offen
    s_add_u32 s71, s70, 1440000
    buffer_load_dword v125, v5, s[64:67], s71 offen
    s_add_u32 s71, s70, 1441280
    buffer_load_dword v126, v5, s[64:67], s71 offen
    s_add_u32 s71, s70, 1442560
    buffer_load_dword v127, v5, s[64:67], s71 offen
    s_waitcnt vmcnt(63)
    v_perm_b32 v28, v33, v32, s72
    v_perm_b32 v29, v35, v34, s72
    v_perm_b32 v30, v37, v36, s72
    v_perm_b32 v31, v39, v38, s72
    v_accvgpr_write_b32 a96, v28
    v_accvgpr_write_b32 a97, v29
    v_accvgpr_write_b32 a98, v30
    v_accvgpr_write_b32 a99, v31
    v_perm_b32 v160, v33, v32, s73
    v_perm_b32 v161, v35, v34, s73
    v_perm_b32 v162, v37, v36, s73
    v_perm_b32 v163, v39, v38, s73
    v_perm_b32 v28, v41, v40, s72
    v_perm_b32 v29, v43, v42, s72
    v_perm_b32 v30, v45, v44, s72
    v_perm_b32 v31, v47, v46, s72
    v_accvgpr_write_b32 a100, v28
    v_accvgpr_write_b32 a101, v29
    v_accvgpr_write_b32 a102, v30
    v_accvgpr_write_b32 a103, v31
    v_perm_b32 v164, v41, v40, s73
    v_perm_b32 v165, v43, v42, s73
    v_perm_b32 v166, v45, v44, s73
    v_perm_b32 v167, v47, v46, s73
    v_perm_b32 v28, v49, v48, s72
    v_perm_b32 v29, v51, v50, s72
    v_perm_b32 v30, v53, v52, s72
    v_perm_b32 v31, v55, v54, s72
    v_accvgpr_write_b32 a104, v28
    v_accvgpr_write_b32 a105, v29
    v_accvgpr_write_b32 a106, v30
    v_accvgpr_write_b32 a107, v31
    v_perm_b32 v168, v49, v48, s73
    v_perm_b32 v169, v51, v50, s73
    v_perm_b32 v170, v53, v52, s73
    v_perm_b32 v171, v55, v54, s73
    v_perm_b32 v28, v57, v56, s72
    v_perm_b32 v29, v59, v58, s72
    v_perm_b32 v30, v61, v60, s72
    v_perm_b32 v31, v63, v62, s72
    v_accvgpr_write_b32 a108, v28
    v_accvgpr_write_b32 a109, v29
    v_accvgpr_write_b32 a110, v30
    v_accvgpr_write_b32 a111, v31
    v_perm_b32 v172, v57, v56, s73
    v_perm_b32 v173, v59, v58, s73
    v_perm_b32 v174, v61, v60, s73
    v_perm_b32 v175, v63, v62, s73
    s_add_u32 s71, s70, 1474560
    buffer_load_dword v32, v5, s[64:67], s71 offen
    s_add_u32 s71, s70, 1475840
    buffer_load_dword v33, v5, s[64:67], s71 offen
    s_add_u32 s71, s70, 1477120
    buffer_load_dword v34, v5, s[64:67], s71 offen
    s_add_u32 s71, s70, 1478400
    buffer_load_dword v35, v5, s[64:67], s71 offen
    s_add_u32 s71, s70, 1479680
    buffer_load_dword v36, v5, s[64:67], s71 offen
    s_add_u32 s71, s70, 1480960
    buffer_load_dword v37, v5, s[64:67], s71 offen
    s_add_u32 s71, s70, 1482240
    buffer_load_dword v38, v5, s[64:67], s71 offen
    s_add_u32 s71, s70, 1483520
    buffer_load_dword v39, v5, s[64:67], s71 offen
    s_add_u32 s71, s70, 1515520
    buffer_load_dword v40, v5, s[64:67], s71 offen
    s_add_u32 s71, s70, 1516800
    buffer_load_dword v41, v5, s[64:67], s71 offen
    s_add_u32 s71, s70, 1518080
    buffer_load_dword v42, v5, s[64:67], s71 offen
    s_add_u32 s71, s70, 1519360
    buffer_load_dword v43, v5, s[64:67], s71 offen
    s_add_u32 s71, s70, 1520640
    buffer_load_dword v44, v5, s[64:67], s71 offen
    s_add_u32 s71, s70, 1521920
    buffer_load_dword v45, v5, s[64:67], s71 offen
    s_add_u32 s71, s70, 1523200
    buffer_load_dword v46, v5, s[64:67], s71 offen
    s_add_u32 s71, s70, 1524480
    buffer_load_dword v47, v5, s[64:67], s71 offen
    s_add_u32 s71, s70, 1556480
    buffer_load_dword v48, v5, s[64:67], s71 offen
    s_add_u32 s71, s70, 1557760
    buffer_load_dword v49, v5, s[64:67], s71 offen
    s_add_u32 s71, s70, 1559040
    buffer_load_dword v50, v5, s[64:67], s71 offen
    s_add_u32 s71, s70, 1560320
    buffer_load_dword v51, v5, s[64:67], s71 offen
    s_add_u32 s71, s70, 1561600
    buffer_load_dword v52, v5, s[64:67], s71 offen
    s_add_u32 s71, s70, 1562880
    buffer_load_dword v53, v5, s[64:67], s71 offen
    s_add_u32 s71, s70, 1564160
    buffer_load_dword v54, v5, s[64:67], s71 offen
    s_add_u32 s71, s70, 1565440
    buffer_load_dword v55, v5, s[64:67], s71 offen
    s_add_u32 s71, s70, 1597440
    buffer_load_dword v56, v5, s[64:67], s71 offen
    s_add_u32 s71, s70, 1598720
    buffer_load_dword v57, v5, s[64:67], s71 offen
    s_add_u32 s71, s70, 1600000
    buffer_load_dword v58, v5, s[64:67], s71 offen
    s_add_u32 s71, s70, 1601280
    buffer_load_dword v59, v5, s[64:67], s71 offen
    s_add_u32 s71, s70, 1602560
    buffer_load_dword v60, v5, s[64:67], s71 offen
    s_add_u32 s71, s70, 1603840
    buffer_load_dword v61, v5, s[64:67], s71 offen
    s_add_u32 s71, s70, 1605120
    buffer_load_dword v62, v5, s[64:67], s71 offen
    s_add_u32 s71, s70, 1606400
    buffer_load_dword v63, v5, s[64:67], s71 offen
    s_waitcnt vmcnt(63)
    v_perm_b32 v28, v65, v64, s72
    v_perm_b32 v29, v67, v66, s72
    v_perm_b32 v30, v69, v68, s72
    v_perm_b32 v31, v71, v70, s72
    v_accvgpr_write_b32 a112, v28
    v_accvgpr_write_b32 a113, v29
    v_accvgpr_write_b32 a114, v30
    v_accvgpr_write_b32 a115, v31
    v_perm_b32 v176, v65, v64, s73
    v_perm_b32 v177, v67, v66, s73
    v_perm_b32 v178, v69, v68, s73
    v_perm_b32 v179, v71, v70, s73
    v_perm_b32 v28, v73, v72, s72
    v_perm_b32 v29, v75, v74, s72
    v_perm_b32 v30, v77, v76, s72
    v_perm_b32 v31, v79, v78, s72
    v_accvgpr_write_b32 a116, v28
    v_accvgpr_write_b32 a117, v29
    v_accvgpr_write_b32 a118, v30
    v_accvgpr_write_b32 a119, v31
    v_perm_b32 v180, v73, v72, s73
    v_perm_b32 v181, v75, v74, s73
    v_perm_b32 v182, v77, v76, s73
    v_perm_b32 v183, v79, v78, s73
    v_perm_b32 v28, v81, v80, s72
    v_perm_b32 v29, v83, v82, s72
    v_perm_b32 v30, v85, v84, s72
    v_perm_b32 v31, v87, v86, s72
    v_accvgpr_write_b32 a120, v28
    v_accvgpr_write_b32 a121, v29
    v_accvgpr_write_b32 a122, v30
    v_accvgpr_write_b32 a123, v31
    v_perm_b32 v184, v81, v80, s73
    v_perm_b32 v185, v83, v82, s73
    v_perm_b32 v186, v85, v84, s73
    v_perm_b32 v187, v87, v86, s73
    v_perm_b32 v28, v89, v88, s72
    v_perm_b32 v29, v91, v90, s72
    v_perm_b32 v30, v93, v92, s72
    v_perm_b32 v31, v95, v94, s72
    v_accvgpr_write_b32 a124, v28
    v_accvgpr_write_b32 a125, v29
    v_accvgpr_write_b32 a126, v30
    v_accvgpr_write_b32 a127, v31
    v_perm_b32 v188, v89, v88, s73
    v_perm_b32 v189, v91, v90, s73
    v_perm_b32 v190, v93, v92, s73
    v_perm_b32 v191, v95, v94, s73
    s_add_u32 s71, s70, 1638400
    buffer_load_dword v64, v5, s[64:67], s71 offen
    s_add_u32 s71, s70, 1639680
    buffer_load_dword v65, v5, s[64:67], s71 offen
    s_add_u32 s71, s70, 1640960
    buffer_load_dword v66, v5, s[64:67], s71 offen
    s_add_u32 s71, s70, 1642240
    buffer_load_dword v67, v5, s[64:67], s71 offen
    s_add_u32 s71, s70, 1643520
    buffer_load_dword v68, v5, s[64:67], s71 offen
    s_add_u32 s71, s70, 1644800
    buffer_load_dword v69, v5, s[64:67], s71 offen
    s_add_u32 s71, s70, 1646080
    buffer_load_dword v70, v5, s[64:67], s71 offen
    s_add_u32 s71, s70, 1647360
    buffer_load_dword v71, v5, s[64:67], s71 offen
    s_add_u32 s71, s70, 1679360
    buffer_load_dword v72, v5, s[64:67], s71 offen
    s_add_u32 s71, s70, 1680640
    buffer_load_dword v73, v5, s[64:67], s71 offen
    s_add_u32 s71, s70, 1681920
    buffer_load_dword v74, v5, s[64:67], s71 offen
    s_add_u32 s71, s70, 1683200
    buffer_load_dword v75, v5, s[64:67], s71 offen
    s_add_u32 s71, s70, 1684480
    buffer_load_dword v76, v5, s[64:67], s71 offen
    s_add_u32 s71, s70, 1685760
    buffer_load_dword v77, v5, s[64:67], s71 offen
    s_add_u32 s71, s70, 1687040
    buffer_load_dword v78, v5, s[64:67], s71 offen
    s_add_u32 s71, s70, 1688320
    buffer_load_dword v79, v5, s[64:67], s71 offen
    s_add_u32 s71, s70, 1720320
    buffer_load_dword v80, v5, s[64:67], s71 offen
    s_add_u32 s71, s70, 1721600
    buffer_load_dword v81, v5, s[64:67], s71 offen
    s_add_u32 s71, s70, 1722880
    buffer_load_dword v82, v5, s[64:67], s71 offen
    s_add_u32 s71, s70, 1724160
    buffer_load_dword v83, v5, s[64:67], s71 offen
    s_add_u32 s71, s70, 1725440
    buffer_load_dword v84, v5, s[64:67], s71 offen
    s_add_u32 s71, s70, 1726720
    buffer_load_dword v85, v5, s[64:67], s71 offen
    s_add_u32 s71, s70, 1728000
    buffer_load_dword v86, v5, s[64:67], s71 offen
    s_add_u32 s71, s70, 1729280
    buffer_load_dword v87, v5, s[64:67], s71 offen
    s_add_u32 s71, s70, 1761280
    buffer_load_dword v88, v5, s[64:67], s71 offen
    s_add_u32 s71, s70, 1762560
    buffer_load_dword v89, v5, s[64:67], s71 offen
    s_add_u32 s71, s70, 1763840
    buffer_load_dword v90, v5, s[64:67], s71 offen
    s_add_u32 s71, s70, 1765120
    buffer_load_dword v91, v5, s[64:67], s71 offen
    s_add_u32 s71, s70, 1766400
    buffer_load_dword v92, v5, s[64:67], s71 offen
    s_add_u32 s71, s70, 1767680
    buffer_load_dword v93, v5, s[64:67], s71 offen
    s_add_u32 s71, s70, 1768960
    buffer_load_dword v94, v5, s[64:67], s71 offen
    s_add_u32 s71, s70, 1770240
    buffer_load_dword v95, v5, s[64:67], s71 offen
    s_waitcnt vmcnt(63)
    v_perm_b32 v28, v97, v96, s72
    v_perm_b32 v29, v99, v98, s72
    v_perm_b32 v30, v101, v100, s72
    v_perm_b32 v31, v103, v102, s72
    v_accvgpr_write_b32 a128, v28
    v_accvgpr_write_b32 a129, v29
    v_accvgpr_write_b32 a130, v30
    v_accvgpr_write_b32 a131, v31
    v_perm_b32 v192, v97, v96, s73
    v_perm_b32 v193, v99, v98, s73
    v_perm_b32 v194, v101, v100, s73
    v_perm_b32 v195, v103, v102, s73
    v_perm_b32 v28, v105, v104, s72
    v_perm_b32 v29, v107, v106, s72
    v_perm_b32 v30, v109, v108, s72
    v_perm_b32 v31, v111, v110, s72
    v_accvgpr_write_b32 a132, v28
    v_accvgpr_write_b32 a133, v29
    v_accvgpr_write_b32 a134, v30
    v_accvgpr_write_b32 a135, v31
    v_perm_b32 v196, v105, v104, s73
    v_perm_b32 v197, v107, v106, s73
    v_perm_b32 v198, v109, v108, s73
    v_perm_b32 v199, v111, v110, s73
    v_perm_b32 v28, v113, v112, s72
    v_perm_b32 v29, v115, v114, s72
    v_perm_b32 v30, v117, v116, s72
    v_perm_b32 v31, v119, v118, s72
    v_accvgpr_write_b32 a136, v28
    v_accvgpr_write_b32 a137, v29
    v_accvgpr_write_b32 a138, v30
    v_accvgpr_write_b32 a139, v31
    v_perm_b32 v200, v113, v112, s73
    v_perm_b32 v201, v115, v114, s73
    v_perm_b32 v202, v117, v116, s73
    v_perm_b32 v203, v119, v118, s73
    v_perm_b32 v28, v121, v120, s72
    v_perm_b32 v29, v123, v122, s72
    v_perm_b32 v30, v125, v124, s72
    v_perm_b32 v31, v127, v126, s72
    v_accvgpr_write_b32 a140, v28
    v_accvgpr_write_b32 a141, v29
    v_accvgpr_write_b32 a142, v30
    v_accvgpr_write_b32 a143, v31
    v_perm_b32 v204, v121, v120, s73
    v_perm_b32 v205, v123, v122, s73
    v_perm_b32 v206, v125, v124, s73
    v_perm_b32 v207, v127, v126, s73
    s_add_u32 s71, s70, 1802240
    buffer_load_dword v96, v5, s[64:67], s71 offen
    s_add_u32 s71, s70, 1803520
    buffer_load_dword v97, v5, s[64:67], s71 offen
    s_add_u32 s71, s70, 1804800
    buffer_load_dword v98, v5, s[64:67], s71 offen
    s_add_u32 s71, s70, 1806080
    buffer_load_dword v99, v5, s[64:67], s71 offen
    s_add_u32 s71, s70, 1807360
    buffer_load_dword v100, v5, s[64:67], s71 offen
    s_add_u32 s71, s70, 1808640
    buffer_load_dword v101, v5, s[64:67], s71 offen
    s_add_u32 s71, s70, 1809920
    buffer_load_dword v102, v5, s[64:67], s71 offen
    s_add_u32 s71, s70, 1811200
    buffer_load_dword v103, v5, s[64:67], s71 offen
    s_add_u32 s71, s70, 1843200
    buffer_load_dword v104, v5, s[64:67], s71 offen
    s_add_u32 s71, s70, 1844480
    buffer_load_dword v105, v5, s[64:67], s71 offen
    s_add_u32 s71, s70, 1845760
    buffer_load_dword v106, v5, s[64:67], s71 offen
    s_add_u32 s71, s70, 1847040
    buffer_load_dword v107, v5, s[64:67], s71 offen
    s_add_u32 s71, s70, 1848320
    buffer_load_dword v108, v5, s[64:67], s71 offen
    s_add_u32 s71, s70, 1849600
    buffer_load_dword v109, v5, s[64:67], s71 offen
    s_add_u32 s71, s70, 1850880
    buffer_load_dword v110, v5, s[64:67], s71 offen
    s_add_u32 s71, s70, 1852160
    buffer_load_dword v111, v5, s[64:67], s71 offen
    s_add_u32 s71, s70, 1884160
    buffer_load_dword v112, v5, s[64:67], s71 offen
    s_add_u32 s71, s70, 1885440
    buffer_load_dword v113, v5, s[64:67], s71 offen
    s_add_u32 s71, s70, 1886720
    buffer_load_dword v114, v5, s[64:67], s71 offen
    s_add_u32 s71, s70, 1888000
    buffer_load_dword v115, v5, s[64:67], s71 offen
    s_add_u32 s71, s70, 1889280
    buffer_load_dword v116, v5, s[64:67], s71 offen
    s_add_u32 s71, s70, 1890560
    buffer_load_dword v117, v5, s[64:67], s71 offen
    s_add_u32 s71, s70, 1891840
    buffer_load_dword v118, v5, s[64:67], s71 offen
    s_add_u32 s71, s70, 1893120
    buffer_load_dword v119, v5, s[64:67], s71 offen
    s_add_u32 s71, s70, 1925120
    buffer_load_dword v120, v5, s[64:67], s71 offen
    s_add_u32 s71, s70, 1926400
    buffer_load_dword v121, v5, s[64:67], s71 offen
    s_add_u32 s71, s70, 1927680
    buffer_load_dword v122, v5, s[64:67], s71 offen
    s_add_u32 s71, s70, 1928960
    buffer_load_dword v123, v5, s[64:67], s71 offen
    s_add_u32 s71, s70, 1930240
    buffer_load_dword v124, v5, s[64:67], s71 offen
    s_add_u32 s71, s70, 1931520
    buffer_load_dword v125, v5, s[64:67], s71 offen
    s_add_u32 s71, s70, 1932800
    buffer_load_dword v126, v5, s[64:67], s71 offen
    s_add_u32 s71, s70, 1934080
    buffer_load_dword v127, v5, s[64:67], s71 offen
    s_waitcnt vmcnt(63)
    v_perm_b32 v28, v33, v32, s72
    v_perm_b32 v29, v35, v34, s72
    v_perm_b32 v30, v37, v36, s72
    v_perm_b32 v31, v39, v38, s72
    v_accvgpr_write_b32 a144, v28
    v_accvgpr_write_b32 a145, v29
    v_accvgpr_write_b32 a146, v30
    v_accvgpr_write_b32 a147, v31
    v_perm_b32 v208, v33, v32, s73
    v_perm_b32 v209, v35, v34, s73
    v_perm_b32 v210, v37, v36, s73
    v_perm_b32 v211, v39, v38, s73
    v_perm_b32 v28, v41, v40, s72
    v_perm_b32 v29, v43, v42, s72
    v_perm_b32 v30, v45, v44, s72
    v_perm_b32 v31, v47, v46, s72
    v_accvgpr_write_b32 a148, v28
    v_accvgpr_write_b32 a149, v29
    v_accvgpr_write_b32 a150, v30
    v_accvgpr_write_b32 a151, v31
    v_perm_b32 v212, v41, v40, s73
    v_perm_b32 v213, v43, v42, s73
    v_perm_b32 v214, v45, v44, s73
    v_perm_b32 v215, v47, v46, s73
    v_perm_b32 v28, v49, v48, s72
    v_perm_b32 v29, v51, v50, s72
    v_perm_b32 v30, v53, v52, s72
    v_perm_b32 v31, v55, v54, s72
    v_accvgpr_write_b32 a152, v28
    v_accvgpr_write_b32 a153, v29
    v_accvgpr_write_b32 a154, v30
    v_accvgpr_write_b32 a155, v31
    v_perm_b32 v216, v49, v48, s73
    v_perm_b32 v217, v51, v50, s73
    v_perm_b32 v218, v53, v52, s73
    v_perm_b32 v219, v55, v54, s73
    v_perm_b32 v28, v57, v56, s72
    v_perm_b32 v29, v59, v58, s72
    v_perm_b32 v30, v61, v60, s72
    v_perm_b32 v31, v63, v62, s72
    v_accvgpr_write_b32 a156, v28
    v_accvgpr_write_b32 a157, v29
    v_accvgpr_write_b32 a158, v30
    v_accvgpr_write_b32 a159, v31
    v_perm_b32 v220, v57, v56, s73
    v_perm_b32 v221, v59, v58, s73
    v_perm_b32 v222, v61, v60, s73
    v_perm_b32 v223, v63, v62, s73
    s_waitcnt vmcnt(32)
    v_perm_b32 v28, v65, v64, s72
    v_perm_b32 v29, v67, v66, s72
    v_perm_b32 v30, v69, v68, s72
    v_perm_b32 v31, v71, v70, s72
    v_accvgpr_write_b32 a160, v28
    v_accvgpr_write_b32 a161, v29
    v_accvgpr_write_b32 a162, v30
    v_accvgpr_write_b32 a163, v31
    v_perm_b32 v224, v65, v64, s73
    v_perm_b32 v225, v67, v66, s73
    v_perm_b32 v226, v69, v68, s73
    v_perm_b32 v227, v71, v70, s73
    v_perm_b32 v28, v73, v72, s72
    v_perm_b32 v29, v75, v74, s72
    v_perm_b32 v30, v77, v76, s72
    v_perm_b32 v31, v79, v78, s72
    v_accvgpr_write_b32 a164, v28
    v_accvgpr_write_b32 a165, v29
    v_accvgpr_write_b32 a166, v30
    v_accvgpr_write_b32 a167, v31
    v_perm_b32 v228, v73, v72, s73
    v_perm_b32 v229, v75, v74, s73
    v_perm_b32 v230, v77, v76, s73
    v_perm_b32 v231, v79, v78, s73
    v_perm_b32 v28, v81, v80, s72
    v_perm_b32 v29, v83, v82, s72
    v_perm_b32 v30, v85, v84, s72
    v_perm_b32 v31, v87, v86, s72
    v_accvgpr_write_b32 a168, v28
    v_accvgpr_write_b32 a169, v29
    v_accvgpr_write_b32 a170, v30
    v_accvgpr_write_b32 a171, v31
    v_perm_b32 v232, v81, v80, s73
    v_perm_b32 v233, v83, v82, s73
    v_perm_b32 v234, v85, v84, s73
    v_perm_b32 v235, v87, v86, s73
    v_perm_b32 v28, v89, v88, s72
    v_perm_b32 v29, v91, v90, s72
    v_perm_b32 v30, v93, v92, s72
    v_perm_b32 v31, v95, v94, s72
    v_accvgpr_write_b32 a172, v28
    v_accvgpr_write_b32 a173, v29
    v_accvgpr_write_b32 a174, v30
    v_accvgpr_write_b32 a175, v31
    v_perm_b32 v236, v89, v88, s73
    v_perm_b32 v237, v91, v90, s73
    v_perm_b32 v238, v93, v92, s73
    v_perm_b32 v239, v95, v94, s73
    s_waitcnt vmcnt(0)
    v_perm_b32 v28, v97, v96, s72
    v_perm_b32 v29, v99, v98, s72
    v_perm_b32 v30, v101, v100, s72
    v_perm_b32 v31, v103, v102, s72
    v_accvgpr_write_b32 a176, v28
    v_accvgpr_write_b32 a177, v29
    v_accvgpr_write_b32 a178, v30
    v_accvgpr_write_b32 a179, v31
    v_perm_b32 v240, v97, v96, s73
    v_perm_b32 v241, v99, v98, s73
    v_perm_b32 v242, v101, v100, s73
    v_perm_b32 v243, v103, v102, s73
    v_perm_b32 v28, v105, v104, s72
    v_perm_b32 v29, v107, v106, s72
    v_perm_b32 v30, v109, v108, s72
    v_perm_b32 v31, v111, v110, s72
    v_accvgpr_write_b32 a180, v28
    v_accvgpr_write_b32 a181, v29
    v_accvgpr_write_b32 a182, v30
    v_accvgpr_write_b32 a183, v31
    v_perm_b32 v244, v105, v104, s73
    v_perm_b32 v245, v107, v106, s73
    v_perm_b32 v246, v109, v108, s73
    v_perm_b32 v247, v111, v110, s73
    v_perm_b32 v28, v113, v112, s72
    v_perm_b32 v29, v115, v114, s72
    v_perm_b32 v30, v117, v116, s72
    v_perm_b32 v31, v119, v118, s72
    v_accvgpr_write_b32 a184, v28
    v_accvgpr_write_b32 a185, v29
    v_accvgpr_write_b32 a186, v30
    v_accvgpr_write_b32 a187, v31
    v_perm_b32 v248, v113, v112, s73
    v_perm_b32 v249, v115, v114, s73
    v_perm_b32 v250, v117, v116, s73
    v_perm_b32 v251, v119, v118, s73
    v_perm_b32 v28, v121, v120, s72
    v_perm_b32 v29, v123, v122, s72
    v_perm_b32 v30, v125, v124, s72
    v_perm_b32 v31, v127, v126, s72
    v_accvgpr_write_b32 a188, v28
    v_accvgpr_write_b32 a189, v29
    v_accvgpr_write_b32 a190, v30
    v_accvgpr_write_b32 a191, v31
    v_perm_b32 v252, v121, v120, s73
    v_perm_b32 v253, v123, v122, s73
    v_perm_b32 v254, v125, v124, s73
    v_perm_b32 v255, v127, v126, s73
    v_mov_b32 v21, v20
    s_mul_i32 s20, s15, 49152
    s_add_u32 s20, s20, 197160960
    s_movk_i32 s3, 5120
    v_mul_lo_u32 v23, v4, s3
    v_lshl_add_u32 v23, v3, 2, v23
    v_min_u32 v25, 11, v2
    v_add_u32 v25, 256, v25
    s_lshr_b32 s3, s15, 1
    s_mul_i32 s3, s3, 12
    v_add_u32 v25, s3, v25
    v_lshlrev_b32 v25, 2, v25
    s_mov_b32 s43, 0
    v_mov_b32 v101, 192
    s_mov_b32 s69, 0
mega_kernel_cw161:
    buffer_load_dword v100, v101, s[88:91], 0 offen sc1
    s_add_u32 s69, s69, 1
    s_cmp_ge_u32 s69, 1048576
    s_cbranch_scc1 mega_kernel_cwo162
    s_waitcnt vmcnt(0)
    v_cmp_gt_u32 vcc, 256, v100
    s_cbranch_vccz mega_kernel_cwo162
    s_sleep 8
    s_branch mega_kernel_cw161
mega_kernel_cwo162:
    s_mul_i32 s79, s74, 12288
    s_add_u32 s76, s20, s79
    s_mov_b32 s77, s79
    s_mov_b32 s75, 0
mega_kernel_loop163:
    s_add_u32 s68, s75, 1
    s_cmp_ge_u32 s43, s68
    s_cbranch_scc1 mega_kernel_wn164
    s_mov_b32 s69, 0
mega_kernel_wnl165:
    s_mov_b32 s71, 204500992
    buffer_load_dword v100, v25, s[60:63], s71 offen sc1
    s_add_u32 s69, s69, 1
    s_cmp_ge_u32 s69, 262144
    s_cbranch_scc1 mega_kernel_wnb166
    s_waitcnt vmcnt(0)
    v_cmp_gt_u32 vcc, s68, v100
    s_cbranch_vccnz mega_kernel_wnl165
mega_kernel_wnb166:
    s_mov_b32 s43, s68
    s_add_u32 s71, s68, 8
    v_cmp_gt_u32 vcc, s71, v100
    s_cbranch_vccnz mega_kernel_wn164
    s_mov_b32 s43, s71
mega_kernel_wn164:
    s_add_u32 m0, s77, 0
    s_add_u32 s71, s76, 0
    buffer_load_dwordx4 v20, s[60:63], s71 offen lds
    s_add_u32 m0, s77, 1024
    s_add_u32 s71, s76, 1024
    buffer_load_dwordx4 v20, s[60:63], s71 offen lds
    s_add_u32 m0, s77, 2048
    s_add_u32 s71, s76, 2048
    buffer_load_dwordx4 v20, s[60:63], s71 offen lds
    s_add_u32 m0, s77, 3072
    s_add_u32 s71, s76, 3072
    buffer_load_dwordx4 v20, s[60:63], s71 offen lds
    s_add_u32 m0, s77, 4096
    s_add_u32 s71, s76, 4096
    buffer_load_dwordx4 v20, s[60:63], s71 offen lds
    s_add_u32 m0, s77, 5120
    s_add_u32 s71, s76, 5120
    buffer_load_dwordx4 v20, s[60:63], s71 offen lds
    s_add_u32 m0, s77, 6144
    s_add_u32 s71, s76, 6144
    buffer_load_dwordx4 v20, s[60:63], s71 offen lds
    s_add_u32 m0, s77, 7168
    s_add_u32 s71, s76, 7168
    buffer_load_dwordx4 v20, s[60:63], s71 offen lds
    s_add_u32 m0, s77, 8192
    s_add_u32 s71, s76, 8192
    buffer_load_dwordx4 v20, s[60:63], s71 offen lds
    s_add_u32 m0, s77, 9216
    s_add_u32 s71, s76, 9216
    buffer_load_dwordx4 v20, s[60:63], s71 offen lds
    s_add_u32 m0, s77, 10240
    s_add_u32 s71, s76, 10240
    buffer_load_dwordx4 v20, s[60:63], s71 offen lds
    s_add_u32 m0, s77, 11264
    s_add_u32 s71, s76, 11264
    buffer_load_dwordx4 v20, s[60:63], s71 offen lds
    s_add_u32 s76, s76, 196608
    s_waitcnt vmcnt(0)
    s_barrier
    ds_read_b128 v[64:67], v21 offset:0
    ds_read_b128 v[68:71], v21 offset:1024
    ds_read_b128 v[72:75], v21 offset:2048
    ds_read_b128 v[76:79], v21 offset:3072
    s_waitcnt lgkmcnt(3)
    v_mfma_f32_16x16x32_bf16 v[32:35], v[64:67], a[0:3], 0
    v_mfma_f32_16x16x32_bf16 v[36:39], v[64:67], a[192:195], 0
    ds_read_b128 v[64:67], v21 offset:4096
    s_waitcnt lgkmcnt(3)
    v_mfma_f32_16x16x32_bf16 v[32:35], v[68:71], a[4:7], v[32:35]
    v_mfma_f32_16x16x32_bf16 v[36:39], v[68:71], a[196:199], v[36:39]
    ds_read_b128 v[68:71], v21 offset:5120
    s_waitcnt lgkmcnt(3)
    v_mfma_f32_16x16x32_bf16 v[32:35], v[72:75], a[8:11], v[32:35]
    v_mfma_f32_16x16x32_bf16 v[36:39], v[72:75], a[200:203], v[36:39]
    ds_read_b128 v[72:75], v21 offset:6144
    s_waitcnt lgkmcnt(3)
    v_mfma_f32_16x16x32_bf16 v[32:35], v[76:79], a[12:15], v[32:35]
    v_mfma_f32_16x16x32_bf16 v[36:39], v[76:79], a[204:207], v[36:39]
    ds_read_b128 v[76:79], v21 offset:7168
    s_waitcnt lgkmcnt(3)
    v_mfma_f32_16x16x32_bf16 v[32:35], v[64:67], a[16:19], v[32:35]
    v_mfma_f32_16x16x32_bf16 v[36:39], v[64:67], a[208:211], v[36:39]
    ds_read_b128 v[64:67], v21 offset:8192
    s_waitcnt lgkmcnt(3)
    v_mfma_f32_16x16x32_bf16 v[32:35], v[68:71], a[20:23], v[32:35]
    v_mfma_f32_16x16x32_bf16 v[36:39], v[68:71], a[212:215], v[36:39]
    ds_read_b128 v[68:71], v21 offset:9216
    s_waitcnt lgkmcnt(3)
    v_mfma_f32_16x16x32_bf16 v[32:35], v[72:75], a[24:27], v[32:35]
    v_mfma_f32_16x16x32_bf16 v[36:39], v[72:75], a[216:219], v[36:39]
    ds_read_b128 v[72:75], v21 offset:10240
    s_waitcnt lgkmcnt(3)
    v_mfma_f32_16x16x32_bf16 v[32:35], v[76:79], a[28:31], v[32:35]
    v_mfma_f32_16x16x32_bf16 v[36:39], v[76:79], a[220:223], v[36:39]
    ds_read_b128 v[76:79], v21 offset:11264
    s_waitcnt lgkmcnt(3)
    v_mfma_f32_16x16x32_bf16 v[32:35], v[64:67], a[32:35], v[32:35]
    v_mfma_f32_16x16x32_bf16 v[36:39], v[64:67], a[224:227], v[36:39]
    ds_read_b128 v[64:67], v21 offset:12288
    s_waitcnt lgkmcnt(3)
    v_mfma_f32_16x16x32_bf16 v[32:35], v[68:71], a[36:39], v[32:35]
    v_mfma_f32_16x16x32_bf16 v[36:39], v[68:71], a[228:231], v[36:39]
    ds_read_b128 v[68:71], v21 offset:13312
    s_waitcnt lgkmcnt(3)
    v_mfma_f32_16x16x32_bf16 v[32:35], v[72:75], a[40:43], v[32:35]
    v_mfma_f32_16x16x32_bf16 v[36:39], v[72:75], a[232:235], v[36:39]
    ds_read_b128 v[72:75], v21 offset:14336
    s_waitcnt lgkmcnt(3)
    v_mfma_f32_16x16x32_bf16 v[32:35], v[76:79], a[44:47], v[32:35]
    v_mfma_f32_16x16x32_bf16 v[36:39], v[76:79], a[236:239], v[36:39]
    ds_read_b128 v[76:79], v21 offset:15360
    s_waitcnt lgkmcnt(3)
    v_mfma_f32_16x16x32_bf16 v[32:35], v[64:67], a[48:51], v[32:35]
    v_mfma_f32_16x16x32_bf16 v[36:39], v[64:67], a[240:243], v[36:39]
    ds_read_b128 v[64:67], v21 offset:16384
    s_waitcnt lgkmcnt(3)
    v_mfma_f32_16x16x32_bf16 v[32:35], v[68:71], a[52:55], v[32:35]
    v_mfma_f32_16x16x32_bf16 v[36:39], v[68:71], a[244:247], v[36:39]
    ds_read_b128 v[68:71], v21 offset:17408
    s_waitcnt lgkmcnt(3)
    v_mfma_f32_16x16x32_bf16 v[32:35], v[72:75], a[56:59], v[32:35]
    v_mfma_f32_16x16x32_bf16 v[36:39], v[72:75], a[248:251], v[36:39]
    ds_read_b128 v[72:75], v21 offset:18432
    s_waitcnt lgkmcnt(3)
    v_mfma_f32_16x16x32_bf16 v[32:35], v[76:79], a[60:63], v[32:35]
    v_mfma_f32_16x16x32_bf16 v[36:39], v[76:79], a[252:255], v[36:39]
    ds_read_b128 v[76:79], v21 offset:19456
    s_waitcnt lgkmcnt(3)
    v_mfma_f32_16x16x32_bf16 v[32:35], v[64:67], a[64:67], v[32:35]
    v_mfma_f32_16x16x32_bf16 v[36:39], v[64:67], v[128:131], v[36:39]
    ds_read_b128 v[64:67], v21 offset:20480
    s_waitcnt lgkmcnt(3)
    v_mfma_f32_16x16x32_bf16 v[32:35], v[68:71], a[68:71], v[32:35]
    v_mfma_f32_16x16x32_bf16 v[36:39], v[68:71], v[132:135], v[36:39]
    ds_read_b128 v[68:71], v21 offset:21504
    s_waitcnt lgkmcnt(3)
    v_mfma_f32_16x16x32_bf16 v[32:35], v[72:75], a[72:75], v[32:35]
    v_mfma_f32_16x16x32_bf16 v[36:39], v[72:75], v[136:139], v[36:39]
    ds_read_b128 v[72:75], v21 offset:22528
    s_waitcnt lgkmcnt(3)
    v_mfma_f32_16x16x32_bf16 v[32:35], v[76:79], a[76:79], v[32:35]
    v_mfma_f32_16x16x32_bf16 v[36:39], v[76:79], v[140:143], v[36:39]
    ds_read_b128 v[76:79], v21 offset:23552
    s_waitcnt lgkmcnt(3)
    v_mfma_f32_16x16x32_bf16 v[32:35], v[64:67], a[80:83], v[32:35]
    v_mfma_f32_16x16x32_bf16 v[36:39], v[64:67], v[144:147], v[36:39]
    ds_read_b128 v[64:67], v21 offset:24576
    s_waitcnt lgkmcnt(3)
    v_mfma_f32_16x16x32_bf16 v[32:35], v[68:71], a[84:87], v[32:35]
    v_mfma_f32_16x16x32_bf16 v[36:39], v[68:71], v[148:151], v[36:39]
    ds_read_b128 v[68:71], v21 offset:25600
    s_waitcnt lgkmcnt(3)
    v_mfma_f32_16x16x32_bf16 v[32:35], v[72:75], a[88:91], v[32:35]
    v_mfma_f32_16x16x32_bf16 v[36:39], v[72:75], v[152:155], v[36:39]
    ds_read_b128 v[72:75], v21 offset:26624
    s_waitcnt lgkmcnt(3)
    v_mfma_f32_16x16x32_bf16 v[32:35], v[76:79], a[92:95], v[32:35]
    v_mfma_f32_16x16x32_bf16 v[36:39], v[76:79], v[156:159], v[36:39]
    ds_read_b128 v[76:79], v21 offset:27648
    s_waitcnt lgkmcnt(3)
    v_mfma_f32_16x16x32_bf16 v[32:35], v[64:67], a[96:99], v[32:35]
    v_mfma_f32_16x16x32_bf16 v[36:39], v[64:67], v[160:163], v[36:39]
    ds_read_b128 v[64:67], v21 offset:28672
    s_waitcnt lgkmcnt(3)
    v_mfma_f32_16x16x32_bf16 v[32:35], v[68:71], a[100:103], v[32:35]
    v_mfma_f32_16x16x32_bf16 v[36:39], v[68:71], v[164:167], v[36:39]
    ds_read_b128 v[68:71], v21 offset:29696
    s_waitcnt lgkmcnt(3)
    v_mfma_f32_16x16x32_bf16 v[32:35], v[72:75], a[104:107], v[32:35]
    v_mfma_f32_16x16x32_bf16 v[36:39], v[72:75], v[168:171], v[36:39]
    ds_read_b128 v[72:75], v21 offset:30720
    s_waitcnt lgkmcnt(3)
    v_mfma_f32_16x16x32_bf16 v[32:35], v[76:79], a[108:111], v[32:35]
    v_mfma_f32_16x16x32_bf16 v[36:39], v[76:79], v[172:175], v[36:39]
    ds_read_b128 v[76:79], v21 offset:31744
    s_waitcnt lgkmcnt(3)
    v_mfma_f32_16x16x32_bf16 v[32:35], v[64:67], a[112:115], v[32:35]
    v_mfma_f32_16x16x32_bf16 v[36:39], v[64:67], v[176:179], v[36:39]
    ds_read_b128 v[64:67], v21 offset:32768
    s_waitcnt lgkmcnt(3)
    v_mfma_f32_16x16x32_bf16 v[32:35], v[68:71], a[116:119], v[32:35]
    v_mfma_f32_16x16x32_bf16 v[36:39], v[68:71], v[180:183], v[36:39]
    ds_read_b128 v[68:71], v21 offset:33792
    s_waitcnt lgkmcnt(3)
    v_mfma_f32_16x16x32_bf16 v[32:35], v[72:75], a[120:123], v[32:35]
    v_mfma_f32_16x16x32_bf16 v[36:39], v[72:75], v[184:187], v[36:39]
    ds_read_b128 v[72:75], v21 offset:34816
    s_waitcnt lgkmcnt(3)
    v_mfma_f32_16x16x32_bf16 v[32:35], v[76:79], a[124:127], v[32:35]
    v_mfma_f32_16x16x32_bf16 v[36:39], v[76:79], v[188:191], v[36:39]
    ds_read_b128 v[76:79], v21 offset:35840
    s_waitcnt lgkmcnt(3)
    v_mfma_f32_16x16x32_bf16 v[32:35], v[64:67], a[128:131], v[32:35]
    v_mfma_f32_16x16x32_bf16 v[36:39], v[64:67], v[192:195], v[36:39]
    ds_read_b128 v[64:67], v21 offset:36864
    s_waitcnt lgkmcnt(3)
    v_mfma_f32_16x16x32_bf16 v[32:35], v[68:71], a[132:135], v[32:35]
    v_mfma_f32_16x16x32_bf16 v[36:39], v[68:71], v[196:199], v[36:39]
    ds_read_b128 v[68:71], v21 offset:37888
    s_waitcnt lgkmcnt(3)
    v_mfma_f32_16x16x32_bf16 v[32:35], v[72:75], a[136:139], v[32:35]
    v_mfma_f32_16x16x32_bf16 v[36:39], v[72:75], v[200:203], v[36:39]
    ds_read_b128 v[72:75], v21 offset:38912
    s_waitcnt lgkmcnt(3)
    v_mfma_f32_16x16x32_bf16 v[32:35], v[76:79], a[140:143], v[32:35]
    v_mfma_f32_16x16x32_bf16 v[36:39], v[76:79], v[204:207], v[36:39]
    ds_read_b128 v[76:79], v21 offset:39936
    s_waitcnt lgkmcnt(3)
    v_mfma_f32_16x16x32_bf16 v[32:35], v[64:67], a[144:147], v[32:35]
    v_mfma_f32_16x16x32_bf16 v[36:39], v[64:67], v[208:211], v[36:39]
    ds_read_b128 v[64:67], v21 offset:40960
    s_waitcnt lgkmcnt(3)
    v_mfma_f32_16x16x32_bf16 v[32:35], v[68:71], a[148:151], v[32:35]
    v_mfma_f32_16x16x32_bf16 v[36:39], v[68:71], v[212:215], v[36:39]
    ds_read_b128 v[68:71], v21 offset:41984
    s_waitcnt lgkmcnt(3)
    v_mfma_f32_16x16x32_bf16 v[32:35], v[72:75], a[152:155], v[32:35]
    v_mfma_f32_16x16x32_bf16 v[36:39], v[72:75], v[216:219], v[36:39]
    ds_read_b128 v[72:75], v21 offset:43008
    s_waitcnt lgkmcnt(3)
    v_mfma_f32_16x16x32_bf16 v[32:35], v[76:79], a[156:159], v[32:35]
    v_mfma_f32_16x16x32_bf16 v[36:39], v[76:79], v[220:223], v[36:39]
    ds_read_b128 v[76:79], v21 offset:44032
    s_waitcnt lgkmcnt(3)
    v_mfma_f32_16x16x32_bf16 v[32:35], v[64:67], a[160:163], v[32:35]
    v_mfma_f32_16x16x32_bf16 v[36:39], v[64:67], v[224:227], v[36:39]
    ds_read_b128 v[64:67], v21 offset:45056
    s_waitcnt lgkmcnt(3)
    v_mfma_f32_16x16x32_bf16 v[32:35], v[68:71], a[164:167], v[32:35]
    v_mfma_f32_16x16x32_bf16 v[36:39], v[68:71], v[228:231], v[36:39]
    ds_read_b128 v[68:71], v21 offset:46080
    s_waitcnt lgkmcnt(3)
    v_mfma_f32_16x16x32_bf16 v[32:35], v[72:75], a[168:171], v[32:35]
    v_mfma_f32_16x16x32_bf16 v[36:39], v[72:75], v[232:235], v[36:39]
    ds_read_b128 v[72:75], v21 offset:47104
    s_waitcnt lgkmcnt(3)
    v_mfma_f32_16x16x32_bf16 v[32:35], v[76:79], a[172:175], v[32:35]
    v_mfma_f32_16x16x32_bf16 v[36:39], v[76:79], v[236:239], v[36:39]
    ds_read_b128 v[76:79], v21 offset:48128
    s_waitcnt lgkmcnt(3)
    v_mfma_f32_16x16x32_bf16 v[32:35], v[64:67], a[176:179], v[32:35]
    v_mfma_f32_16x16x32_bf16 v[36:39], v[64:67], v[240:243], v[36:39]
    s_waitcnt lgkmcnt(2)
    v_mfma_f32_16x16x32_bf16 v[32:35], v[68:71], a[180:183], v[32:35]
    v_mfma_f32_16x16x32_bf16 v[36:39], v[68:71], v[244:247], v[36:39]
    s_waitcnt lgkmcnt(1)
    v_mfma_f32_16x16x32_bf16 v[32:35], v[72:75], a[184:187], v[32:35]
    v_mfma_f32_16x16x32_bf16 v[36:39], v[72:75], v[248:251], v[36:39]
    s_waitcnt lgkmcnt(0)
    v_mfma_f32_16x16x32_bf16 v[32:35], v[76:79], a[188:191], v[32:35]
    v_mfma_f32_16x16x32_bf16 v[36:39], v[76:79], v[252:255], v[36:39]
    s_nop 7
    s_lshl_b32 s3, s75, 2
    s_add_u32 s3, s3, s15
    s_mul_i32 s3, s3, 20480
    s_add_u32 s3, s3, s70
    s_add_u32 s23, s3, 5259264
    buffer_load_dword v80, v23, s[60:63], s23 offen offset:0
    buffer_load_dword v81, v23, s[60:63], s23 offen offset:1280
    buffer_load_dword v82, v23, s[60:63], s23 offen offset:2560
    buffer_load_dword v83, v23, s[60:63], s23 offen offset:3840
    v_cvt_pk_bf16_f32 v84, v32, v36
    v_lshlrev_b32 v85, 16, v84
    v_and_b32 v86, 0xffff0000, v84
    v_mul_f32 v85, v85, v26
    v_mul_f32 v86, v86, v27
    v_cvt_pk_bf16_f32 v88, v85, v86
    v_cvt_pk_bf16_f32 v84, v33, v37
    v_lshlrev_b32 v85, 16, v84
    v_and_b32 v86, 0xffff0000, v84
    v_mul_f32 v85, v85, v26
    v_mul_f32 v86, v86, v27
    v_cvt_pk_bf16_f32 v89, v85, v86
    v_cvt_pk_bf16_f32 v84, v34, v38
    v_lshlrev_b32 v85, 16, v84
    v_and_b32 v86, 0xffff0000, v84
    v_mul_f32 v85, v85, v26
    v_mul_f32 v86, v86, v27
    v_cvt_pk_bf16_f32 v90, v85, v86
    v_cvt_pk_bf16_f32 v84, v35, v39
    v_lshlrev_b32 v85, 16, v84
    v_and_b32 v86, 0xffff0000, v84
    v_mul_f32 v85, v85, v26
    v_mul_f32 v86, v86, v27
    v_cvt_pk_bf16_f32 v91, v85, v86
    s_waitcnt vmcnt(0)
    v_lshlrev_b32 v85, 16, v88
    v_and_b32 v86, 0xffff0000, v88
    v_lshlrev_b32 v84, 16, v80
    v_and_b32 v87, 0xffff0000, v80
    v_add_f32 v85, v85, v84
    v_add_f32 v86, v86, v87
    v_cvt_pk_bf16_f32 v92, v85, v86
    buffer_store_dword v92, v23, s[84:87], s3 offen offset:0
    v_lshlrev_b32 v85, 16, v89
    v_and_b32 v86, 0xffff0000, v89
    v_lshlrev_b32 v84, 16, v81
    v_and_b32 v87, 0xffff0000, v81
    v_add_f32 v85, v85, v84
    v_add_f32 v86, v86, v87
    v_cvt_pk_bf16_f32 v93, v85, v86
    buffer_store_dword v93, v23, s[84:87], s3 offen offset:1280
    v_lshlrev_b32 v85, 16, v90
    v_and_b32 v86, 0xffff0000, v90
    v_lshlrev_b32 v84, 16, v82
    v_and_b32 v87, 0xffff0000, v82
    v_add_f32 v85, v85, v84
    v_add_f32 v86, v86, v87
    v_cvt_pk_bf16_f32 v94, v85, v86
    buffer_store_dword v94, v23, s[84:87], s3 offen offset:2560
    v_lshlrev_b32 v85, 16, v91
    v_and_b32 v86, 0xffff0000, v91
    v_lshlrev_b32 v84, 16, v83
    v_and_b32 v87, 0xffff0000, v83
    v_add_f32 v85, v85, v84
    v_add_f32 v86, v86, v87
    v_cvt_pk_bf16_f32 v95, v85, v86
    buffer_store_dword v95, v23, s[84:87], s3 offen offset:3840
    s_add_u32 s75, s75, 1
    s_waitcnt vmcnt(0)
    s_barrier
    s_cmp_lt_u32 s75, 32
    s_cbranch_scc1 mega_kernel_loop163
    s_branch mega_kernel_done1
mega_kernel_done1:
    s_endpgm
.section .rodata,"a"
.p2align 6
.amdhsa_kernel mega_kernel
  .amdhsa_next_free_vgpr 512
  .amdhsa_next_free_sgpr 100
  .amdhsa_accum_offset 256
  .amdhsa_group_segment_fixed_size 0
  .amdhsa_kernarg_size 128
  .amdhsa_user_sgpr_count 2
  .amdhsa_user_sgpr_kernarg_segment_ptr 1
  .amdhsa_system_sgpr_workgroup_id_x 1
.end_amdhsa_kernel
```
